```python
import torch

def _softmax(x, axis=-1):
    return torch.softmax(x, dim=axis)
def _gelu(x):
    return torch.nn.functional.gelu(x, approximate="tanh")
def _silu(x):
    return torch.nn.functional.silu(x)
def _sigmoid(x):
    return torch.sigmoid(x)
def _layernorm(x, axis=-1, eps=1e-5):
    m = x.mean(dim=axis, keepdim=True)
    v = x.var(dim=axis, keepdim=True, unbiased=False)
    return (x - m) / torch.sqrt(v + eps)
def _scatter_add(tgt, idx, src, axis=0):
    return tgt.clone().index_add_(axis, idx, src)
def _segment_sum(src, seg, n):
    out = torch.zeros((n,) + src.shape[1:], dtype=src.dtype)
    return out.index_add_(0, seg, src)
def _pad(x, pw):
    flat = tuple(v for pair in reversed(pw) for v in pair)
    return torch.nn.functional.pad(x, flat)

kernel_name = 'gated_mix__compressed_kv_cla__mixer_token_mlp__prompt'

def setup_inputs():

    _w = (lambda a: (lambda t: t.to(torch.bfloat16) if t.is_floating_point() else t)(torch.as_tensor(a)))
    def _A_setup():
        B, H, Sq, Sk, D, M = 1, 32, 2048, 2048, 128, 512
        Dc = 4 * D
        return {
            "x": _w((lambda *s: torch.randn(*s, dtype=torch.bfloat16) * 0.05)(B, Sq, M)),
            "c_kv": _w((lambda *s: torch.randn(*s, dtype=torch.bfloat16) * 0.8)(B, Sk, Dc)),
            "w_q": _w((lambda *s: torch.randn(*s, dtype=torch.bfloat16) * 6.4)(M, H, D) * (M ** -0.5)),
            "w_uk": _w((lambda *s: torch.randn(*s, dtype=torch.bfloat16) * 6.4)(Dc, H, D) * (Dc ** -0.5)),
            "w_uv": _w((lambda *s: torch.randn(*s, dtype=torch.bfloat16) * 0.8)(Dc, H, D) * (Dc ** -0.5)),
            "w_o": _w((lambda *s: torch.randn(*s, dtype=torch.bfloat16) * 0.8)(H, D, M) * ((H * D) ** -0.5)),
        }
    _A_in = _A_setup()

    def _B_setup():
        B, S, D, F = 1, 2048, 512, 1792
        return {
            "x": _w((lambda *s: torch.randn(*s, dtype=torch.bfloat16) * 0.05)(B, S, D)),
            "w1": _w((lambda *s: torch.randn(*s, dtype=torch.bfloat16) * 3.2)(S, F) * (S ** -0.5)),
            "b1": _w((lambda *s: torch.randn(*s, dtype=torch.bfloat16) * 3.2)(F) * 0.02),
            "w2": _w((lambda *s: torch.randn(*s, dtype=torch.bfloat16) * 0.1)(F, S) * (F ** -0.5)),
            "b2": _w((lambda *s: torch.randn(*s, dtype=torch.bfloat16) * 0.1)(S) * 0.02),
        }
    _B_in = _B_setup()

    return {
        "A_x": _A_in["x"],
        "A_c_kv": _A_in["c_kv"],
        "A_w_q": _A_in["w_q"],
        "A_w_uk": _A_in["w_uk"],
        "A_w_uv": _A_in["w_uv"],
        "A_w_o": _A_in["w_o"],
        "B_x": _B_in["x"],
        "B_w1": _B_in["w1"],
        "B_b1": _B_in["b1"],
        "B_w2": _B_in["w2"],
        "B_b2": _B_in["b2"],
        "gate_w": _w((lambda *s: torch.randn(*s, dtype=torch.bfloat16) * 0.05)(512) * 16.0),
    }

def reference(A_x, A_c_kv, A_w_q, A_w_uk, A_w_uv, A_w_o, B_x, B_w1, B_b1, B_w2, B_b2, gate_w):
    def _A_ref(x, c_kv, w_q, w_uk, w_uv, w_o):
        B, Sq, M = x.shape[0], x.shape[1], x.shape[2]
        Sk = c_kv.shape[1]
        H, D = w_q.shape[1], w_q.shape[2]
        q = torch.einsum("bqm,mhd->bhqd", x, w_q)
        k = torch.einsum("bkc,chd->bhkd", c_kv, w_uk)
        v = torch.einsum("bkc,chd->bhkd", c_kv, w_uv)
        scores = torch.einsum("bhqd,bhkd->bhqk", q, k) * (D ** -0.5)
        off = Sk - Sq
        qi = torch.arange(Sq)[:, None]
        kj = torch.arange(Sk)[None, :]
        cmask = kj <= (qi + off)
        scores = torch.where(cmask[None, None], scores, -1e9)
        p = _softmax(scores, axis=-1)
        ctx = torch.einsum("bhqk,bhkd->bhqd", p, v)
        return torch.einsum("bhqd,hdm->bqm", ctx, w_o)

    def _B_ref(x, w1, b1, w2, b2):
        B, S, D = x.shape
        h = _layernorm(x, axis=-1)
        u = torch.einsum("bsd,sf->bdf", h, w1) + b1
        u = _gelu(u)
        y = torch.einsum("bdf,fs->bds", u, w2) + b2
        return (lambda x, *d: x.permute(*d))(y, 0, 2, 1)

    x = A_x
    g = _sigmoid((x * gate_w).sum(-1, keepdims=True))
    a = _A_ref(x, A_c_kv, A_w_q, A_w_uk, A_w_uv, A_w_o)
    b = _B_ref(x, B_w1, B_b1, B_w2, B_b2)
    return g * a + (1 - g) * b
```

```asm
; @launch grid=(256,1,1) block=(256,1,1) lds=163840
.amdgcn_target "amdgcn-amd-amdhsa--gfx950"
.text
.globl gated_mix__compressed_kv_cla__mixer_token_mlp__prompt_kernel
.p2align 8
.type gated_mix__compressed_kv_cla__mixer_token_mlp__prompt_kernel,@function
gated_mix__compressed_kv_cla__mixer_token_mlp__prompt_kernel:
s_cmp_ge_u32 s2, 256
s_cbranch_scc1 attn_end
s_getpc_b64 s[92:93]
attn_pc0:
s_lshr_b32 s32, s2, 3
s_lshl_b32 s32, s32, 2
v_lshrrev_b32 v6, 6, v0
v_add_u32 v6, s32, v6
v_mul_u32_u24 v6, 5, v6
v_and_b32 v7, 63, v0
v_min_u32 v7, 4, v7
v_add_u32 v6, v6, v7
v_lshlrev_b32 v6, 7, v6
v_min_u32 v6, attn_end-attn_pc0, v6
v_mov_b32 v7, s93
v_add_co_u32 v6, vcc, s92, v6
s_nop 1
v_addc_co_u32 v7, vcc, 0, v7, vcc
global_load_dword v253, v[6:7], off
s_load_dwordx2 s[34:35], s[0:1], 112
s_load_dwordx2 s[64:65], s[0:1], 0
s_load_dwordx2 s[90:91], s[0:1], 8
s_load_dwordx4 s[96:99], s[0:1], 24
s_load_dwordx2 s[38:39], s[0:1], 88
s_load_dwordx2 s[66:67], s[0:1], 16
s_load_dwordx2 s[68:69], s[0:1], 56
s_load_dwordx2 s[86:87], s[0:1], 64
s_load_dwordx2 s[70:71], s[0:1], 40
s_load_dwordx2 s[72:73], s[0:1], 72
s_load_dwordx2 s[100:101], s[0:1], 104
v_lshrrev_b32 v1, 6, v0
v_and_b32 v2, 63, v0
v_lshlrev_b32 v204, 4, v2
v_readfirstlane_b32 s20, v1
s_and_b32 s27, s2, 7
s_lshr_b32 s29, s2, 3
s_lshl_b32 s21, s27, 2
s_and_b32 s27, s29, 3
s_add_u32 s21, s21, s27
s_lshr_b32 s22, s29, 2
s_add_u32 s23, s22, 1
s_lshl_b32 s23, s23, 2
s_lshl_b32 s36, s22, 2
s_add_u32 s36, s36, s20
s_lshl_b32 s37, s22, 2
s_sub_u32 s37, 60, s37
s_add_u32 s37, s37, s20
v_and_b32 v33, 63, v0
s_lshl_b32 s45, s20, 12
s_lshl_b32 s46, s20, 13
s_add_u32 s46, s46, 16384
s_mov_b32 s43, 16384
s_mov_b32 s44, 16384
v_and_b32 v34, 31, v33
v_lshrrev_b32 v35, 5, v33
v_bfe_u32 v36, v34, 1, 3
v_xor_b32 v36, v36, v35
v_lshlrev_b32 v36, 4, v36
v_lshl_add_u32 v36, v34, 7, v36
v_add_u32 v16, s46, v36
v_xor_b32 v17, 32, v16
v_xor_b32 v18, 64, v16
v_xor_b32 v19, 96, v16
v_bfe_u32 v36, v33, 2, 2
v_lshl_add_u32 v37, v35, 3, v36
v_lshlrev_b32 v37, 8, v37
v_bfe_u32 v38, v33, 4, 1
v_lshl_add_u32 v37, v38, 5, v37
v_and_b32 v38, 3, v33
v_lshl_add_u32 v37, v38, 3, v37
v_xor_b32 v38, 0, v36
v_lshl_add_u32 v20, v38, 6, v37
v_xor_b32 v38, 1, v36
v_lshl_add_u32 v21, v38, 6, v37
v_xor_b32 v38, 2, v36
v_lshl_add_u32 v22, v38, 6, v37
v_xor_b32 v38, 3, v36
v_lshl_add_u32 v23, v38, 6, v37
v_lshrrev_b32 v36, 3, v33
v_and_b32 v37, 7, v33
v_lshrrev_b32 v38, 1, v36
v_xor_b32 v39, v37, v38
v_lshlrev_b32 v39, 4, v39
v_lshl_add_u32 v39, v36, 10, v39
v_add_u32 v24, 0, v39
v_xor_b32 v39, v37, v38
v_xor_b32 v39, 4, v39
v_lshlrev_b32 v39, 4, v39
v_lshl_add_u32 v39, v36, 10, v39
v_add_u32 v25, 7168, v39
v_xor_b32 v39, v37, v38
v_lshlrev_b32 v39, 4, v39
v_lshl_add_u32 v39, v36, 10, v39
v_add_u32 v26, 14336, v39
v_xor_b32 v39, v37, v38
v_xor_b32 v39, 4, v39
v_lshlrev_b32 v39, 4, v39
v_lshl_add_u32 v39, v36, 10, v39
v_add_u32 v27, 21504, v39
v_lshrrev_b32 v36, 4, v33
v_bfe_u32 v37, v33, 2, 2
v_xor_b32 v37, v37, v36
v_lshlrev_b32 v37, 6, v37
v_and_b32 v38, 3, v33
v_lshl_add_u32 v37, v38, 4, v37
v_lshl_add_u32 v37, v36, 13, v37
v_add_u32 v28, 0, v37
v_add_u32 v29, 31744, v37
v_add_u32 v30, 63488, v37
v_add_u32 v31, 95232, v37
s_lshl_b32 s82, s2, 3
s_lshl_b32 s83, s20, 1
s_add_u32 s82, s82, s83
s_lshl_b32 s83, s82, 2
s_lshl_b32 s82, s82, 10
s_waitcnt lgkmcnt(0)
s_mov_b32 s4, s90
s_and_b32 s5, s91, 0xffff
s_mov_b32 s6, 2097152
s_mov_b32 s7, 0x20000
s_mov_b32 s8, s96
s_and_b32 s9, s97, 0xffff
s_mov_b32 s10, 4194304
s_mov_b32 s11, 0x20000
s_mov_b32 s12, s64
s_and_b32 s13, s65, 0xffff
s_mov_b32 s14, 2097152
s_mov_b32 s15, 0x20000
s_mov_b32 s52, s38
s_and_b32 s53, s39, 0xffff
s_mov_b32 s54, 1024
s_mov_b32 s55, 0x20000
buffer_load_dwordx4 v[40:43], v204, s[12:15], s82 offen
buffer_load_dwordx4 v[44:47], v204, s[12:15], s82 offen offset:1024
buffer_load_dwordx4 v[56:59], v204, s[52:55], 0 offen
s_lshl_b32 s40, s22, 18
s_lshl_b32 s49, s20, 16
s_add_u32 s40, s40, s49
s_add_u32 s41, s40, 32768
s_lshl_b32 s42, s20, 17
s_lshl_b32 s49, s21, 8
s_add_u32 s42, s42, s49
s_add_u32 m0, s43, s45
s_nop 0
buffer_load_dwordx4 v28, s[8:11], s42 offen lds
buffer_load_dwordx4 v29, s[8:11], s42 offen offset:1024 lds
buffer_load_dwordx4 v30, s[8:11], s42 offen offset:2048 lds
buffer_load_dwordx4 v31, s[8:11], s42 offen offset:3072 lds
s_add_u32 s42, s42, 524288
s_add_u32 s47, s43, s46
s_mov_b32 m0, s47
s_nop 0
buffer_load_dwordx4 v24, s[4:7], s40 offen lds
buffer_load_dwordx4 v25, s[4:7], s40 offen offset:1024 lds
buffer_load_dwordx4 v26, s[4:7], s40 offen offset:2048 lds
buffer_load_dwordx4 v27, s[4:7], s40 offen offset:3072 lds
s_add_u32 s40, s40, 128
s_add_u32 m0, s47, 4096
s_nop 0
buffer_load_dwordx4 v24, s[4:7], s41 offen lds
buffer_load_dwordx4 v25, s[4:7], s41 offen offset:1024 lds
buffer_load_dwordx4 v26, s[4:7], s41 offen offset:2048 lds
buffer_load_dwordx4 v27, s[4:7], s41 offen offset:3072 lds
s_add_u32 s41, s41, 128
s_add_u32 s43, s43, 49152
s_cmp_ge_u32 s43, 163840
s_cselect_b32 s43, 16384, s43
s_add_u32 m0, s43, s45
s_nop 0
buffer_load_dwordx4 v28, s[8:11], s42 offen lds
buffer_load_dwordx4 v29, s[8:11], s42 offen offset:1024 lds
buffer_load_dwordx4 v30, s[8:11], s42 offen offset:2048 lds
buffer_load_dwordx4 v31, s[8:11], s42 offen offset:3072 lds
s_add_u32 s42, s42, 524288
s_add_u32 s47, s43, s46
s_mov_b32 m0, s47
s_nop 0
buffer_load_dwordx4 v24, s[4:7], s40 offen lds
buffer_load_dwordx4 v25, s[4:7], s40 offen offset:1024 lds
buffer_load_dwordx4 v26, s[4:7], s40 offen offset:2048 lds
buffer_load_dwordx4 v27, s[4:7], s40 offen offset:3072 lds
s_add_u32 s40, s40, 128
s_add_u32 m0, s47, 4096
s_nop 0
buffer_load_dwordx4 v24, s[4:7], s41 offen lds
buffer_load_dwordx4 v25, s[4:7], s41 offen offset:1024 lds
buffer_load_dwordx4 v26, s[4:7], s41 offen offset:2048 lds
buffer_load_dwordx4 v27, s[4:7], s41 offen offset:3072 lds
s_add_u32 s41, s41, 128
s_add_u32 s43, s43, 49152
s_cmp_ge_u32 s43, 163840
s_cselect_b32 s43, 16384, s43
s_add_u32 m0, s43, s45
s_nop 0
buffer_load_dwordx4 v28, s[8:11], s42 offen lds
buffer_load_dwordx4 v29, s[8:11], s42 offen offset:1024 lds
buffer_load_dwordx4 v30, s[8:11], s42 offen offset:2048 lds
s_mov_b32 s92, s98
s_and_b32 s93, s99, 0xffff
s_mov_b32 s94, 4194304
s_mov_b32 s95, 0x20000
s_mov_b32 s60, s66
s_and_b32 s61, s67, 0xffff
s_mov_b32 s62, 4194304
s_mov_b32 s63, 0x20000
s_add_u32 s16, s34, 16777216
s_addc_u32 s17, s35, 0
s_and_b32 s17, s17, 0xffff
s_mov_b32 s18, 33554432
s_mov_b32 s19, 0x20000
s_add_u32 s76, s34, 67108864
s_addc_u32 s77, s35, 0
s_and_b32 s77, s77, 0xffff
s_mov_b32 s78, 2097152
s_mov_b32 s79, 0x20000
s_add_u32 s48, s34, 71303168
s_addc_u32 s49, s35, 0
s_and_b32 s49, s49, 0xffff
s_mov_b32 s50, 8192
s_mov_b32 s51, 0x20000
s_waitcnt vmcnt(27)
v_lshlrev_b32 v64, 16, v40
v_and_b32 v65, 0xffff0000, v40
v_lshlrev_b32 v66, 16, v41
v_and_b32 v67, 0xffff0000, v41
v_lshlrev_b32 v68, 16, v42
v_and_b32 v69, 0xffff0000, v42
v_lshlrev_b32 v70, 16, v43
v_and_b32 v71, 0xffff0000, v43
v_lshlrev_b32 v72, 16, v44
v_and_b32 v73, 0xffff0000, v44
v_lshlrev_b32 v74, 16, v45
v_and_b32 v75, 0xffff0000, v45
v_lshlrev_b32 v76, 16, v46
v_and_b32 v77, 0xffff0000, v46
v_lshlrev_b32 v78, 16, v47
v_and_b32 v79, 0xffff0000, v47
v_lshlrev_b32 v96, 16, v56
v_and_b32 v97, 0xffff0000, v56
v_lshlrev_b32 v98, 16, v57
v_and_b32 v99, 0xffff0000, v57
v_lshlrev_b32 v100, 16, v58
v_and_b32 v101, 0xffff0000, v58
v_lshlrev_b32 v102, 16, v59
v_and_b32 v103, 0xffff0000, v59
v_add_f32 v104, v64, v65
v_add_f32 v104, v104, v66
v_add_f32 v104, v104, v67
v_add_f32 v104, v104, v68
v_add_f32 v104, v104, v69
v_add_f32 v104, v104, v70
v_add_f32 v104, v104, v71
v_mul_f32 v106, v64, v96
v_fmac_f32 v106, v65, v97
v_fmac_f32 v106, v66, v98
v_fmac_f32 v106, v67, v99
v_fmac_f32 v106, v68, v100
v_fmac_f32 v106, v69, v101
v_fmac_f32 v106, v70, v102
v_fmac_f32 v106, v71, v103
v_add_f32 v105, v72, v73
v_add_f32 v105, v105, v74
v_add_f32 v105, v105, v75
v_add_f32 v105, v105, v76
v_add_f32 v105, v105, v77
v_add_f32 v105, v105, v78
v_add_f32 v105, v105, v79
v_mul_f32 v107, v72, v96
v_fmac_f32 v107, v73, v97
v_fmac_f32 v107, v74, v98
v_fmac_f32 v107, v75, v99
v_fmac_f32 v107, v76, v100
v_fmac_f32 v107, v77, v101
v_fmac_f32 v107, v78, v102
v_fmac_f32 v107, v79, v103
s_nop 1
v_add_f32_dpp v104, v104, v104 quad_perm:[1,0,3,2] row_mask:0xf bank_mask:0xf
v_add_f32_dpp v105, v105, v105 quad_perm:[1,0,3,2] row_mask:0xf bank_mask:0xf
v_add_f32_dpp v106, v106, v106 quad_perm:[1,0,3,2] row_mask:0xf bank_mask:0xf
v_add_f32_dpp v107, v107, v107 quad_perm:[1,0,3,2] row_mask:0xf bank_mask:0xf
s_nop 1
v_add_f32_dpp v104, v104, v104 quad_perm:[2,3,0,1] row_mask:0xf bank_mask:0xf
v_add_f32_dpp v105, v105, v105 quad_perm:[2,3,0,1] row_mask:0xf bank_mask:0xf
v_add_f32_dpp v106, v106, v106 quad_perm:[2,3,0,1] row_mask:0xf bank_mask:0xf
v_add_f32_dpp v107, v107, v107 quad_perm:[2,3,0,1] row_mask:0xf bank_mask:0xf
s_nop 1
v_add_f32_dpp v104, v104, v104 row_half_mirror row_mask:0xf bank_mask:0xf
v_add_f32_dpp v105, v105, v105 row_half_mirror row_mask:0xf bank_mask:0xf
v_add_f32_dpp v106, v106, v106 row_half_mirror row_mask:0xf bank_mask:0xf
v_add_f32_dpp v107, v107, v107 row_half_mirror row_mask:0xf bank_mask:0xf
s_nop 1
v_add_f32_dpp v104, v104, v104 row_mirror row_mask:0xf bank_mask:0xf
v_add_f32_dpp v105, v105, v105 row_mirror row_mask:0xf bank_mask:0xf
v_add_f32_dpp v106, v106, v106 row_mirror row_mask:0xf bank_mask:0xf
v_add_f32_dpp v107, v107, v107 row_mirror row_mask:0xf bank_mask:0xf
v_mov_b32 v108, v104
v_mov_b32 v109, v105
v_mov_b32 v110, v106
v_mov_b32 v111, v107
s_nop 1
v_permlane16_swap_b32 v108, v104
v_permlane16_swap_b32 v109, v105
v_permlane16_swap_b32 v110, v106
v_permlane16_swap_b32 v111, v107
s_nop 1
v_add_f32 v104, v104, v108
v_add_f32 v105, v105, v109
v_add_f32 v106, v106, v110
v_add_f32 v107, v107, v111
v_mov_b32 v108, v104
v_mov_b32 v109, v105
v_mov_b32 v110, v106
v_mov_b32 v111, v107
s_nop 1
v_permlane32_swap_b32 v108, v104
v_permlane32_swap_b32 v109, v105
v_permlane32_swap_b32 v110, v106
v_permlane32_swap_b32 v111, v107
s_nop 1
v_add_f32 v104, v104, v108
v_add_f32 v105, v105, v109
v_add_f32 v106, v106, v110
v_add_f32 v107, v107, v111
v_mul_f32 v104, 0x3b000000, v104
v_sub_f32 v64, v64, v104
v_sub_f32 v65, v65, v104
v_sub_f32 v66, v66, v104
v_sub_f32 v67, v67, v104
v_sub_f32 v68, v68, v104
v_sub_f32 v69, v69, v104
v_sub_f32 v70, v70, v104
v_sub_f32 v71, v71, v104
v_mul_f32 v105, 0x3b000000, v105
v_sub_f32 v72, v72, v105
v_sub_f32 v73, v73, v105
v_sub_f32 v74, v74, v105
v_sub_f32 v75, v75, v105
v_sub_f32 v76, v76, v105
v_sub_f32 v77, v77, v105
v_sub_f32 v78, v78, v105
v_sub_f32 v79, v79, v105
v_mul_f32 v106, 0xbfb8aa3b, v106
v_mul_f32 v107, 0xbfb8aa3b, v107
v_exp_f32 v106, v106
v_exp_f32 v107, v107
s_nop 0
v_add_f32 v106, 1.0, v106
v_add_f32 v107, 1.0, v107
v_rcp_f32 v106, v106
v_rcp_f32 v107, v107
v_mul_f32 v104, v64, v64
v_fmac_f32 v104, v65, v65
v_fmac_f32 v104, v66, v66
v_fmac_f32 v104, v67, v67
v_fmac_f32 v104, v68, v68
v_fmac_f32 v104, v69, v69
v_fmac_f32 v104, v70, v70
v_fmac_f32 v104, v71, v71
v_mul_f32 v105, v72, v72
v_fmac_f32 v105, v73, v73
v_fmac_f32 v105, v74, v74
v_fmac_f32 v105, v75, v75
v_fmac_f32 v105, v76, v76
v_fmac_f32 v105, v77, v77
v_fmac_f32 v105, v78, v78
v_fmac_f32 v105, v79, v79
s_nop 1
v_add_f32_dpp v104, v104, v104 quad_perm:[1,0,3,2] row_mask:0xf bank_mask:0xf
v_add_f32_dpp v105, v105, v105 quad_perm:[1,0,3,2] row_mask:0xf bank_mask:0xf
s_nop 1
v_add_f32_dpp v104, v104, v104 quad_perm:[2,3,0,1] row_mask:0xf bank_mask:0xf
v_add_f32_dpp v105, v105, v105 quad_perm:[2,3,0,1] row_mask:0xf bank_mask:0xf
s_nop 1
v_add_f32_dpp v104, v104, v104 row_half_mirror row_mask:0xf bank_mask:0xf
v_add_f32_dpp v105, v105, v105 row_half_mirror row_mask:0xf bank_mask:0xf
s_nop 1
v_add_f32_dpp v104, v104, v104 row_mirror row_mask:0xf bank_mask:0xf
v_add_f32_dpp v105, v105, v105 row_mirror row_mask:0xf bank_mask:0xf
v_mov_b32 v108, v104
v_mov_b32 v109, v105
s_nop 1
v_permlane16_swap_b32 v108, v104
v_permlane16_swap_b32 v109, v105
s_nop 1
v_add_f32 v104, v104, v108
v_add_f32 v105, v105, v109
v_mov_b32 v108, v104
v_mov_b32 v109, v105
s_nop 1
v_permlane32_swap_b32 v108, v104
v_permlane32_swap_b32 v109, v105
s_nop 1
v_add_f32 v104, v104, v108
v_add_f32 v105, v105, v109
v_mov_b32 v110, 0x3727c5ac
v_fmac_f32 v110, 0x3b000000, v104
v_rsq_f32 v104, v110
s_nop 0
v_mul_f32 v64, v64, v104
v_mul_f32 v65, v65, v104
v_mul_f32 v66, v66, v104
v_mul_f32 v67, v67, v104
v_mul_f32 v68, v68, v104
v_mul_f32 v69, v69, v104
v_mul_f32 v70, v70, v104
v_mul_f32 v71, v71, v104
v_cvt_pk_bf16_f32 v64, v64, v65
v_cvt_pk_bf16_f32 v65, v66, v67
v_cvt_pk_bf16_f32 v66, v68, v69
v_cvt_pk_bf16_f32 v67, v70, v71
buffer_store_dwordx4 v[64:67], v204, s[76:79], s82 offen sc1
v_mov_b32 v110, 0x3727c5ac
v_fmac_f32 v110, 0x3b000000, v105
v_rsq_f32 v105, v110
s_nop 0
v_mul_f32 v72, v72, v105
v_mul_f32 v73, v73, v105
v_mul_f32 v74, v74, v105
v_mul_f32 v75, v75, v105
v_mul_f32 v76, v76, v105
v_mul_f32 v77, v77, v105
v_mul_f32 v78, v78, v105
v_mul_f32 v79, v79, v105
v_cvt_pk_bf16_f32 v72, v72, v73
v_cvt_pk_bf16_f32 v73, v74, v75
v_cvt_pk_bf16_f32 v74, v76, v77
v_cvt_pk_bf16_f32 v75, v78, v79
buffer_store_dwordx4 v[72:75], v204, s[76:79], s82 offen offset:1024 sc1
v_and_b32 v110, 63, v0
v_cmp_eq_u32 vcc, 1, v110
v_lshlrev_b32 v111, 2, v110
s_nop 0
v_cndmask_b32 v106, v106, v107, vcc
v_cmp_gt_u32 vcc, 2, v110
s_and_saveexec_b64 s[54:55], vcc
buffer_store_dword v106, v111, s[48:51], s83 offen sc1
s_mov_b64 exec, s[54:55]
s_getreg_b32 s33, hwreg(HW_REG_XCC_ID, 0, 4)
s_or_b32 s33, s33, 0x50
s_add_u32 s76, s34, 71368704
s_addc_u32 s77, s35, 0
s_and_b32 s77, s77, 0xffff
s_mov_b32 s78, 4096
s_mov_b32 s79, 0x20000
s_lshl_b32 s32, s21, 7
v_mov_b32 v41, 0
v_lshrrev_b32 v42, 2, v204
s_or_b32 s27, s20, s22
s_cmp_eq_u32 s27, 0
s_cselect_b32 exec_lo, -1, 0
s_mov_b32 exec_hi, 0
buffer_store_dword v41, v42, s[76:79], s32 offen sc1
s_mov_b64 exec, -1
s_add_u32 s76, s34, 71434240
s_addc_u32 s77, s35, 0
s_and_b32 s77, s77, 0xffff
s_mov_b32 s78, 14336
s_mov_b32 s79, 0x20000
s_lshl_b32 s32, s2, 7
s_cmp_eq_u32 s20, 0
s_cselect_b32 exec_lo, -1, 0
s_mov_b32 exec_hi, 0
buffer_store_dword v41, v42, s[76:79], s32 offen sc1
s_mov_b64 exec, -1
s_and_b32 s91, s21, 3
s_cmp_eq_u32 s20, 0
s_cselect_b32 s91, s91, 0xff
s_lshl_b32 s27, s21, 6
s_lshl_b32 s29, s22, 3
s_add_u32 s27, s27, s29
s_lshl_b32 s29, s20, 1
s_add_u32 s27, s27, s29
s_lshl_b32 s27, s27, 13
s_add_u32 s50, s27, 0
s_add_u32 s96, s27, 16777216
s_add_u32 s51, s27, 4096
s_add_u32 s97, s27, 16781312
s_add_u32 s52, s27, 8192
s_add_u32 s98, s27, 16785408
s_add_u32 s53, s27, 12288
s_add_u32 s99, s27, 16789504
s_waitcnt vmcnt(20)
s_barrier
v_add_u32 v8, s44, v16
v_add_u32 v12, s44, v20
v_add_u32 v9, s44, v17
v_add_u32 v13, s44, v21
v_add_u32 v10, s44, v18
v_add_u32 v14, s44, v22
v_add_u32 v11, s44, v19
v_add_u32 v15, s44, v23
s_add_u32 s44, s44, 49152
s_cmp_ge_u32 s44, 163840
s_cselect_b32 s44, 16384, s44
ds_read_b128 a[208:211], v8 offset:0
ds_read_b64_tr_b16 a[192:193], v12 offset:0
ds_read_b64_tr_b16 a[194:195], v12 offset:1024
ds_read_b128 a[212:215], v8 offset:4096
ds_read_b64_tr_b16 a[196:197], v13 offset:0
ds_read_b64_tr_b16 a[198:199], v13 offset:1024
ds_read_b64_tr_b16 a[200:201], v14 offset:0
ds_read_b64_tr_b16 a[202:203], v14 offset:1024
ds_read_b64_tr_b16 a[204:205], v15 offset:0
ds_read_b64_tr_b16 a[206:207], v15 offset:1024
s_waitcnt lgkmcnt(7)
v_mfma_f32_32x32x16_bf16 v[64:79], a[192:195], a[208:211], 0
ds_read_b128 a[232:235], v9 offset:0
ds_read_b64_tr_b16 a[216:217], v12 offset:4096
s_waitcnt lgkmcnt(8)
v_mfma_f32_32x32x16_bf16 v[128:143], a[192:195], a[212:215], 0
ds_read_b64_tr_b16 a[218:219], v12 offset:5120
ds_read_b128 a[236:239], v9 offset:4096
s_waitcnt lgkmcnt(8)
v_mfma_f32_32x32x16_bf16 v[80:95], a[196:199], a[208:211], 0
ds_read_b64_tr_b16 a[220:221], v13 offset:4096
ds_read_b64_tr_b16 a[222:223], v13 offset:5120
v_mfma_f32_32x32x16_bf16 v[144:159], a[196:199], a[212:215], 0
ds_read_b64_tr_b16 a[224:225], v14 offset:4096
ds_read_b64_tr_b16 a[226:227], v14 offset:5120
s_waitcnt lgkmcnt(10)
v_mfma_f32_32x32x16_bf16 v[96:111], a[200:203], a[208:211], 0
ds_read_b64_tr_b16 a[228:229], v15 offset:4096
ds_read_b64_tr_b16 a[230:231], v15 offset:5120
v_mfma_f32_32x32x16_bf16 v[160:175], a[200:203], a[212:215], 0
buffer_load_dwordx4 v31, s[8:11], s42 offen offset:3072 lds
s_add_u32 s42, s42, 524288
s_waitcnt lgkmcnt(10)
v_mfma_f32_32x32x16_bf16 v[112:127], a[204:207], a[208:211], 0
s_add_u32 s47, s43, s46
s_mov_b32 m0, s47
s_nop 0
buffer_load_dwordx4 v24, s[4:7], s40 offen lds
v_mfma_f32_32x32x16_bf16 v[176:191], a[204:207], a[212:215], 0
buffer_load_dwordx4 v25, s[4:7], s40 offen offset:1024 lds
s_waitcnt lgkmcnt(7)
v_mfma_f32_32x32x16_bf16 v[64:79], a[216:219], a[232:235], v[64:79]
ds_read_b128 a[208:211], v10 offset:0
ds_read_b64_tr_b16 a[192:193], v12 offset:8192
s_waitcnt lgkmcnt(8)
v_mfma_f32_32x32x16_bf16 v[128:143], a[216:219], a[236:239], v[128:143]
ds_read_b64_tr_b16 a[194:195], v12 offset:9216
ds_read_b128 a[212:215], v10 offset:4096
s_waitcnt lgkmcnt(8)
v_mfma_f32_32x32x16_bf16 v[80:95], a[220:223], a[232:235], v[80:95]
ds_read_b64_tr_b16 a[196:197], v13 offset:8192
ds_read_b64_tr_b16 a[198:199], v13 offset:9216
v_mfma_f32_32x32x16_bf16 v[144:159], a[220:223], a[236:239], v[144:159]
ds_read_b64_tr_b16 a[200:201], v14 offset:8192
ds_read_b64_tr_b16 a[202:203], v14 offset:9216
s_waitcnt lgkmcnt(10)
v_mfma_f32_32x32x16_bf16 v[96:111], a[224:227], a[232:235], v[96:111]
ds_read_b64_tr_b16 a[204:205], v15 offset:8192
ds_read_b64_tr_b16 a[206:207], v15 offset:9216
v_mfma_f32_32x32x16_bf16 v[160:175], a[224:227], a[236:239], v[160:175]
buffer_load_dwordx4 v26, s[4:7], s40 offen offset:2048 lds
s_waitcnt lgkmcnt(10)
v_mfma_f32_32x32x16_bf16 v[112:127], a[228:231], a[232:235], v[112:127]
buffer_load_dwordx4 v27, s[4:7], s40 offen offset:3072 lds
s_add_u32 s40, s40, 128
v_mfma_f32_32x32x16_bf16 v[176:191], a[228:231], a[236:239], v[176:191]
s_add_u32 m0, s47, 4096
s_nop 0
buffer_load_dwordx4 v24, s[4:7], s41 offen lds
s_waitcnt lgkmcnt(7)
v_mfma_f32_32x32x16_bf16 v[64:79], a[192:195], a[208:211], v[64:79]
ds_read_b128 a[232:235], v11 offset:0
ds_read_b64_tr_b16 a[216:217], v12 offset:12288
s_waitcnt lgkmcnt(8)
v_mfma_f32_32x32x16_bf16 v[128:143], a[192:195], a[212:215], v[128:143]
ds_read_b64_tr_b16 a[218:219], v12 offset:13312
ds_read_b128 a[236:239], v11 offset:4096
s_waitcnt lgkmcnt(8)
v_mfma_f32_32x32x16_bf16 v[80:95], a[196:199], a[208:211], v[80:95]
ds_read_b64_tr_b16 a[220:221], v13 offset:12288
ds_read_b64_tr_b16 a[222:223], v13 offset:13312
v_mfma_f32_32x32x16_bf16 v[144:159], a[196:199], a[212:215], v[144:159]
ds_read_b64_tr_b16 a[224:225], v14 offset:12288
ds_read_b64_tr_b16 a[226:227], v14 offset:13312
s_waitcnt lgkmcnt(10)
v_mfma_f32_32x32x16_bf16 v[96:111], a[200:203], a[208:211], v[96:111]
ds_read_b64_tr_b16 a[228:229], v15 offset:12288
ds_read_b64_tr_b16 a[230:231], v15 offset:13312
v_mfma_f32_32x32x16_bf16 v[160:175], a[200:203], a[212:215], v[160:175]
buffer_load_dwordx4 v25, s[4:7], s41 offen offset:1024 lds
s_waitcnt lgkmcnt(10)
v_mfma_f32_32x32x16_bf16 v[112:127], a[204:207], a[208:211], v[112:127]
buffer_load_dwordx4 v26, s[4:7], s41 offen offset:2048 lds
v_mfma_f32_32x32x16_bf16 v[176:191], a[204:207], a[212:215], v[176:191]
buffer_load_dwordx4 v27, s[4:7], s41 offen offset:3072 lds
s_add_u32 s41, s41, 128
s_add_u32 s43, s43, 49152
s_cmp_ge_u32 s43, 163840
s_cselect_b32 s43, 16384, s43
s_waitcnt lgkmcnt(0)
s_waitcnt vmcnt(17)
s_barrier
v_mfma_f32_32x32x16_bf16 v[64:79], a[216:219], a[232:235], v[64:79]
v_add_u32 v8, s44, v16
v_add_u32 v12, s44, v20
v_add_u32 v9, s44, v17
v_add_u32 v13, s44, v21
v_add_u32 v10, s44, v18
v_add_u32 v14, s44, v22
v_add_u32 v11, s44, v19
v_add_u32 v15, s44, v23
ds_read_b128 a[208:211], v8 offset:0
ds_read_b64_tr_b16 a[192:193], v12 offset:0
v_mfma_f32_32x32x16_bf16 v[128:143], a[216:219], a[236:239], v[128:143]
ds_read_b64_tr_b16 a[194:195], v12 offset:1024
ds_read_b128 a[212:215], v8 offset:4096
s_add_u32 s44, s44, 49152
s_cmp_ge_u32 s44, 163840
s_cselect_b32 s44, 16384, s44
v_mfma_f32_32x32x16_bf16 v[80:95], a[220:223], a[232:235], v[80:95]
ds_read_b64_tr_b16 a[196:197], v13 offset:0
ds_read_b64_tr_b16 a[198:199], v13 offset:1024
v_mfma_f32_32x32x16_bf16 v[144:159], a[220:223], a[236:239], v[144:159]
ds_read_b64_tr_b16 a[200:201], v14 offset:0
ds_read_b64_tr_b16 a[202:203], v14 offset:1024
v_mfma_f32_32x32x16_bf16 v[96:111], a[224:227], a[232:235], v[96:111]
ds_read_b64_tr_b16 a[204:205], v15 offset:0
ds_read_b64_tr_b16 a[206:207], v15 offset:1024
v_mfma_f32_32x32x16_bf16 v[160:175], a[224:227], a[236:239], v[160:175]
s_add_u32 m0, s43, s45
s_nop 0
buffer_load_dwordx4 v28, s[8:11], s42 offen lds
v_mfma_f32_32x32x16_bf16 v[112:127], a[228:231], a[232:235], v[112:127]
buffer_load_dwordx4 v29, s[8:11], s42 offen offset:1024 lds
v_mfma_f32_32x32x16_bf16 v[176:191], a[228:231], a[236:239], v[176:191]
buffer_load_dwordx4 v30, s[8:11], s42 offen offset:2048 lds
s_waitcnt lgkmcnt(7)
v_mfma_f32_32x32x16_bf16 v[64:79], a[192:195], a[208:211], v[64:79]
ds_read_b128 a[232:235], v9 offset:0
ds_read_b64_tr_b16 a[216:217], v12 offset:4096
s_waitcnt lgkmcnt(8)
v_mfma_f32_32x32x16_bf16 v[128:143], a[192:195], a[212:215], v[128:143]
ds_read_b64_tr_b16 a[218:219], v12 offset:5120
ds_read_b128 a[236:239], v9 offset:4096
s_lshl_b32 s25, s20, 11
s_mov_b32 s26, s25
s_mov_b32 s28, 1317011456
v_mov_b32 v209, 0xf149f2ca
s_waitcnt lgkmcnt(8)
v_mfma_f32_32x32x16_bf16 v[80:95], a[196:199], a[208:211], v[80:95]
ds_read_b64_tr_b16 a[220:221], v13 offset:4096
ds_read_b64_tr_b16 a[222:223], v13 offset:5120
v_mov_b32 v230, 0xffff
v_mov_b32 v231, 0x10000
v_mov_b32 v205, v204
v_add_u32 v206, 0x10000, v204
v_mfma_f32_32x32x16_bf16 v[144:159], a[196:199], a[212:215], v[144:159]
ds_read_b64_tr_b16 a[224:225], v14 offset:4096
ds_read_b64_tr_b16 a[226:227], v14 offset:5120
s_waitcnt lgkmcnt(10)
v_mfma_f32_32x32x16_bf16 v[96:111], a[200:203], a[208:211], v[96:111]
ds_read_b64_tr_b16 a[228:229], v15 offset:4096
ds_read_b64_tr_b16 a[230:231], v15 offset:5120
v_and_b32 v3, 31, v2
v_lshrrev_b32 v4, 5, v2
v_lshlrev_b32 v4, 2, v4
v_sub_u32 v3, v3, v4
v_mfma_f32_32x32x16_bf16 v[160:175], a[200:203], a[212:215], v[160:175]
buffer_load_dwordx4 v31, s[8:11], s42 offen offset:3072 lds
s_add_u32 s42, s42, 524288
s_waitcnt lgkmcnt(10)
v_mfma_f32_32x32x16_bf16 v[112:127], a[204:207], a[208:211], v[112:127]
s_add_u32 s47, s43, s46
s_mov_b32 m0, s47
s_nop 0
buffer_load_dwordx4 v24, s[4:7], s40 offen lds
v_mfma_f32_32x32x16_bf16 v[176:191], a[204:207], a[212:215], v[176:191]
buffer_load_dwordx4 v25, s[4:7], s40 offen offset:1024 lds
s_waitcnt lgkmcnt(7)
v_mfma_f32_32x32x16_bf16 v[64:79], a[216:219], a[232:235], v[64:79]
ds_read_b128 a[208:211], v10 offset:0
ds_read_b64_tr_b16 a[192:193], v12 offset:8192
s_waitcnt lgkmcnt(8)
v_mfma_f32_32x32x16_bf16 v[128:143], a[216:219], a[236:239], v[128:143]
ds_read_b64_tr_b16 a[194:195], v12 offset:9216
ds_read_b128 a[212:215], v10 offset:4096
s_lshl_b32 s27, s36, 5
v_add_u32 v207, s27, v3
s_lshl_b32 s27, s37, 5
v_add_u32 v208, s27, v3
s_waitcnt lgkmcnt(8)
v_mfma_f32_32x32x16_bf16 v[80:95], a[220:223], a[232:235], v[80:95]
ds_read_b64_tr_b16 a[196:197], v13 offset:8192
ds_read_b64_tr_b16 a[198:199], v13 offset:9216
s_lshr_b32 s27, s2, 3
s_and_b32 s29, s2, 7
s_lshr_b32 s30, s29, 1
s_mul_i32 s30, s30, 7
v_mfma_f32_32x32x16_bf16 v[144:159], a[220:223], a[236:239], v[144:159]
ds_read_b64_tr_b16 a[200:201], v14 offset:8192
ds_read_b64_tr_b16 a[202:203], v14 offset:9216
s_lshr_b32 s31, s27, 2
s_add_u32 s80, s30, s31
s_and_b32 s30, s29, 1
s_lshl_b32 s30, s30, 2
s_waitcnt lgkmcnt(10)
v_mfma_f32_32x32x16_bf16 v[96:111], a[224:227], a[232:235], v[96:111]
ds_read_b64_tr_b16 a[204:205], v15 offset:8192
ds_read_b64_tr_b16 a[206:207], v15 offset:9216
v_mfma_f32_32x32x16_bf16 v[160:175], a[224:227], a[236:239], v[160:175]
buffer_load_dwordx4 v26, s[4:7], s40 offen offset:2048 lds
s_waitcnt lgkmcnt(10)
v_mfma_f32_32x32x16_bf16 v[112:127], a[228:231], a[232:235], v[112:127]
buffer_load_dwordx4 v27, s[4:7], s40 offen offset:3072 lds
s_add_u32 s40, s40, 128
v_mfma_f32_32x32x16_bf16 v[176:191], a[228:231], a[236:239], v[176:191]
s_add_u32 m0, s47, 4096
s_nop 0
buffer_load_dwordx4 v24, s[4:7], s41 offen lds
s_waitcnt lgkmcnt(7)
v_mfma_f32_32x32x16_bf16 v[64:79], a[192:195], a[208:211], v[64:79]
ds_read_b128 a[232:235], v11 offset:0
ds_read_b64_tr_b16 a[216:217], v12 offset:12288
s_and_b32 s31, s27, 3
s_add_u32 s81, s30, s31
s_lshl_b32 s84, s20, 13
s_lshl_b32 s89, s20, 13
s_waitcnt lgkmcnt(8)
v_mfma_f32_32x32x16_bf16 v[128:143], a[192:195], a[212:215], v[128:143]
ds_read_b64_tr_b16 a[218:219], v12 offset:13312
ds_read_b128 a[236:239], v11 offset:4096
s_waitcnt lgkmcnt(8)
v_mfma_f32_32x32x16_bf16 v[80:95], a[196:199], a[208:211], v[80:95]
ds_read_b64_tr_b16 a[220:221], v13 offset:12288
ds_read_b64_tr_b16 a[222:223], v13 offset:13312
s_add_u32 s89, s89, 131072
v_and_b32 v5, 63, v0
v_lshrrev_b32 v33, 5, v5
v_bfe_u32 v34, v5, 2, 2
v_mfma_f32_32x32x16_bf16 v[144:159], a[196:199], a[212:215], v[144:159]
ds_read_b64_tr_b16 a[224:225], v14 offset:12288
ds_read_b64_tr_b16 a[226:227], v14 offset:13312
v_bfe_u32 v35, v5, 4, 1
v_and_b32 v36, 3, v5
v_bfe_u32 v37, v5, 3, 1
v_mul_u32_u24 v38, 8, v33
s_waitcnt lgkmcnt(10)
v_mfma_f32_32x32x16_bf16 v[96:111], a[200:203], a[208:211], v[96:111]
ds_read_b64_tr_b16 a[228:229], v15 offset:12288
ds_read_b64_tr_b16 a[230:231], v15 offset:13312
v_mfma_f32_32x32x16_bf16 v[160:175], a[200:203], a[212:215], v[160:175]
buffer_load_dwordx4 v25, s[4:7], s41 offen offset:1024 lds
s_waitcnt lgkmcnt(10)
v_mfma_f32_32x32x16_bf16 v[112:127], a[204:207], a[208:211], v[112:127]
buffer_load_dwordx4 v26, s[4:7], s41 offen offset:2048 lds
v_mfma_f32_32x32x16_bf16 v[176:191], a[204:207], a[212:215], v[176:191]
buffer_load_dwordx4 v27, s[4:7], s41 offen offset:3072 lds
s_add_u32 s41, s41, 128
s_add_u32 s43, s43, 49152
s_cmp_ge_u32 s43, 163840
s_cselect_b32 s43, 16384, s43
s_waitcnt lgkmcnt(0)
s_waitcnt vmcnt(12)
s_barrier
v_mfma_f32_32x32x16_bf16 v[64:79], a[216:219], a[232:235], v[64:79]
v_add_u32 v8, s44, v16
v_add_u32 v12, s44, v20
v_add_u32 v9, s44, v17
v_add_u32 v13, s44, v21
v_add_u32 v10, s44, v18
v_add_u32 v14, s44, v22
v_add_u32 v11, s44, v19
v_add_u32 v15, s44, v23
ds_read_b128 a[208:211], v8 offset:0
ds_read_b64_tr_b16 a[192:193], v12 offset:0
v_mfma_f32_32x32x16_bf16 v[128:143], a[216:219], a[236:239], v[128:143]
ds_read_b64_tr_b16 a[194:195], v12 offset:1024
ds_read_b128 a[212:215], v8 offset:4096
s_add_u32 s44, s44, 49152
s_cmp_ge_u32 s44, 163840
s_cselect_b32 s44, 16384, s44
v_mfma_f32_32x32x16_bf16 v[80:95], a[220:223], a[232:235], v[80:95]
ds_read_b64_tr_b16 a[196:197], v13 offset:0
ds_read_b64_tr_b16 a[198:199], v13 offset:1024
v_mfma_f32_32x32x16_bf16 v[144:159], a[220:223], a[236:239], v[144:159]
ds_read_b64_tr_b16 a[200:201], v14 offset:0
ds_read_b64_tr_b16 a[202:203], v14 offset:1024
v_lshrrev_b32 v58, 5, v204
v_lshlrev_b32 v58, 13, v58
v_bfe_u32 v59, v204, 4, 1
v_lshl_add_u32 v58, v59, 7, v58
s_lshl_b32 s32, s20, 4
s_lshl_b32 s49, s22, 6
s_add_u32 s32, s32, s49
s_lshl_b32 s32, s32, 13
s_lshl_b32 s49, s21, 8
s_add_u32 s32, s32, s49
s_and_b32 s49, s21, 3
s_cmp_eq_u32 s49, 0
s_cselect_b32 exec_lo, -1, 0
s_mov_b32 exec_hi, 0
buffer_load_dword v253, v58, s[92:95], s32 offen
s_mov_b64 exec, -1
v_mfma_f32_32x32x16_bf16 v[96:111], a[224:227], a[232:235], v[96:111]
ds_read_b64_tr_b16 a[204:205], v15 offset:0
ds_read_b64_tr_b16 a[206:207], v15 offset:1024
v_mfma_f32_32x32x16_bf16 v[160:175], a[224:227], a[236:239], v[160:175]
s_add_u32 m0, s43, s45
s_nop 0
buffer_load_dwordx4 v28, s[8:11], s42 offen lds
v_mfma_f32_32x32x16_bf16 v[112:127], a[228:231], a[232:235], v[112:127]
buffer_load_dwordx4 v29, s[8:11], s42 offen offset:1024 lds
v_mfma_f32_32x32x16_bf16 v[176:191], a[228:231], a[236:239], v[176:191]
buffer_load_dwordx4 v30, s[8:11], s42 offen offset:2048 lds
s_waitcnt lgkmcnt(7)
v_mfma_f32_32x32x16_bf16 v[64:79], a[192:195], a[208:211], v[64:79]
ds_read_b128 a[232:235], v9 offset:0
ds_read_b64_tr_b16 a[216:217], v12 offset:4096
s_waitcnt lgkmcnt(8)
v_mfma_f32_32x32x16_bf16 v[128:143], a[192:195], a[212:215], v[128:143]
ds_read_b64_tr_b16 a[218:219], v12 offset:5120
ds_read_b128 a[236:239], v9 offset:4096
v_add_u32 v38, v38, v34
v_lshlrev_b32 v38, 7, v38
v_xor_b32 v218, 0, v37
v_lshl_add_u32 v38, v218, 6, v38
s_waitcnt lgkmcnt(8)
v_mfma_f32_32x32x16_bf16 v[80:95], a[196:199], a[208:211], v[80:95]
ds_read_b64_tr_b16 a[220:221], v13 offset:4096
ds_read_b64_tr_b16 a[222:223], v13 offset:5120
v_lshl_add_u32 v38, v35, 5, v38
v_lshl_add_u32 v38, v36, 3, v38
v_add_u32 v218, s89, v38
v_mul_u32_u24 v38, 8, v33
v_mfma_f32_32x32x16_bf16 v[144:159], a[196:199], a[212:215], v[144:159]
ds_read_b64_tr_b16 a[224:225], v14 offset:4096
ds_read_b64_tr_b16 a[226:227], v14 offset:5120
s_waitcnt lgkmcnt(10)
v_mfma_f32_32x32x16_bf16 v[96:111], a[200:203], a[208:211], v[96:111]
ds_read_b64_tr_b16 a[228:229], v15 offset:4096
ds_read_b64_tr_b16 a[230:231], v15 offset:5120
v_add_u32 v38, v38, v34
v_lshlrev_b32 v38, 7, v38
v_xor_b32 v219, 1, v37
v_lshl_add_u32 v38, v219, 6, v38
v_mfma_f32_32x32x16_bf16 v[160:175], a[200:203], a[212:215], v[160:175]
buffer_load_dwordx4 v31, s[8:11], s42 offen offset:3072 lds
s_add_u32 s42, s42, 524288
s_waitcnt lgkmcnt(10)
v_mfma_f32_32x32x16_bf16 v[112:127], a[204:207], a[208:211], v[112:127]
s_add_u32 s47, s43, s46
s_mov_b32 m0, s47
s_nop 0
buffer_load_dwordx4 v24, s[4:7], s40 offen lds
v_mfma_f32_32x32x16_bf16 v[176:191], a[204:207], a[212:215], v[176:191]
buffer_load_dwordx4 v25, s[4:7], s40 offen offset:1024 lds
s_waitcnt lgkmcnt(7)
v_mfma_f32_32x32x16_bf16 v[64:79], a[216:219], a[232:235], v[64:79]
ds_read_b128 a[208:211], v10 offset:0
ds_read_b64_tr_b16 a[192:193], v12 offset:8192
s_waitcnt lgkmcnt(8)
v_mfma_f32_32x32x16_bf16 v[128:143], a[216:219], a[236:239], v[128:143]
ds_read_b64_tr_b16 a[194:195], v12 offset:9216
ds_read_b128 a[212:215], v10 offset:4096
v_lshl_add_u32 v38, v35, 5, v38
v_lshl_add_u32 v38, v36, 3, v38
v_add_u32 v219, s89, v38
v_lshrrev_b32 v33, 3, v5
s_waitcnt lgkmcnt(8)
v_mfma_f32_32x32x16_bf16 v[80:95], a[220:223], a[232:235], v[80:95]
ds_read_b64_tr_b16 a[196:197], v13 offset:8192
ds_read_b64_tr_b16 a[198:199], v13 offset:9216
v_bfe_u32 v34, v5, 2, 1
v_bfe_u32 v35, v5, 4, 1
v_xor_b32 v34, v34, v35
v_lshlrev_b32 v34, 6, v34
v_mfma_f32_32x32x16_bf16 v[144:159], a[220:223], a[236:239], v[144:159]
ds_read_b64_tr_b16 a[200:201], v14 offset:8192
ds_read_b64_tr_b16 a[202:203], v14 offset:9216
v_and_b32 v35, 3, v5
v_lshl_add_u32 v34, v35, 4, v34
s_mov_b32 s29, 3584
v_mul_lo_u32 v33, v33, s29
s_waitcnt lgkmcnt(10)
v_mfma_f32_32x32x16_bf16 v[96:111], a[224:227], a[232:235], v[96:111]
ds_read_b64_tr_b16 a[204:205], v15 offset:8192
ds_read_b64_tr_b16 a[206:207], v15 offset:9216
v_mfma_f32_32x32x16_bf16 v[160:175], a[224:227], a[236:239], v[160:175]
buffer_load_dwordx4 v26, s[4:7], s40 offen offset:2048 lds
s_waitcnt lgkmcnt(10)
v_mfma_f32_32x32x16_bf16 v[112:127], a[228:231], a[232:235], v[112:127]
buffer_load_dwordx4 v27, s[4:7], s40 offen offset:3072 lds
s_add_u32 s40, s40, 128
v_mfma_f32_32x32x16_bf16 v[176:191], a[228:231], a[236:239], v[176:191]
s_add_u32 m0, s47, 4096
s_nop 0
buffer_load_dwordx4 v24, s[4:7], s41 offen lds
s_waitcnt lgkmcnt(7)
v_mfma_f32_32x32x16_bf16 v[64:79], a[192:195], a[208:211], v[64:79]
ds_read_b128 a[232:235], v11 offset:0
ds_read_b64_tr_b16 a[216:217], v12 offset:12288
v_add_u32 v33, v33, v34
v_add_u32 v48, 0, v33
v_add_u32 v49, 27648, v33
v_add_u32 v50, 55296, v33
s_waitcnt lgkmcnt(8)
v_mfma_f32_32x32x16_bf16 v[128:143], a[192:195], a[212:215], v[128:143]
ds_read_b64_tr_b16 a[218:219], v12 offset:13312
ds_read_b128 a[236:239], v11 offset:4096
s_waitcnt lgkmcnt(8)
v_mfma_f32_32x32x16_bf16 v[80:95], a[196:199], a[208:211], v[80:95]
ds_read_b64_tr_b16 a[220:221], v13 offset:12288
ds_read_b64_tr_b16 a[222:223], v13 offset:13312
v_add_u32 v51, 82944, v33
v_mov_b32 v214, v48
v_mov_b32 v215, v49
v_lshrrev_b32 v33, 3, v5
v_mfma_f32_32x32x16_bf16 v[144:159], a[196:199], a[212:215], v[144:159]
ds_read_b64_tr_b16 a[224:225], v14 offset:12288
ds_read_b64_tr_b16 a[226:227], v14 offset:13312
v_bfe_u32 v34, v5, 2, 1
v_bfe_u32 v35, v5, 4, 1
v_xor_b32 v34, v34, v35
v_lshlrev_b32 v34, 6, v34
s_waitcnt lgkmcnt(10)
v_mfma_f32_32x32x16_bf16 v[96:111], a[200:203], a[208:211], v[96:111]
ds_read_b64_tr_b16 a[228:229], v15 offset:12288
ds_read_b64_tr_b16 a[230:231], v15 offset:13312
v_mfma_f32_32x32x16_bf16 v[160:175], a[200:203], a[212:215], v[160:175]
buffer_load_dwordx4 v25, s[4:7], s41 offen offset:1024 lds
s_waitcnt lgkmcnt(10)
v_mfma_f32_32x32x16_bf16 v[112:127], a[204:207], a[208:211], v[112:127]
buffer_load_dwordx4 v26, s[4:7], s41 offen offset:2048 lds
v_mfma_f32_32x32x16_bf16 v[176:191], a[204:207], a[212:215], v[176:191]
buffer_load_dwordx4 v27, s[4:7], s41 offen offset:3072 lds
s_add_u32 s41, s41, 128
s_add_u32 s43, s43, 49152
s_cmp_ge_u32 s43, 163840
s_cselect_b32 s43, 16384, s43
s_waitcnt lgkmcnt(0)
s_waitcnt vmcnt(13)
s_barrier
v_mfma_f32_32x32x16_bf16 v[64:79], a[216:219], a[232:235], v[64:79]
v_add_u32 v8, s44, v16
v_add_u32 v12, s44, v20
v_add_u32 v9, s44, v17
v_add_u32 v13, s44, v21
v_add_u32 v10, s44, v18
v_add_u32 v14, s44, v22
v_add_u32 v11, s44, v19
v_add_u32 v15, s44, v23
ds_read_b128 a[208:211], v8 offset:0
ds_read_b64_tr_b16 a[192:193], v12 offset:0
v_mfma_f32_32x32x16_bf16 v[128:143], a[216:219], a[236:239], v[128:143]
ds_read_b64_tr_b16 a[194:195], v12 offset:1024
ds_read_b128 a[212:215], v8 offset:4096
s_add_u32 s44, s44, 49152
s_cmp_ge_u32 s44, 163840
s_cselect_b32 s44, 16384, s44
v_mfma_f32_32x32x16_bf16 v[80:95], a[220:223], a[232:235], v[80:95]
ds_read_b64_tr_b16 a[196:197], v13 offset:0
ds_read_b64_tr_b16 a[198:199], v13 offset:1024
s_mov_b32 s76, s100
s_and_b32 s77, s101, 0xffff
s_mov_b32 s78, 256
s_mov_b32 s79, 0x20000
v_mov_b32 v58, 0
v_mov_b32 v59, s33
s_cmp_eq_u32 s91, 0
s_cselect_b64 exec, 1, 0
buffer_store_byte v59, v58, s[76:79], s2 offen sc1
s_mov_b64 exec, -1
v_mfma_f32_32x32x16_bf16 v[144:159], a[220:223], a[236:239], v[144:159]
ds_read_b64_tr_b16 a[200:201], v14 offset:0
ds_read_b64_tr_b16 a[202:203], v14 offset:1024
v_mfma_f32_32x32x16_bf16 v[96:111], a[224:227], a[232:235], v[96:111]
ds_read_b64_tr_b16 a[204:205], v15 offset:0
ds_read_b64_tr_b16 a[206:207], v15 offset:1024
v_mfma_f32_32x32x16_bf16 v[160:175], a[224:227], a[236:239], v[160:175]
s_add_u32 m0, s43, s45
s_nop 0
buffer_load_dwordx4 v28, s[8:11], s42 offen lds
v_lshrrev_b32 v58, 5, v204
v_lshlrev_b32 v58, 13, v58
v_bfe_u32 v59, v204, 4, 1
v_lshl_add_u32 v58, v59, 7, v58
s_lshl_b32 s32, s20, 4
s_lshl_b32 s49, s22, 6
s_add_u32 s32, s32, s49
s_lshl_b32 s32, s32, 13
s_lshl_b32 s49, s21, 8
s_add_u32 s32, s32, s49
s_and_b32 s49, s21, 3
s_cmp_eq_u32 s49, 1
s_cselect_b32 exec_lo, -1, 0
s_mov_b32 exec_hi, 0
buffer_load_dword v253, v58, s[92:95], s32 offen
s_mov_b64 exec, -1
v_mfma_f32_32x32x16_bf16 v[112:127], a[228:231], a[232:235], v[112:127]
buffer_load_dwordx4 v29, s[8:11], s42 offen offset:1024 lds
v_mfma_f32_32x32x16_bf16 v[176:191], a[228:231], a[236:239], v[176:191]
buffer_load_dwordx4 v30, s[8:11], s42 offen offset:2048 lds
s_waitcnt lgkmcnt(7)
v_mfma_f32_32x32x16_bf16 v[64:79], a[192:195], a[208:211], v[64:79]
ds_read_b128 a[232:235], v9 offset:0
ds_read_b64_tr_b16 a[216:217], v12 offset:4096
s_waitcnt lgkmcnt(8)
v_mfma_f32_32x32x16_bf16 v[128:143], a[192:195], a[212:215], v[128:143]
ds_read_b64_tr_b16 a[218:219], v12 offset:5120
ds_read_b128 a[236:239], v9 offset:4096
v_and_b32 v35, 3, v5
v_lshl_add_u32 v34, v35, 4, v34
s_mov_b32 s29, 1024
v_mul_lo_u32 v33, v33, s29
s_waitcnt lgkmcnt(8)
v_mfma_f32_32x32x16_bf16 v[80:95], a[196:199], a[208:211], v[80:95]
ds_read_b64_tr_b16 a[220:221], v13 offset:4096
ds_read_b64_tr_b16 a[222:223], v13 offset:5120
v_add_u32 v33, v33, v34
v_add_u32 v48, 0, v33
v_add_u32 v49, 7168, v33
v_add_u32 v50, 14336, v33
v_mfma_f32_32x32x16_bf16 v[144:159], a[196:199], a[212:215], v[144:159]
ds_read_b64_tr_b16 a[224:225], v14 offset:4096
ds_read_b64_tr_b16 a[226:227], v14 offset:5120
s_waitcnt lgkmcnt(10)
v_mfma_f32_32x32x16_bf16 v[96:111], a[200:203], a[208:211], v[96:111]
ds_read_b64_tr_b16 a[228:229], v15 offset:4096
ds_read_b64_tr_b16 a[230:231], v15 offset:5120
v_add_u32 v51, 21504, v33
v_mov_b32 v216, v48
v_mov_b32 v217, v49
s_mul_i32 s85, s20, 1835008
v_mfma_f32_32x32x16_bf16 v[160:175], a[200:203], a[212:215], v[160:175]
buffer_load_dwordx4 v31, s[8:11], s42 offen offset:3072 lds
s_add_u32 s42, s42, 524288
s_waitcnt lgkmcnt(10)
v_mfma_f32_32x32x16_bf16 v[112:127], a[204:207], a[208:211], v[112:127]
s_add_u32 s47, s43, s46
s_mov_b32 m0, s47
s_nop 0
buffer_load_dwordx4 v24, s[4:7], s40 offen lds
v_mfma_f32_32x32x16_bf16 v[176:191], a[204:207], a[212:215], v[176:191]
buffer_load_dwordx4 v25, s[4:7], s40 offen offset:1024 lds
s_waitcnt lgkmcnt(7)
v_mfma_f32_32x32x16_bf16 v[64:79], a[216:219], a[232:235], v[64:79]
ds_read_b128 a[208:211], v10 offset:0
ds_read_b64_tr_b16 a[192:193], v12 offset:8192
s_waitcnt lgkmcnt(8)
v_mfma_f32_32x32x16_bf16 v[128:143], a[216:219], a[236:239], v[128:143]
ds_read_b64_tr_b16 a[194:195], v12 offset:9216
ds_read_b128 a[212:215], v10 offset:4096
s_lshl_b32 s29, s80, 7
s_add_u32 s85, s85, s29
s_lshl_b32 s88, s20, 19
s_lshl_b32 s29, s81, 7
s_waitcnt lgkmcnt(8)
v_mfma_f32_32x32x16_bf16 v[80:95], a[220:223], a[232:235], v[80:95]
ds_read_b64_tr_b16 a[196:197], v13 offset:8192
ds_read_b64_tr_b16 a[198:199], v13 offset:9216
s_add_u32 s88, s88, s29
v_lshlrev_b32 v252, 3, v204
s_sub_u32 s27, s2, 32
s_lshl_b32 s27, s27, 2
v_mfma_f32_32x32x16_bf16 v[144:159], a[220:223], a[236:239], v[144:159]
ds_read_b64_tr_b16 a[200:201], v14 offset:8192
ds_read_b64_tr_b16 a[202:203], v14 offset:9216
s_add_u32 s27, s27, s20
s_lshl_b32 s74, s27, 13
s_mul_i32 s75, s27, 4736
v_mov_b32 v2, 0x3e0293ee
s_waitcnt lgkmcnt(10)
v_mfma_f32_32x32x16_bf16 v[96:111], a[224:227], a[232:235], v[96:111]
ds_read_b64_tr_b16 a[204:205], v15 offset:8192
ds_read_b64_tr_b16 a[206:207], v15 offset:9216
v_mfma_f32_32x32x16_bf16 v[160:175], a[224:227], a[236:239], v[160:175]
buffer_load_dwordx4 v26, s[4:7], s40 offen offset:2048 lds
s_waitcnt lgkmcnt(10)
v_mfma_f32_32x32x16_bf16 v[112:127], a[228:231], a[232:235], v[112:127]
buffer_load_dwordx4 v27, s[4:7], s40 offen offset:3072 lds
s_add_u32 s40, s40, 128
v_mfma_f32_32x32x16_bf16 v[176:191], a[228:231], a[236:239], v[176:191]
s_add_u32 m0, s47, 4096
s_nop 0
buffer_load_dwordx4 v24, s[4:7], s41 offen lds
s_waitcnt lgkmcnt(7)
v_mfma_f32_32x32x16_bf16 v[64:79], a[192:195], a[208:211], v[64:79]
ds_read_b128 a[232:235], v11 offset:0
ds_read_b64_tr_b16 a[216:217], v12 offset:12288
v_mov_b32 v3, 0x3e0293ee
v_accvgpr_write_b32 a0, 0
v_accvgpr_write_b32 a1, 0
v_accvgpr_write_b32 a2, 0
s_waitcnt lgkmcnt(8)
v_mfma_f32_32x32x16_bf16 v[128:143], a[192:195], a[212:215], v[128:143]
ds_read_b64_tr_b16 a[218:219], v12 offset:13312
ds_read_b128 a[236:239], v11 offset:4096
s_waitcnt lgkmcnt(8)
v_mfma_f32_32x32x16_bf16 v[80:95], a[196:199], a[208:211], v[80:95]
ds_read_b64_tr_b16 a[220:221], v13 offset:12288
ds_read_b64_tr_b16 a[222:223], v13 offset:13312
v_accvgpr_write_b32 a3, 0
v_accvgpr_write_b32 a4, 0
v_accvgpr_write_b32 a5, 0
v_accvgpr_write_b32 a6, 0
v_mfma_f32_32x32x16_bf16 v[144:159], a[196:199], a[212:215], v[144:159]
ds_read_b64_tr_b16 a[224:225], v14 offset:12288
ds_read_b64_tr_b16 a[226:227], v14 offset:13312
v_accvgpr_write_b32 a7, 0
v_accvgpr_write_b32 a8, 0
v_accvgpr_write_b32 a9, 0
v_accvgpr_write_b32 a10, 0
s_waitcnt lgkmcnt(10)
v_mfma_f32_32x32x16_bf16 v[96:111], a[200:203], a[208:211], v[96:111]
ds_read_b64_tr_b16 a[228:229], v15 offset:12288
ds_read_b64_tr_b16 a[230:231], v15 offset:13312
v_mfma_f32_32x32x16_bf16 v[160:175], a[200:203], a[212:215], v[160:175]
buffer_load_dwordx4 v25, s[4:7], s41 offen offset:1024 lds
s_waitcnt lgkmcnt(10)
v_mfma_f32_32x32x16_bf16 v[112:127], a[204:207], a[208:211], v[112:127]
buffer_load_dwordx4 v26, s[4:7], s41 offen offset:2048 lds
v_mfma_f32_32x32x16_bf16 v[176:191], a[204:207], a[212:215], v[176:191]
buffer_load_dwordx4 v27, s[4:7], s41 offen offset:3072 lds
s_add_u32 s41, s41, 128
s_add_u32 s43, s43, 49152
s_cmp_ge_u32 s43, 163840
s_cselect_b32 s43, 16384, s43
s_waitcnt lgkmcnt(0)
s_waitcnt vmcnt(14)
s_barrier
v_mfma_f32_32x32x16_bf16 v[64:79], a[216:219], a[232:235], v[64:79]
v_add_u32 v8, s44, v16
v_add_u32 v12, s44, v20
v_add_u32 v9, s44, v17
v_add_u32 v13, s44, v21
v_add_u32 v10, s44, v18
v_add_u32 v14, s44, v22
v_add_u32 v11, s44, v19
v_add_u32 v15, s44, v23
ds_read_b128 a[208:211], v8 offset:0
ds_read_b64_tr_b16 a[192:193], v12 offset:0
v_mfma_f32_32x32x16_bf16 v[128:143], a[216:219], a[236:239], v[128:143]
ds_read_b64_tr_b16 a[194:195], v12 offset:1024
ds_read_b128 a[212:215], v8 offset:4096
s_add_u32 s44, s44, 49152
s_cmp_ge_u32 s44, 163840
s_cselect_b32 s44, 16384, s44
v_mfma_f32_32x32x16_bf16 v[80:95], a[220:223], a[232:235], v[80:95]
ds_read_b64_tr_b16 a[196:197], v13 offset:0
ds_read_b64_tr_b16 a[198:199], v13 offset:1024
s_mov_b32 s76, s100
s_and_b32 s77, s101, 0xffff
s_mov_b32 s78, 256
s_mov_b32 s79, 0x20000
v_mov_b32 v58, 0
v_mov_b32 v59, s33
s_cmp_eq_u32 s91, 1
s_cselect_b64 exec, 1, 0
buffer_store_byte v59, v58, s[76:79], s2 offen sc1
s_mov_b64 exec, -1
v_mfma_f32_32x32x16_bf16 v[144:159], a[220:223], a[236:239], v[144:159]
ds_read_b64_tr_b16 a[200:201], v14 offset:0
ds_read_b64_tr_b16 a[202:203], v14 offset:1024
v_mfma_f32_32x32x16_bf16 v[96:111], a[224:227], a[232:235], v[96:111]
ds_read_b64_tr_b16 a[204:205], v15 offset:0
ds_read_b64_tr_b16 a[206:207], v15 offset:1024
v_mfma_f32_32x32x16_bf16 v[160:175], a[224:227], a[236:239], v[160:175]
s_add_u32 m0, s43, s45
s_nop 0
buffer_load_dwordx4 v28, s[8:11], s42 offen lds
v_lshrrev_b32 v58, 5, v204
v_lshlrev_b32 v58, 13, v58
v_bfe_u32 v59, v204, 4, 1
v_lshl_add_u32 v58, v59, 7, v58
s_lshl_b32 s32, s20, 4
s_lshl_b32 s49, s22, 6
s_add_u32 s32, s32, s49
s_lshl_b32 s32, s32, 13
s_lshl_b32 s49, s21, 8
s_add_u32 s32, s32, s49
s_and_b32 s49, s21, 3
s_cmp_eq_u32 s49, 2
s_cselect_b32 exec_lo, -1, 0
s_mov_b32 exec_hi, 0
buffer_load_dword v253, v58, s[92:95], s32 offen
s_mov_b64 exec, -1
v_mfma_f32_32x32x16_bf16 v[112:127], a[228:231], a[232:235], v[112:127]
buffer_load_dwordx4 v29, s[8:11], s42 offen offset:1024 lds
v_mfma_f32_32x32x16_bf16 v[176:191], a[228:231], a[236:239], v[176:191]
buffer_load_dwordx4 v30, s[8:11], s42 offen offset:2048 lds
s_waitcnt lgkmcnt(7)
v_mfma_f32_32x32x16_bf16 v[64:79], a[192:195], a[208:211], v[64:79]
ds_read_b128 a[232:235], v9 offset:0
ds_read_b64_tr_b16 a[216:217], v12 offset:4096
s_waitcnt lgkmcnt(8)
v_mfma_f32_32x32x16_bf16 v[128:143], a[192:195], a[212:215], v[128:143]
ds_read_b64_tr_b16 a[218:219], v12 offset:5120
ds_read_b128 a[236:239], v9 offset:4096
v_accvgpr_write_b32 a11, 0
v_accvgpr_write_b32 a12, 0
v_accvgpr_write_b32 a13, 0
v_accvgpr_write_b32 a14, 0
s_waitcnt lgkmcnt(8)
v_mfma_f32_32x32x16_bf16 v[80:95], a[196:199], a[208:211], v[80:95]
ds_read_b64_tr_b16 a[220:221], v13 offset:4096
ds_read_b64_tr_b16 a[222:223], v13 offset:5120
v_accvgpr_write_b32 a15, 0
v_accvgpr_write_b32 a16, 0
v_accvgpr_write_b32 a17, 0
v_accvgpr_write_b32 a18, 0
v_mfma_f32_32x32x16_bf16 v[144:159], a[196:199], a[212:215], v[144:159]
ds_read_b64_tr_b16 a[224:225], v14 offset:4096
ds_read_b64_tr_b16 a[226:227], v14 offset:5120
s_waitcnt lgkmcnt(10)
v_mfma_f32_32x32x16_bf16 v[96:111], a[200:203], a[208:211], v[96:111]
ds_read_b64_tr_b16 a[228:229], v15 offset:4096
ds_read_b64_tr_b16 a[230:231], v15 offset:5120
v_accvgpr_write_b32 a19, 0
v_accvgpr_write_b32 a20, 0
v_accvgpr_write_b32 a21, 0
v_accvgpr_write_b32 a22, 0
v_mfma_f32_32x32x16_bf16 v[160:175], a[200:203], a[212:215], v[160:175]
buffer_load_dwordx4 v31, s[8:11], s42 offen offset:3072 lds
s_add_u32 s42, s42, 524288
s_waitcnt lgkmcnt(10)
v_mfma_f32_32x32x16_bf16 v[112:127], a[204:207], a[208:211], v[112:127]
s_add_u32 s47, s43, s46
s_mov_b32 m0, s47
s_nop 0
buffer_load_dwordx4 v24, s[4:7], s40 offen lds
v_mfma_f32_32x32x16_bf16 v[176:191], a[204:207], a[212:215], v[176:191]
buffer_load_dwordx4 v25, s[4:7], s40 offen offset:1024 lds
s_waitcnt lgkmcnt(7)
v_mfma_f32_32x32x16_bf16 v[64:79], a[216:219], a[232:235], v[64:79]
ds_read_b128 a[208:211], v10 offset:0
ds_read_b64_tr_b16 a[192:193], v12 offset:8192
s_waitcnt lgkmcnt(8)
v_mfma_f32_32x32x16_bf16 v[128:143], a[216:219], a[236:239], v[128:143]
ds_read_b64_tr_b16 a[194:195], v12 offset:9216
ds_read_b128 a[212:215], v10 offset:4096
v_accvgpr_write_b32 a23, 0
v_accvgpr_write_b32 a24, 0
v_accvgpr_write_b32 a25, 0
v_accvgpr_write_b32 a26, 0
s_waitcnt lgkmcnt(8)
v_mfma_f32_32x32x16_bf16 v[80:95], a[220:223], a[232:235], v[80:95]
ds_read_b64_tr_b16 a[196:197], v13 offset:8192
ds_read_b64_tr_b16 a[198:199], v13 offset:9216
v_accvgpr_write_b32 a27, 0
v_accvgpr_write_b32 a28, 0
v_accvgpr_write_b32 a29, 0
v_accvgpr_write_b32 a30, 0
v_mfma_f32_32x32x16_bf16 v[144:159], a[220:223], a[236:239], v[144:159]
ds_read_b64_tr_b16 a[200:201], v14 offset:8192
ds_read_b64_tr_b16 a[202:203], v14 offset:9216
v_accvgpr_write_b32 a31, 0
v_accvgpr_write_b32 a32, 0
v_accvgpr_write_b32 a33, 0
v_accvgpr_write_b32 a34, 0
s_waitcnt lgkmcnt(10)
v_mfma_f32_32x32x16_bf16 v[96:111], a[224:227], a[232:235], v[96:111]
ds_read_b64_tr_b16 a[204:205], v15 offset:8192
ds_read_b64_tr_b16 a[206:207], v15 offset:9216
v_mfma_f32_32x32x16_bf16 v[160:175], a[224:227], a[236:239], v[160:175]
buffer_load_dwordx4 v26, s[4:7], s40 offen offset:2048 lds
s_waitcnt lgkmcnt(10)
v_mfma_f32_32x32x16_bf16 v[112:127], a[228:231], a[232:235], v[112:127]
buffer_load_dwordx4 v27, s[4:7], s40 offen offset:3072 lds
s_add_u32 s40, s40, 128
v_mfma_f32_32x32x16_bf16 v[176:191], a[228:231], a[236:239], v[176:191]
s_add_u32 m0, s47, 4096
s_nop 0
buffer_load_dwordx4 v24, s[4:7], s41 offen lds
s_waitcnt lgkmcnt(7)
v_mfma_f32_32x32x16_bf16 v[64:79], a[192:195], a[208:211], v[64:79]
ds_read_b128 a[232:235], v11 offset:0
ds_read_b64_tr_b16 a[216:217], v12 offset:12288
v_accvgpr_write_b32 a35, 0
v_accvgpr_write_b32 a36, 0
v_accvgpr_write_b32 a37, 0
v_accvgpr_write_b32 a38, 0
s_waitcnt lgkmcnt(8)
v_mfma_f32_32x32x16_bf16 v[128:143], a[192:195], a[212:215], v[128:143]
ds_read_b64_tr_b16 a[218:219], v12 offset:13312
ds_read_b128 a[236:239], v11 offset:4096
s_waitcnt lgkmcnt(8)
v_mfma_f32_32x32x16_bf16 v[80:95], a[196:199], a[208:211], v[80:95]
ds_read_b64_tr_b16 a[220:221], v13 offset:12288
ds_read_b64_tr_b16 a[222:223], v13 offset:13312
v_accvgpr_write_b32 a39, 0
v_accvgpr_write_b32 a40, 0
v_accvgpr_write_b32 a41, 0
v_accvgpr_write_b32 a42, 0
v_mfma_f32_32x32x16_bf16 v[144:159], a[196:199], a[212:215], v[144:159]
ds_read_b64_tr_b16 a[224:225], v14 offset:12288
ds_read_b64_tr_b16 a[226:227], v14 offset:13312
v_accvgpr_write_b32 a43, 0
v_accvgpr_write_b32 a44, 0
v_accvgpr_write_b32 a45, 0
v_accvgpr_write_b32 a46, 0
s_waitcnt lgkmcnt(10)
v_mfma_f32_32x32x16_bf16 v[96:111], a[200:203], a[208:211], v[96:111]
ds_read_b64_tr_b16 a[228:229], v15 offset:12288
ds_read_b64_tr_b16 a[230:231], v15 offset:13312
v_mfma_f32_32x32x16_bf16 v[160:175], a[200:203], a[212:215], v[160:175]
buffer_load_dwordx4 v25, s[4:7], s41 offen offset:1024 lds
s_waitcnt lgkmcnt(10)
v_mfma_f32_32x32x16_bf16 v[112:127], a[204:207], a[208:211], v[112:127]
buffer_load_dwordx4 v26, s[4:7], s41 offen offset:2048 lds
v_mfma_f32_32x32x16_bf16 v[176:191], a[204:207], a[212:215], v[176:191]
buffer_load_dwordx4 v27, s[4:7], s41 offen offset:3072 lds
s_add_u32 s41, s41, 128
s_add_u32 s43, s43, 49152
s_cmp_ge_u32 s43, 163840
s_cselect_b32 s43, 16384, s43
s_waitcnt lgkmcnt(0)
s_waitcnt vmcnt(14)
s_barrier
v_mfma_f32_32x32x16_bf16 v[64:79], a[216:219], a[232:235], v[64:79]
v_add_u32 v8, s44, v16
v_add_u32 v12, s44, v20
v_add_u32 v9, s44, v17
v_add_u32 v13, s44, v21
v_add_u32 v10, s44, v18
v_add_u32 v14, s44, v22
v_add_u32 v11, s44, v19
v_add_u32 v15, s44, v23
ds_read_b128 a[208:211], v8 offset:0
ds_read_b64_tr_b16 a[192:193], v12 offset:0
v_mfma_f32_32x32x16_bf16 v[128:143], a[216:219], a[236:239], v[128:143]
ds_read_b64_tr_b16 a[194:195], v12 offset:1024
ds_read_b128 a[212:215], v8 offset:4096
s_add_u32 s44, s44, 49152
s_cmp_ge_u32 s44, 163840
s_cselect_b32 s44, 16384, s44
v_mfma_f32_32x32x16_bf16 v[80:95], a[220:223], a[232:235], v[80:95]
ds_read_b64_tr_b16 a[196:197], v13 offset:0
ds_read_b64_tr_b16 a[198:199], v13 offset:1024
s_mov_b32 s76, s100
s_and_b32 s77, s101, 0xffff
s_mov_b32 s78, 256
s_mov_b32 s79, 0x20000
v_mov_b32 v58, 0
v_mov_b32 v59, s33
s_cmp_eq_u32 s91, 2
s_cselect_b64 exec, 1, 0
buffer_store_byte v59, v58, s[76:79], s2 offen sc1
s_mov_b64 exec, -1
v_mfma_f32_32x32x16_bf16 v[144:159], a[220:223], a[236:239], v[144:159]
ds_read_b64_tr_b16 a[200:201], v14 offset:0
ds_read_b64_tr_b16 a[202:203], v14 offset:1024
v_mfma_f32_32x32x16_bf16 v[96:111], a[224:227], a[232:235], v[96:111]
ds_read_b64_tr_b16 a[204:205], v15 offset:0
ds_read_b64_tr_b16 a[206:207], v15 offset:1024
v_mfma_f32_32x32x16_bf16 v[160:175], a[224:227], a[236:239], v[160:175]
s_add_u32 m0, s43, s45
s_nop 0
buffer_load_dwordx4 v28, s[8:11], s42 offen lds
v_lshrrev_b32 v58, 5, v204
v_lshlrev_b32 v58, 13, v58
v_bfe_u32 v59, v204, 4, 1
v_lshl_add_u32 v58, v59, 7, v58
s_lshl_b32 s32, s20, 4
s_lshl_b32 s49, s22, 6
s_add_u32 s32, s32, s49
s_lshl_b32 s32, s32, 13
s_lshl_b32 s49, s21, 8
s_add_u32 s32, s32, s49
s_and_b32 s49, s21, 3
s_cmp_eq_u32 s49, 3
s_cselect_b32 exec_lo, -1, 0
s_mov_b32 exec_hi, 0
buffer_load_dword v253, v58, s[92:95], s32 offen
s_mov_b64 exec, -1
v_mfma_f32_32x32x16_bf16 v[112:127], a[228:231], a[232:235], v[112:127]
buffer_load_dwordx4 v29, s[8:11], s42 offen offset:1024 lds
v_mfma_f32_32x32x16_bf16 v[176:191], a[228:231], a[236:239], v[176:191]
buffer_load_dwordx4 v30, s[8:11], s42 offen offset:2048 lds
s_waitcnt lgkmcnt(7)
v_mfma_f32_32x32x16_bf16 v[64:79], a[192:195], a[208:211], v[64:79]
ds_read_b128 a[232:235], v9 offset:0
ds_read_b64_tr_b16 a[216:217], v12 offset:4096
s_waitcnt lgkmcnt(8)
v_mfma_f32_32x32x16_bf16 v[128:143], a[192:195], a[212:215], v[128:143]
ds_read_b64_tr_b16 a[218:219], v12 offset:5120
ds_read_b128 a[236:239], v9 offset:4096
v_accvgpr_write_b32 a47, 0
v_accvgpr_write_b32 a48, 0
v_accvgpr_write_b32 a49, 0
v_accvgpr_write_b32 a50, 0
s_waitcnt lgkmcnt(8)
v_mfma_f32_32x32x16_bf16 v[80:95], a[196:199], a[208:211], v[80:95]
ds_read_b64_tr_b16 a[220:221], v13 offset:4096
ds_read_b64_tr_b16 a[222:223], v13 offset:5120
v_mfma_f32_32x32x16_bf16 v[144:159], a[196:199], a[212:215], v[144:159]
ds_read_b64_tr_b16 a[224:225], v14 offset:4096
ds_read_b64_tr_b16 a[226:227], v14 offset:5120
v_accvgpr_write_b32 a51, 0
v_accvgpr_write_b32 a52, 0
v_accvgpr_write_b32 a53, 0
v_accvgpr_write_b32 a54, 0
s_waitcnt lgkmcnt(10)
v_mfma_f32_32x32x16_bf16 v[96:111], a[200:203], a[208:211], v[96:111]
ds_read_b64_tr_b16 a[228:229], v15 offset:4096
ds_read_b64_tr_b16 a[230:231], v15 offset:5120
v_mfma_f32_32x32x16_bf16 v[160:175], a[200:203], a[212:215], v[160:175]
buffer_load_dwordx4 v31, s[8:11], s42 offen offset:3072 lds
s_add_u32 s42, s42, 524288
s_waitcnt lgkmcnt(10)
v_mfma_f32_32x32x16_bf16 v[112:127], a[204:207], a[208:211], v[112:127]
s_add_u32 s47, s43, s46
s_mov_b32 m0, s47
s_nop 0
buffer_load_dwordx4 v24, s[4:7], s40 offen lds
v_mfma_f32_32x32x16_bf16 v[176:191], a[204:207], a[212:215], v[176:191]
buffer_load_dwordx4 v25, s[4:7], s40 offen offset:1024 lds
s_waitcnt lgkmcnt(7)
v_mfma_f32_32x32x16_bf16 v[64:79], a[216:219], a[232:235], v[64:79]
ds_read_b128 a[208:211], v10 offset:0
ds_read_b64_tr_b16 a[192:193], v12 offset:8192
s_waitcnt lgkmcnt(8)
v_mfma_f32_32x32x16_bf16 v[128:143], a[216:219], a[236:239], v[128:143]
ds_read_b64_tr_b16 a[194:195], v12 offset:9216
ds_read_b128 a[212:215], v10 offset:4096
s_waitcnt lgkmcnt(8)
v_mfma_f32_32x32x16_bf16 v[80:95], a[220:223], a[232:235], v[80:95]
ds_read_b64_tr_b16 a[196:197], v13 offset:8192
ds_read_b64_tr_b16 a[198:199], v13 offset:9216
v_accvgpr_write_b32 a55, 0
v_accvgpr_write_b32 a56, 0
v_accvgpr_write_b32 a57, 0
v_accvgpr_write_b32 a58, 0
v_mfma_f32_32x32x16_bf16 v[144:159], a[220:223], a[236:239], v[144:159]
ds_read_b64_tr_b16 a[200:201], v14 offset:8192
ds_read_b64_tr_b16 a[202:203], v14 offset:9216
s_waitcnt lgkmcnt(10)
v_mfma_f32_32x32x16_bf16 v[96:111], a[224:227], a[232:235], v[96:111]
ds_read_b64_tr_b16 a[204:205], v15 offset:8192
ds_read_b64_tr_b16 a[206:207], v15 offset:9216
v_accvgpr_write_b32 a59, 0
v_accvgpr_write_b32 a60, 0
v_accvgpr_write_b32 a61, 0
v_accvgpr_write_b32 a62, 0
v_mfma_f32_32x32x16_bf16 v[160:175], a[224:227], a[236:239], v[160:175]
buffer_load_dwordx4 v26, s[4:7], s40 offen offset:2048 lds
s_waitcnt lgkmcnt(10)
v_mfma_f32_32x32x16_bf16 v[112:127], a[228:231], a[232:235], v[112:127]
buffer_load_dwordx4 v27, s[4:7], s40 offen offset:3072 lds
s_add_u32 s40, s40, 128
v_mfma_f32_32x32x16_bf16 v[176:191], a[228:231], a[236:239], v[176:191]
s_add_u32 m0, s47, 4096
s_nop 0
buffer_load_dwordx4 v24, s[4:7], s41 offen lds
s_waitcnt lgkmcnt(7)
v_mfma_f32_32x32x16_bf16 v[64:79], a[192:195], a[208:211], v[64:79]
ds_read_b128 a[232:235], v11 offset:0
ds_read_b64_tr_b16 a[216:217], v12 offset:12288
s_waitcnt lgkmcnt(8)
v_mfma_f32_32x32x16_bf16 v[128:143], a[192:195], a[212:215], v[128:143]
ds_read_b64_tr_b16 a[218:219], v12 offset:13312
ds_read_b128 a[236:239], v11 offset:4096
s_waitcnt lgkmcnt(8)
v_mfma_f32_32x32x16_bf16 v[80:95], a[196:199], a[208:211], v[80:95]
ds_read_b64_tr_b16 a[220:221], v13 offset:12288
ds_read_b64_tr_b16 a[222:223], v13 offset:13312
v_accvgpr_write_b32 a63, 0
v_mfma_f32_32x32x16_bf16 v[144:159], a[196:199], a[212:215], v[144:159]
ds_read_b64_tr_b16 a[224:225], v14 offset:12288
ds_read_b64_tr_b16 a[226:227], v14 offset:13312
s_waitcnt lgkmcnt(10)
v_mfma_f32_32x32x16_bf16 v[96:111], a[200:203], a[208:211], v[96:111]
ds_read_b64_tr_b16 a[228:229], v15 offset:12288
ds_read_b64_tr_b16 a[230:231], v15 offset:13312
v_mfma_f32_32x32x16_bf16 v[160:175], a[200:203], a[212:215], v[160:175]
buffer_load_dwordx4 v25, s[4:7], s41 offen offset:1024 lds
s_waitcnt lgkmcnt(10)
v_mfma_f32_32x32x16_bf16 v[112:127], a[204:207], a[208:211], v[112:127]
buffer_load_dwordx4 v26, s[4:7], s41 offen offset:2048 lds
v_mfma_f32_32x32x16_bf16 v[176:191], a[204:207], a[212:215], v[176:191]
buffer_load_dwordx4 v27, s[4:7], s41 offen offset:3072 lds
s_add_u32 s41, s41, 128
s_add_u32 s43, s43, 49152
s_cmp_ge_u32 s43, 163840
s_cselect_b32 s43, 16384, s43
s_waitcnt lgkmcnt(0)
s_waitcnt vmcnt(14)
s_barrier
v_mfma_f32_32x32x16_bf16 v[64:79], a[216:219], a[232:235], v[64:79]
v_add_u32 v8, s44, v16
v_add_u32 v12, s44, v20
v_add_u32 v9, s44, v17
v_add_u32 v13, s44, v21
v_add_u32 v10, s44, v18
v_add_u32 v14, s44, v22
v_add_u32 v11, s44, v19
v_add_u32 v15, s44, v23
ds_read_b128 a[208:211], v8 offset:0
ds_read_b64_tr_b16 a[192:193], v12 offset:0
v_mfma_f32_32x32x16_bf16 v[128:143], a[216:219], a[236:239], v[128:143]
ds_read_b64_tr_b16 a[194:195], v12 offset:1024
ds_read_b128 a[212:215], v8 offset:4096
s_add_u32 s44, s44, 49152
s_cmp_ge_u32 s44, 163840
s_cselect_b32 s44, 16384, s44
v_mfma_f32_32x32x16_bf16 v[80:95], a[220:223], a[232:235], v[80:95]
ds_read_b64_tr_b16 a[196:197], v13 offset:0
ds_read_b64_tr_b16 a[198:199], v13 offset:1024
v_mfma_f32_32x32x16_bf16 v[144:159], a[220:223], a[236:239], v[144:159]
ds_read_b64_tr_b16 a[200:201], v14 offset:0
ds_read_b64_tr_b16 a[202:203], v14 offset:1024
s_mov_b32 s76, s100
s_and_b32 s77, s101, 0xffff
s_mov_b32 s78, 256
s_mov_b32 s79, 0x20000
v_mov_b32 v58, 0
v_mov_b32 v59, s33
s_cmp_eq_u32 s91, 3
s_cselect_b64 exec, 1, 0
buffer_store_byte v59, v58, s[76:79], s2 offen sc1
s_mov_b64 exec, -1
v_mfma_f32_32x32x16_bf16 v[96:111], a[224:227], a[232:235], v[96:111]
ds_read_b64_tr_b16 a[204:205], v15 offset:0
ds_read_b64_tr_b16 a[206:207], v15 offset:1024
v_mfma_f32_32x32x16_bf16 v[160:175], a[224:227], a[236:239], v[160:175]
s_lshl_b32 s40, s22, 18
s_lshl_b32 s49, s20, 16
s_add_u32 s40, s40, s49
s_add_u32 s41, s40, 32768
s_lshl_b32 s42, s20, 17
s_lshl_b32 s49, s21, 8
s_add_u32 s42, s42, s49
s_add_u32 m0, s43, s45
s_nop 0
buffer_load_dwordx4 v28, s[92:95], s42 offen lds
v_mfma_f32_32x32x16_bf16 v[112:127], a[228:231], a[232:235], v[112:127]
buffer_load_dwordx4 v29, s[92:95], s42 offen offset:1024 lds
v_mfma_f32_32x32x16_bf16 v[176:191], a[228:231], a[236:239], v[176:191]
buffer_load_dwordx4 v30, s[92:95], s42 offen offset:2048 lds
s_waitcnt lgkmcnt(7)
v_mfma_f32_32x32x16_bf16 v[64:79], a[192:195], a[208:211], v[64:79]
ds_read_b128 a[232:235], v9 offset:0
ds_read_b64_tr_b16 a[216:217], v12 offset:4096
s_waitcnt lgkmcnt(8)
v_mfma_f32_32x32x16_bf16 v[128:143], a[192:195], a[212:215], v[128:143]
ds_read_b64_tr_b16 a[218:219], v12 offset:5120
ds_read_b128 a[236:239], v9 offset:4096
s_waitcnt lgkmcnt(8)
v_mfma_f32_32x32x16_bf16 v[80:95], a[196:199], a[208:211], v[80:95]
ds_read_b64_tr_b16 a[220:221], v13 offset:4096
ds_read_b64_tr_b16 a[222:223], v13 offset:5120
v_mfma_f32_32x32x16_bf16 v[144:159], a[196:199], a[212:215], v[144:159]
ds_read_b64_tr_b16 a[224:225], v14 offset:4096
ds_read_b64_tr_b16 a[226:227], v14 offset:5120
s_waitcnt lgkmcnt(10)
v_mfma_f32_32x32x16_bf16 v[96:111], a[200:203], a[208:211], v[96:111]
ds_read_b64_tr_b16 a[228:229], v15 offset:4096
ds_read_b64_tr_b16 a[230:231], v15 offset:5120
v_mfma_f32_32x32x16_bf16 v[160:175], a[200:203], a[212:215], v[160:175]
buffer_load_dwordx4 v31, s[92:95], s42 offen offset:3072 lds
s_add_u32 s42, s42, 524288
s_waitcnt lgkmcnt(10)
v_mfma_f32_32x32x16_bf16 v[112:127], a[204:207], a[208:211], v[112:127]
s_add_u32 s47, s43, s46
s_mov_b32 m0, s47
s_nop 0
buffer_load_dwordx4 v24, s[4:7], s40 offen lds
v_mfma_f32_32x32x16_bf16 v[176:191], a[204:207], a[212:215], v[176:191]
buffer_load_dwordx4 v25, s[4:7], s40 offen offset:1024 lds
s_waitcnt lgkmcnt(7)
v_mfma_f32_32x32x16_bf16 v[64:79], a[216:219], a[232:235], v[64:79]
ds_read_b128 a[208:211], v10 offset:0
ds_read_b64_tr_b16 a[192:193], v12 offset:8192
s_waitcnt lgkmcnt(8)
v_mfma_f32_32x32x16_bf16 v[128:143], a[216:219], a[236:239], v[128:143]
ds_read_b64_tr_b16 a[194:195], v12 offset:9216
ds_read_b128 a[212:215], v10 offset:4096
s_waitcnt lgkmcnt(8)
v_mfma_f32_32x32x16_bf16 v[80:95], a[220:223], a[232:235], v[80:95]
ds_read_b64_tr_b16 a[196:197], v13 offset:8192
ds_read_b64_tr_b16 a[198:199], v13 offset:9216
v_mfma_f32_32x32x16_bf16 v[144:159], a[220:223], a[236:239], v[144:159]
ds_read_b64_tr_b16 a[200:201], v14 offset:8192
ds_read_b64_tr_b16 a[202:203], v14 offset:9216
s_waitcnt lgkmcnt(10)
v_mfma_f32_32x32x16_bf16 v[96:111], a[224:227], a[232:235], v[96:111]
ds_read_b64_tr_b16 a[204:205], v15 offset:8192
ds_read_b64_tr_b16 a[206:207], v15 offset:9216
v_mfma_f32_32x32x16_bf16 v[160:175], a[224:227], a[236:239], v[160:175]
buffer_load_dwordx4 v26, s[4:7], s40 offen offset:2048 lds
s_waitcnt lgkmcnt(10)
v_mfma_f32_32x32x16_bf16 v[112:127], a[228:231], a[232:235], v[112:127]
buffer_load_dwordx4 v27, s[4:7], s40 offen offset:3072 lds
s_add_u32 s40, s40, 128
v_mfma_f32_32x32x16_bf16 v[176:191], a[228:231], a[236:239], v[176:191]
s_add_u32 m0, s47, 4096
s_nop 0
buffer_load_dwordx4 v24, s[4:7], s41 offen lds
s_waitcnt lgkmcnt(7)
v_mfma_f32_32x32x16_bf16 v[64:79], a[192:195], a[208:211], v[64:79]
ds_read_b128 a[232:235], v11 offset:0
ds_read_b64_tr_b16 a[216:217], v12 offset:12288
s_waitcnt lgkmcnt(8)
v_mfma_f32_32x32x16_bf16 v[128:143], a[192:195], a[212:215], v[128:143]
ds_read_b64_tr_b16 a[218:219], v12 offset:13312
ds_read_b128 a[236:239], v11 offset:4096
s_waitcnt lgkmcnt(8)
v_mfma_f32_32x32x16_bf16 v[80:95], a[196:199], a[208:211], v[80:95]
ds_read_b64_tr_b16 a[220:221], v13 offset:12288
ds_read_b64_tr_b16 a[222:223], v13 offset:13312
v_mfma_f32_32x32x16_bf16 v[144:159], a[196:199], a[212:215], v[144:159]
ds_read_b64_tr_b16 a[224:225], v14 offset:12288
ds_read_b64_tr_b16 a[226:227], v14 offset:13312
s_waitcnt lgkmcnt(10)
v_mfma_f32_32x32x16_bf16 v[96:111], a[200:203], a[208:211], v[96:111]
ds_read_b64_tr_b16 a[228:229], v15 offset:12288
ds_read_b64_tr_b16 a[230:231], v15 offset:13312
v_mfma_f32_32x32x16_bf16 v[160:175], a[200:203], a[212:215], v[160:175]
buffer_load_dwordx4 v25, s[4:7], s41 offen offset:1024 lds
s_waitcnt lgkmcnt(10)
v_mfma_f32_32x32x16_bf16 v[112:127], a[204:207], a[208:211], v[112:127]
buffer_load_dwordx4 v26, s[4:7], s41 offen offset:2048 lds
v_mfma_f32_32x32x16_bf16 v[176:191], a[204:207], a[212:215], v[176:191]
buffer_load_dwordx4 v27, s[4:7], s41 offen offset:3072 lds
s_add_u32 s41, s41, 128
s_add_u32 s43, s43, 49152
s_cmp_ge_u32 s43, 163840
s_cselect_b32 s43, 16384, s43
s_waitcnt lgkmcnt(0)
s_waitcnt vmcnt(13)
s_barrier
v_mfma_f32_32x32x16_bf16 v[64:79], a[216:219], a[232:235], v[64:79]
v_add_u32 v8, s44, v16
v_add_u32 v12, s44, v20
v_add_u32 v9, s44, v17
v_add_u32 v13, s44, v21
v_add_u32 v10, s44, v18
v_add_u32 v14, s44, v22
v_add_u32 v11, s44, v19
v_add_u32 v15, s44, v23
ds_read_b128 a[208:211], v8 offset:0
ds_read_b64_tr_b16 a[192:193], v12 offset:0
v_mfma_f32_32x32x16_bf16 v[128:143], a[216:219], a[236:239], v[128:143]
ds_read_b64_tr_b16 a[194:195], v12 offset:1024
ds_read_b128 a[212:215], v8 offset:4096
s_add_u32 s44, s44, 49152
s_cmp_ge_u32 s44, 163840
s_cselect_b32 s44, 16384, s44
v_mfma_f32_32x32x16_bf16 v[80:95], a[220:223], a[232:235], v[80:95]
ds_read_b64_tr_b16 a[196:197], v13 offset:0
ds_read_b64_tr_b16 a[198:199], v13 offset:1024
v_mfma_f32_32x32x16_bf16 v[144:159], a[220:223], a[236:239], v[144:159]
ds_read_b64_tr_b16 a[200:201], v14 offset:0
ds_read_b64_tr_b16 a[202:203], v14 offset:1024
v_mfma_f32_32x32x16_bf16 v[96:111], a[224:227], a[232:235], v[96:111]
ds_read_b64_tr_b16 a[204:205], v15 offset:0
ds_read_b64_tr_b16 a[206:207], v15 offset:1024
v_mfma_f32_32x32x16_bf16 v[160:175], a[224:227], a[236:239], v[160:175]
s_add_u32 m0, s43, s45
s_nop 0
buffer_load_dwordx4 v28, s[92:95], s42 offen lds
v_mfma_f32_32x32x16_bf16 v[112:127], a[228:231], a[232:235], v[112:127]
buffer_load_dwordx4 v29, s[92:95], s42 offen offset:1024 lds
v_mfma_f32_32x32x16_bf16 v[176:191], a[228:231], a[236:239], v[176:191]
buffer_load_dwordx4 v30, s[92:95], s42 offen offset:2048 lds
s_waitcnt lgkmcnt(7)
v_mfma_f32_32x32x16_bf16 v[64:79], a[192:195], a[208:211], v[64:79]
ds_read_b128 a[232:235], v9 offset:0
ds_read_b64_tr_b16 a[216:217], v12 offset:4096
s_waitcnt lgkmcnt(8)
v_mfma_f32_32x32x16_bf16 v[128:143], a[192:195], a[212:215], v[128:143]
ds_read_b64_tr_b16 a[218:219], v12 offset:5120
ds_read_b128 a[236:239], v9 offset:4096
s_waitcnt lgkmcnt(8)
v_mfma_f32_32x32x16_bf16 v[80:95], a[196:199], a[208:211], v[80:95]
ds_read_b64_tr_b16 a[220:221], v13 offset:4096
ds_read_b64_tr_b16 a[222:223], v13 offset:5120
v_mfma_f32_32x32x16_bf16 v[144:159], a[196:199], a[212:215], v[144:159]
ds_read_b64_tr_b16 a[224:225], v14 offset:4096
ds_read_b64_tr_b16 a[226:227], v14 offset:5120
s_waitcnt lgkmcnt(10)
v_mfma_f32_32x32x16_bf16 v[96:111], a[200:203], a[208:211], v[96:111]
ds_read_b64_tr_b16 a[228:229], v15 offset:4096
ds_read_b64_tr_b16 a[230:231], v15 offset:5120
v_mfma_f32_32x32x16_bf16 v[160:175], a[200:203], a[212:215], v[160:175]
buffer_load_dwordx4 v31, s[92:95], s42 offen offset:3072 lds
s_add_u32 s42, s42, 524288
s_waitcnt lgkmcnt(10)
v_mfma_f32_32x32x16_bf16 v[112:127], a[204:207], a[208:211], v[112:127]
s_add_u32 s47, s43, s46
s_mov_b32 m0, s47
s_nop 0
buffer_load_dwordx4 v24, s[4:7], s40 offen lds
v_mfma_f32_32x32x16_bf16 v[176:191], a[204:207], a[212:215], v[176:191]
buffer_load_dwordx4 v25, s[4:7], s40 offen offset:1024 lds
s_waitcnt lgkmcnt(7)
v_mfma_f32_32x32x16_bf16 v[64:79], a[216:219], a[232:235], v[64:79]
ds_read_b128 a[208:211], v10 offset:0
ds_read_b64_tr_b16 a[192:193], v12 offset:8192
s_waitcnt lgkmcnt(8)
v_mfma_f32_32x32x16_bf16 v[128:143], a[216:219], a[236:239], v[128:143]
ds_read_b64_tr_b16 a[194:195], v12 offset:9216
ds_read_b128 a[212:215], v10 offset:4096
s_waitcnt lgkmcnt(8)
v_mfma_f32_32x32x16_bf16 v[80:95], a[220:223], a[232:235], v[80:95]
ds_read_b64_tr_b16 a[196:197], v13 offset:8192
ds_read_b64_tr_b16 a[198:199], v13 offset:9216
v_mfma_f32_32x32x16_bf16 v[144:159], a[220:223], a[236:239], v[144:159]
ds_read_b64_tr_b16 a[200:201], v14 offset:8192
ds_read_b64_tr_b16 a[202:203], v14 offset:9216
s_waitcnt lgkmcnt(10)
v_mfma_f32_32x32x16_bf16 v[96:111], a[224:227], a[232:235], v[96:111]
ds_read_b64_tr_b16 a[204:205], v15 offset:8192
ds_read_b64_tr_b16 a[206:207], v15 offset:9216
v_mfma_f32_32x32x16_bf16 v[160:175], a[224:227], a[236:239], v[160:175]
buffer_load_dwordx4 v26, s[4:7], s40 offen offset:2048 lds
s_waitcnt lgkmcnt(10)
v_mfma_f32_32x32x16_bf16 v[112:127], a[228:231], a[232:235], v[112:127]
buffer_load_dwordx4 v27, s[4:7], s40 offen offset:3072 lds
s_add_u32 s40, s40, 128
v_mfma_f32_32x32x16_bf16 v[176:191], a[228:231], a[236:239], v[176:191]
s_add_u32 m0, s47, 4096
s_nop 0
buffer_load_dwordx4 v24, s[4:7], s41 offen lds
s_waitcnt lgkmcnt(7)
v_mfma_f32_32x32x16_bf16 v[64:79], a[192:195], a[208:211], v[64:79]
ds_read_b128 a[232:235], v11 offset:0
ds_read_b64_tr_b16 a[216:217], v12 offset:12288
s_waitcnt lgkmcnt(8)
v_mfma_f32_32x32x16_bf16 v[128:143], a[192:195], a[212:215], v[128:143]
ds_read_b64_tr_b16 a[218:219], v12 offset:13312
ds_read_b128 a[236:239], v11 offset:4096
s_waitcnt lgkmcnt(8)
v_mfma_f32_32x32x16_bf16 v[80:95], a[196:199], a[208:211], v[80:95]
ds_read_b64_tr_b16 a[220:221], v13 offset:12288
ds_read_b64_tr_b16 a[222:223], v13 offset:13312
v_mfma_f32_32x32x16_bf16 v[144:159], a[196:199], a[212:215], v[144:159]
ds_read_b64_tr_b16 a[224:225], v14 offset:12288
ds_read_b64_tr_b16 a[226:227], v14 offset:13312
s_waitcnt lgkmcnt(10)
v_mfma_f32_32x32x16_bf16 v[96:111], a[200:203], a[208:211], v[96:111]
ds_read_b64_tr_b16 a[228:229], v15 offset:12288
ds_read_b64_tr_b16 a[230:231], v15 offset:13312
v_mfma_f32_32x32x16_bf16 v[160:175], a[200:203], a[212:215], v[160:175]
buffer_load_dwordx4 v25, s[4:7], s41 offen offset:1024 lds
s_waitcnt lgkmcnt(10)
v_mfma_f32_32x32x16_bf16 v[112:127], a[204:207], a[208:211], v[112:127]
buffer_load_dwordx4 v26, s[4:7], s41 offen offset:2048 lds
v_mfma_f32_32x32x16_bf16 v[176:191], a[204:207], a[212:215], v[176:191]
buffer_load_dwordx4 v27, s[4:7], s41 offen offset:3072 lds
s_add_u32 s41, s41, 128
s_add_u32 s43, s43, 49152
s_cmp_ge_u32 s43, 163840
s_cselect_b32 s43, 16384, s43
s_waitcnt lgkmcnt(0)
s_waitcnt vmcnt(12)
s_barrier
v_mfma_f32_32x32x16_bf16 v[64:79], a[216:219], a[232:235], v[64:79]
v_add_u32 v8, s44, v16
v_add_u32 v12, s44, v20
v_add_u32 v9, s44, v17
v_add_u32 v13, s44, v21
v_add_u32 v10, s44, v18
v_add_u32 v14, s44, v22
v_add_u32 v11, s44, v19
v_add_u32 v15, s44, v23
ds_read_b128 a[208:211], v8 offset:0
ds_read_b64_tr_b16 a[192:193], v12 offset:0
v_mfma_f32_32x32x16_bf16 v[128:143], a[216:219], a[236:239], v[128:143]
ds_read_b64_tr_b16 a[194:195], v12 offset:1024
ds_read_b128 a[212:215], v8 offset:4096
s_add_u32 s44, s44, 49152
s_cmp_ge_u32 s44, 163840
s_cselect_b32 s44, 16384, s44
v_mfma_f32_32x32x16_bf16 v[80:95], a[220:223], a[232:235], v[80:95]
ds_read_b64_tr_b16 a[196:197], v13 offset:0
ds_read_b64_tr_b16 a[198:199], v13 offset:1024
v_mfma_f32_32x32x16_bf16 v[144:159], a[220:223], a[236:239], v[144:159]
ds_read_b64_tr_b16 a[200:201], v14 offset:0
ds_read_b64_tr_b16 a[202:203], v14 offset:1024
v_mfma_f32_32x32x16_bf16 v[96:111], a[224:227], a[232:235], v[96:111]
ds_read_b64_tr_b16 a[204:205], v15 offset:0
ds_read_b64_tr_b16 a[206:207], v15 offset:1024
v_mfma_f32_32x32x16_bf16 v[160:175], a[224:227], a[236:239], v[160:175]
s_add_u32 m0, s43, s45
s_nop 0
buffer_load_dwordx4 v28, s[92:95], s42 offen lds
v_mfma_f32_32x32x16_bf16 v[112:127], a[228:231], a[232:235], v[112:127]
buffer_load_dwordx4 v29, s[92:95], s42 offen offset:1024 lds
v_mfma_f32_32x32x16_bf16 v[176:191], a[228:231], a[236:239], v[176:191]
buffer_load_dwordx4 v30, s[92:95], s42 offen offset:2048 lds
s_waitcnt lgkmcnt(7)
v_mfma_f32_32x32x16_bf16 a[64:79], a[208:211], a[192:195], 0
ds_read_b128 a[232:235], v9 offset:0
ds_read_b64_tr_b16 a[216:217], v12 offset:4096
s_waitcnt lgkmcnt(8)
v_mfma_f32_32x32x16_bf16 a[128:143], a[212:215], a[192:195], 0
ds_read_b64_tr_b16 a[218:219], v12 offset:5120
ds_read_b128 a[236:239], v9 offset:4096
v_pk_mul_f32 v[64:65], v[64:65], v[2:3]
v_pk_mul_f32 v[66:67], v[66:67], v[2:3]
v_pk_mul_f32 v[68:69], v[68:69], v[2:3]
v_pk_mul_f32 v[70:71], v[70:71], v[2:3]
s_waitcnt lgkmcnt(8)
v_mfma_f32_32x32x16_bf16 a[80:95], a[208:211], a[196:199], 0
ds_read_b64_tr_b16 a[220:221], v13 offset:4096
ds_read_b64_tr_b16 a[222:223], v13 offset:5120
v_mfma_f32_32x32x16_bf16 a[144:159], a[212:215], a[196:199], 0
ds_read_b64_tr_b16 a[224:225], v14 offset:4096
ds_read_b64_tr_b16 a[226:227], v14 offset:5120
s_waitcnt lgkmcnt(10)
v_mfma_f32_32x32x16_bf16 a[96:111], a[208:211], a[200:203], 0
ds_read_b64_tr_b16 a[228:229], v15 offset:4096
ds_read_b64_tr_b16 a[230:231], v15 offset:5120
v_cvt_pk_bf16_f32 v64, v64, v65
v_cvt_pk_bf16_f32 v65, v66, v67
v_cvt_pk_bf16_f32 v66, v68, v69
v_cvt_pk_bf16_f32 v67, v70, v71
buffer_store_dwordx4 v[64:67], v204, s[16:19], s50 offen offset:0
v_mfma_f32_32x32x16_bf16 a[160:175], a[212:215], a[200:203], 0
buffer_load_dwordx4 v31, s[92:95], s42 offen offset:3072 lds
s_add_u32 s42, s42, 524288
s_waitcnt lgkmcnt(10)
v_mfma_f32_32x32x16_bf16 a[112:127], a[208:211], a[204:207], 0
s_add_u32 s47, s43, s46
s_mov_b32 m0, s47
s_nop 0
buffer_load_dwordx4 v24, s[4:7], s40 offen lds
v_mfma_f32_32x32x16_bf16 a[176:191], a[212:215], a[204:207], 0
buffer_load_dwordx4 v25, s[4:7], s40 offen offset:1024 lds
s_waitcnt lgkmcnt(7)
v_mfma_f32_32x32x16_bf16 a[64:79], a[232:235], a[216:219], a[64:79]
ds_read_b128 a[208:211], v10 offset:0
ds_read_b64_tr_b16 a[192:193], v12 offset:8192
s_waitcnt lgkmcnt(8)
v_mfma_f32_32x32x16_bf16 a[128:143], a[236:239], a[216:219], a[128:143]
ds_read_b64_tr_b16 a[194:195], v12 offset:9216
ds_read_b128 a[212:215], v10 offset:4096
s_waitcnt lgkmcnt(8)
v_mfma_f32_32x32x16_bf16 a[80:95], a[232:235], a[220:223], a[80:95]
ds_read_b64_tr_b16 a[196:197], v13 offset:8192
ds_read_b64_tr_b16 a[198:199], v13 offset:9216
v_mfma_f32_32x32x16_bf16 a[144:159], a[236:239], a[220:223], a[144:159]
ds_read_b64_tr_b16 a[200:201], v14 offset:8192
ds_read_b64_tr_b16 a[202:203], v14 offset:9216
v_pk_mul_f32 v[72:73], v[72:73], v[2:3]
v_pk_mul_f32 v[74:75], v[74:75], v[2:3]
v_pk_mul_f32 v[76:77], v[76:77], v[2:3]
v_pk_mul_f32 v[78:79], v[78:79], v[2:3]
s_waitcnt lgkmcnt(10)
v_mfma_f32_32x32x16_bf16 a[96:111], a[232:235], a[224:227], a[96:111]
ds_read_b64_tr_b16 a[204:205], v15 offset:8192
ds_read_b64_tr_b16 a[206:207], v15 offset:9216
v_mfma_f32_32x32x16_bf16 a[160:175], a[236:239], a[224:227], a[160:175]
buffer_load_dwordx4 v26, s[4:7], s40 offen offset:2048 lds
s_waitcnt lgkmcnt(10)
v_mfma_f32_32x32x16_bf16 a[112:127], a[232:235], a[228:231], a[112:127]
buffer_load_dwordx4 v27, s[4:7], s40 offen offset:3072 lds
s_add_u32 s40, s40, 128
v_mfma_f32_32x32x16_bf16 a[176:191], a[236:239], a[228:231], a[176:191]
s_add_u32 m0, s47, 4096
s_nop 0
buffer_load_dwordx4 v24, s[4:7], s41 offen lds
s_waitcnt lgkmcnt(7)
v_mfma_f32_32x32x16_bf16 a[64:79], a[208:211], a[192:195], a[64:79]
ds_read_b128 a[232:235], v11 offset:0
ds_read_b64_tr_b16 a[216:217], v12 offset:12288
s_waitcnt lgkmcnt(8)
v_mfma_f32_32x32x16_bf16 a[128:143], a[212:215], a[192:195], a[128:143]
ds_read_b64_tr_b16 a[218:219], v12 offset:13312
ds_read_b128 a[236:239], v11 offset:4096
v_cvt_pk_bf16_f32 v72, v72, v73
v_cvt_pk_bf16_f32 v73, v74, v75
v_cvt_pk_bf16_f32 v74, v76, v77
v_cvt_pk_bf16_f32 v75, v78, v79
buffer_store_dwordx4 v[72:75], v204, s[16:19], s50 offen offset:1024
s_waitcnt lgkmcnt(8)
v_mfma_f32_32x32x16_bf16 a[80:95], a[208:211], a[196:199], a[80:95]
ds_read_b64_tr_b16 a[220:221], v13 offset:12288
ds_read_b64_tr_b16 a[222:223], v13 offset:13312
v_mfma_f32_32x32x16_bf16 a[144:159], a[212:215], a[196:199], a[144:159]
ds_read_b64_tr_b16 a[224:225], v14 offset:12288
ds_read_b64_tr_b16 a[226:227], v14 offset:13312
s_waitcnt lgkmcnt(10)
v_mfma_f32_32x32x16_bf16 a[96:111], a[208:211], a[200:203], a[96:111]
ds_read_b64_tr_b16 a[228:229], v15 offset:12288
ds_read_b64_tr_b16 a[230:231], v15 offset:13312
v_mfma_f32_32x32x16_bf16 a[160:175], a[212:215], a[200:203], a[160:175]
buffer_load_dwordx4 v25, s[4:7], s41 offen offset:1024 lds
s_waitcnt lgkmcnt(10)
v_mfma_f32_32x32x16_bf16 a[112:127], a[208:211], a[204:207], a[112:127]
buffer_load_dwordx4 v26, s[4:7], s41 offen offset:2048 lds
v_mfma_f32_32x32x16_bf16 a[176:191], a[212:215], a[204:207], a[176:191]
buffer_load_dwordx4 v27, s[4:7], s41 offen offset:3072 lds
s_add_u32 s41, s41, 128
s_add_u32 s43, s43, 49152
s_cmp_ge_u32 s43, 163840
s_cselect_b32 s43, 16384, s43
s_waitcnt lgkmcnt(0)
s_waitcnt vmcnt(14)
s_barrier
v_mfma_f32_32x32x16_bf16 a[64:79], a[232:235], a[216:219], a[64:79]
v_add_u32 v8, s44, v16
v_add_u32 v12, s44, v20
v_add_u32 v9, s44, v17
v_add_u32 v13, s44, v21
v_add_u32 v10, s44, v18
v_add_u32 v14, s44, v22
v_add_u32 v11, s44, v19
v_add_u32 v15, s44, v23
ds_read_b128 a[208:211], v8 offset:0
ds_read_b64_tr_b16 a[192:193], v12 offset:0
v_mfma_f32_32x32x16_bf16 a[128:143], a[236:239], a[216:219], a[128:143]
ds_read_b64_tr_b16 a[194:195], v12 offset:1024
ds_read_b128 a[212:215], v8 offset:4096
s_add_u32 s44, s44, 49152
s_cmp_ge_u32 s44, 163840
s_cselect_b32 s44, 16384, s44
v_mfma_f32_32x32x16_bf16 a[80:95], a[232:235], a[220:223], a[80:95]
ds_read_b64_tr_b16 a[196:197], v13 offset:0
ds_read_b64_tr_b16 a[198:199], v13 offset:1024
v_mfma_f32_32x32x16_bf16 a[144:159], a[236:239], a[220:223], a[144:159]
ds_read_b64_tr_b16 a[200:201], v14 offset:0
ds_read_b64_tr_b16 a[202:203], v14 offset:1024
v_lshrrev_b32 v58, 5, v204
v_lshlrev_b32 v58, 13, v58
v_bfe_u32 v59, v204, 4, 1
v_lshl_add_u32 v58, v59, 7, v58
s_lshl_b32 s32, s20, 4
s_lshl_b32 s49, s22, 6
s_add_u32 s32, s32, s49
s_lshl_b32 s32, s32, 13
s_lshl_b32 s49, s21, 8
s_add_u32 s32, s32, s49
s_and_b32 s49, s21, 3
s_cmp_eq_u32 s49, 0
s_cselect_b32 exec_lo, -1, 0
s_mov_b32 exec_hi, 0
buffer_load_dword v253, v58, s[60:63], s32 offen
s_mov_b64 exec, -1
v_mfma_f32_32x32x16_bf16 a[96:111], a[232:235], a[224:227], a[96:111]
ds_read_b64_tr_b16 a[204:205], v15 offset:0
ds_read_b64_tr_b16 a[206:207], v15 offset:1024
v_mfma_f32_32x32x16_bf16 a[160:175], a[236:239], a[224:227], a[160:175]
s_add_u32 m0, s43, s45
s_nop 0
buffer_load_dwordx4 v28, s[92:95], s42 offen lds
v_mfma_f32_32x32x16_bf16 a[112:127], a[232:235], a[228:231], a[112:127]
buffer_load_dwordx4 v29, s[92:95], s42 offen offset:1024 lds
v_mfma_f32_32x32x16_bf16 a[176:191], a[236:239], a[228:231], a[176:191]
buffer_load_dwordx4 v30, s[92:95], s42 offen offset:2048 lds
s_waitcnt lgkmcnt(7)
v_mfma_f32_32x32x16_bf16 a[64:79], a[208:211], a[192:195], a[64:79]
ds_read_b128 a[232:235], v9 offset:0
ds_read_b64_tr_b16 a[216:217], v12 offset:4096
s_waitcnt lgkmcnt(8)
v_mfma_f32_32x32x16_bf16 a[128:143], a[212:215], a[192:195], a[128:143]
ds_read_b64_tr_b16 a[218:219], v12 offset:5120
ds_read_b128 a[236:239], v9 offset:4096
v_pk_mul_f32 v[128:129], v[128:129], v[2:3]
v_pk_mul_f32 v[130:131], v[130:131], v[2:3]
v_pk_mul_f32 v[132:133], v[132:133], v[2:3]
v_pk_mul_f32 v[134:135], v[134:135], v[2:3]
s_waitcnt lgkmcnt(8)
v_mfma_f32_32x32x16_bf16 a[80:95], a[208:211], a[196:199], a[80:95]
ds_read_b64_tr_b16 a[220:221], v13 offset:4096
ds_read_b64_tr_b16 a[222:223], v13 offset:5120
v_mfma_f32_32x32x16_bf16 a[144:159], a[212:215], a[196:199], a[144:159]
ds_read_b64_tr_b16 a[224:225], v14 offset:4096
ds_read_b64_tr_b16 a[226:227], v14 offset:5120
s_waitcnt lgkmcnt(10)
v_mfma_f32_32x32x16_bf16 a[96:111], a[208:211], a[200:203], a[96:111]
ds_read_b64_tr_b16 a[228:229], v15 offset:4096
ds_read_b64_tr_b16 a[230:231], v15 offset:5120
v_cvt_pk_bf16_f32 v128, v128, v129
v_cvt_pk_bf16_f32 v129, v130, v131
v_cvt_pk_bf16_f32 v130, v132, v133
v_cvt_pk_bf16_f32 v131, v134, v135
buffer_store_dwordx4 v[128:131], v204, s[16:19], s52 offen offset:0
v_mfma_f32_32x32x16_bf16 a[160:175], a[212:215], a[200:203], a[160:175]
buffer_load_dwordx4 v31, s[92:95], s42 offen offset:3072 lds
s_add_u32 s42, s42, 524288
s_waitcnt lgkmcnt(10)
v_mfma_f32_32x32x16_bf16 a[112:127], a[208:211], a[204:207], a[112:127]
s_add_u32 s47, s43, s46
s_mov_b32 m0, s47
s_nop 0
buffer_load_dwordx4 v24, s[4:7], s40 offen lds
v_mfma_f32_32x32x16_bf16 a[176:191], a[212:215], a[204:207], a[176:191]
buffer_load_dwordx4 v25, s[4:7], s40 offen offset:1024 lds
s_waitcnt lgkmcnt(7)
v_mfma_f32_32x32x16_bf16 a[64:79], a[232:235], a[216:219], a[64:79]
ds_read_b128 a[208:211], v10 offset:0
ds_read_b64_tr_b16 a[192:193], v12 offset:8192
s_waitcnt lgkmcnt(8)
v_mfma_f32_32x32x16_bf16 a[128:143], a[236:239], a[216:219], a[128:143]
ds_read_b64_tr_b16 a[194:195], v12 offset:9216
ds_read_b128 a[212:215], v10 offset:4096
s_waitcnt lgkmcnt(8)
v_mfma_f32_32x32x16_bf16 a[80:95], a[232:235], a[220:223], a[80:95]
ds_read_b64_tr_b16 a[196:197], v13 offset:8192
ds_read_b64_tr_b16 a[198:199], v13 offset:9216
v_mfma_f32_32x32x16_bf16 a[144:159], a[236:239], a[220:223], a[144:159]
ds_read_b64_tr_b16 a[200:201], v14 offset:8192
ds_read_b64_tr_b16 a[202:203], v14 offset:9216
v_pk_mul_f32 v[136:137], v[136:137], v[2:3]
v_pk_mul_f32 v[138:139], v[138:139], v[2:3]
v_pk_mul_f32 v[140:141], v[140:141], v[2:3]
v_pk_mul_f32 v[142:143], v[142:143], v[2:3]
s_waitcnt lgkmcnt(10)
v_mfma_f32_32x32x16_bf16 a[96:111], a[232:235], a[224:227], a[96:111]
ds_read_b64_tr_b16 a[204:205], v15 offset:8192
ds_read_b64_tr_b16 a[206:207], v15 offset:9216
v_mfma_f32_32x32x16_bf16 a[160:175], a[236:239], a[224:227], a[160:175]
buffer_load_dwordx4 v26, s[4:7], s40 offen offset:2048 lds
s_waitcnt lgkmcnt(10)
v_mfma_f32_32x32x16_bf16 a[112:127], a[232:235], a[228:231], a[112:127]
buffer_load_dwordx4 v27, s[4:7], s40 offen offset:3072 lds
s_add_u32 s40, s40, 128
v_mfma_f32_32x32x16_bf16 a[176:191], a[236:239], a[228:231], a[176:191]
s_add_u32 m0, s47, 4096
s_nop 0
buffer_load_dwordx4 v24, s[4:7], s41 offen lds
s_waitcnt lgkmcnt(7)
v_mfma_f32_32x32x16_bf16 a[64:79], a[208:211], a[192:195], a[64:79]
ds_read_b128 a[232:235], v11 offset:0
ds_read_b64_tr_b16 a[216:217], v12 offset:12288
s_waitcnt lgkmcnt(8)
v_mfma_f32_32x32x16_bf16 a[128:143], a[212:215], a[192:195], a[128:143]
ds_read_b64_tr_b16 a[218:219], v12 offset:13312
ds_read_b128 a[236:239], v11 offset:4096
v_cvt_pk_bf16_f32 v136, v136, v137
v_cvt_pk_bf16_f32 v137, v138, v139
v_cvt_pk_bf16_f32 v138, v140, v141
v_cvt_pk_bf16_f32 v139, v142, v143
buffer_store_dwordx4 v[136:139], v204, s[16:19], s52 offen offset:1024
s_waitcnt lgkmcnt(8)
v_mfma_f32_32x32x16_bf16 a[80:95], a[208:211], a[196:199], a[80:95]
ds_read_b64_tr_b16 a[220:221], v13 offset:12288
ds_read_b64_tr_b16 a[222:223], v13 offset:13312
v_mfma_f32_32x32x16_bf16 a[144:159], a[212:215], a[196:199], a[144:159]
ds_read_b64_tr_b16 a[224:225], v14 offset:12288
ds_read_b64_tr_b16 a[226:227], v14 offset:13312
s_waitcnt lgkmcnt(10)
v_mfma_f32_32x32x16_bf16 a[96:111], a[208:211], a[200:203], a[96:111]
ds_read_b64_tr_b16 a[228:229], v15 offset:12288
ds_read_b64_tr_b16 a[230:231], v15 offset:13312
v_mfma_f32_32x32x16_bf16 a[160:175], a[212:215], a[200:203], a[160:175]
buffer_load_dwordx4 v25, s[4:7], s41 offen offset:1024 lds
s_waitcnt lgkmcnt(10)
v_mfma_f32_32x32x16_bf16 a[112:127], a[208:211], a[204:207], a[112:127]
buffer_load_dwordx4 v26, s[4:7], s41 offen offset:2048 lds
v_mfma_f32_32x32x16_bf16 a[176:191], a[212:215], a[204:207], a[176:191]
buffer_load_dwordx4 v27, s[4:7], s41 offen offset:3072 lds
s_add_u32 s41, s41, 128
s_add_u32 s43, s43, 49152
s_cmp_ge_u32 s43, 163840
s_cselect_b32 s43, 16384, s43
s_waitcnt lgkmcnt(0)
s_waitcnt vmcnt(15)
s_barrier
v_mfma_f32_32x32x16_bf16 a[64:79], a[232:235], a[216:219], a[64:79]
v_add_u32 v8, s44, v16
v_add_u32 v12, s44, v20
v_add_u32 v9, s44, v17
v_add_u32 v13, s44, v21
v_add_u32 v10, s44, v18
v_add_u32 v14, s44, v22
v_add_u32 v11, s44, v19
v_add_u32 v15, s44, v23
ds_read_b128 a[208:211], v8 offset:0
ds_read_b64_tr_b16 a[192:193], v12 offset:0
v_mfma_f32_32x32x16_bf16 a[128:143], a[236:239], a[216:219], a[128:143]
ds_read_b64_tr_b16 a[194:195], v12 offset:1024
ds_read_b128 a[212:215], v8 offset:4096
s_add_u32 s44, s44, 49152
s_cmp_ge_u32 s44, 163840
s_cselect_b32 s44, 16384, s44
v_mfma_f32_32x32x16_bf16 a[80:95], a[232:235], a[220:223], a[80:95]
ds_read_b64_tr_b16 a[196:197], v13 offset:0
ds_read_b64_tr_b16 a[198:199], v13 offset:1024
v_mfma_f32_32x32x16_bf16 a[144:159], a[236:239], a[220:223], a[144:159]
ds_read_b64_tr_b16 a[200:201], v14 offset:0
ds_read_b64_tr_b16 a[202:203], v14 offset:1024
v_lshrrev_b32 v58, 5, v204
v_lshlrev_b32 v58, 13, v58
v_bfe_u32 v59, v204, 4, 1
v_lshl_add_u32 v58, v59, 7, v58
s_lshl_b32 s32, s20, 4
s_lshl_b32 s49, s22, 6
s_add_u32 s32, s32, s49
s_lshl_b32 s32, s32, 13
s_lshl_b32 s49, s21, 8
s_add_u32 s32, s32, s49
s_and_b32 s49, s21, 3
s_cmp_eq_u32 s49, 1
s_cselect_b32 exec_lo, -1, 0
s_mov_b32 exec_hi, 0
buffer_load_dword v253, v58, s[60:63], s32 offen
s_mov_b64 exec, -1
v_mfma_f32_32x32x16_bf16 a[96:111], a[232:235], a[224:227], a[96:111]
ds_read_b64_tr_b16 a[204:205], v15 offset:0
ds_read_b64_tr_b16 a[206:207], v15 offset:1024
v_mfma_f32_32x32x16_bf16 a[160:175], a[236:239], a[224:227], a[160:175]
s_add_u32 m0, s43, s45
s_nop 0
buffer_load_dwordx4 v28, s[92:95], s42 offen lds
v_mfma_f32_32x32x16_bf16 a[112:127], a[232:235], a[228:231], a[112:127]
buffer_load_dwordx4 v29, s[92:95], s42 offen offset:1024 lds
v_mfma_f32_32x32x16_bf16 a[176:191], a[236:239], a[228:231], a[176:191]
buffer_load_dwordx4 v30, s[92:95], s42 offen offset:2048 lds
s_waitcnt lgkmcnt(7)
v_mfma_f32_32x32x16_bf16 a[64:79], a[208:211], a[192:195], a[64:79]
ds_read_b128 a[232:235], v9 offset:0
ds_read_b64_tr_b16 a[216:217], v12 offset:4096
s_waitcnt lgkmcnt(8)
v_mfma_f32_32x32x16_bf16 a[128:143], a[212:215], a[192:195], a[128:143]
ds_read_b64_tr_b16 a[218:219], v12 offset:5120
ds_read_b128 a[236:239], v9 offset:4096
v_pk_mul_f32 v[80:81], v[80:81], v[2:3]
v_pk_mul_f32 v[82:83], v[82:83], v[2:3]
v_pk_mul_f32 v[84:85], v[84:85], v[2:3]
v_pk_mul_f32 v[86:87], v[86:87], v[2:3]
s_waitcnt lgkmcnt(8)
v_mfma_f32_32x32x16_bf16 a[80:95], a[208:211], a[196:199], a[80:95]
ds_read_b64_tr_b16 a[220:221], v13 offset:4096
ds_read_b64_tr_b16 a[222:223], v13 offset:5120
v_mfma_f32_32x32x16_bf16 a[144:159], a[212:215], a[196:199], a[144:159]
ds_read_b64_tr_b16 a[224:225], v14 offset:4096
ds_read_b64_tr_b16 a[226:227], v14 offset:5120
s_waitcnt lgkmcnt(10)
v_mfma_f32_32x32x16_bf16 a[96:111], a[208:211], a[200:203], a[96:111]
ds_read_b64_tr_b16 a[228:229], v15 offset:4096
ds_read_b64_tr_b16 a[230:231], v15 offset:5120
v_cvt_pk_bf16_f32 v80, v80, v81
v_cvt_pk_bf16_f32 v81, v82, v83
v_cvt_pk_bf16_f32 v82, v84, v85
v_cvt_pk_bf16_f32 v83, v86, v87
buffer_store_dwordx4 v[80:83], v204, s[16:19], s50 offen offset:2048
v_mfma_f32_32x32x16_bf16 a[160:175], a[212:215], a[200:203], a[160:175]
buffer_load_dwordx4 v31, s[92:95], s42 offen offset:3072 lds
s_add_u32 s42, s42, 524288
s_waitcnt lgkmcnt(10)
v_mfma_f32_32x32x16_bf16 a[112:127], a[208:211], a[204:207], a[112:127]
s_add_u32 s47, s43, s46
s_mov_b32 m0, s47
s_nop 0
buffer_load_dwordx4 v24, s[4:7], s40 offen lds
v_mfma_f32_32x32x16_bf16 a[176:191], a[212:215], a[204:207], a[176:191]
buffer_load_dwordx4 v25, s[4:7], s40 offen offset:1024 lds
s_waitcnt lgkmcnt(7)
v_mfma_f32_32x32x16_bf16 a[64:79], a[232:235], a[216:219], a[64:79]
ds_read_b128 a[208:211], v10 offset:0
ds_read_b64_tr_b16 a[192:193], v12 offset:8192
s_waitcnt lgkmcnt(8)
v_mfma_f32_32x32x16_bf16 a[128:143], a[236:239], a[216:219], a[128:143]
ds_read_b64_tr_b16 a[194:195], v12 offset:9216
ds_read_b128 a[212:215], v10 offset:4096
s_waitcnt lgkmcnt(8)
v_mfma_f32_32x32x16_bf16 a[80:95], a[232:235], a[220:223], a[80:95]
ds_read_b64_tr_b16 a[196:197], v13 offset:8192
ds_read_b64_tr_b16 a[198:199], v13 offset:9216
v_mfma_f32_32x32x16_bf16 a[144:159], a[236:239], a[220:223], a[144:159]
ds_read_b64_tr_b16 a[200:201], v14 offset:8192
ds_read_b64_tr_b16 a[202:203], v14 offset:9216
v_pk_mul_f32 v[88:89], v[88:89], v[2:3]
v_pk_mul_f32 v[90:91], v[90:91], v[2:3]
v_pk_mul_f32 v[92:93], v[92:93], v[2:3]
v_pk_mul_f32 v[94:95], v[94:95], v[2:3]
s_waitcnt lgkmcnt(10)
v_mfma_f32_32x32x16_bf16 a[96:111], a[232:235], a[224:227], a[96:111]
ds_read_b64_tr_b16 a[204:205], v15 offset:8192
ds_read_b64_tr_b16 a[206:207], v15 offset:9216
v_mfma_f32_32x32x16_bf16 a[160:175], a[236:239], a[224:227], a[160:175]
buffer_load_dwordx4 v26, s[4:7], s40 offen offset:2048 lds
s_waitcnt lgkmcnt(10)
v_mfma_f32_32x32x16_bf16 a[112:127], a[232:235], a[228:231], a[112:127]
buffer_load_dwordx4 v27, s[4:7], s40 offen offset:3072 lds
s_add_u32 s40, s40, 128
v_mfma_f32_32x32x16_bf16 a[176:191], a[236:239], a[228:231], a[176:191]
s_add_u32 m0, s47, 4096
s_nop 0
buffer_load_dwordx4 v24, s[4:7], s41 offen lds
s_waitcnt lgkmcnt(7)
v_mfma_f32_32x32x16_bf16 a[64:79], a[208:211], a[192:195], a[64:79]
ds_read_b128 a[232:235], v11 offset:0
ds_read_b64_tr_b16 a[216:217], v12 offset:12288
s_waitcnt lgkmcnt(8)
v_mfma_f32_32x32x16_bf16 a[128:143], a[212:215], a[192:195], a[128:143]
ds_read_b64_tr_b16 a[218:219], v12 offset:13312
ds_read_b128 a[236:239], v11 offset:4096
v_cvt_pk_bf16_f32 v88, v88, v89
v_cvt_pk_bf16_f32 v89, v90, v91
v_cvt_pk_bf16_f32 v90, v92, v93
v_cvt_pk_bf16_f32 v91, v94, v95
buffer_store_dwordx4 v[88:91], v204, s[16:19], s50 offen offset:3072
s_waitcnt lgkmcnt(8)
v_mfma_f32_32x32x16_bf16 a[80:95], a[208:211], a[196:199], a[80:95]
ds_read_b64_tr_b16 a[220:221], v13 offset:12288
ds_read_b64_tr_b16 a[222:223], v13 offset:13312
v_mfma_f32_32x32x16_bf16 a[144:159], a[212:215], a[196:199], a[144:159]
ds_read_b64_tr_b16 a[224:225], v14 offset:12288
ds_read_b64_tr_b16 a[226:227], v14 offset:13312
s_waitcnt lgkmcnt(10)
v_mfma_f32_32x32x16_bf16 a[96:111], a[208:211], a[200:203], a[96:111]
ds_read_b64_tr_b16 a[228:229], v15 offset:12288
ds_read_b64_tr_b16 a[230:231], v15 offset:13312
v_mfma_f32_32x32x16_bf16 a[160:175], a[212:215], a[200:203], a[160:175]
buffer_load_dwordx4 v25, s[4:7], s41 offen offset:1024 lds
s_waitcnt lgkmcnt(10)
v_mfma_f32_32x32x16_bf16 a[112:127], a[208:211], a[204:207], a[112:127]
buffer_load_dwordx4 v26, s[4:7], s41 offen offset:2048 lds
v_mfma_f32_32x32x16_bf16 a[176:191], a[212:215], a[204:207], a[176:191]
buffer_load_dwordx4 v27, s[4:7], s41 offen offset:3072 lds
s_add_u32 s41, s41, 128
s_add_u32 s43, s43, 49152
s_cmp_ge_u32 s43, 163840
s_cselect_b32 s43, 16384, s43
s_waitcnt lgkmcnt(0)
s_waitcnt vmcnt(15)
s_barrier
v_mfma_f32_32x32x16_bf16 a[64:79], a[232:235], a[216:219], a[64:79]
v_add_u32 v8, s44, v16
v_add_u32 v12, s44, v20
v_add_u32 v9, s44, v17
v_add_u32 v13, s44, v21
v_add_u32 v10, s44, v18
v_add_u32 v14, s44, v22
v_add_u32 v11, s44, v19
v_add_u32 v15, s44, v23
ds_read_b128 a[208:211], v8 offset:0
ds_read_b64_tr_b16 a[192:193], v12 offset:0
v_mfma_f32_32x32x16_bf16 a[128:143], a[236:239], a[216:219], a[128:143]
ds_read_b64_tr_b16 a[194:195], v12 offset:1024
ds_read_b128 a[212:215], v8 offset:4096
s_add_u32 s44, s44, 49152
s_cmp_ge_u32 s44, 163840
s_cselect_b32 s44, 16384, s44
v_mfma_f32_32x32x16_bf16 a[80:95], a[232:235], a[220:223], a[80:95]
ds_read_b64_tr_b16 a[196:197], v13 offset:0
ds_read_b64_tr_b16 a[198:199], v13 offset:1024
v_mfma_f32_32x32x16_bf16 a[144:159], a[236:239], a[220:223], a[144:159]
ds_read_b64_tr_b16 a[200:201], v14 offset:0
ds_read_b64_tr_b16 a[202:203], v14 offset:1024
v_lshrrev_b32 v58, 5, v204
v_lshlrev_b32 v58, 13, v58
v_bfe_u32 v59, v204, 4, 1
v_lshl_add_u32 v58, v59, 7, v58
s_lshl_b32 s32, s20, 4
s_lshl_b32 s49, s22, 6
s_add_u32 s32, s32, s49
s_lshl_b32 s32, s32, 13
s_lshl_b32 s49, s21, 8
s_add_u32 s32, s32, s49
s_and_b32 s49, s21, 3
s_cmp_eq_u32 s49, 2
s_cselect_b32 exec_lo, -1, 0
s_mov_b32 exec_hi, 0
buffer_load_dword v253, v58, s[60:63], s32 offen
s_mov_b64 exec, -1
v_mfma_f32_32x32x16_bf16 a[96:111], a[232:235], a[224:227], a[96:111]
ds_read_b64_tr_b16 a[204:205], v15 offset:0
ds_read_b64_tr_b16 a[206:207], v15 offset:1024
v_mfma_f32_32x32x16_bf16 a[160:175], a[236:239], a[224:227], a[160:175]
s_add_u32 m0, s43, s45
s_nop 0
buffer_load_dwordx4 v28, s[92:95], s42 offen lds
v_mfma_f32_32x32x16_bf16 a[112:127], a[232:235], a[228:231], a[112:127]
buffer_load_dwordx4 v29, s[92:95], s42 offen offset:1024 lds
v_mfma_f32_32x32x16_bf16 a[176:191], a[236:239], a[228:231], a[176:191]
buffer_load_dwordx4 v30, s[92:95], s42 offen offset:2048 lds
s_waitcnt lgkmcnt(7)
v_mfma_f32_32x32x16_bf16 a[64:79], a[208:211], a[192:195], a[64:79]
ds_read_b128 a[232:235], v9 offset:0
ds_read_b64_tr_b16 a[216:217], v12 offset:4096
s_waitcnt lgkmcnt(8)
v_mfma_f32_32x32x16_bf16 a[128:143], a[212:215], a[192:195], a[128:143]
ds_read_b64_tr_b16 a[218:219], v12 offset:5120
ds_read_b128 a[236:239], v9 offset:4096
v_pk_mul_f32 v[144:145], v[144:145], v[2:3]
v_pk_mul_f32 v[146:147], v[146:147], v[2:3]
v_pk_mul_f32 v[148:149], v[148:149], v[2:3]
v_pk_mul_f32 v[150:151], v[150:151], v[2:3]
s_waitcnt lgkmcnt(8)
v_mfma_f32_32x32x16_bf16 a[80:95], a[208:211], a[196:199], a[80:95]
ds_read_b64_tr_b16 a[220:221], v13 offset:4096
ds_read_b64_tr_b16 a[222:223], v13 offset:5120
v_mfma_f32_32x32x16_bf16 a[144:159], a[212:215], a[196:199], a[144:159]
ds_read_b64_tr_b16 a[224:225], v14 offset:4096
ds_read_b64_tr_b16 a[226:227], v14 offset:5120
s_waitcnt lgkmcnt(10)
v_mfma_f32_32x32x16_bf16 a[96:111], a[208:211], a[200:203], a[96:111]
ds_read_b64_tr_b16 a[228:229], v15 offset:4096
ds_read_b64_tr_b16 a[230:231], v15 offset:5120
v_cvt_pk_bf16_f32 v144, v144, v145
v_cvt_pk_bf16_f32 v145, v146, v147
v_cvt_pk_bf16_f32 v146, v148, v149
v_cvt_pk_bf16_f32 v147, v150, v151
buffer_store_dwordx4 v[144:147], v204, s[16:19], s52 offen offset:2048
v_mfma_f32_32x32x16_bf16 a[160:175], a[212:215], a[200:203], a[160:175]
buffer_load_dwordx4 v31, s[92:95], s42 offen offset:3072 lds
s_add_u32 s42, s42, 524288
s_waitcnt lgkmcnt(10)
v_mfma_f32_32x32x16_bf16 a[112:127], a[208:211], a[204:207], a[112:127]
s_add_u32 s47, s43, s46
s_mov_b32 m0, s47
s_nop 0
buffer_load_dwordx4 v24, s[4:7], s40 offen lds
v_mfma_f32_32x32x16_bf16 a[176:191], a[212:215], a[204:207], a[176:191]
buffer_load_dwordx4 v25, s[4:7], s40 offen offset:1024 lds
s_waitcnt lgkmcnt(7)
v_mfma_f32_32x32x16_bf16 a[64:79], a[232:235], a[216:219], a[64:79]
ds_read_b128 a[208:211], v10 offset:0
ds_read_b64_tr_b16 a[192:193], v12 offset:8192
s_waitcnt lgkmcnt(8)
v_mfma_f32_32x32x16_bf16 a[128:143], a[236:239], a[216:219], a[128:143]
ds_read_b64_tr_b16 a[194:195], v12 offset:9216
ds_read_b128 a[212:215], v10 offset:4096
s_waitcnt lgkmcnt(8)
v_mfma_f32_32x32x16_bf16 a[80:95], a[232:235], a[220:223], a[80:95]
ds_read_b64_tr_b16 a[196:197], v13 offset:8192
ds_read_b64_tr_b16 a[198:199], v13 offset:9216
v_mfma_f32_32x32x16_bf16 a[144:159], a[236:239], a[220:223], a[144:159]
ds_read_b64_tr_b16 a[200:201], v14 offset:8192
ds_read_b64_tr_b16 a[202:203], v14 offset:9216
v_pk_mul_f32 v[152:153], v[152:153], v[2:3]
v_pk_mul_f32 v[154:155], v[154:155], v[2:3]
v_pk_mul_f32 v[156:157], v[156:157], v[2:3]
v_pk_mul_f32 v[158:159], v[158:159], v[2:3]
s_waitcnt lgkmcnt(10)
v_mfma_f32_32x32x16_bf16 a[96:111], a[232:235], a[224:227], a[96:111]
ds_read_b64_tr_b16 a[204:205], v15 offset:8192
ds_read_b64_tr_b16 a[206:207], v15 offset:9216
v_mfma_f32_32x32x16_bf16 a[160:175], a[236:239], a[224:227], a[160:175]
buffer_load_dwordx4 v26, s[4:7], s40 offen offset:2048 lds
s_waitcnt lgkmcnt(10)
v_mfma_f32_32x32x16_bf16 a[112:127], a[232:235], a[228:231], a[112:127]
buffer_load_dwordx4 v27, s[4:7], s40 offen offset:3072 lds
s_add_u32 s40, s40, 128
v_mfma_f32_32x32x16_bf16 a[176:191], a[236:239], a[228:231], a[176:191]
s_add_u32 m0, s47, 4096
s_nop 0
buffer_load_dwordx4 v24, s[4:7], s41 offen lds
s_waitcnt lgkmcnt(7)
v_mfma_f32_32x32x16_bf16 a[64:79], a[208:211], a[192:195], a[64:79]
ds_read_b128 a[232:235], v11 offset:0
ds_read_b64_tr_b16 a[216:217], v12 offset:12288
s_waitcnt lgkmcnt(8)
v_mfma_f32_32x32x16_bf16 a[128:143], a[212:215], a[192:195], a[128:143]
ds_read_b64_tr_b16 a[218:219], v12 offset:13312
ds_read_b128 a[236:239], v11 offset:4096
v_cvt_pk_bf16_f32 v152, v152, v153
v_cvt_pk_bf16_f32 v153, v154, v155
v_cvt_pk_bf16_f32 v154, v156, v157
v_cvt_pk_bf16_f32 v155, v158, v159
buffer_store_dwordx4 v[152:155], v204, s[16:19], s52 offen offset:3072
s_waitcnt lgkmcnt(8)
v_mfma_f32_32x32x16_bf16 a[80:95], a[208:211], a[196:199], a[80:95]
ds_read_b64_tr_b16 a[220:221], v13 offset:12288
ds_read_b64_tr_b16 a[222:223], v13 offset:13312
v_mfma_f32_32x32x16_bf16 a[144:159], a[212:215], a[196:199], a[144:159]
ds_read_b64_tr_b16 a[224:225], v14 offset:12288
ds_read_b64_tr_b16 a[226:227], v14 offset:13312
s_waitcnt lgkmcnt(10)
v_mfma_f32_32x32x16_bf16 a[96:111], a[208:211], a[200:203], a[96:111]
ds_read_b64_tr_b16 a[228:229], v15 offset:12288
ds_read_b64_tr_b16 a[230:231], v15 offset:13312
v_mfma_f32_32x32x16_bf16 a[160:175], a[212:215], a[200:203], a[160:175]
buffer_load_dwordx4 v25, s[4:7], s41 offen offset:1024 lds
s_waitcnt lgkmcnt(10)
v_mfma_f32_32x32x16_bf16 a[112:127], a[208:211], a[204:207], a[112:127]
buffer_load_dwordx4 v26, s[4:7], s41 offen offset:2048 lds
v_mfma_f32_32x32x16_bf16 a[176:191], a[212:215], a[204:207], a[176:191]
buffer_load_dwordx4 v27, s[4:7], s41 offen offset:3072 lds
s_add_u32 s41, s41, 128
s_add_u32 s43, s43, 49152
s_cmp_ge_u32 s43, 163840
s_cselect_b32 s43, 16384, s43
s_waitcnt lgkmcnt(0)
s_waitcnt vmcnt(15)
s_barrier
v_mfma_f32_32x32x16_bf16 a[64:79], a[232:235], a[216:219], a[64:79]
v_add_u32 v8, s44, v16
v_add_u32 v12, s44, v20
v_add_u32 v9, s44, v17
v_add_u32 v13, s44, v21
v_add_u32 v10, s44, v18
v_add_u32 v14, s44, v22
v_add_u32 v11, s44, v19
v_add_u32 v15, s44, v23
ds_read_b128 a[208:211], v8 offset:0
ds_read_b64_tr_b16 a[192:193], v12 offset:0
v_mfma_f32_32x32x16_bf16 a[128:143], a[236:239], a[216:219], a[128:143]
ds_read_b64_tr_b16 a[194:195], v12 offset:1024
ds_read_b128 a[212:215], v8 offset:4096
s_add_u32 s44, s44, 49152
s_cmp_ge_u32 s44, 163840
s_cselect_b32 s44, 16384, s44
v_mfma_f32_32x32x16_bf16 a[80:95], a[232:235], a[220:223], a[80:95]
ds_read_b64_tr_b16 a[196:197], v13 offset:0
ds_read_b64_tr_b16 a[198:199], v13 offset:1024
v_mfma_f32_32x32x16_bf16 a[144:159], a[236:239], a[220:223], a[144:159]
ds_read_b64_tr_b16 a[200:201], v14 offset:0
ds_read_b64_tr_b16 a[202:203], v14 offset:1024
v_lshrrev_b32 v58, 5, v204
v_lshlrev_b32 v58, 13, v58
v_bfe_u32 v59, v204, 4, 1
v_lshl_add_u32 v58, v59, 7, v58
s_lshl_b32 s32, s20, 4
s_lshl_b32 s49, s22, 6
s_add_u32 s32, s32, s49
s_lshl_b32 s32, s32, 13
s_lshl_b32 s49, s21, 8
s_add_u32 s32, s32, s49
s_and_b32 s49, s21, 3
s_cmp_eq_u32 s49, 3
s_cselect_b32 exec_lo, -1, 0
s_mov_b32 exec_hi, 0
buffer_load_dword v253, v58, s[60:63], s32 offen
s_mov_b64 exec, -1
v_mfma_f32_32x32x16_bf16 a[96:111], a[232:235], a[224:227], a[96:111]
ds_read_b64_tr_b16 a[204:205], v15 offset:0
ds_read_b64_tr_b16 a[206:207], v15 offset:1024
v_mfma_f32_32x32x16_bf16 a[160:175], a[236:239], a[224:227], a[160:175]
s_add_u32 m0, s43, s45
s_nop 0
buffer_load_dwordx4 v28, s[92:95], s42 offen lds
v_mfma_f32_32x32x16_bf16 a[112:127], a[232:235], a[228:231], a[112:127]
buffer_load_dwordx4 v29, s[92:95], s42 offen offset:1024 lds
v_mfma_f32_32x32x16_bf16 a[176:191], a[236:239], a[228:231], a[176:191]
buffer_load_dwordx4 v30, s[92:95], s42 offen offset:2048 lds
s_waitcnt lgkmcnt(7)
v_mfma_f32_32x32x16_bf16 a[64:79], a[208:211], a[192:195], a[64:79]
ds_read_b128 a[232:235], v9 offset:0
ds_read_b64_tr_b16 a[216:217], v12 offset:4096
s_waitcnt lgkmcnt(8)
v_mfma_f32_32x32x16_bf16 a[128:143], a[212:215], a[192:195], a[128:143]
ds_read_b64_tr_b16 a[218:219], v12 offset:5120
ds_read_b128 a[236:239], v9 offset:4096
v_pk_mul_f32 v[96:97], v[96:97], v[2:3]
v_pk_mul_f32 v[98:99], v[98:99], v[2:3]
v_pk_mul_f32 v[100:101], v[100:101], v[2:3]
v_pk_mul_f32 v[102:103], v[102:103], v[2:3]
s_waitcnt lgkmcnt(8)
v_mfma_f32_32x32x16_bf16 a[80:95], a[208:211], a[196:199], a[80:95]
ds_read_b64_tr_b16 a[220:221], v13 offset:4096
ds_read_b64_tr_b16 a[222:223], v13 offset:5120
v_mfma_f32_32x32x16_bf16 a[144:159], a[212:215], a[196:199], a[144:159]
ds_read_b64_tr_b16 a[224:225], v14 offset:4096
ds_read_b64_tr_b16 a[226:227], v14 offset:5120
s_waitcnt lgkmcnt(10)
v_mfma_f32_32x32x16_bf16 a[96:111], a[208:211], a[200:203], a[96:111]
ds_read_b64_tr_b16 a[228:229], v15 offset:4096
ds_read_b64_tr_b16 a[230:231], v15 offset:5120
v_cvt_pk_bf16_f32 v96, v96, v97
v_cvt_pk_bf16_f32 v97, v98, v99
v_cvt_pk_bf16_f32 v98, v100, v101
v_cvt_pk_bf16_f32 v99, v102, v103
buffer_store_dwordx4 v[96:99], v204, s[16:19], s51 offen offset:0
v_mfma_f32_32x32x16_bf16 a[160:175], a[212:215], a[200:203], a[160:175]
buffer_load_dwordx4 v31, s[92:95], s42 offen offset:3072 lds
s_add_u32 s42, s42, 524288
s_waitcnt lgkmcnt(10)
v_mfma_f32_32x32x16_bf16 a[112:127], a[208:211], a[204:207], a[112:127]
s_add_u32 s47, s43, s46
s_mov_b32 m0, s47
s_nop 0
buffer_load_dwordx4 v24, s[4:7], s40 offen lds
v_mfma_f32_32x32x16_bf16 a[176:191], a[212:215], a[204:207], a[176:191]
buffer_load_dwordx4 v25, s[4:7], s40 offen offset:1024 lds
s_waitcnt lgkmcnt(7)
v_mfma_f32_32x32x16_bf16 a[64:79], a[232:235], a[216:219], a[64:79]
ds_read_b128 a[208:211], v10 offset:0
ds_read_b64_tr_b16 a[192:193], v12 offset:8192
s_waitcnt lgkmcnt(8)
v_mfma_f32_32x32x16_bf16 a[128:143], a[236:239], a[216:219], a[128:143]
ds_read_b64_tr_b16 a[194:195], v12 offset:9216
ds_read_b128 a[212:215], v10 offset:4096
s_waitcnt lgkmcnt(8)
v_mfma_f32_32x32x16_bf16 a[80:95], a[232:235], a[220:223], a[80:95]
ds_read_b64_tr_b16 a[196:197], v13 offset:8192
ds_read_b64_tr_b16 a[198:199], v13 offset:9216
v_mfma_f32_32x32x16_bf16 a[144:159], a[236:239], a[220:223], a[144:159]
ds_read_b64_tr_b16 a[200:201], v14 offset:8192
ds_read_b64_tr_b16 a[202:203], v14 offset:9216
v_pk_mul_f32 v[104:105], v[104:105], v[2:3]
v_pk_mul_f32 v[106:107], v[106:107], v[2:3]
v_pk_mul_f32 v[108:109], v[108:109], v[2:3]
v_pk_mul_f32 v[110:111], v[110:111], v[2:3]
s_waitcnt lgkmcnt(10)
v_mfma_f32_32x32x16_bf16 a[96:111], a[232:235], a[224:227], a[96:111]
ds_read_b64_tr_b16 a[204:205], v15 offset:8192
ds_read_b64_tr_b16 a[206:207], v15 offset:9216
v_mfma_f32_32x32x16_bf16 a[160:175], a[236:239], a[224:227], a[160:175]
buffer_load_dwordx4 v26, s[4:7], s40 offen offset:2048 lds
s_waitcnt lgkmcnt(10)
v_mfma_f32_32x32x16_bf16 a[112:127], a[232:235], a[228:231], a[112:127]
buffer_load_dwordx4 v27, s[4:7], s40 offen offset:3072 lds
s_add_u32 s40, s40, 128
v_mfma_f32_32x32x16_bf16 a[176:191], a[236:239], a[228:231], a[176:191]
s_add_u32 m0, s47, 4096
s_nop 0
buffer_load_dwordx4 v24, s[4:7], s41 offen lds
s_waitcnt lgkmcnt(7)
v_mfma_f32_32x32x16_bf16 a[64:79], a[208:211], a[192:195], a[64:79]
ds_read_b128 a[232:235], v11 offset:0
ds_read_b64_tr_b16 a[216:217], v12 offset:12288
s_waitcnt lgkmcnt(8)
v_mfma_f32_32x32x16_bf16 a[128:143], a[212:215], a[192:195], a[128:143]
ds_read_b64_tr_b16 a[218:219], v12 offset:13312
ds_read_b128 a[236:239], v11 offset:4096
v_cvt_pk_bf16_f32 v104, v104, v105
v_cvt_pk_bf16_f32 v105, v106, v107
v_cvt_pk_bf16_f32 v106, v108, v109
v_cvt_pk_bf16_f32 v107, v110, v111
buffer_store_dwordx4 v[104:107], v204, s[16:19], s51 offen offset:1024
s_waitcnt lgkmcnt(8)
v_mfma_f32_32x32x16_bf16 a[80:95], a[208:211], a[196:199], a[80:95]
ds_read_b64_tr_b16 a[220:221], v13 offset:12288
ds_read_b64_tr_b16 a[222:223], v13 offset:13312
v_mfma_f32_32x32x16_bf16 a[144:159], a[212:215], a[196:199], a[144:159]
ds_read_b64_tr_b16 a[224:225], v14 offset:12288
ds_read_b64_tr_b16 a[226:227], v14 offset:13312
s_waitcnt lgkmcnt(10)
v_mfma_f32_32x32x16_bf16 a[96:111], a[208:211], a[200:203], a[96:111]
ds_read_b64_tr_b16 a[228:229], v15 offset:12288
ds_read_b64_tr_b16 a[230:231], v15 offset:13312
v_mfma_f32_32x32x16_bf16 a[160:175], a[212:215], a[200:203], a[160:175]
buffer_load_dwordx4 v25, s[4:7], s41 offen offset:1024 lds
s_waitcnt lgkmcnt(10)
v_mfma_f32_32x32x16_bf16 a[112:127], a[208:211], a[204:207], a[112:127]
buffer_load_dwordx4 v26, s[4:7], s41 offen offset:2048 lds
v_mfma_f32_32x32x16_bf16 a[176:191], a[212:215], a[204:207], a[176:191]
buffer_load_dwordx4 v27, s[4:7], s41 offen offset:3072 lds
s_add_u32 s41, s41, 128
s_add_u32 s43, s43, 49152
s_cmp_ge_u32 s43, 163840
s_cselect_b32 s43, 16384, s43
s_waitcnt lgkmcnt(0)
s_waitcnt vmcnt(15)
s_barrier
v_mfma_f32_32x32x16_bf16 a[64:79], a[232:235], a[216:219], a[64:79]
v_add_u32 v8, s44, v16
v_add_u32 v12, s44, v20
v_add_u32 v9, s44, v17
v_add_u32 v13, s44, v21
v_add_u32 v10, s44, v18
v_add_u32 v14, s44, v22
v_add_u32 v11, s44, v19
v_add_u32 v15, s44, v23
ds_read_b128 a[208:211], v8 offset:0
ds_read_b64_tr_b16 a[192:193], v12 offset:0
v_mfma_f32_32x32x16_bf16 a[128:143], a[236:239], a[216:219], a[128:143]
ds_read_b64_tr_b16 a[194:195], v12 offset:1024
ds_read_b128 a[212:215], v8 offset:4096
s_add_u32 s44, s44, 49152
s_cmp_ge_u32 s44, 163840
s_cselect_b32 s44, 16384, s44
v_mfma_f32_32x32x16_bf16 a[80:95], a[232:235], a[220:223], a[80:95]
ds_read_b64_tr_b16 a[196:197], v13 offset:0
ds_read_b64_tr_b16 a[198:199], v13 offset:1024
v_mfma_f32_32x32x16_bf16 a[144:159], a[236:239], a[220:223], a[144:159]
ds_read_b64_tr_b16 a[200:201], v14 offset:0
ds_read_b64_tr_b16 a[202:203], v14 offset:1024
v_mfma_f32_32x32x16_bf16 a[96:111], a[232:235], a[224:227], a[96:111]
ds_read_b64_tr_b16 a[204:205], v15 offset:0
ds_read_b64_tr_b16 a[206:207], v15 offset:1024
v_mfma_f32_32x32x16_bf16 a[160:175], a[236:239], a[224:227], a[160:175]
s_add_u32 m0, s43, s45
s_nop 0
buffer_load_dwordx4 v28, s[92:95], s42 offen lds
v_mfma_f32_32x32x16_bf16 a[112:127], a[232:235], a[228:231], a[112:127]
buffer_load_dwordx4 v29, s[92:95], s42 offen offset:1024 lds
v_mfma_f32_32x32x16_bf16 a[176:191], a[236:239], a[228:231], a[176:191]
buffer_load_dwordx4 v30, s[92:95], s42 offen offset:2048 lds
s_waitcnt lgkmcnt(7)
v_mfma_f32_32x32x16_bf16 a[64:79], a[208:211], a[192:195], a[64:79]
ds_read_b128 a[232:235], v9 offset:0
ds_read_b64_tr_b16 a[216:217], v12 offset:4096
s_waitcnt lgkmcnt(8)
v_mfma_f32_32x32x16_bf16 a[128:143], a[212:215], a[192:195], a[128:143]
ds_read_b64_tr_b16 a[218:219], v12 offset:5120
ds_read_b128 a[236:239], v9 offset:4096
v_pk_mul_f32 v[160:161], v[160:161], v[2:3]
v_pk_mul_f32 v[162:163], v[162:163], v[2:3]
v_pk_mul_f32 v[164:165], v[164:165], v[2:3]
v_pk_mul_f32 v[166:167], v[166:167], v[2:3]
s_waitcnt lgkmcnt(8)
v_mfma_f32_32x32x16_bf16 a[80:95], a[208:211], a[196:199], a[80:95]
ds_read_b64_tr_b16 a[220:221], v13 offset:4096
ds_read_b64_tr_b16 a[222:223], v13 offset:5120
v_mfma_f32_32x32x16_bf16 a[144:159], a[212:215], a[196:199], a[144:159]
ds_read_b64_tr_b16 a[224:225], v14 offset:4096
ds_read_b64_tr_b16 a[226:227], v14 offset:5120
s_waitcnt lgkmcnt(10)
v_mfma_f32_32x32x16_bf16 a[96:111], a[208:211], a[200:203], a[96:111]
ds_read_b64_tr_b16 a[228:229], v15 offset:4096
ds_read_b64_tr_b16 a[230:231], v15 offset:5120
v_cvt_pk_bf16_f32 v160, v160, v161
v_cvt_pk_bf16_f32 v161, v162, v163
v_cvt_pk_bf16_f32 v162, v164, v165
v_cvt_pk_bf16_f32 v163, v166, v167
buffer_store_dwordx4 v[160:163], v204, s[16:19], s53 offen offset:0
v_mfma_f32_32x32x16_bf16 a[160:175], a[212:215], a[200:203], a[160:175]
buffer_load_dwordx4 v31, s[92:95], s42 offen offset:3072 lds
s_add_u32 s42, s42, 524288
s_waitcnt lgkmcnt(10)
v_mfma_f32_32x32x16_bf16 a[112:127], a[208:211], a[204:207], a[112:127]
s_add_u32 s47, s43, s46
s_mov_b32 m0, s47
s_nop 0
buffer_load_dwordx4 v24, s[4:7], s40 offen lds
v_mfma_f32_32x32x16_bf16 a[176:191], a[212:215], a[204:207], a[176:191]
buffer_load_dwordx4 v25, s[4:7], s40 offen offset:1024 lds
s_waitcnt lgkmcnt(7)
v_mfma_f32_32x32x16_bf16 a[64:79], a[232:235], a[216:219], a[64:79]
ds_read_b128 a[208:211], v10 offset:0
ds_read_b64_tr_b16 a[192:193], v12 offset:8192
s_waitcnt lgkmcnt(8)
v_mfma_f32_32x32x16_bf16 a[128:143], a[236:239], a[216:219], a[128:143]
ds_read_b64_tr_b16 a[194:195], v12 offset:9216
ds_read_b128 a[212:215], v10 offset:4096
s_waitcnt lgkmcnt(8)
v_mfma_f32_32x32x16_bf16 a[80:95], a[232:235], a[220:223], a[80:95]
ds_read_b64_tr_b16 a[196:197], v13 offset:8192
ds_read_b64_tr_b16 a[198:199], v13 offset:9216
v_mfma_f32_32x32x16_bf16 a[144:159], a[236:239], a[220:223], a[144:159]
ds_read_b64_tr_b16 a[200:201], v14 offset:8192
ds_read_b64_tr_b16 a[202:203], v14 offset:9216
v_pk_mul_f32 v[168:169], v[168:169], v[2:3]
v_pk_mul_f32 v[170:171], v[170:171], v[2:3]
v_pk_mul_f32 v[172:173], v[172:173], v[2:3]
v_pk_mul_f32 v[174:175], v[174:175], v[2:3]
s_waitcnt lgkmcnt(10)
v_mfma_f32_32x32x16_bf16 a[96:111], a[232:235], a[224:227], a[96:111]
ds_read_b64_tr_b16 a[204:205], v15 offset:8192
ds_read_b64_tr_b16 a[206:207], v15 offset:9216
v_mfma_f32_32x32x16_bf16 a[160:175], a[236:239], a[224:227], a[160:175]
buffer_load_dwordx4 v26, s[4:7], s40 offen offset:2048 lds
s_waitcnt lgkmcnt(10)
v_mfma_f32_32x32x16_bf16 a[112:127], a[232:235], a[228:231], a[112:127]
buffer_load_dwordx4 v27, s[4:7], s40 offen offset:3072 lds
s_add_u32 s40, s40, 128
v_mfma_f32_32x32x16_bf16 a[176:191], a[236:239], a[228:231], a[176:191]
s_add_u32 m0, s47, 4096
s_nop 0
buffer_load_dwordx4 v24, s[4:7], s41 offen lds
s_waitcnt lgkmcnt(7)
v_mfma_f32_32x32x16_bf16 a[64:79], a[208:211], a[192:195], a[64:79]
ds_read_b128 a[232:235], v11 offset:0
ds_read_b64_tr_b16 a[216:217], v12 offset:12288
s_waitcnt lgkmcnt(8)
v_mfma_f32_32x32x16_bf16 a[128:143], a[212:215], a[192:195], a[128:143]
ds_read_b64_tr_b16 a[218:219], v12 offset:13312
ds_read_b128 a[236:239], v11 offset:4096
v_cvt_pk_bf16_f32 v168, v168, v169
v_cvt_pk_bf16_f32 v169, v170, v171
v_cvt_pk_bf16_f32 v170, v172, v173
v_cvt_pk_bf16_f32 v171, v174, v175
buffer_store_dwordx4 v[168:171], v204, s[16:19], s53 offen offset:1024
s_waitcnt lgkmcnt(8)
v_mfma_f32_32x32x16_bf16 a[80:95], a[208:211], a[196:199], a[80:95]
ds_read_b64_tr_b16 a[220:221], v13 offset:12288
ds_read_b64_tr_b16 a[222:223], v13 offset:13312
v_mfma_f32_32x32x16_bf16 a[144:159], a[212:215], a[196:199], a[144:159]
ds_read_b64_tr_b16 a[224:225], v14 offset:12288
ds_read_b64_tr_b16 a[226:227], v14 offset:13312
s_waitcnt lgkmcnt(10)
v_mfma_f32_32x32x16_bf16 a[96:111], a[208:211], a[200:203], a[96:111]
ds_read_b64_tr_b16 a[228:229], v15 offset:12288
ds_read_b64_tr_b16 a[230:231], v15 offset:13312
v_mfma_f32_32x32x16_bf16 a[160:175], a[212:215], a[200:203], a[160:175]
buffer_load_dwordx4 v25, s[4:7], s41 offen offset:1024 lds
s_waitcnt lgkmcnt(10)
v_mfma_f32_32x32x16_bf16 a[112:127], a[208:211], a[204:207], a[112:127]
buffer_load_dwordx4 v26, s[4:7], s41 offen offset:2048 lds
v_mfma_f32_32x32x16_bf16 a[176:191], a[212:215], a[204:207], a[176:191]
buffer_load_dwordx4 v27, s[4:7], s41 offen offset:3072 lds
s_add_u32 s41, s41, 128
s_add_u32 s43, s43, 49152
s_cmp_ge_u32 s43, 163840
s_cselect_b32 s43, 16384, s43
s_waitcnt lgkmcnt(0)
s_waitcnt vmcnt(14)
s_barrier
v_mfma_f32_32x32x16_bf16 a[64:79], a[232:235], a[216:219], a[64:79]
v_add_u32 v8, s44, v16
v_add_u32 v12, s44, v20
v_add_u32 v9, s44, v17
v_add_u32 v13, s44, v21
v_add_u32 v10, s44, v18
v_add_u32 v14, s44, v22
v_add_u32 v11, s44, v19
v_add_u32 v15, s44, v23
ds_read_b128 a[208:211], v8 offset:0
ds_read_b64_tr_b16 a[192:193], v12 offset:0
v_mfma_f32_32x32x16_bf16 a[128:143], a[236:239], a[216:219], a[128:143]
ds_read_b64_tr_b16 a[194:195], v12 offset:1024
ds_read_b128 a[212:215], v8 offset:4096
s_add_u32 s44, s44, 49152
s_cmp_ge_u32 s44, 163840
s_cselect_b32 s44, 16384, s44
v_mfma_f32_32x32x16_bf16 a[80:95], a[232:235], a[220:223], a[80:95]
ds_read_b64_tr_b16 a[196:197], v13 offset:0
ds_read_b64_tr_b16 a[198:199], v13 offset:1024
v_mfma_f32_32x32x16_bf16 a[144:159], a[236:239], a[220:223], a[144:159]
ds_read_b64_tr_b16 a[200:201], v14 offset:0
ds_read_b64_tr_b16 a[202:203], v14 offset:1024
v_mfma_f32_32x32x16_bf16 a[96:111], a[232:235], a[224:227], a[96:111]
ds_read_b64_tr_b16 a[204:205], v15 offset:0
ds_read_b64_tr_b16 a[206:207], v15 offset:1024
v_mfma_f32_32x32x16_bf16 a[160:175], a[236:239], a[224:227], a[160:175]
s_lshl_b32 s40, s36, 15
s_lshl_b32 s41, s37, 15
s_lshl_b32 s42, s20, 17
s_lshl_b32 s49, s21, 8
s_add_u32 s42, s42, s49
s_add_u32 m0, s43, s45
s_nop 0
buffer_load_dwordx4 v28, s[60:63], s42 offen lds
v_mfma_f32_32x32x16_bf16 a[112:127], a[232:235], a[228:231], a[112:127]
buffer_load_dwordx4 v29, s[60:63], s42 offen offset:1024 lds
v_mfma_f32_32x32x16_bf16 a[176:191], a[236:239], a[228:231], a[176:191]
buffer_load_dwordx4 v30, s[60:63], s42 offen offset:2048 lds
s_waitcnt lgkmcnt(7)
v_mfma_f32_32x32x16_bf16 a[64:79], a[208:211], a[192:195], a[64:79]
ds_read_b128 a[232:235], v9 offset:0
ds_read_b64_tr_b16 a[216:217], v12 offset:4096
s_waitcnt lgkmcnt(8)
v_mfma_f32_32x32x16_bf16 a[128:143], a[212:215], a[192:195], a[128:143]
ds_read_b64_tr_b16 a[218:219], v12 offset:5120
ds_read_b128 a[236:239], v9 offset:4096
v_pk_mul_f32 v[112:113], v[112:113], v[2:3]
v_pk_mul_f32 v[114:115], v[114:115], v[2:3]
v_pk_mul_f32 v[116:117], v[116:117], v[2:3]
v_pk_mul_f32 v[118:119], v[118:119], v[2:3]
s_waitcnt lgkmcnt(8)
v_mfma_f32_32x32x16_bf16 a[80:95], a[208:211], a[196:199], a[80:95]
ds_read_b64_tr_b16 a[220:221], v13 offset:4096
ds_read_b64_tr_b16 a[222:223], v13 offset:5120
v_mfma_f32_32x32x16_bf16 a[144:159], a[212:215], a[196:199], a[144:159]
ds_read_b64_tr_b16 a[224:225], v14 offset:4096
ds_read_b64_tr_b16 a[226:227], v14 offset:5120
s_waitcnt lgkmcnt(10)
v_mfma_f32_32x32x16_bf16 a[96:111], a[208:211], a[200:203], a[96:111]
ds_read_b64_tr_b16 a[228:229], v15 offset:4096
ds_read_b64_tr_b16 a[230:231], v15 offset:5120
v_cvt_pk_bf16_f32 v112, v112, v113
v_cvt_pk_bf16_f32 v113, v114, v115
v_cvt_pk_bf16_f32 v114, v116, v117
v_cvt_pk_bf16_f32 v115, v118, v119
buffer_store_dwordx4 v[112:115], v204, s[16:19], s51 offen offset:2048
v_mfma_f32_32x32x16_bf16 a[160:175], a[212:215], a[200:203], a[160:175]
buffer_load_dwordx4 v31, s[60:63], s42 offen offset:3072 lds
s_add_u32 s42, s42, 524288
s_waitcnt lgkmcnt(10)
v_mfma_f32_32x32x16_bf16 a[112:127], a[208:211], a[204:207], a[112:127]
s_add_u32 s47, s43, s46
s_mov_b32 m0, s47
s_nop 0
buffer_load_dwordx4 v24, s[12:15], s40 offen lds
v_mfma_f32_32x32x16_bf16 a[176:191], a[212:215], a[204:207], a[176:191]
buffer_load_dwordx4 v25, s[12:15], s40 offen offset:1024 lds
s_waitcnt lgkmcnt(7)
v_mfma_f32_32x32x16_bf16 a[64:79], a[232:235], a[216:219], a[64:79]
ds_read_b128 a[208:211], v10 offset:0
ds_read_b64_tr_b16 a[192:193], v12 offset:8192
s_waitcnt lgkmcnt(8)
v_mfma_f32_32x32x16_bf16 a[128:143], a[236:239], a[216:219], a[128:143]
ds_read_b64_tr_b16 a[194:195], v12 offset:9216
ds_read_b128 a[212:215], v10 offset:4096
s_waitcnt lgkmcnt(8)
v_mfma_f32_32x32x16_bf16 a[80:95], a[232:235], a[220:223], a[80:95]
ds_read_b64_tr_b16 a[196:197], v13 offset:8192
ds_read_b64_tr_b16 a[198:199], v13 offset:9216
v_mfma_f32_32x32x16_bf16 a[144:159], a[236:239], a[220:223], a[144:159]
ds_read_b64_tr_b16 a[200:201], v14 offset:8192
ds_read_b64_tr_b16 a[202:203], v14 offset:9216
v_pk_mul_f32 v[120:121], v[120:121], v[2:3]
v_pk_mul_f32 v[122:123], v[122:123], v[2:3]
v_pk_mul_f32 v[124:125], v[124:125], v[2:3]
v_pk_mul_f32 v[126:127], v[126:127], v[2:3]
s_waitcnt lgkmcnt(10)
v_mfma_f32_32x32x16_bf16 a[96:111], a[232:235], a[224:227], a[96:111]
ds_read_b64_tr_b16 a[204:205], v15 offset:8192
ds_read_b64_tr_b16 a[206:207], v15 offset:9216
v_mfma_f32_32x32x16_bf16 a[160:175], a[236:239], a[224:227], a[160:175]
buffer_load_dwordx4 v26, s[12:15], s40 offen offset:2048 lds
s_waitcnt lgkmcnt(10)
v_mfma_f32_32x32x16_bf16 a[112:127], a[232:235], a[228:231], a[112:127]
buffer_load_dwordx4 v27, s[12:15], s40 offen offset:3072 lds
s_add_u32 s40, s40, 128
v_mfma_f32_32x32x16_bf16 a[176:191], a[236:239], a[228:231], a[176:191]
s_add_u32 m0, s47, 4096
s_nop 0
buffer_load_dwordx4 v24, s[12:15], s41 offen lds
s_waitcnt lgkmcnt(7)
v_mfma_f32_32x32x16_bf16 a[64:79], a[208:211], a[192:195], a[64:79]
ds_read_b128 a[232:235], v11 offset:0
ds_read_b64_tr_b16 a[216:217], v12 offset:12288
s_waitcnt lgkmcnt(8)
v_mfma_f32_32x32x16_bf16 a[128:143], a[212:215], a[192:195], a[128:143]
ds_read_b64_tr_b16 a[218:219], v12 offset:13312
ds_read_b128 a[236:239], v11 offset:4096
v_cvt_pk_bf16_f32 v120, v120, v121
v_cvt_pk_bf16_f32 v121, v122, v123
v_cvt_pk_bf16_f32 v122, v124, v125
v_cvt_pk_bf16_f32 v123, v126, v127
buffer_store_dwordx4 v[120:123], v204, s[16:19], s51 offen offset:3072
s_waitcnt lgkmcnt(8)
v_mfma_f32_32x32x16_bf16 a[80:95], a[208:211], a[196:199], a[80:95]
ds_read_b64_tr_b16 a[220:221], v13 offset:12288
ds_read_b64_tr_b16 a[222:223], v13 offset:13312
v_mfma_f32_32x32x16_bf16 a[144:159], a[212:215], a[196:199], a[144:159]
ds_read_b64_tr_b16 a[224:225], v14 offset:12288
ds_read_b64_tr_b16 a[226:227], v14 offset:13312
s_waitcnt lgkmcnt(10)
v_mfma_f32_32x32x16_bf16 a[96:111], a[208:211], a[200:203], a[96:111]
ds_read_b64_tr_b16 a[228:229], v15 offset:12288
ds_read_b64_tr_b16 a[230:231], v15 offset:13312
v_mfma_f32_32x32x16_bf16 a[160:175], a[212:215], a[200:203], a[160:175]
buffer_load_dwordx4 v25, s[12:15], s41 offen offset:1024 lds
s_waitcnt lgkmcnt(10)
v_mfma_f32_32x32x16_bf16 a[112:127], a[208:211], a[204:207], a[112:127]
buffer_load_dwordx4 v26, s[12:15], s41 offen offset:2048 lds
v_mfma_f32_32x32x16_bf16 a[176:191], a[212:215], a[204:207], a[176:191]
buffer_load_dwordx4 v27, s[12:15], s41 offen offset:3072 lds
s_add_u32 s41, s41, 128
s_add_u32 s43, s43, 49152
s_cmp_ge_u32 s43, 163840
s_cselect_b32 s43, 16384, s43
s_waitcnt lgkmcnt(0)
s_waitcnt vmcnt(14)
s_barrier
v_mfma_f32_32x32x16_bf16 a[64:79], a[232:235], a[216:219], a[64:79]
v_add_u32 v8, s44, v16
v_add_u32 v12, s44, v20
v_add_u32 v9, s44, v17
v_add_u32 v13, s44, v21
v_add_u32 v10, s44, v18
v_add_u32 v14, s44, v22
v_add_u32 v11, s44, v19
v_add_u32 v15, s44, v23
ds_read_b128 a[208:211], v8 offset:0
ds_read_b64_tr_b16 a[192:193], v12 offset:0
v_mfma_f32_32x32x16_bf16 a[128:143], a[236:239], a[216:219], a[128:143]
ds_read_b64_tr_b16 a[194:195], v12 offset:1024
ds_read_b128 a[212:215], v8 offset:4096
s_add_u32 s44, s44, 49152
s_cmp_ge_u32 s44, 163840
s_cselect_b32 s44, 16384, s44
v_mfma_f32_32x32x16_bf16 a[80:95], a[232:235], a[220:223], a[80:95]
ds_read_b64_tr_b16 a[196:197], v13 offset:0
ds_read_b64_tr_b16 a[198:199], v13 offset:1024
v_mfma_f32_32x32x16_bf16 a[144:159], a[236:239], a[220:223], a[144:159]
ds_read_b64_tr_b16 a[200:201], v14 offset:0
ds_read_b64_tr_b16 a[202:203], v14 offset:1024
v_mfma_f32_32x32x16_bf16 a[96:111], a[232:235], a[224:227], a[96:111]
ds_read_b64_tr_b16 a[204:205], v15 offset:0
ds_read_b64_tr_b16 a[206:207], v15 offset:1024
v_mfma_f32_32x32x16_bf16 a[160:175], a[236:239], a[224:227], a[160:175]
s_add_u32 m0, s43, s45
s_nop 0
buffer_load_dwordx4 v28, s[60:63], s42 offen lds
v_mfma_f32_32x32x16_bf16 a[112:127], a[232:235], a[228:231], a[112:127]
buffer_load_dwordx4 v29, s[60:63], s42 offen offset:1024 lds
v_mfma_f32_32x32x16_bf16 a[176:191], a[236:239], a[228:231], a[176:191]
buffer_load_dwordx4 v30, s[60:63], s42 offen offset:2048 lds
s_waitcnt lgkmcnt(7)
v_mfma_f32_32x32x16_bf16 a[64:79], a[208:211], a[192:195], a[64:79]
ds_read_b128 a[232:235], v9 offset:0
ds_read_b64_tr_b16 a[216:217], v12 offset:4096
s_waitcnt lgkmcnt(8)
v_mfma_f32_32x32x16_bf16 a[128:143], a[212:215], a[192:195], a[128:143]
ds_read_b64_tr_b16 a[218:219], v12 offset:5120
ds_read_b128 a[236:239], v9 offset:4096
v_pk_mul_f32 v[176:177], v[176:177], v[2:3]
v_pk_mul_f32 v[178:179], v[178:179], v[2:3]
v_pk_mul_f32 v[180:181], v[180:181], v[2:3]
v_pk_mul_f32 v[182:183], v[182:183], v[2:3]
s_waitcnt lgkmcnt(8)
v_mfma_f32_32x32x16_bf16 a[80:95], a[208:211], a[196:199], a[80:95]
ds_read_b64_tr_b16 a[220:221], v13 offset:4096
ds_read_b64_tr_b16 a[222:223], v13 offset:5120
v_mfma_f32_32x32x16_bf16 a[144:159], a[212:215], a[196:199], a[144:159]
ds_read_b64_tr_b16 a[224:225], v14 offset:4096
ds_read_b64_tr_b16 a[226:227], v14 offset:5120
s_waitcnt lgkmcnt(10)
v_mfma_f32_32x32x16_bf16 a[96:111], a[208:211], a[200:203], a[96:111]
ds_read_b64_tr_b16 a[228:229], v15 offset:4096
ds_read_b64_tr_b16 a[230:231], v15 offset:5120
v_cvt_pk_bf16_f32 v176, v176, v177
v_cvt_pk_bf16_f32 v177, v178, v179
v_cvt_pk_bf16_f32 v178, v180, v181
v_cvt_pk_bf16_f32 v179, v182, v183
buffer_store_dwordx4 v[176:179], v204, s[16:19], s53 offen offset:2048
v_mfma_f32_32x32x16_bf16 a[160:175], a[212:215], a[200:203], a[160:175]
buffer_load_dwordx4 v31, s[60:63], s42 offen offset:3072 lds
s_add_u32 s42, s42, 524288
s_waitcnt lgkmcnt(10)
v_mfma_f32_32x32x16_bf16 a[112:127], a[208:211], a[204:207], a[112:127]
s_add_u32 s47, s43, s46
s_mov_b32 m0, s47
s_nop 0
buffer_load_dwordx4 v24, s[12:15], s40 offen lds
v_mfma_f32_32x32x16_bf16 a[176:191], a[212:215], a[204:207], a[176:191]
buffer_load_dwordx4 v25, s[12:15], s40 offen offset:1024 lds
s_waitcnt lgkmcnt(7)
v_mfma_f32_32x32x16_bf16 a[64:79], a[232:235], a[216:219], a[64:79]
ds_read_b128 a[208:211], v10 offset:0
ds_read_b64_tr_b16 a[192:193], v12 offset:8192
s_waitcnt lgkmcnt(8)
v_mfma_f32_32x32x16_bf16 a[128:143], a[236:239], a[216:219], a[128:143]
ds_read_b64_tr_b16 a[194:195], v12 offset:9216
ds_read_b128 a[212:215], v10 offset:4096
s_waitcnt lgkmcnt(8)
v_mfma_f32_32x32x16_bf16 a[80:95], a[232:235], a[220:223], a[80:95]
ds_read_b64_tr_b16 a[196:197], v13 offset:8192
ds_read_b64_tr_b16 a[198:199], v13 offset:9216
v_mfma_f32_32x32x16_bf16 a[144:159], a[236:239], a[220:223], a[144:159]
ds_read_b64_tr_b16 a[200:201], v14 offset:8192
ds_read_b64_tr_b16 a[202:203], v14 offset:9216
v_pk_mul_f32 v[184:185], v[184:185], v[2:3]
v_pk_mul_f32 v[186:187], v[186:187], v[2:3]
v_pk_mul_f32 v[188:189], v[188:189], v[2:3]
v_pk_mul_f32 v[190:191], v[190:191], v[2:3]
s_waitcnt lgkmcnt(10)
v_mfma_f32_32x32x16_bf16 a[96:111], a[232:235], a[224:227], a[96:111]
ds_read_b64_tr_b16 a[204:205], v15 offset:8192
ds_read_b64_tr_b16 a[206:207], v15 offset:9216
v_mfma_f32_32x32x16_bf16 a[160:175], a[236:239], a[224:227], a[160:175]
buffer_load_dwordx4 v26, s[12:15], s40 offen offset:2048 lds
s_waitcnt lgkmcnt(10)
v_mfma_f32_32x32x16_bf16 a[112:127], a[232:235], a[228:231], a[112:127]
buffer_load_dwordx4 v27, s[12:15], s40 offen offset:3072 lds
s_add_u32 s40, s40, 128
v_mfma_f32_32x32x16_bf16 a[176:191], a[236:239], a[228:231], a[176:191]
s_add_u32 m0, s47, 4096
s_nop 0
buffer_load_dwordx4 v24, s[12:15], s41 offen lds
s_waitcnt lgkmcnt(7)
v_mfma_f32_32x32x16_bf16 a[64:79], a[208:211], a[192:195], a[64:79]
ds_read_b128 a[232:235], v11 offset:0
ds_read_b64_tr_b16 a[216:217], v12 offset:12288
s_waitcnt lgkmcnt(8)
v_mfma_f32_32x32x16_bf16 a[128:143], a[212:215], a[192:195], a[128:143]
ds_read_b64_tr_b16 a[218:219], v12 offset:13312
ds_read_b128 a[236:239], v11 offset:4096
v_cvt_pk_bf16_f32 v184, v184, v185
v_cvt_pk_bf16_f32 v185, v186, v187
v_cvt_pk_bf16_f32 v186, v188, v189
v_cvt_pk_bf16_f32 v187, v190, v191
buffer_store_dwordx4 v[184:187], v204, s[16:19], s53 offen offset:3072
s_waitcnt lgkmcnt(8)
v_mfma_f32_32x32x16_bf16 a[80:95], a[208:211], a[196:199], a[80:95]
ds_read_b64_tr_b16 a[220:221], v13 offset:12288
ds_read_b64_tr_b16 a[222:223], v13 offset:13312
v_mfma_f32_32x32x16_bf16 a[144:159], a[212:215], a[196:199], a[144:159]
ds_read_b64_tr_b16 a[224:225], v14 offset:12288
ds_read_b64_tr_b16 a[226:227], v14 offset:13312
s_waitcnt lgkmcnt(10)
v_mfma_f32_32x32x16_bf16 a[96:111], a[208:211], a[200:203], a[96:111]
ds_read_b64_tr_b16 a[228:229], v15 offset:12288
ds_read_b64_tr_b16 a[230:231], v15 offset:13312
v_mfma_f32_32x32x16_bf16 a[160:175], a[212:215], a[200:203], a[160:175]
buffer_load_dwordx4 v25, s[12:15], s41 offen offset:1024 lds
s_waitcnt lgkmcnt(10)
v_mfma_f32_32x32x16_bf16 a[112:127], a[208:211], a[204:207], a[112:127]
buffer_load_dwordx4 v26, s[12:15], s41 offen offset:2048 lds
v_mfma_f32_32x32x16_bf16 a[176:191], a[212:215], a[204:207], a[176:191]
buffer_load_dwordx4 v27, s[12:15], s41 offen offset:3072 lds
s_add_u32 s41, s41, 128
s_add_u32 s43, s43, 49152
s_cmp_ge_u32 s43, 163840
s_cselect_b32 s43, 16384, s43
s_waitcnt lgkmcnt(0)
s_waitcnt vmcnt(14)
s_barrier
v_mfma_f32_32x32x16_bf16 a[64:79], a[232:235], a[216:219], a[64:79]
v_add_u32 v8, s44, v16
v_add_u32 v12, s44, v20
v_add_u32 v9, s44, v17
v_add_u32 v13, s44, v21
v_add_u32 v10, s44, v18
v_add_u32 v14, s44, v22
v_add_u32 v11, s44, v19
v_add_u32 v15, s44, v23
ds_read_b128 a[208:211], v8 offset:0
ds_read_b64_tr_b16 a[192:193], v12 offset:0
v_mfma_f32_32x32x16_bf16 a[128:143], a[236:239], a[216:219], a[128:143]
ds_read_b64_tr_b16 a[194:195], v12 offset:1024
ds_read_b128 a[212:215], v8 offset:4096
s_add_u32 s44, s44, 49152
s_cmp_ge_u32 s44, 163840
s_cselect_b32 s44, 16384, s44
v_mfma_f32_32x32x16_bf16 a[80:95], a[232:235], a[220:223], a[80:95]
ds_read_b64_tr_b16 a[196:197], v13 offset:0
ds_read_b64_tr_b16 a[198:199], v13 offset:1024
v_mfma_f32_32x32x16_bf16 a[144:159], a[236:239], a[220:223], a[144:159]
ds_read_b64_tr_b16 a[200:201], v14 offset:0
ds_read_b64_tr_b16 a[202:203], v14 offset:1024
v_mfma_f32_32x32x16_bf16 a[96:111], a[232:235], a[224:227], a[96:111]
ds_read_b64_tr_b16 a[204:205], v15 offset:0
ds_read_b64_tr_b16 a[206:207], v15 offset:1024
v_mfma_f32_32x32x16_bf16 a[160:175], a[236:239], a[224:227], a[160:175]
s_add_u32 m0, s43, s45
s_nop 0
buffer_load_dwordx4 v28, s[60:63], s42 offen lds
v_mfma_f32_32x32x16_bf16 a[112:127], a[232:235], a[228:231], a[112:127]
buffer_load_dwordx4 v29, s[60:63], s42 offen offset:1024 lds
v_mfma_f32_32x32x16_bf16 a[176:191], a[236:239], a[228:231], a[176:191]
buffer_load_dwordx4 v30, s[60:63], s42 offen offset:2048 lds
s_waitcnt lgkmcnt(7)
v_mfma_f32_32x32x16_bf16 v[64:79], a[192:195], a[208:211], 0
ds_read_b128 a[232:235], v9 offset:0
ds_read_b64_tr_b16 a[216:217], v12 offset:4096
s_waitcnt lgkmcnt(8)
v_mfma_f32_32x32x16_bf16 v[128:143], a[192:195], a[212:215], 0
ds_read_b64_tr_b16 a[218:219], v12 offset:5120
ds_read_b128 a[236:239], v9 offset:4096
v_accvgpr_read_b32 v40, a64
v_accvgpr_read_b32 v41, a65
v_accvgpr_read_b32 v42, a66
v_accvgpr_read_b32 v43, a67
v_accvgpr_read_b32 v44, a68
v_accvgpr_read_b32 v45, a69
v_accvgpr_read_b32 v46, a70
v_accvgpr_read_b32 v47, a71
s_waitcnt lgkmcnt(8)
v_mfma_f32_32x32x16_bf16 v[80:95], a[196:199], a[208:211], 0
ds_read_b64_tr_b16 a[220:221], v13 offset:4096
ds_read_b64_tr_b16 a[222:223], v13 offset:5120
v_cvt_pk_bf16_f32 v40, v40, v41
v_cvt_pk_bf16_f32 v41, v42, v43
v_cvt_pk_bf16_f32 v42, v44, v45
v_cvt_pk_bf16_f32 v43, v46, v47
buffer_store_dwordx4 v[40:43], v204, s[16:19], s96 offen offset:0
v_mfma_f32_32x32x16_bf16 v[144:159], a[196:199], a[212:215], 0
ds_read_b64_tr_b16 a[224:225], v14 offset:4096
ds_read_b64_tr_b16 a[226:227], v14 offset:5120
v_accvgpr_read_b32 v48, a72
v_accvgpr_read_b32 v49, a73
v_accvgpr_read_b32 v50, a74
v_accvgpr_read_b32 v51, a75
v_accvgpr_read_b32 v52, a76
v_accvgpr_read_b32 v53, a77
v_accvgpr_read_b32 v54, a78
v_accvgpr_read_b32 v55, a79
s_waitcnt lgkmcnt(10)
v_mfma_f32_32x32x16_bf16 v[96:111], a[200:203], a[208:211], 0
ds_read_b64_tr_b16 a[228:229], v15 offset:4096
ds_read_b64_tr_b16 a[230:231], v15 offset:5120
v_cvt_pk_bf16_f32 v48, v48, v49
v_cvt_pk_bf16_f32 v49, v50, v51
v_cvt_pk_bf16_f32 v50, v52, v53
v_cvt_pk_bf16_f32 v51, v54, v55
buffer_store_dwordx4 v[48:51], v204, s[16:19], s97 offen offset:0
v_mfma_f32_32x32x16_bf16 v[160:175], a[200:203], a[212:215], 0
buffer_load_dwordx4 v31, s[60:63], s42 offen offset:3072 lds
s_add_u32 s42, s42, 524288
v_accvgpr_read_b32 v40, a128
v_accvgpr_read_b32 v41, a129
v_accvgpr_read_b32 v42, a130
v_accvgpr_read_b32 v43, a131
s_waitcnt lgkmcnt(10)
v_mfma_f32_32x32x16_bf16 v[112:127], a[204:207], a[208:211], 0
s_add_u32 s47, s43, s46
s_mov_b32 m0, s47
s_nop 0
buffer_load_dwordx4 v24, s[12:15], s40 offen lds
v_mfma_f32_32x32x16_bf16 v[176:191], a[204:207], a[212:215], 0
buffer_load_dwordx4 v25, s[12:15], s40 offen offset:1024 lds
v_accvgpr_read_b32 v44, a132
v_accvgpr_read_b32 v45, a133
v_accvgpr_read_b32 v46, a134
v_accvgpr_read_b32 v47, a135
s_waitcnt lgkmcnt(7)
v_mfma_f32_32x32x16_bf16 v[64:79], a[216:219], a[232:235], v[64:79]
ds_read_b128 a[208:211], v10 offset:0
ds_read_b64_tr_b16 a[192:193], v12 offset:8192
v_cvt_pk_bf16_f32 v40, v40, v41
v_cvt_pk_bf16_f32 v41, v42, v43
v_cvt_pk_bf16_f32 v42, v44, v45
v_cvt_pk_bf16_f32 v43, v46, v47
buffer_store_dwordx4 v[40:43], v204, s[16:19], s98 offen offset:0
s_waitcnt lgkmcnt(8)
v_mfma_f32_32x32x16_bf16 v[128:143], a[216:219], a[236:239], v[128:143]
ds_read_b64_tr_b16 a[194:195], v12 offset:9216
ds_read_b128 a[212:215], v10 offset:4096
v_accvgpr_read_b32 v48, a136
v_accvgpr_read_b32 v49, a137
v_accvgpr_read_b32 v50, a138
v_accvgpr_read_b32 v51, a139
v_accvgpr_read_b32 v52, a140
v_accvgpr_read_b32 v53, a141
v_accvgpr_read_b32 v54, a142
v_accvgpr_read_b32 v55, a143
s_waitcnt lgkmcnt(8)
v_mfma_f32_32x32x16_bf16 v[80:95], a[220:223], a[232:235], v[80:95]
ds_read_b64_tr_b16 a[196:197], v13 offset:8192
ds_read_b64_tr_b16 a[198:199], v13 offset:9216
v_cvt_pk_bf16_f32 v48, v48, v49
v_cvt_pk_bf16_f32 v49, v50, v51
v_cvt_pk_bf16_f32 v50, v52, v53
v_cvt_pk_bf16_f32 v51, v54, v55
buffer_store_dwordx4 v[48:51], v204, s[16:19], s99 offen offset:0
v_mfma_f32_32x32x16_bf16 v[144:159], a[220:223], a[236:239], v[144:159]
ds_read_b64_tr_b16 a[200:201], v14 offset:8192
ds_read_b64_tr_b16 a[202:203], v14 offset:9216
v_accvgpr_read_b32 v40, a80
v_accvgpr_read_b32 v41, a81
v_accvgpr_read_b32 v42, a82
v_accvgpr_read_b32 v43, a83
v_accvgpr_read_b32 v44, a84
v_accvgpr_read_b32 v45, a85
v_accvgpr_read_b32 v46, a86
v_accvgpr_read_b32 v47, a87
s_waitcnt lgkmcnt(10)
v_mfma_f32_32x32x16_bf16 v[96:111], a[224:227], a[232:235], v[96:111]
ds_read_b64_tr_b16 a[204:205], v15 offset:8192
ds_read_b64_tr_b16 a[206:207], v15 offset:9216
v_cvt_pk_bf16_f32 v40, v40, v41
v_cvt_pk_bf16_f32 v41, v42, v43
v_cvt_pk_bf16_f32 v42, v44, v45
v_cvt_pk_bf16_f32 v43, v46, v47
buffer_store_dwordx4 v[40:43], v204, s[16:19], s96 offen offset:1024
v_mfma_f32_32x32x16_bf16 v[160:175], a[224:227], a[236:239], v[160:175]
buffer_load_dwordx4 v26, s[12:15], s40 offen offset:2048 lds
v_accvgpr_read_b32 v48, a88
v_accvgpr_read_b32 v49, a89
v_accvgpr_read_b32 v50, a90
v_accvgpr_read_b32 v51, a91
s_waitcnt lgkmcnt(10)
v_mfma_f32_32x32x16_bf16 v[112:127], a[228:231], a[232:235], v[112:127]
buffer_load_dwordx4 v27, s[12:15], s40 offen offset:3072 lds
s_add_u32 s40, s40, 128
v_accvgpr_read_b32 v52, a92
v_accvgpr_read_b32 v53, a93
v_accvgpr_read_b32 v54, a94
v_accvgpr_read_b32 v55, a95
v_mfma_f32_32x32x16_bf16 v[176:191], a[228:231], a[236:239], v[176:191]
s_add_u32 m0, s47, 4096
s_nop 0
buffer_load_dwordx4 v24, s[12:15], s41 offen lds
v_cvt_pk_bf16_f32 v48, v48, v49
v_cvt_pk_bf16_f32 v49, v50, v51
v_cvt_pk_bf16_f32 v50, v52, v53
v_cvt_pk_bf16_f32 v51, v54, v55
buffer_store_dwordx4 v[48:51], v204, s[16:19], s97 offen offset:1024
s_waitcnt lgkmcnt(7)
v_mfma_f32_32x32x16_bf16 v[64:79], a[192:195], a[208:211], v[64:79]
ds_read_b128 a[232:235], v11 offset:0
ds_read_b64_tr_b16 a[216:217], v12 offset:12288
v_accvgpr_read_b32 v40, a144
v_accvgpr_read_b32 v41, a145
v_accvgpr_read_b32 v42, a146
v_accvgpr_read_b32 v43, a147
s_waitcnt lgkmcnt(8)
v_mfma_f32_32x32x16_bf16 v[128:143], a[192:195], a[212:215], v[128:143]
ds_read_b64_tr_b16 a[218:219], v12 offset:13312
ds_read_b128 a[236:239], v11 offset:4096
v_accvgpr_read_b32 v44, a148
v_accvgpr_read_b32 v45, a149
v_accvgpr_read_b32 v46, a150
v_accvgpr_read_b32 v47, a151
s_waitcnt lgkmcnt(8)
v_mfma_f32_32x32x16_bf16 v[80:95], a[196:199], a[208:211], v[80:95]
ds_read_b64_tr_b16 a[220:221], v13 offset:12288
ds_read_b64_tr_b16 a[222:223], v13 offset:13312
v_cvt_pk_bf16_f32 v40, v40, v41
v_cvt_pk_bf16_f32 v41, v42, v43
v_cvt_pk_bf16_f32 v42, v44, v45
v_cvt_pk_bf16_f32 v43, v46, v47
buffer_store_dwordx4 v[40:43], v204, s[16:19], s98 offen offset:1024
v_accvgpr_read_b32 v48, a152
v_accvgpr_read_b32 v49, a153
v_accvgpr_read_b32 v50, a154
v_accvgpr_read_b32 v51, a155
v_mfma_f32_32x32x16_bf16 v[144:159], a[196:199], a[212:215], v[144:159]
ds_read_b64_tr_b16 a[224:225], v14 offset:12288
ds_read_b64_tr_b16 a[226:227], v14 offset:13312
v_accvgpr_read_b32 v52, a156
v_accvgpr_read_b32 v53, a157
v_accvgpr_read_b32 v54, a158
v_accvgpr_read_b32 v55, a159
s_waitcnt lgkmcnt(10)
v_mfma_f32_32x32x16_bf16 v[96:111], a[200:203], a[208:211], v[96:111]
ds_read_b64_tr_b16 a[228:229], v15 offset:12288
ds_read_b64_tr_b16 a[230:231], v15 offset:13312
v_cvt_pk_bf16_f32 v48, v48, v49
v_cvt_pk_bf16_f32 v49, v50, v51
v_cvt_pk_bf16_f32 v50, v52, v53
v_cvt_pk_bf16_f32 v51, v54, v55
buffer_store_dwordx4 v[48:51], v204, s[16:19], s99 offen offset:1024
v_mfma_f32_32x32x16_bf16 v[160:175], a[200:203], a[212:215], v[160:175]
buffer_load_dwordx4 v25, s[12:15], s41 offen offset:1024 lds
s_mov_b32 s76, s100
s_and_b32 s77, s101, 0xffff
s_mov_b32 s78, 256
s_mov_b32 s79, 0x20000
v_lshlrev_b32 v57, 1, v204
s_lshr_b32 s29, s21, 2
s_and_b32 s32, s21, 3
s_lshl_b32 s32, s32, 3
s_add_u32 s48, s32, s29
buffer_load_ubyte v56, v57, s[76:79], s48 offen sc1
s_waitcnt lgkmcnt(10)
v_mfma_f32_32x32x16_bf16 v[112:127], a[204:207], a[208:211], v[112:127]
buffer_load_dwordx4 v26, s[12:15], s41 offen offset:2048 lds
v_mfma_f32_32x32x16_bf16 v[176:191], a[204:207], a[212:215], v[176:191]
buffer_load_dwordx4 v27, s[12:15], s41 offen offset:3072 lds
s_add_u32 s41, s41, 128
s_add_u32 s43, s43, 49152
s_cmp_ge_u32 s43, 163840
s_cselect_b32 s43, 16384, s43
s_waitcnt lgkmcnt(0)
s_waitcnt vmcnt(21)
s_barrier
v_mfma_f32_32x32x16_bf16 v[64:79], a[216:219], a[232:235], v[64:79]
v_add_u32 v8, s44, v16
v_add_u32 v12, s44, v20
v_add_u32 v9, s44, v17
v_add_u32 v13, s44, v21
v_add_u32 v10, s44, v18
v_add_u32 v14, s44, v22
v_add_u32 v11, s44, v19
v_add_u32 v15, s44, v23
ds_read_b128 a[208:211], v8 offset:0
ds_read_b64_tr_b16 a[192:193], v12 offset:0
v_mfma_f32_32x32x16_bf16 v[128:143], a[216:219], a[236:239], v[128:143]
ds_read_b64_tr_b16 a[194:195], v12 offset:1024
ds_read_b128 a[212:215], v8 offset:4096
s_add_u32 s44, s44, 49152
s_cmp_ge_u32 s44, 163840
s_cselect_b32 s44, 16384, s44
v_mfma_f32_32x32x16_bf16 v[80:95], a[220:223], a[232:235], v[80:95]
ds_read_b64_tr_b16 a[196:197], v13 offset:0
ds_read_b64_tr_b16 a[198:199], v13 offset:1024
v_mfma_f32_32x32x16_bf16 v[144:159], a[220:223], a[236:239], v[144:159]
ds_read_b64_tr_b16 a[200:201], v14 offset:0
ds_read_b64_tr_b16 a[202:203], v14 offset:1024
v_mfma_f32_32x32x16_bf16 v[96:111], a[224:227], a[232:235], v[96:111]
ds_read_b64_tr_b16 a[204:205], v15 offset:0
ds_read_b64_tr_b16 a[206:207], v15 offset:1024
v_mfma_f32_32x32x16_bf16 v[160:175], a[224:227], a[236:239], v[160:175]
s_add_u32 m0, s43, s45
s_nop 0
buffer_load_dwordx4 v28, s[60:63], s42 offen lds
v_mfma_f32_32x32x16_bf16 v[112:127], a[228:231], a[232:235], v[112:127]
buffer_load_dwordx4 v29, s[60:63], s42 offen offset:1024 lds
v_mfma_f32_32x32x16_bf16 v[176:191], a[228:231], a[236:239], v[176:191]
buffer_load_dwordx4 v30, s[60:63], s42 offen offset:2048 lds
s_waitcnt lgkmcnt(7)
v_mfma_f32_32x32x16_bf16 v[64:79], a[192:195], a[208:211], v[64:79]
ds_read_b128 a[232:235], v9 offset:0
ds_read_b64_tr_b16 a[216:217], v12 offset:4096
s_waitcnt lgkmcnt(8)
v_mfma_f32_32x32x16_bf16 v[128:143], a[192:195], a[212:215], v[128:143]
ds_read_b64_tr_b16 a[218:219], v12 offset:5120
ds_read_b128 a[236:239], v9 offset:4096
v_accvgpr_read_b32 v40, a96
v_accvgpr_read_b32 v41, a97
v_accvgpr_read_b32 v42, a98
v_accvgpr_read_b32 v43, a99
v_accvgpr_read_b32 v44, a100
v_accvgpr_read_b32 v45, a101
v_accvgpr_read_b32 v46, a102
v_accvgpr_read_b32 v47, a103
s_waitcnt lgkmcnt(8)
v_mfma_f32_32x32x16_bf16 v[80:95], a[196:199], a[208:211], v[80:95]
ds_read_b64_tr_b16 a[220:221], v13 offset:4096
ds_read_b64_tr_b16 a[222:223], v13 offset:5120
v_cvt_pk_bf16_f32 v40, v40, v41
v_cvt_pk_bf16_f32 v41, v42, v43
v_cvt_pk_bf16_f32 v42, v44, v45
v_cvt_pk_bf16_f32 v43, v46, v47
buffer_store_dwordx4 v[40:43], v204, s[16:19], s96 offen offset:2048
v_mfma_f32_32x32x16_bf16 v[144:159], a[196:199], a[212:215], v[144:159]
ds_read_b64_tr_b16 a[224:225], v14 offset:4096
ds_read_b64_tr_b16 a[226:227], v14 offset:5120
v_accvgpr_read_b32 v48, a104
v_accvgpr_read_b32 v49, a105
v_accvgpr_read_b32 v50, a106
v_accvgpr_read_b32 v51, a107
s_waitcnt lgkmcnt(10)
v_mfma_f32_32x32x16_bf16 v[96:111], a[200:203], a[208:211], v[96:111]
ds_read_b64_tr_b16 a[228:229], v15 offset:4096
ds_read_b64_tr_b16 a[230:231], v15 offset:5120
v_accvgpr_read_b32 v52, a108
v_accvgpr_read_b32 v53, a109
v_accvgpr_read_b32 v54, a110
v_accvgpr_read_b32 v55, a111
v_cvt_pk_bf16_f32 v48, v48, v49
v_cvt_pk_bf16_f32 v49, v50, v51
v_cvt_pk_bf16_f32 v50, v52, v53
v_cvt_pk_bf16_f32 v51, v54, v55
buffer_store_dwordx4 v[48:51], v204, s[16:19], s97 offen offset:2048
v_mfma_f32_32x32x16_bf16 v[160:175], a[200:203], a[212:215], v[160:175]
buffer_load_dwordx4 v31, s[60:63], s42 offen offset:3072 lds
s_add_u32 s42, s42, 524288
s_waitcnt lgkmcnt(10)
v_mfma_f32_32x32x16_bf16 v[112:127], a[204:207], a[208:211], v[112:127]
s_add_u32 s47, s43, s46
s_mov_b32 m0, s47
s_nop 0
buffer_load_dwordx4 v24, s[12:15], s40 offen lds
v_mfma_f32_32x32x16_bf16 v[176:191], a[204:207], a[212:215], v[176:191]
buffer_load_dwordx4 v25, s[12:15], s40 offen offset:1024 lds
v_accvgpr_read_b32 v40, a160
v_accvgpr_read_b32 v41, a161
v_accvgpr_read_b32 v42, a162
v_accvgpr_read_b32 v43, a163
s_waitcnt lgkmcnt(7)
v_mfma_f32_32x32x16_bf16 v[64:79], a[216:219], a[232:235], v[64:79]
ds_read_b128 a[208:211], v10 offset:0
ds_read_b64_tr_b16 a[192:193], v12 offset:8192
v_accvgpr_read_b32 v44, a164
v_accvgpr_read_b32 v45, a165
v_accvgpr_read_b32 v46, a166
v_accvgpr_read_b32 v47, a167
v_cvt_pk_bf16_f32 v40, v40, v41
v_cvt_pk_bf16_f32 v41, v42, v43
v_cvt_pk_bf16_f32 v42, v44, v45
v_cvt_pk_bf16_f32 v43, v46, v47
buffer_store_dwordx4 v[40:43], v204, s[16:19], s98 offen offset:2048
s_waitcnt lgkmcnt(8)
v_mfma_f32_32x32x16_bf16 v[128:143], a[216:219], a[236:239], v[128:143]
ds_read_b64_tr_b16 a[194:195], v12 offset:9216
ds_read_b128 a[212:215], v10 offset:4096
v_accvgpr_read_b32 v48, a168
v_accvgpr_read_b32 v49, a169
v_accvgpr_read_b32 v50, a170
v_accvgpr_read_b32 v51, a171
s_waitcnt lgkmcnt(8)
v_mfma_f32_32x32x16_bf16 v[80:95], a[220:223], a[232:235], v[80:95]
ds_read_b64_tr_b16 a[196:197], v13 offset:8192
ds_read_b64_tr_b16 a[198:199], v13 offset:9216
v_accvgpr_read_b32 v52, a172
v_accvgpr_read_b32 v53, a173
v_accvgpr_read_b32 v54, a174
v_accvgpr_read_b32 v55, a175
v_mfma_f32_32x32x16_bf16 v[144:159], a[220:223], a[236:239], v[144:159]
ds_read_b64_tr_b16 a[200:201], v14 offset:8192
ds_read_b64_tr_b16 a[202:203], v14 offset:9216
v_cvt_pk_bf16_f32 v48, v48, v49
v_cvt_pk_bf16_f32 v49, v50, v51
v_cvt_pk_bf16_f32 v50, v52, v53
v_cvt_pk_bf16_f32 v51, v54, v55
buffer_store_dwordx4 v[48:51], v204, s[16:19], s99 offen offset:2048
v_accvgpr_read_b32 v40, a112
v_accvgpr_read_b32 v41, a113
v_accvgpr_read_b32 v42, a114
v_accvgpr_read_b32 v43, a115
s_waitcnt lgkmcnt(10)
v_mfma_f32_32x32x16_bf16 v[96:111], a[224:227], a[232:235], v[96:111]
ds_read_b64_tr_b16 a[204:205], v15 offset:8192
ds_read_b64_tr_b16 a[206:207], v15 offset:9216
v_accvgpr_read_b32 v44, a116
v_accvgpr_read_b32 v45, a117
v_accvgpr_read_b32 v46, a118
v_accvgpr_read_b32 v47, a119
v_mfma_f32_32x32x16_bf16 v[160:175], a[224:227], a[236:239], v[160:175]
buffer_load_dwordx4 v26, s[12:15], s40 offen offset:2048 lds
v_cvt_pk_bf16_f32 v40, v40, v41
v_cvt_pk_bf16_f32 v41, v42, v43
v_cvt_pk_bf16_f32 v42, v44, v45
v_cvt_pk_bf16_f32 v43, v46, v47
buffer_store_dwordx4 v[40:43], v204, s[16:19], s96 offen offset:3072
s_waitcnt lgkmcnt(10)
v_mfma_f32_32x32x16_bf16 v[112:127], a[228:231], a[232:235], v[112:127]
buffer_load_dwordx4 v27, s[12:15], s40 offen offset:3072 lds
s_add_u32 s40, s40, 128
v_mfma_f32_32x32x16_bf16 v[176:191], a[228:231], a[236:239], v[176:191]
s_add_u32 m0, s47, 4096
s_nop 0
buffer_load_dwordx4 v24, s[12:15], s41 offen lds
v_accvgpr_read_b32 v48, a120
v_accvgpr_read_b32 v49, a121
v_accvgpr_read_b32 v50, a122
v_accvgpr_read_b32 v51, a123
s_waitcnt lgkmcnt(7)
v_mfma_f32_32x32x16_bf16 v[64:79], a[192:195], a[208:211], v[64:79]
ds_read_b128 a[232:235], v11 offset:0
ds_read_b64_tr_b16 a[216:217], v12 offset:12288
v_accvgpr_read_b32 v52, a124
v_accvgpr_read_b32 v53, a125
v_accvgpr_read_b32 v54, a126
v_accvgpr_read_b32 v55, a127
s_waitcnt lgkmcnt(8)
v_mfma_f32_32x32x16_bf16 v[128:143], a[192:195], a[212:215], v[128:143]
ds_read_b64_tr_b16 a[218:219], v12 offset:13312
ds_read_b128 a[236:239], v11 offset:4096
v_cvt_pk_bf16_f32 v48, v48, v49
v_cvt_pk_bf16_f32 v49, v50, v51
v_cvt_pk_bf16_f32 v50, v52, v53
v_cvt_pk_bf16_f32 v51, v54, v55
buffer_store_dwordx4 v[48:51], v204, s[16:19], s97 offen offset:3072
s_waitcnt lgkmcnt(8)
v_mfma_f32_32x32x16_bf16 v[80:95], a[196:199], a[208:211], v[80:95]
ds_read_b64_tr_b16 a[220:221], v13 offset:12288
ds_read_b64_tr_b16 a[222:223], v13 offset:13312
v_accvgpr_read_b32 v40, a176
v_accvgpr_read_b32 v41, a177
v_accvgpr_read_b32 v42, a178
v_accvgpr_read_b32 v43, a179
v_accvgpr_read_b32 v44, a180
v_accvgpr_read_b32 v45, a181
v_accvgpr_read_b32 v46, a182
v_accvgpr_read_b32 v47, a183
v_mfma_f32_32x32x16_bf16 v[144:159], a[196:199], a[212:215], v[144:159]
ds_read_b64_tr_b16 a[224:225], v14 offset:12288
ds_read_b64_tr_b16 a[226:227], v14 offset:13312
v_cvt_pk_bf16_f32 v40, v40, v41
v_cvt_pk_bf16_f32 v41, v42, v43
v_cvt_pk_bf16_f32 v42, v44, v45
v_cvt_pk_bf16_f32 v43, v46, v47
buffer_store_dwordx4 v[40:43], v204, s[16:19], s98 offen offset:3072
s_waitcnt lgkmcnt(10)
v_mfma_f32_32x32x16_bf16 v[96:111], a[200:203], a[208:211], v[96:111]
ds_read_b64_tr_b16 a[228:229], v15 offset:12288
ds_read_b64_tr_b16 a[230:231], v15 offset:13312
v_accvgpr_read_b32 v48, a184
v_accvgpr_read_b32 v49, a185
v_accvgpr_read_b32 v50, a186
v_accvgpr_read_b32 v51, a187
v_accvgpr_read_b32 v52, a188
v_accvgpr_read_b32 v53, a189
v_accvgpr_read_b32 v54, a190
v_accvgpr_read_b32 v55, a191
v_mfma_f32_32x32x16_bf16 v[160:175], a[200:203], a[212:215], v[160:175]
buffer_load_dwordx4 v25, s[12:15], s41 offen offset:1024 lds
s_waitcnt lgkmcnt(10)
v_mfma_f32_32x32x16_bf16 v[112:127], a[204:207], a[208:211], v[112:127]
buffer_load_dwordx4 v26, s[12:15], s41 offen offset:2048 lds
v_cvt_pk_bf16_f32 v48, v48, v49
v_cvt_pk_bf16_f32 v49, v50, v51
v_cvt_pk_bf16_f32 v50, v52, v53
v_cvt_pk_bf16_f32 v51, v54, v55
buffer_store_dwordx4 v[48:51], v204, s[16:19], s99 offen offset:3072
v_mfma_f32_32x32x16_bf16 v[176:191], a[204:207], a[212:215], v[176:191]
buffer_load_dwordx4 v27, s[12:15], s41 offen offset:3072 lds
s_add_u32 s41, s41, 128
s_add_u32 s43, s43, 49152
s_cmp_ge_u32 s43, 163840
s_cselect_b32 s43, 16384, s43
s_waitcnt lgkmcnt(0)
s_waitcnt vmcnt(20)
s_barrier
v_mfma_f32_32x32x16_bf16 v[64:79], a[216:219], a[232:235], v[64:79]
v_add_u32 v8, s44, v16
v_add_u32 v12, s44, v20
v_add_u32 v9, s44, v17
v_add_u32 v13, s44, v21
v_add_u32 v10, s44, v18
v_add_u32 v14, s44, v22
v_add_u32 v11, s44, v19
v_add_u32 v15, s44, v23
ds_read_b128 a[208:211], v8 offset:0
ds_read_b64_tr_b16 a[192:193], v12 offset:0
v_mfma_f32_32x32x16_bf16 v[128:143], a[216:219], a[236:239], v[128:143]
ds_read_b64_tr_b16 a[194:195], v12 offset:1024
ds_read_b128 a[212:215], v8 offset:4096
s_add_u32 s44, s44, 49152
s_cmp_ge_u32 s44, 163840
s_cselect_b32 s44, 16384, s44
v_mfma_f32_32x32x16_bf16 v[80:95], a[220:223], a[232:235], v[80:95]
ds_read_b64_tr_b16 a[196:197], v13 offset:0
ds_read_b64_tr_b16 a[198:199], v13 offset:1024
v_mfma_f32_32x32x16_bf16 v[144:159], a[220:223], a[236:239], v[144:159]
ds_read_b64_tr_b16 a[200:201], v14 offset:0
ds_read_b64_tr_b16 a[202:203], v14 offset:1024
v_mfma_f32_32x32x16_bf16 v[96:111], a[224:227], a[232:235], v[96:111]
ds_read_b64_tr_b16 a[204:205], v15 offset:0
ds_read_b64_tr_b16 a[206:207], v15 offset:1024
v_mfma_f32_32x32x16_bf16 v[160:175], a[224:227], a[236:239], v[160:175]
s_add_u32 m0, s43, s45
s_nop 0
buffer_load_dwordx4 v28, s[60:63], s42 offen lds
v_mfma_f32_32x32x16_bf16 v[112:127], a[228:231], a[232:235], v[112:127]
buffer_load_dwordx4 v29, s[60:63], s42 offen offset:1024 lds
v_mfma_f32_32x32x16_bf16 v[176:191], a[228:231], a[236:239], v[176:191]
buffer_load_dwordx4 v30, s[60:63], s42 offen offset:2048 lds
s_waitcnt lgkmcnt(7)
v_mfma_f32_32x32x16_bf16 v[64:79], a[192:195], a[208:211], v[64:79]
ds_read_b128 a[232:235], v9 offset:0
ds_read_b64_tr_b16 a[216:217], v12 offset:4096
s_waitcnt lgkmcnt(8)
v_mfma_f32_32x32x16_bf16 v[128:143], a[192:195], a[212:215], v[128:143]
ds_read_b64_tr_b16 a[218:219], v12 offset:5120
ds_read_b128 a[236:239], v9 offset:4096
v_accvgpr_write_b32 a64, 0
v_accvgpr_write_b32 a65, 0
v_accvgpr_write_b32 a66, 0
v_accvgpr_write_b32 a67, 0
s_waitcnt lgkmcnt(8)
v_mfma_f32_32x32x16_bf16 v[80:95], a[196:199], a[208:211], v[80:95]
ds_read_b64_tr_b16 a[220:221], v13 offset:4096
ds_read_b64_tr_b16 a[222:223], v13 offset:5120
v_accvgpr_write_b32 a68, 0
v_accvgpr_write_b32 a69, 0
v_accvgpr_write_b32 a70, 0
v_accvgpr_write_b32 a71, 0
v_mfma_f32_32x32x16_bf16 v[144:159], a[196:199], a[212:215], v[144:159]
ds_read_b64_tr_b16 a[224:225], v14 offset:4096
ds_read_b64_tr_b16 a[226:227], v14 offset:5120
v_accvgpr_write_b32 a72, 0
v_accvgpr_write_b32 a73, 0
v_accvgpr_write_b32 a74, 0
v_accvgpr_write_b32 a75, 0
s_waitcnt lgkmcnt(10)
v_mfma_f32_32x32x16_bf16 v[96:111], a[200:203], a[208:211], v[96:111]
ds_read_b64_tr_b16 a[228:229], v15 offset:4096
ds_read_b64_tr_b16 a[230:231], v15 offset:5120
v_accvgpr_write_b32 a76, 0
v_accvgpr_write_b32 a77, 0
v_accvgpr_write_b32 a78, 0
v_accvgpr_write_b32 a79, 0
v_mfma_f32_32x32x16_bf16 v[160:175], a[200:203], a[212:215], v[160:175]
buffer_load_dwordx4 v31, s[60:63], s42 offen offset:3072 lds
s_add_u32 s42, s42, 524288
v_accvgpr_write_b32 a80, 0
v_accvgpr_write_b32 a81, 0
v_accvgpr_write_b32 a82, 0
v_accvgpr_write_b32 a83, 0
s_waitcnt lgkmcnt(10)
v_mfma_f32_32x32x16_bf16 v[112:127], a[204:207], a[208:211], v[112:127]
s_add_u32 s47, s43, s46
s_mov_b32 m0, s47
s_nop 0
buffer_load_dwordx4 v24, s[12:15], s40 offen lds
v_mfma_f32_32x32x16_bf16 v[176:191], a[204:207], a[212:215], v[176:191]
buffer_load_dwordx4 v25, s[12:15], s40 offen offset:1024 lds
s_waitcnt lgkmcnt(7)
v_mfma_f32_32x32x16_bf16 v[64:79], a[216:219], a[232:235], v[64:79]
ds_read_b128 a[208:211], v10 offset:0
ds_read_b64_tr_b16 a[192:193], v12 offset:8192
v_accvgpr_write_b32 a84, 0
v_accvgpr_write_b32 a85, 0
v_accvgpr_write_b32 a86, 0
v_accvgpr_write_b32 a87, 0
s_waitcnt lgkmcnt(8)
v_mfma_f32_32x32x16_bf16 v[128:143], a[216:219], a[236:239], v[128:143]
ds_read_b64_tr_b16 a[194:195], v12 offset:9216
ds_read_b128 a[212:215], v10 offset:4096
v_accvgpr_write_b32 a88, 0
v_accvgpr_write_b32 a89, 0
v_accvgpr_write_b32 a90, 0
v_accvgpr_write_b32 a91, 0
s_waitcnt lgkmcnt(8)
v_mfma_f32_32x32x16_bf16 v[80:95], a[220:223], a[232:235], v[80:95]
ds_read_b64_tr_b16 a[196:197], v13 offset:8192
ds_read_b64_tr_b16 a[198:199], v13 offset:9216
v_accvgpr_write_b32 a92, 0
v_accvgpr_write_b32 a93, 0
v_accvgpr_write_b32 a94, 0
v_accvgpr_write_b32 a95, 0
v_mfma_f32_32x32x16_bf16 v[144:159], a[220:223], a[236:239], v[144:159]
ds_read_b64_tr_b16 a[200:201], v14 offset:8192
ds_read_b64_tr_b16 a[202:203], v14 offset:9216
v_accvgpr_write_b32 a96, 0
v_accvgpr_write_b32 a97, 0
v_accvgpr_write_b32 a98, 0
v_accvgpr_write_b32 a99, 0
s_waitcnt lgkmcnt(10)
v_mfma_f32_32x32x16_bf16 v[96:111], a[224:227], a[232:235], v[96:111]
ds_read_b64_tr_b16 a[204:205], v15 offset:8192
ds_read_b64_tr_b16 a[206:207], v15 offset:9216
v_accvgpr_write_b32 a100, 0
v_accvgpr_write_b32 a101, 0
v_accvgpr_write_b32 a102, 0
v_accvgpr_write_b32 a103, 0
v_mfma_f32_32x32x16_bf16 v[160:175], a[224:227], a[236:239], v[160:175]
buffer_load_dwordx4 v26, s[12:15], s40 offen offset:2048 lds
s_waitcnt lgkmcnt(10)
v_mfma_f32_32x32x16_bf16 v[112:127], a[228:231], a[232:235], v[112:127]
buffer_load_dwordx4 v27, s[12:15], s40 offen offset:3072 lds
s_add_u32 s40, s40, 128
v_accvgpr_write_b32 a104, 0
v_accvgpr_write_b32 a105, 0
v_accvgpr_write_b32 a106, 0
v_accvgpr_write_b32 a107, 0
v_mfma_f32_32x32x16_bf16 v[176:191], a[228:231], a[236:239], v[176:191]
s_add_u32 m0, s47, 4096
s_nop 0
buffer_load_dwordx4 v24, s[12:15], s41 offen lds
s_waitcnt lgkmcnt(7)
v_mfma_f32_32x32x16_bf16 v[64:79], a[192:195], a[208:211], v[64:79]
ds_read_b128 a[232:235], v11 offset:0
ds_read_b64_tr_b16 a[216:217], v12 offset:12288
s_waitcnt lgkmcnt(8)
v_mfma_f32_32x32x16_bf16 v[128:143], a[192:195], a[212:215], v[128:143]
ds_read_b64_tr_b16 a[218:219], v12 offset:13312
ds_read_b128 a[236:239], v11 offset:4096
v_accvgpr_write_b32 a108, 0
v_accvgpr_write_b32 a109, 0
v_accvgpr_write_b32 a110, 0
v_accvgpr_write_b32 a111, 0
v_accvgpr_write_b32 a112, 0
v_accvgpr_write_b32 a113, 0
v_accvgpr_write_b32 a114, 0
v_accvgpr_write_b32 a115, 0
s_waitcnt lgkmcnt(8)
v_mfma_f32_32x32x16_bf16 v[80:95], a[196:199], a[208:211], v[80:95]
ds_read_b64_tr_b16 a[220:221], v13 offset:12288
ds_read_b64_tr_b16 a[222:223], v13 offset:13312
v_accvgpr_write_b32 a116, 0
v_accvgpr_write_b32 a117, 0
v_accvgpr_write_b32 a118, 0
v_accvgpr_write_b32 a119, 0
v_mfma_f32_32x32x16_bf16 v[144:159], a[196:199], a[212:215], v[144:159]
ds_read_b64_tr_b16 a[224:225], v14 offset:12288
ds_read_b64_tr_b16 a[226:227], v14 offset:13312
v_accvgpr_write_b32 a120, 0
v_accvgpr_write_b32 a121, 0
v_accvgpr_write_b32 a122, 0
v_accvgpr_write_b32 a123, 0
s_waitcnt lgkmcnt(10)
v_mfma_f32_32x32x16_bf16 v[96:111], a[200:203], a[208:211], v[96:111]
ds_read_b64_tr_b16 a[228:229], v15 offset:12288
ds_read_b64_tr_b16 a[230:231], v15 offset:13312
v_accvgpr_write_b32 a124, 0
v_accvgpr_write_b32 a125, 0
v_accvgpr_write_b32 a126, 0
v_accvgpr_write_b32 a127, 0
v_mfma_f32_32x32x16_bf16 v[160:175], a[200:203], a[212:215], v[160:175]
buffer_load_dwordx4 v25, s[12:15], s41 offen offset:1024 lds
s_waitcnt lgkmcnt(10)
v_mfma_f32_32x32x16_bf16 v[112:127], a[204:207], a[208:211], v[112:127]
buffer_load_dwordx4 v26, s[12:15], s41 offen offset:2048 lds
v_mfma_f32_32x32x16_bf16 v[176:191], a[204:207], a[212:215], v[176:191]
buffer_load_dwordx4 v27, s[12:15], s41 offen offset:3072 lds
s_add_u32 s41, s41, 128
s_add_u32 s43, s43, 49152
s_cmp_ge_u32 s43, 163840
s_cselect_b32 s43, 16384, s43
s_waitcnt lgkmcnt(0)
s_waitcnt vmcnt(12)
s_barrier
v_mfma_f32_32x32x16_bf16 v[64:79], a[216:219], a[232:235], v[64:79]
v_add_u32 v8, s44, v16
v_add_u32 v12, s44, v20
v_add_u32 v9, s44, v17
v_add_u32 v13, s44, v21
v_add_u32 v10, s44, v18
v_add_u32 v14, s44, v22
v_add_u32 v11, s44, v19
v_add_u32 v15, s44, v23
ds_read_b128 a[208:211], v8 offset:0
ds_read_b64_tr_b16 a[192:193], v12 offset:0
v_mfma_f32_32x32x16_bf16 v[128:143], a[216:219], a[236:239], v[128:143]
ds_read_b64_tr_b16 a[194:195], v12 offset:1024
ds_read_b128 a[212:215], v8 offset:4096
s_add_u32 s44, s44, 49152
s_cmp_ge_u32 s44, 163840
s_cselect_b32 s44, 16384, s44
v_mfma_f32_32x32x16_bf16 v[80:95], a[220:223], a[232:235], v[80:95]
ds_read_b64_tr_b16 a[196:197], v13 offset:0
ds_read_b64_tr_b16 a[198:199], v13 offset:1024
v_mfma_f32_32x32x16_bf16 v[144:159], a[220:223], a[236:239], v[144:159]
ds_read_b64_tr_b16 a[200:201], v14 offset:0
ds_read_b64_tr_b16 a[202:203], v14 offset:1024
v_mfma_f32_32x32x16_bf16 v[96:111], a[224:227], a[232:235], v[96:111]
ds_read_b64_tr_b16 a[204:205], v15 offset:0
ds_read_b64_tr_b16 a[206:207], v15 offset:1024
v_mfma_f32_32x32x16_bf16 v[160:175], a[224:227], a[236:239], v[160:175]
s_add_u32 m0, s43, s45
s_nop 0
buffer_load_dwordx4 v28, s[60:63], s42 offen lds
v_mfma_f32_32x32x16_bf16 v[112:127], a[228:231], a[232:235], v[112:127]
buffer_load_dwordx4 v29, s[60:63], s42 offen offset:1024 lds
v_mfma_f32_32x32x16_bf16 v[176:191], a[228:231], a[236:239], v[176:191]
buffer_load_dwordx4 v30, s[60:63], s42 offen offset:2048 lds
s_waitcnt lgkmcnt(7)
v_mfma_f32_32x32x16_bf16 v[64:79], a[192:195], a[208:211], v[64:79]
ds_read_b128 a[232:235], v9 offset:0
ds_read_b64_tr_b16 a[216:217], v12 offset:4096
s_waitcnt lgkmcnt(8)
v_mfma_f32_32x32x16_bf16 v[128:143], a[192:195], a[212:215], v[128:143]
ds_read_b64_tr_b16 a[218:219], v12 offset:5120
ds_read_b128 a[236:239], v9 offset:4096
s_waitcnt lgkmcnt(8)
v_mfma_f32_32x32x16_bf16 v[80:95], a[196:199], a[208:211], v[80:95]
ds_read_b64_tr_b16 a[220:221], v13 offset:4096
ds_read_b64_tr_b16 a[222:223], v13 offset:5120
v_mfma_f32_32x32x16_bf16 v[144:159], a[196:199], a[212:215], v[144:159]
ds_read_b64_tr_b16 a[224:225], v14 offset:4096
ds_read_b64_tr_b16 a[226:227], v14 offset:5120
s_waitcnt lgkmcnt(10)
v_mfma_f32_32x32x16_bf16 v[96:111], a[200:203], a[208:211], v[96:111]
ds_read_b64_tr_b16 a[228:229], v15 offset:4096
ds_read_b64_tr_b16 a[230:231], v15 offset:5120
v_mfma_f32_32x32x16_bf16 v[160:175], a[200:203], a[212:215], v[160:175]
buffer_load_dwordx4 v31, s[60:63], s42 offen offset:3072 lds
s_add_u32 s42, s42, 524288
s_waitcnt lgkmcnt(10)
v_mfma_f32_32x32x16_bf16 v[112:127], a[204:207], a[208:211], v[112:127]
s_add_u32 s47, s43, s46
s_mov_b32 m0, s47
s_nop 0
buffer_load_dwordx4 v24, s[12:15], s40 offen lds
v_mfma_f32_32x32x16_bf16 v[176:191], a[204:207], a[212:215], v[176:191]
buffer_load_dwordx4 v25, s[12:15], s40 offen offset:1024 lds
s_waitcnt lgkmcnt(7)
v_mfma_f32_32x32x16_bf16 v[64:79], a[216:219], a[232:235], v[64:79]
ds_read_b128 a[208:211], v10 offset:0
ds_read_b64_tr_b16 a[192:193], v12 offset:8192
s_waitcnt lgkmcnt(8)
v_mfma_f32_32x32x16_bf16 v[128:143], a[216:219], a[236:239], v[128:143]
ds_read_b64_tr_b16 a[194:195], v12 offset:9216
ds_read_b128 a[212:215], v10 offset:4096
s_waitcnt lgkmcnt(8)
v_mfma_f32_32x32x16_bf16 v[80:95], a[220:223], a[232:235], v[80:95]
ds_read_b64_tr_b16 a[196:197], v13 offset:8192
ds_read_b64_tr_b16 a[198:199], v13 offset:9216
v_mfma_f32_32x32x16_bf16 v[144:159], a[220:223], a[236:239], v[144:159]
ds_read_b64_tr_b16 a[200:201], v14 offset:8192
ds_read_b64_tr_b16 a[202:203], v14 offset:9216
s_waitcnt lgkmcnt(10)
v_mfma_f32_32x32x16_bf16 v[96:111], a[224:227], a[232:235], v[96:111]
ds_read_b64_tr_b16 a[204:205], v15 offset:8192
ds_read_b64_tr_b16 a[206:207], v15 offset:9216
v_mfma_f32_32x32x16_bf16 v[160:175], a[224:227], a[236:239], v[160:175]
buffer_load_dwordx4 v26, s[12:15], s40 offen offset:2048 lds
s_waitcnt lgkmcnt(10)
v_mfma_f32_32x32x16_bf16 v[112:127], a[228:231], a[232:235], v[112:127]
buffer_load_dwordx4 v27, s[12:15], s40 offen offset:3072 lds
s_add_u32 s40, s40, 128
v_mfma_f32_32x32x16_bf16 v[176:191], a[228:231], a[236:239], v[176:191]
s_add_u32 m0, s47, 4096
s_nop 0
buffer_load_dwordx4 v24, s[12:15], s41 offen lds
s_waitcnt lgkmcnt(7)
v_mfma_f32_32x32x16_bf16 v[64:79], a[192:195], a[208:211], v[64:79]
ds_read_b128 a[232:235], v11 offset:0
ds_read_b64_tr_b16 a[216:217], v12 offset:12288
s_waitcnt lgkmcnt(8)
v_mfma_f32_32x32x16_bf16 v[128:143], a[192:195], a[212:215], v[128:143]
ds_read_b64_tr_b16 a[218:219], v12 offset:13312
ds_read_b128 a[236:239], v11 offset:4096
s_waitcnt lgkmcnt(8)
v_mfma_f32_32x32x16_bf16 v[80:95], a[196:199], a[208:211], v[80:95]
ds_read_b64_tr_b16 a[220:221], v13 offset:12288
ds_read_b64_tr_b16 a[222:223], v13 offset:13312
v_mfma_f32_32x32x16_bf16 v[144:159], a[196:199], a[212:215], v[144:159]
ds_read_b64_tr_b16 a[224:225], v14 offset:12288
ds_read_b64_tr_b16 a[226:227], v14 offset:13312
s_waitcnt lgkmcnt(10)
v_mfma_f32_32x32x16_bf16 v[96:111], a[200:203], a[208:211], v[96:111]
ds_read_b64_tr_b16 a[228:229], v15 offset:12288
ds_read_b64_tr_b16 a[230:231], v15 offset:13312
v_mfma_f32_32x32x16_bf16 v[160:175], a[200:203], a[212:215], v[160:175]
buffer_load_dwordx4 v25, s[12:15], s41 offen offset:1024 lds
s_waitcnt lgkmcnt(10)
v_mfma_f32_32x32x16_bf16 v[112:127], a[204:207], a[208:211], v[112:127]
buffer_load_dwordx4 v26, s[12:15], s41 offen offset:2048 lds
v_mfma_f32_32x32x16_bf16 v[176:191], a[204:207], a[212:215], v[176:191]
buffer_load_dwordx4 v27, s[12:15], s41 offen offset:3072 lds
s_add_u32 s41, s41, 128
s_add_u32 s43, s43, 49152
s_cmp_ge_u32 s43, 163840
s_cselect_b32 s43, 16384, s43
s_waitcnt lgkmcnt(0)
s_waitcnt vmcnt(12)
s_barrier
v_mfma_f32_32x32x16_bf16 v[64:79], a[216:219], a[232:235], v[64:79]
v_add_u32 v8, s44, v16
v_add_u32 v12, s44, v20
v_add_u32 v9, s44, v17
v_add_u32 v13, s44, v21
v_add_u32 v10, s44, v18
v_add_u32 v14, s44, v22
v_add_u32 v11, s44, v19
v_add_u32 v15, s44, v23
ds_read_b128 a[208:211], v8 offset:0
ds_read_b64_tr_b16 a[192:193], v12 offset:0
v_mfma_f32_32x32x16_bf16 v[128:143], a[216:219], a[236:239], v[128:143]
ds_read_b64_tr_b16 a[194:195], v12 offset:1024
ds_read_b128 a[212:215], v8 offset:4096
s_add_u32 s44, s44, 49152
s_cmp_ge_u32 s44, 163840
s_cselect_b32 s44, 16384, s44
v_mfma_f32_32x32x16_bf16 v[80:95], a[220:223], a[232:235], v[80:95]
ds_read_b64_tr_b16 a[196:197], v13 offset:0
ds_read_b64_tr_b16 a[198:199], v13 offset:1024
v_mfma_f32_32x32x16_bf16 v[144:159], a[220:223], a[236:239], v[144:159]
ds_read_b64_tr_b16 a[200:201], v14 offset:0
ds_read_b64_tr_b16 a[202:203], v14 offset:1024
v_mfma_f32_32x32x16_bf16 v[96:111], a[224:227], a[232:235], v[96:111]
ds_read_b64_tr_b16 a[204:205], v15 offset:0
ds_read_b64_tr_b16 a[206:207], v15 offset:1024
s_mov_b32 s76, s100
s_and_b32 s77, s101, 0xffff
s_mov_b32 s78, 256
s_mov_b32 s79, 0x20000
s_add_u32 s92, s34, 71368704
s_addc_u32 s93, s35, 0
s_and_b32 s93, s93, 0xffff
s_mov_b32 s94, 4096
s_mov_b32 s95, 0x20000
s_cmp_eq_u32 s20, 0
s_cbranch_scc0 attn_nosig
s_mov_b32 s24, 0
attn_idchk:
v_readfirstlane_b32 s32, v56
s_and_b32 s32, s32, 0x40
s_cmp_lg_u32 s32, 0
s_cbranch_scc1 attn_idok
s_add_u32 s24, s24, 1
s_cmp_ge_u32 s24, 0x20000
s_cbranch_scc1 attn_idok
buffer_load_ubyte v56, v57, s[76:79], s48 offen sc1
s_waitcnt vmcnt(0)
s_nop 0
s_branch attn_idchk
attn_idok:
v_cmp_ne_u32 vcc, s33, v56
s_nop 3
s_and_b32 s32, vcc_lo, 0xff
s_cmp_eq_u32 s32, 0
s_cbranch_scc1 attn_samexcd
buffer_wbl2 sc1
s_waitcnt vmcnt(0)
attn_samexcd:
s_lshl_b32 s32, s21, 7
s_lshl_b32 s29, s22, 2
s_add_u32 s32, s32, s29
v_mov_b32 v41, 0
v_mov_b32 v42, 1
s_mov_b64 exec, 1
buffer_store_dword v42, v41, s[92:95], s32 offen sc1
s_mov_b64 exec, -1
attn_nosig:
v_mfma_f32_32x32x16_bf16 v[160:175], a[224:227], a[236:239], v[160:175]
s_add_u32 m0, s43, s45
s_nop 0
buffer_load_dwordx4 v28, s[60:63], s42 offen lds
v_mfma_f32_32x32x16_bf16 v[112:127], a[228:231], a[232:235], v[112:127]
buffer_load_dwordx4 v29, s[60:63], s42 offen offset:1024 lds
v_mfma_f32_32x32x16_bf16 v[176:191], a[228:231], a[236:239], v[176:191]
buffer_load_dwordx4 v30, s[60:63], s42 offen offset:2048 lds
s_waitcnt lgkmcnt(7)
v_mfma_f32_32x32x16_bf16 v[64:79], a[192:195], a[208:211], v[64:79]
ds_read_b128 a[232:235], v9 offset:0
ds_read_b64_tr_b16 a[216:217], v12 offset:4096
s_waitcnt lgkmcnt(8)
v_mfma_f32_32x32x16_bf16 v[128:143], a[192:195], a[212:215], v[128:143]
ds_read_b64_tr_b16 a[218:219], v12 offset:5120
ds_read_b128 a[236:239], v9 offset:4096
s_waitcnt lgkmcnt(8)
v_mfma_f32_32x32x16_bf16 v[80:95], a[196:199], a[208:211], v[80:95]
ds_read_b64_tr_b16 a[220:221], v13 offset:4096
ds_read_b64_tr_b16 a[222:223], v13 offset:5120
v_mfma_f32_32x32x16_bf16 v[144:159], a[196:199], a[212:215], v[144:159]
ds_read_b64_tr_b16 a[224:225], v14 offset:4096
ds_read_b64_tr_b16 a[226:227], v14 offset:5120
s_waitcnt lgkmcnt(10)
v_mfma_f32_32x32x16_bf16 v[96:111], a[200:203], a[208:211], v[96:111]
ds_read_b64_tr_b16 a[228:229], v15 offset:4096
ds_read_b64_tr_b16 a[230:231], v15 offset:5120
v_mfma_f32_32x32x16_bf16 v[160:175], a[200:203], a[212:215], v[160:175]
buffer_load_dwordx4 v31, s[60:63], s42 offen offset:3072 lds
s_add_u32 s42, s42, 524288
s_waitcnt lgkmcnt(10)
v_mfma_f32_32x32x16_bf16 v[112:127], a[204:207], a[208:211], v[112:127]
s_add_u32 s47, s43, s46
s_mov_b32 m0, s47
s_nop 0
buffer_load_dwordx4 v24, s[12:15], s40 offen lds
v_mfma_f32_32x32x16_bf16 v[176:191], a[204:207], a[212:215], v[176:191]
buffer_load_dwordx4 v25, s[12:15], s40 offen offset:1024 lds
s_waitcnt lgkmcnt(7)
v_mfma_f32_32x32x16_bf16 v[64:79], a[216:219], a[232:235], v[64:79]
ds_read_b128 a[208:211], v10 offset:0
ds_read_b64_tr_b16 a[192:193], v12 offset:8192
s_waitcnt lgkmcnt(8)
v_mfma_f32_32x32x16_bf16 v[128:143], a[216:219], a[236:239], v[128:143]
ds_read_b64_tr_b16 a[194:195], v12 offset:9216
ds_read_b128 a[212:215], v10 offset:4096
s_waitcnt lgkmcnt(8)
v_mfma_f32_32x32x16_bf16 v[80:95], a[220:223], a[232:235], v[80:95]
ds_read_b64_tr_b16 a[196:197], v13 offset:8192
ds_read_b64_tr_b16 a[198:199], v13 offset:9216
v_mfma_f32_32x32x16_bf16 v[144:159], a[220:223], a[236:239], v[144:159]
ds_read_b64_tr_b16 a[200:201], v14 offset:8192
ds_read_b64_tr_b16 a[202:203], v14 offset:9216
s_waitcnt lgkmcnt(10)
v_mfma_f32_32x32x16_bf16 v[96:111], a[224:227], a[232:235], v[96:111]
ds_read_b64_tr_b16 a[204:205], v15 offset:8192
ds_read_b64_tr_b16 a[206:207], v15 offset:9216
v_mfma_f32_32x32x16_bf16 v[160:175], a[224:227], a[236:239], v[160:175]
buffer_load_dwordx4 v26, s[12:15], s40 offen offset:2048 lds
s_waitcnt lgkmcnt(10)
v_mfma_f32_32x32x16_bf16 v[112:127], a[228:231], a[232:235], v[112:127]
buffer_load_dwordx4 v27, s[12:15], s40 offen offset:3072 lds
s_add_u32 s40, s40, 128
v_mfma_f32_32x32x16_bf16 v[176:191], a[228:231], a[236:239], v[176:191]
s_add_u32 m0, s47, 4096
s_nop 0
buffer_load_dwordx4 v24, s[12:15], s41 offen lds
s_waitcnt lgkmcnt(7)
v_mfma_f32_32x32x16_bf16 v[64:79], a[192:195], a[208:211], v[64:79]
ds_read_b128 a[232:235], v11 offset:0
ds_read_b64_tr_b16 a[216:217], v12 offset:12288
s_waitcnt lgkmcnt(8)
v_mfma_f32_32x32x16_bf16 v[128:143], a[192:195], a[212:215], v[128:143]
ds_read_b64_tr_b16 a[218:219], v12 offset:13312
ds_read_b128 a[236:239], v11 offset:4096
s_waitcnt lgkmcnt(8)
v_mfma_f32_32x32x16_bf16 v[80:95], a[196:199], a[208:211], v[80:95]
ds_read_b64_tr_b16 a[220:221], v13 offset:12288
ds_read_b64_tr_b16 a[222:223], v13 offset:13312
v_mfma_f32_32x32x16_bf16 v[144:159], a[196:199], a[212:215], v[144:159]
ds_read_b64_tr_b16 a[224:225], v14 offset:12288
ds_read_b64_tr_b16 a[226:227], v14 offset:13312
s_waitcnt lgkmcnt(10)
v_mfma_f32_32x32x16_bf16 v[96:111], a[200:203], a[208:211], v[96:111]
ds_read_b64_tr_b16 a[228:229], v15 offset:12288
ds_read_b64_tr_b16 a[230:231], v15 offset:13312
v_mfma_f32_32x32x16_bf16 v[160:175], a[200:203], a[212:215], v[160:175]
buffer_load_dwordx4 v25, s[12:15], s41 offen offset:1024 lds
s_waitcnt lgkmcnt(10)
v_mfma_f32_32x32x16_bf16 v[112:127], a[204:207], a[208:211], v[112:127]
buffer_load_dwordx4 v26, s[12:15], s41 offen offset:2048 lds
v_mfma_f32_32x32x16_bf16 v[176:191], a[204:207], a[212:215], v[176:191]
buffer_load_dwordx4 v27, s[12:15], s41 offen offset:3072 lds
s_add_u32 s41, s41, 128
s_add_u32 s43, s43, 49152
s_cmp_ge_u32 s43, 163840
s_cselect_b32 s43, 16384, s43
s_waitcnt lgkmcnt(0)
s_waitcnt vmcnt(12)
s_barrier
v_mfma_f32_32x32x16_bf16 v[64:79], a[216:219], a[232:235], v[64:79]
v_add_u32 v8, s44, v16
v_add_u32 v12, s44, v20
v_add_u32 v9, s44, v17
v_add_u32 v13, s44, v21
v_add_u32 v10, s44, v18
v_add_u32 v14, s44, v22
v_add_u32 v11, s44, v19
v_add_u32 v15, s44, v23
ds_read_b128 a[208:211], v8 offset:0
ds_read_b64_tr_b16 a[192:193], v12 offset:0
v_mfma_f32_32x32x16_bf16 v[128:143], a[216:219], a[236:239], v[128:143]
ds_read_b64_tr_b16 a[194:195], v12 offset:1024
ds_read_b128 a[212:215], v8 offset:4096
s_add_u32 s44, s44, 49152
s_cmp_ge_u32 s44, 163840
s_cselect_b32 s44, 16384, s44
v_mfma_f32_32x32x16_bf16 v[80:95], a[220:223], a[232:235], v[80:95]
ds_read_b64_tr_b16 a[196:197], v13 offset:0
ds_read_b64_tr_b16 a[198:199], v13 offset:1024
v_mfma_f32_32x32x16_bf16 v[144:159], a[220:223], a[236:239], v[144:159]
ds_read_b64_tr_b16 a[200:201], v14 offset:0
ds_read_b64_tr_b16 a[202:203], v14 offset:1024
s_getpc_b64 s[54:55]
attn_pcb:
s_lshr_b32 s32, s2, 3
s_lshl_b32 s32, s32, 2
s_add_u32 s32, s32, s20
s_mul_i32 s32, s32, 256
v_lshrrev_b32 v58, 4, v204
v_min_u32 v58, 1, v58
v_lshlrev_b32 v58, 7, v58
v_add_u32 v58, s32, v58
v_add_u32 v58, attn_body-attn_pcb, v58
v_min_u32 v58, attn_phasec-attn_pcb, v58
v_mov_b32 v59, s55
v_add_co_u32 v58, s[52:53], s54, v58
s_nop 1
v_addc_co_u32 v59, s[52:53], 0, v59, s[52:53]
global_load_dword v253, v[58:59], off
v_mfma_f32_32x32x16_bf16 v[96:111], a[224:227], a[232:235], v[96:111]
ds_read_b64_tr_b16 a[204:205], v15 offset:0
ds_read_b64_tr_b16 a[206:207], v15 offset:1024
v_mfma_f32_32x32x16_bf16 v[160:175], a[224:227], a[236:239], v[160:175]
s_add_u32 m0, s43, s45
s_nop 0
buffer_load_dwordx4 v28, s[60:63], s42 offen lds
v_mfma_f32_32x32x16_bf16 v[112:127], a[228:231], a[232:235], v[112:127]
buffer_load_dwordx4 v29, s[60:63], s42 offen offset:1024 lds
v_mfma_f32_32x32x16_bf16 v[176:191], a[228:231], a[236:239], v[176:191]
buffer_load_dwordx4 v30, s[60:63], s42 offen offset:2048 lds
s_waitcnt lgkmcnt(7)
v_mfma_f32_32x32x16_bf16 v[64:79], a[192:195], a[208:211], v[64:79]
ds_read_b128 a[232:235], v9 offset:0
ds_read_b64_tr_b16 a[216:217], v12 offset:4096
s_waitcnt lgkmcnt(8)
v_mfma_f32_32x32x16_bf16 v[128:143], a[192:195], a[212:215], v[128:143]
ds_read_b64_tr_b16 a[218:219], v12 offset:5120
ds_read_b128 a[236:239], v9 offset:4096
s_waitcnt lgkmcnt(8)
v_mfma_f32_32x32x16_bf16 v[80:95], a[196:199], a[208:211], v[80:95]
ds_read_b64_tr_b16 a[220:221], v13 offset:4096
ds_read_b64_tr_b16 a[222:223], v13 offset:5120
v_mfma_f32_32x32x16_bf16 v[144:159], a[196:199], a[212:215], v[144:159]
ds_read_b64_tr_b16 a[224:225], v14 offset:4096
ds_read_b64_tr_b16 a[226:227], v14 offset:5120
s_waitcnt lgkmcnt(10)
v_mfma_f32_32x32x16_bf16 v[96:111], a[200:203], a[208:211], v[96:111]
ds_read_b64_tr_b16 a[228:229], v15 offset:4096
ds_read_b64_tr_b16 a[230:231], v15 offset:5120
v_mfma_f32_32x32x16_bf16 v[160:175], a[200:203], a[212:215], v[160:175]
buffer_load_dwordx4 v31, s[60:63], s42 offen offset:3072 lds
s_add_u32 s42, s42, 524288
s_waitcnt lgkmcnt(10)
v_mfma_f32_32x32x16_bf16 v[112:127], a[204:207], a[208:211], v[112:127]
s_add_u32 s47, s43, s46
s_mov_b32 m0, s47
s_nop 0
buffer_load_dwordx4 v24, s[12:15], s40 offen lds
v_mfma_f32_32x32x16_bf16 v[176:191], a[204:207], a[212:215], v[176:191]
buffer_load_dwordx4 v25, s[12:15], s40 offen offset:1024 lds
s_waitcnt lgkmcnt(7)
v_mfma_f32_32x32x16_bf16 v[64:79], a[216:219], a[232:235], v[64:79]
ds_read_b128 a[208:211], v10 offset:0
ds_read_b64_tr_b16 a[192:193], v12 offset:8192
s_waitcnt lgkmcnt(8)
v_mfma_f32_32x32x16_bf16 v[128:143], a[216:219], a[236:239], v[128:143]
ds_read_b64_tr_b16 a[194:195], v12 offset:9216
ds_read_b128 a[212:215], v10 offset:4096
s_waitcnt lgkmcnt(8)
v_mfma_f32_32x32x16_bf16 v[80:95], a[220:223], a[232:235], v[80:95]
ds_read_b64_tr_b16 a[196:197], v13 offset:8192
ds_read_b64_tr_b16 a[198:199], v13 offset:9216
s_lshl_b32 s27, s21, 19
s_lshl_b32 s29, s22, 15
s_sub_u32 s29, 0x80000, s29
s_add_u32 s4, s34, 16777216
s_addc_u32 s5, s35, 0
s_add_u32 s4, s4, s27
s_addc_u32 s5, s5, 0
s_and_b32 s5, s5, 0xffff
s_mov_b32 s6, s29
s_mov_b32 s7, 0x20000
s_add_u32 s8, s34, 33554432
s_addc_u32 s9, s35, 0
s_add_u32 s8, s8, s27
s_addc_u32 s9, s9, 0
s_and_b32 s9, s9, 0xffff
s_mov_b32 s10, s29
s_mov_b32 s11, 0x20000
s_add_u32 s16, s34, 50331648
s_addc_u32 s17, s35, 0
s_and_b32 s17, s17, 0xffff
s_mov_b32 s18, 16777216
s_mov_b32 s19, 0x20000
s_lshl_b32 s27, s36, 5
s_add_u32 s27, s27, s21
s_lshl_b32 s56, s27, 13
s_add_u32 s57, s56, 4096
s_lshl_b32 s27, s37, 5
s_add_u32 s27, s27, s21
s_lshl_b32 s58, s27, 13
s_add_u32 s59, s58, 4096
v_mfma_f32_32x32x16_bf16 v[144:159], a[220:223], a[236:239], v[144:159]
ds_read_b64_tr_b16 a[200:201], v14 offset:8192
ds_read_b64_tr_b16 a[202:203], v14 offset:9216
s_waitcnt lgkmcnt(10)
v_mfma_f32_32x32x16_bf16 v[96:111], a[224:227], a[232:235], v[96:111]
ds_read_b64_tr_b16 a[204:205], v15 offset:8192
ds_read_b64_tr_b16 a[206:207], v15 offset:9216
v_mfma_f32_32x32x16_bf16 v[160:175], a[224:227], a[236:239], v[160:175]
buffer_load_dwordx4 v26, s[12:15], s40 offen offset:2048 lds
s_waitcnt lgkmcnt(10)
v_mfma_f32_32x32x16_bf16 v[112:127], a[228:231], a[232:235], v[112:127]
buffer_load_dwordx4 v27, s[12:15], s40 offen offset:3072 lds
s_add_u32 s40, s40, 128
v_mfma_f32_32x32x16_bf16 v[176:191], a[228:231], a[236:239], v[176:191]
s_add_u32 m0, s47, 4096
s_nop 0
buffer_load_dwordx4 v24, s[12:15], s41 offen lds
s_waitcnt lgkmcnt(7)
v_mfma_f32_32x32x16_bf16 v[64:79], a[192:195], a[208:211], v[64:79]
ds_read_b128 a[232:235], v11 offset:0
ds_read_b64_tr_b16 a[216:217], v12 offset:12288
s_waitcnt lgkmcnt(8)
v_mfma_f32_32x32x16_bf16 v[128:143], a[192:195], a[212:215], v[128:143]
ds_read_b64_tr_b16 a[218:219], v12 offset:13312
ds_read_b128 a[236:239], v11 offset:4096
s_waitcnt lgkmcnt(8)
v_mfma_f32_32x32x16_bf16 v[80:95], a[196:199], a[208:211], v[80:95]
ds_read_b64_tr_b16 a[220:221], v13 offset:12288
ds_read_b64_tr_b16 a[222:223], v13 offset:13312
v_mfma_f32_32x32x16_bf16 v[144:159], a[196:199], a[212:215], v[144:159]
ds_read_b64_tr_b16 a[224:225], v14 offset:12288
ds_read_b64_tr_b16 a[226:227], v14 offset:13312
s_waitcnt lgkmcnt(10)
v_mfma_f32_32x32x16_bf16 v[96:111], a[200:203], a[208:211], v[96:111]
ds_read_b64_tr_b16 a[228:229], v15 offset:12288
ds_read_b64_tr_b16 a[230:231], v15 offset:13312
v_mfma_f32_32x32x16_bf16 v[160:175], a[200:203], a[212:215], v[160:175]
buffer_load_dwordx4 v25, s[12:15], s41 offen offset:1024 lds
s_waitcnt lgkmcnt(10)
v_mfma_f32_32x32x16_bf16 v[112:127], a[204:207], a[208:211], v[112:127]
buffer_load_dwordx4 v26, s[12:15], s41 offen offset:2048 lds
v_mfma_f32_32x32x16_bf16 v[176:191], a[204:207], a[212:215], v[176:191]
buffer_load_dwordx4 v27, s[12:15], s41 offen offset:3072 lds
s_add_u32 s41, s41, 128
s_add_u32 s43, s43, 49152
s_cmp_ge_u32 s43, 163840
s_cselect_b32 s43, 16384, s43
s_waitcnt lgkmcnt(0)
s_waitcnt vmcnt(13)
s_barrier
v_mfma_f32_32x32x16_bf16 v[64:79], a[216:219], a[232:235], v[64:79]
v_add_u32 v8, s44, v16
v_add_u32 v12, s44, v20
v_add_u32 v9, s44, v17
v_add_u32 v13, s44, v21
v_add_u32 v10, s44, v18
v_add_u32 v14, s44, v22
v_add_u32 v11, s44, v19
v_add_u32 v15, s44, v23
ds_read_b128 a[208:211], v8 offset:0
ds_read_b64_tr_b16 a[192:193], v12 offset:0
v_mfma_f32_32x32x16_bf16 v[128:143], a[216:219], a[236:239], v[128:143]
ds_read_b64_tr_b16 a[194:195], v12 offset:1024
ds_read_b128 a[212:215], v8 offset:4096
s_add_u32 s44, s44, 49152
s_cmp_ge_u32 s44, 163840
s_cselect_b32 s44, 16384, s44
v_mfma_f32_32x32x16_bf16 v[80:95], a[220:223], a[232:235], v[80:95]
ds_read_b64_tr_b16 a[196:197], v13 offset:0
ds_read_b64_tr_b16 a[198:199], v13 offset:1024
v_mfma_f32_32x32x16_bf16 v[144:159], a[220:223], a[236:239], v[144:159]
ds_read_b64_tr_b16 a[200:201], v14 offset:0
ds_read_b64_tr_b16 a[202:203], v14 offset:1024
v_mfma_f32_32x32x16_bf16 v[96:111], a[224:227], a[232:235], v[96:111]
ds_read_b64_tr_b16 a[204:205], v15 offset:0
ds_read_b64_tr_b16 a[206:207], v15 offset:1024
v_mfma_f32_32x32x16_bf16 v[160:175], a[224:227], a[236:239], v[160:175]
v_mfma_f32_32x32x16_bf16 v[112:127], a[228:231], a[232:235], v[112:127]
v_mfma_f32_32x32x16_bf16 v[176:191], a[228:231], a[236:239], v[176:191]
s_waitcnt lgkmcnt(7)
v_mfma_f32_32x32x16_bf16 v[64:79], a[192:195], a[208:211], v[64:79]
ds_read_b128 a[232:235], v9 offset:0
ds_read_b64_tr_b16 a[216:217], v12 offset:4096
s_waitcnt lgkmcnt(8)
v_mfma_f32_32x32x16_bf16 v[128:143], a[192:195], a[212:215], v[128:143]
ds_read_b64_tr_b16 a[218:219], v12 offset:5120
ds_read_b128 a[236:239], v9 offset:4096
s_waitcnt lgkmcnt(8)
v_mfma_f32_32x32x16_bf16 v[80:95], a[196:199], a[208:211], v[80:95]
ds_read_b64_tr_b16 a[220:221], v13 offset:4096
ds_read_b64_tr_b16 a[222:223], v13 offset:5120
v_mfma_f32_32x32x16_bf16 v[144:159], a[196:199], a[212:215], v[144:159]
ds_read_b64_tr_b16 a[224:225], v14 offset:4096
ds_read_b64_tr_b16 a[226:227], v14 offset:5120
s_waitcnt lgkmcnt(10)
v_mfma_f32_32x32x16_bf16 v[96:111], a[200:203], a[208:211], v[96:111]
ds_read_b64_tr_b16 a[228:229], v15 offset:4096
ds_read_b64_tr_b16 a[230:231], v15 offset:5120
v_mfma_f32_32x32x16_bf16 v[160:175], a[200:203], a[212:215], v[160:175]
s_waitcnt lgkmcnt(10)
v_mfma_f32_32x32x16_bf16 v[112:127], a[204:207], a[208:211], v[112:127]
v_mfma_f32_32x32x16_bf16 v[176:191], a[204:207], a[212:215], v[176:191]
s_waitcnt lgkmcnt(7)
v_mfma_f32_32x32x16_bf16 v[64:79], a[216:219], a[232:235], v[64:79]
ds_read_b128 a[208:211], v10 offset:0
ds_read_b64_tr_b16 a[192:193], v12 offset:8192
s_waitcnt lgkmcnt(8)
v_mfma_f32_32x32x16_bf16 v[128:143], a[216:219], a[236:239], v[128:143]
ds_read_b64_tr_b16 a[194:195], v12 offset:9216
ds_read_b128 a[212:215], v10 offset:4096
s_waitcnt lgkmcnt(8)
v_mfma_f32_32x32x16_bf16 v[80:95], a[220:223], a[232:235], v[80:95]
ds_read_b64_tr_b16 a[196:197], v13 offset:8192
ds_read_b64_tr_b16 a[198:199], v13 offset:9216
v_mfma_f32_32x32x16_bf16 v[144:159], a[220:223], a[236:239], v[144:159]
ds_read_b64_tr_b16 a[200:201], v14 offset:8192
ds_read_b64_tr_b16 a[202:203], v14 offset:9216
s_waitcnt lgkmcnt(10)
v_mfma_f32_32x32x16_bf16 v[96:111], a[224:227], a[232:235], v[96:111]
ds_read_b64_tr_b16 a[204:205], v15 offset:8192
ds_read_b64_tr_b16 a[206:207], v15 offset:9216
v_mfma_f32_32x32x16_bf16 v[160:175], a[224:227], a[236:239], v[160:175]
s_waitcnt lgkmcnt(10)
v_mfma_f32_32x32x16_bf16 v[112:127], a[228:231], a[232:235], v[112:127]
s_mov_b32 s76, s100
s_and_b32 s77, s101, 0xffff
s_mov_b32 s78, 256
s_mov_b32 s79, 0x20000
s_add_u32 s92, s34, 71368704
s_addc_u32 s93, s35, 0
s_and_b32 s93, s93, 0xffff
s_mov_b32 s94, 4096
s_mov_b32 s95, 0x20000
s_lshl_b32 s91, s21, 7
v_lshrrev_b32 v233, 2, v204
v_mov_b32 v234, 0x40404040
s_cmp_eq_u32 s20, 0
s_cbranch_scc0 attn_nopoll0
buffer_load_dword v232, v233, s[76:79], 0 offen sc1
buffer_load_dword v235, v233, s[92:95], s91 offen sc1
attn_nopoll0:
v_mfma_f32_32x32x16_bf16 v[176:191], a[228:231], a[236:239], v[176:191]
s_waitcnt lgkmcnt(7)
v_mfma_f32_32x32x16_bf16 v[64:79], a[192:195], a[208:211], v[64:79]
ds_read_b128 a[232:235], v11 offset:0
ds_read_b64_tr_b16 a[216:217], v12 offset:12288
s_waitcnt lgkmcnt(8)
v_mfma_f32_32x32x16_bf16 v[128:143], a[192:195], a[212:215], v[128:143]
ds_read_b64_tr_b16 a[218:219], v12 offset:13312
ds_read_b128 a[236:239], v11 offset:4096
s_waitcnt lgkmcnt(8)
v_mfma_f32_32x32x16_bf16 v[80:95], a[196:199], a[208:211], v[80:95]
ds_read_b64_tr_b16 a[220:221], v13 offset:12288
ds_read_b64_tr_b16 a[222:223], v13 offset:13312
v_mfma_f32_32x32x16_bf16 v[144:159], a[196:199], a[212:215], v[144:159]
ds_read_b64_tr_b16 a[224:225], v14 offset:12288
ds_read_b64_tr_b16 a[226:227], v14 offset:13312
s_waitcnt lgkmcnt(10)
v_mfma_f32_32x32x16_bf16 v[96:111], a[200:203], a[208:211], v[96:111]
ds_read_b64_tr_b16 a[228:229], v15 offset:12288
ds_read_b64_tr_b16 a[230:231], v15 offset:13312
v_mfma_f32_32x32x16_bf16 v[160:175], a[200:203], a[212:215], v[160:175]
s_waitcnt lgkmcnt(10)
v_mfma_f32_32x32x16_bf16 v[112:127], a[204:207], a[208:211], v[112:127]
v_mfma_f32_32x32x16_bf16 v[176:191], a[204:207], a[212:215], v[176:191]
s_waitcnt lgkmcnt(0)
s_waitcnt vmcnt(0)
s_cmp_eq_u32 s20, 0
s_cbranch_scc0 attn_polled
s_mov_b32 s24, 0
attn_poll:
s_waitcnt vmcnt(0)
v_and_b32 v232, v234, v232
v_cmp_ne_u32 vcc, v234, v232
v_cmp_ne_u32 s[54:55], 1, v235
s_nop 3
s_and_b32 s32, s54, 0xff
s_or_b32 s32, s32, vcc_lo
s_or_b32 s32, s32, vcc_hi
s_cmp_eq_u32 s32, 0
s_cbranch_scc1 attn_polled
s_add_u32 s24, s24, 1
s_cmp_ge_u32 s24, 0x20000
s_cbranch_scc1 attn_polled
buffer_load_dword v232, v233, s[76:79], 0 offen sc1
buffer_load_dword v235, v233, s[92:95], s91 offen sc1
s_branch attn_poll
attn_polled:
s_barrier
v_mfma_f32_32x32x16_bf16 v[64:79], a[216:219], a[232:235], v[64:79]
v_add_u32 v8, s44, v16
v_add_u32 v12, s44, v20
v_add_u32 v9, s44, v17
v_add_u32 v13, s44, v21
v_add_u32 v10, s44, v18
v_add_u32 v14, s44, v22
v_add_u32 v11, s44, v19
v_add_u32 v15, s44, v23
ds_read_b128 a[208:211], v8 offset:0
ds_read_b64_tr_b16 a[192:193], v12 offset:0
v_mfma_f32_32x32x16_bf16 v[128:143], a[216:219], a[236:239], v[128:143]
ds_read_b64_tr_b16 a[194:195], v12 offset:1024
ds_read_b128 a[212:215], v8 offset:4096
s_add_u32 s44, s44, 49152
s_cmp_ge_u32 s44, 163840
s_cselect_b32 s44, 16384, s44
v_mfma_f32_32x32x16_bf16 v[80:95], a[220:223], a[232:235], v[80:95]
ds_read_b64_tr_b16 a[196:197], v13 offset:0
ds_read_b64_tr_b16 a[198:199], v13 offset:1024
s_and_b32 m0, s25, 0xffff
s_nop 0
buffer_load_dwordx4 v204, s[4:7], s25 offen lds
v_mfma_f32_32x32x16_bf16 v[144:159], a[220:223], a[236:239], v[144:159]
ds_read_b64_tr_b16 a[200:201], v14 offset:0
ds_read_b64_tr_b16 a[202:203], v14 offset:1024
buffer_load_dwordx4 v204, s[4:7], s25 offen offset:1024 lds
s_add_u32 s25, s25, 8192
v_mfma_f32_32x32x16_bf16 v[96:111], a[224:227], a[232:235], v[96:111]
ds_read_b64_tr_b16 a[204:205], v15 offset:0
ds_read_b64_tr_b16 a[206:207], v15 offset:1024
s_and_b32 m0, s25, 0xffff
s_nop 0
buffer_load_dwordx4 v204, s[4:7], s25 offen lds
v_mfma_f32_32x32x16_bf16 v[160:175], a[224:227], a[236:239], v[160:175]
buffer_load_dwordx4 v204, s[4:7], s25 offen offset:1024 lds
s_add_u32 s25, s25, 8192
v_mfma_f32_32x32x16_bf16 v[112:127], a[228:231], a[232:235], v[112:127]
s_and_b32 m0, s25, 0xffff
s_nop 0
buffer_load_dwordx4 v204, s[4:7], s25 offen lds
v_mfma_f32_32x32x16_bf16 v[176:191], a[228:231], a[236:239], v[176:191]
buffer_load_dwordx4 v204, s[4:7], s25 offen offset:1024 lds
s_add_u32 s25, s25, 8192
s_waitcnt lgkmcnt(7)
v_mfma_f32_32x32x16_bf16 v[64:79], a[192:195], a[208:211], v[64:79]
ds_read_b128 a[232:235], v9 offset:0
ds_read_b64_tr_b16 a[216:217], v12 offset:4096
s_waitcnt lgkmcnt(8)
v_mfma_f32_32x32x16_bf16 v[128:143], a[192:195], a[212:215], v[128:143]
ds_read_b64_tr_b16 a[218:219], v12 offset:5120
ds_read_b128 a[236:239], v9 offset:4096
s_and_b32 m0, s25, 0xffff
s_nop 0
buffer_load_dwordx4 v204, s[4:7], s25 offen lds
s_waitcnt lgkmcnt(8)
v_mfma_f32_32x32x16_bf16 v[80:95], a[196:199], a[208:211], v[80:95]
ds_read_b64_tr_b16 a[220:221], v13 offset:4096
ds_read_b64_tr_b16 a[222:223], v13 offset:5120
buffer_load_dwordx4 v204, s[4:7], s25 offen offset:1024 lds
s_add_u32 s25, s25, 8192
v_mfma_f32_32x32x16_bf16 v[144:159], a[196:199], a[212:215], v[144:159]
ds_read_b64_tr_b16 a[224:225], v14 offset:4096
ds_read_b64_tr_b16 a[226:227], v14 offset:5120
s_waitcnt lgkmcnt(10)
v_mfma_f32_32x32x16_bf16 v[96:111], a[200:203], a[208:211], v[96:111]
ds_read_b64_tr_b16 a[228:229], v15 offset:4096
ds_read_b64_tr_b16 a[230:231], v15 offset:5120
s_and_b32 m0, s25, 0xffff
s_nop 0
buffer_load_dwordx4 v204, s[4:7], s25 offen lds
v_mfma_f32_32x32x16_bf16 v[160:175], a[200:203], a[212:215], v[160:175]
buffer_load_dwordx4 v204, s[4:7], s25 offen offset:1024 lds
s_add_u32 s25, s25, 8192
s_waitcnt lgkmcnt(10)
v_mfma_f32_32x32x16_bf16 v[112:127], a[204:207], a[208:211], v[112:127]
v_mfma_f32_32x32x16_bf16 v[176:191], a[204:207], a[212:215], v[176:191]
s_and_b32 m0, s25, 0xffff
s_nop 0
buffer_load_dwordx4 v204, s[4:7], s25 offen lds
s_waitcnt lgkmcnt(7)
v_mfma_f32_32x32x16_bf16 v[64:79], a[216:219], a[232:235], v[64:79]
ds_read_b128 a[208:211], v10 offset:0
ds_read_b64_tr_b16 a[192:193], v12 offset:8192
s_waitcnt lgkmcnt(8)
v_mfma_f32_32x32x16_bf16 v[128:143], a[216:219], a[236:239], v[128:143]
ds_read_b64_tr_b16 a[194:195], v12 offset:9216
ds_read_b128 a[212:215], v10 offset:4096
buffer_load_dwordx4 v204, s[4:7], s25 offen offset:1024 lds
s_add_u32 s25, s25, 8192
s_waitcnt lgkmcnt(8)
v_mfma_f32_32x32x16_bf16 v[80:95], a[220:223], a[232:235], v[80:95]
ds_read_b64_tr_b16 a[196:197], v13 offset:8192
ds_read_b64_tr_b16 a[198:199], v13 offset:9216
s_and_b32 s27, s26, 0xffff
s_or_b32 m0, s27, 0x10000
s_nop 0
buffer_load_dwordx4 v204, s[8:11], s26 offen lds
v_mfma_f32_32x32x16_bf16 v[144:159], a[220:223], a[236:239], v[144:159]
ds_read_b64_tr_b16 a[200:201], v14 offset:8192
ds_read_b64_tr_b16 a[202:203], v14 offset:9216
s_waitcnt lgkmcnt(10)
v_mfma_f32_32x32x16_bf16 v[96:111], a[224:227], a[232:235], v[96:111]
ds_read_b64_tr_b16 a[204:205], v15 offset:8192
ds_read_b64_tr_b16 a[206:207], v15 offset:9216
buffer_load_dwordx4 v204, s[8:11], s26 offen offset:1024 lds
s_add_u32 s26, s26, 8192
v_mfma_f32_32x32x16_bf16 v[160:175], a[224:227], a[236:239], v[160:175]
s_waitcnt lgkmcnt(10)
v_mfma_f32_32x32x16_bf16 v[112:127], a[228:231], a[232:235], v[112:127]
s_and_b32 s27, s26, 0xffff
s_or_b32 m0, s27, 0x10000
s_nop 0
buffer_load_dwordx4 v204, s[8:11], s26 offen lds
v_mfma_f32_32x32x16_bf16 v[176:191], a[228:231], a[236:239], v[176:191]
buffer_load_dwordx4 v204, s[8:11], s26 offen offset:1024 lds
s_add_u32 s26, s26, 8192
s_waitcnt lgkmcnt(7)
v_mfma_f32_32x32x16_bf16 v[64:79], a[192:195], a[208:211], v[64:79]
ds_read_b128 a[232:235], v11 offset:0
ds_read_b64_tr_b16 a[216:217], v12 offset:12288
s_waitcnt lgkmcnt(8)
v_mfma_f32_32x32x16_bf16 v[128:143], a[192:195], a[212:215], v[128:143]
ds_read_b64_tr_b16 a[218:219], v12 offset:13312
ds_read_b128 a[236:239], v11 offset:4096
s_and_b32 s27, s26, 0xffff
s_or_b32 m0, s27, 0x10000
s_nop 0
buffer_load_dwordx4 v204, s[8:11], s26 offen lds
s_waitcnt lgkmcnt(8)
v_mfma_f32_32x32x16_bf16 v[80:95], a[196:199], a[208:211], v[80:95]
ds_read_b64_tr_b16 a[220:221], v13 offset:12288
ds_read_b64_tr_b16 a[222:223], v13 offset:13312
v_mfma_f32_32x32x16_bf16 v[144:159], a[196:199], a[212:215], v[144:159]
ds_read_b64_tr_b16 a[224:225], v14 offset:12288
ds_read_b64_tr_b16 a[226:227], v14 offset:13312
buffer_load_dwordx4 v204, s[8:11], s26 offen offset:1024 lds
s_add_u32 s26, s26, 8192
s_waitcnt lgkmcnt(10)
v_mfma_f32_32x32x16_bf16 v[96:111], a[200:203], a[208:211], v[96:111]
ds_read_b64_tr_b16 a[228:229], v15 offset:12288
ds_read_b64_tr_b16 a[230:231], v15 offset:13312
s_and_b32 s27, s26, 0xffff
s_or_b32 m0, s27, 0x10000
s_nop 0
buffer_load_dwordx4 v204, s[8:11], s26 offen lds
v_mfma_f32_32x32x16_bf16 v[160:175], a[200:203], a[212:215], v[160:175]
s_waitcnt lgkmcnt(10)
v_mfma_f32_32x32x16_bf16 v[112:127], a[204:207], a[208:211], v[112:127]
buffer_load_dwordx4 v204, s[8:11], s26 offen offset:1024 lds
s_add_u32 s26, s26, 8192
v_mfma_f32_32x32x16_bf16 v[176:191], a[204:207], a[212:215], v[176:191]
s_waitcnt lgkmcnt(7)
v_mfma_f32_32x32x16_bf16 v[64:79], a[216:219], a[232:235], v[64:79]
s_waitcnt lgkmcnt(6)
v_mfma_f32_32x32x16_bf16 v[128:143], a[216:219], a[236:239], v[128:143]
s_waitcnt lgkmcnt(4)
v_mfma_f32_32x32x16_bf16 v[80:95], a[220:223], a[232:235], v[80:95]
v_mfma_f32_32x32x16_bf16 v[144:159], a[220:223], a[236:239], v[144:159]
s_waitcnt lgkmcnt(2)
v_mfma_f32_32x32x16_bf16 v[96:111], a[224:227], a[232:235], v[96:111]
v_mfma_f32_32x32x16_bf16 v[160:175], a[224:227], a[236:239], v[160:175]
s_waitcnt lgkmcnt(0)
v_mfma_f32_32x32x16_bf16 v[112:127], a[228:231], a[232:235], v[112:127]
v_mfma_f32_32x32x16_bf16 v[176:191], a[228:231], a[236:239], v[176:191]
s_nop 7
v_cvt_pk_bf16_f32 v0, v64, v65
v_cvt_pk_bf16_f32 v1, v66, v67
v_cvt_pk_bf16_f32 v2, v68, v69
v_cvt_pk_bf16_f32 v3, v70, v71
v_cvt_pk_bf16_f32 v4, v72, v73
v_cvt_pk_bf16_f32 v5, v74, v75
v_cvt_pk_bf16_f32 v6, v76, v77
v_cvt_pk_bf16_f32 v7, v78, v79
v_cvt_pk_bf16_f32 v8, v80, v81
v_cvt_pk_bf16_f32 v9, v82, v83
v_cvt_pk_bf16_f32 v10, v84, v85
v_cvt_pk_bf16_f32 v11, v86, v87
v_cvt_pk_bf16_f32 v12, v88, v89
v_cvt_pk_bf16_f32 v13, v90, v91
v_cvt_pk_bf16_f32 v14, v92, v93
v_cvt_pk_bf16_f32 v15, v94, v95
v_cvt_pk_bf16_f32 v16, v96, v97
v_cvt_pk_bf16_f32 v17, v98, v99
v_cvt_pk_bf16_f32 v18, v100, v101
v_cvt_pk_bf16_f32 v19, v102, v103
v_cvt_pk_bf16_f32 v20, v104, v105
v_cvt_pk_bf16_f32 v21, v106, v107
v_cvt_pk_bf16_f32 v22, v108, v109
v_cvt_pk_bf16_f32 v23, v110, v111
v_cvt_pk_bf16_f32 v24, v112, v113
v_cvt_pk_bf16_f32 v25, v114, v115
v_cvt_pk_bf16_f32 v26, v116, v117
v_cvt_pk_bf16_f32 v27, v118, v119
v_cvt_pk_bf16_f32 v28, v120, v121
v_cvt_pk_bf16_f32 v29, v122, v123
v_cvt_pk_bf16_f32 v30, v124, v125
v_cvt_pk_bf16_f32 v31, v126, v127
v_cvt_pk_bf16_f32 v32, v128, v129
v_cvt_pk_bf16_f32 v33, v130, v131
v_cvt_pk_bf16_f32 v34, v132, v133
v_cvt_pk_bf16_f32 v35, v134, v135
v_cvt_pk_bf16_f32 v36, v136, v137
v_cvt_pk_bf16_f32 v37, v138, v139
v_cvt_pk_bf16_f32 v38, v140, v141
v_cvt_pk_bf16_f32 v39, v142, v143
v_cvt_pk_bf16_f32 v40, v144, v145
v_cvt_pk_bf16_f32 v41, v146, v147
v_cvt_pk_bf16_f32 v42, v148, v149
v_cvt_pk_bf16_f32 v43, v150, v151
v_cvt_pk_bf16_f32 v44, v152, v153
v_cvt_pk_bf16_f32 v45, v154, v155
v_cvt_pk_bf16_f32 v46, v156, v157
v_cvt_pk_bf16_f32 v47, v158, v159
v_cvt_pk_bf16_f32 v48, v160, v161
v_cvt_pk_bf16_f32 v49, v162, v163
v_cvt_pk_bf16_f32 v50, v164, v165
v_cvt_pk_bf16_f32 v51, v166, v167
v_cvt_pk_bf16_f32 v52, v168, v169
v_cvt_pk_bf16_f32 v53, v170, v171
v_cvt_pk_bf16_f32 v54, v172, v173
v_cvt_pk_bf16_f32 v55, v174, v175
v_cvt_pk_bf16_f32 v56, v176, v177
v_cvt_pk_bf16_f32 v57, v178, v179
v_cvt_pk_bf16_f32 v58, v180, v181
v_cvt_pk_bf16_f32 v59, v182, v183
v_cvt_pk_bf16_f32 v60, v184, v185
v_cvt_pk_bf16_f32 v61, v186, v187
v_cvt_pk_bf16_f32 v62, v188, v189
v_cvt_pk_bf16_f32 v63, v190, v191
s_mov_b32 s12, s68
s_and_b32 s13, s69, 0xffff
s_mov_b32 s14, 7340032
s_mov_b32 s15, 0x20000
s_add_u32 s60, s34, 67108864
s_addc_u32 s61, s35, 0
s_and_b32 s61, s61, 0xffff
s_mov_b32 s62, 2097152
s_mov_b32 s63, 0x20000
s_cmp_eq_u32 s22, 7
s_cselect_b32 s14, 0, s14
s_cselect_b32 s62, 0, s62
attn_body:
s_waitcnt vmcnt(18)
s_barrier
s_and_b32 m0, s25, 0xffff
s_nop 0
buffer_load_dwordx4 v204, s[4:7], s25 offen lds
buffer_load_dwordx4 v204, s[4:7], s25 offen offset:1024 lds
s_add_u32 s25, s25, 8192
ds_read_b128 a[192:195], v205 offset:0
ds_read_b128 a[196:199], v205 offset:1024
ds_read_b128 a[200:203], v205 offset:2048
ds_read_b128 a[204:207], v205 offset:3072
s_waitcnt lgkmcnt(2)
v_mfma_f32_32x32x16_bf16 v[64:79], a[192:195], v[0:3], 0
ds_read_b128 a[208:211], v205 offset:4096
v_accvgpr_write_b32 a128, 0
v_accvgpr_write_b32 a129, 0
v_accvgpr_write_b32 a130, 0
v_accvgpr_write_b32 a131, 0
v_accvgpr_write_b32 a132, 0
v_accvgpr_write_b32 a133, 0
v_accvgpr_write_b32 a134, 0
v_accvgpr_write_b32 a135, 0
v_mfma_f32_32x32x16_bf16 v[80:95], a[192:195], v[32:35], 0
v_accvgpr_write_b32 a136, 0
v_accvgpr_write_b32 a137, 0
v_accvgpr_write_b32 a138, 0
v_accvgpr_write_b32 a139, 0
v_accvgpr_write_b32 a140, 0
v_accvgpr_write_b32 a141, 0
v_accvgpr_write_b32 a142, 0
v_accvgpr_write_b32 a143, 0
v_mfma_f32_32x32x16_bf16 v[64:79], a[196:199], v[4:7], v[64:79]
ds_read_b128 a[212:215], v205 offset:5120
v_accvgpr_write_b32 a144, 0
v_accvgpr_write_b32 a145, 0
v_accvgpr_write_b32 a146, 0
v_accvgpr_write_b32 a147, 0
v_accvgpr_write_b32 a148, 0
v_accvgpr_write_b32 a149, 0
v_accvgpr_write_b32 a150, 0
v_accvgpr_write_b32 a151, 0
v_mfma_f32_32x32x16_bf16 v[80:95], a[196:199], v[36:39], v[80:95]
v_accvgpr_write_b32 a152, 0
v_accvgpr_write_b32 a153, 0
v_accvgpr_write_b32 a154, 0
v_accvgpr_write_b32 a155, 0
v_accvgpr_write_b32 a156, 0
v_accvgpr_write_b32 a157, 0
v_accvgpr_write_b32 a158, 0
v_accvgpr_write_b32 a159, 0
s_waitcnt lgkmcnt(2)
v_mfma_f32_32x32x16_bf16 v[64:79], a[200:203], v[8:11], v[64:79]
ds_read_b128 a[216:219], v205 offset:6144
v_accvgpr_write_b32 a160, 0
v_accvgpr_write_b32 a161, 0
v_accvgpr_write_b32 a162, 0
v_accvgpr_write_b32 a163, 0
v_accvgpr_write_b32 a164, 0
v_accvgpr_write_b32 a165, 0
v_accvgpr_write_b32 a166, 0
v_accvgpr_write_b32 a167, 0
v_mfma_f32_32x32x16_bf16 v[80:95], a[200:203], v[40:43], v[80:95]
v_accvgpr_write_b32 a168, 0
v_accvgpr_write_b32 a169, 0
v_accvgpr_write_b32 a170, 0
v_accvgpr_write_b32 a171, 0
v_accvgpr_write_b32 a172, 0
v_accvgpr_write_b32 a173, 0
v_accvgpr_write_b32 a174, 0
v_accvgpr_write_b32 a175, 0
v_mfma_f32_32x32x16_bf16 v[64:79], a[204:207], v[12:15], v[64:79]
ds_read_b128 a[220:223], v205 offset:7168
v_accvgpr_write_b32 a176, 0
v_accvgpr_write_b32 a177, 0
v_accvgpr_write_b32 a178, 0
v_accvgpr_write_b32 a179, 0
v_accvgpr_write_b32 a180, 0
v_accvgpr_write_b32 a181, 0
v_accvgpr_write_b32 a182, 0
v_accvgpr_write_b32 a183, 0
v_mfma_f32_32x32x16_bf16 v[80:95], a[204:207], v[44:47], v[80:95]
v_accvgpr_write_b32 a184, 0
v_accvgpr_write_b32 a185, 0
v_accvgpr_write_b32 a186, 0
v_accvgpr_write_b32 a187, 0
v_accvgpr_write_b32 a188, 0
v_accvgpr_write_b32 a189, 0
v_accvgpr_write_b32 a190, 0
v_accvgpr_write_b32 a191, 0
s_waitcnt lgkmcnt(2)
v_mfma_f32_32x32x16_bf16 v[64:79], a[208:211], v[16:19], v[64:79]
s_waitcnt vmcnt(18)
s_barrier
v_add_u32 v205, 8192, v205
v_and_b32 v205, 0xffff, v205
ds_read_b128 a[224:227], v205 offset:0
s_and_b32 m0, s25, 0xffff
v_mfma_f32_32x32x16_bf16 v[80:95], a[208:211], v[48:51], v[80:95]
v_mfma_f32_32x32x16_bf16 v[64:79], a[212:215], v[20:23], v[64:79]
ds_read_b128 a[228:231], v205 offset:1024
v_mfma_f32_32x32x16_bf16 v[80:95], a[212:215], v[52:55], v[80:95]
buffer_load_dwordx4 v204, s[4:7], s25 offen lds
s_waitcnt lgkmcnt(2)
v_mfma_f32_32x32x16_bf16 v[64:79], a[216:219], v[24:27], v[64:79]
ds_read_b128 a[232:235], v205 offset:2048
v_mfma_f32_32x32x16_bf16 v[80:95], a[216:219], v[56:59], v[80:95]
buffer_load_dwordx4 v204, s[4:7], s25 offen offset:1024 lds
s_add_u32 s25, s25, 8192
v_mfma_f32_32x32x16_bf16 v[64:79], a[220:223], v[28:31], v[64:79]
ds_read_b128 a[236:239], v205 offset:3072
v_mfma_f32_32x32x16_bf16 v[80:95], a[220:223], v[60:63], v[80:95]
v_mov_b32 v232, v207
s_nop 12
s_cmp_lg_u32 s22, 0
s_cbranch_scc1 attn_nomask0
v_cmp_ge_i32 s[40:41], v232, 0
v_cmp_ge_i32 s[42:43], v232, 1
v_cmp_ge_i32 s[44:45], v232, 2
v_cmp_ge_i32 s[46:47], v232, 3
v_cmp_ge_i32 s[48:49], v232, 8
v_cmp_ge_i32 s[50:51], v232, 9
v_cmp_ge_i32 s[52:53], v232, 10
v_cmp_ge_i32 s[54:55], v232, 11
s_nop 1
v_cndmask_b32 v64, v209, v64, s[40:41]
v_cndmask_b32 v65, v209, v65, s[42:43]
v_cndmask_b32 v66, v209, v66, s[44:45]
v_cndmask_b32 v67, v209, v67, s[46:47]
v_cndmask_b32 v68, v209, v68, s[48:49]
v_cndmask_b32 v69, v209, v69, s[50:51]
v_cndmask_b32 v70, v209, v70, s[52:53]
v_cndmask_b32 v71, v209, v71, s[54:55]
v_cmp_ge_i32 s[40:41], v232, 16
v_cmp_ge_i32 s[42:43], v232, 17
v_cmp_ge_i32 s[44:45], v232, 18
v_cmp_ge_i32 s[46:47], v232, 19
v_cmp_ge_i32 s[48:49], v232, 24
v_cmp_ge_i32 s[50:51], v232, 25
v_cmp_ge_i32 s[52:53], v232, 26
v_cmp_ge_i32 s[54:55], v232, 27
s_nop 1
v_cndmask_b32 v72, v209, v72, s[40:41]
v_cndmask_b32 v73, v209, v73, s[42:43]
v_cndmask_b32 v74, v209, v74, s[44:45]
v_cndmask_b32 v75, v209, v75, s[46:47]
v_cndmask_b32 v76, v209, v76, s[48:49]
v_cndmask_b32 v77, v209, v77, s[50:51]
v_cndmask_b32 v78, v209, v78, s[52:53]
v_cndmask_b32 v79, v209, v79, s[54:55]
attn_nomask0:
v_max3_f32 v226, v64, v65, v66
v_max3_f32 v226, v226, v67, v68
v_max3_f32 v226, v226, v69, v70
v_max3_f32 v226, v226, v71, v72
v_max3_f32 v226, v226, v73, v74
v_max3_f32 v226, v226, v75, v76
v_max3_f32 v226, v226, v77, v78
v_max_f32 v226, v226, v79
v_mov_b32 v211, v226
s_nop 1
v_permlane32_swap_b32 v211, v226
s_nop 1
v_max_f32 v226, v226, v211
v_max3_f32 v227, v80, v81, v82
v_max3_f32 v227, v227, v83, v84
v_max3_f32 v227, v227, v85, v86
v_max3_f32 v227, v227, v87, v88
v_max3_f32 v227, v227, v89, v90
v_max3_f32 v227, v227, v91, v92
v_max3_f32 v227, v227, v93, v94
v_max_f32 v227, v227, v95
v_mov_b32 v211, v227
s_nop 1
v_permlane32_swap_b32 v211, v227
s_nop 1
v_max_f32 v227, v227, v211
v_sub_f32 v160, 0, v226
v_sub_f32 v176, 0, v227
v_sub_f32 v161, 0, v226
v_sub_f32 v177, 0, v227
v_sub_f32 v162, 0, v226
v_sub_f32 v178, 0, v227
v_sub_f32 v163, 0, v226
v_sub_f32 v179, 0, v227
v_sub_f32 v164, 0, v226
v_sub_f32 v180, 0, v227
v_sub_f32 v165, 0, v226
v_sub_f32 v181, 0, v227
v_sub_f32 v166, 0, v226
v_sub_f32 v182, 0, v227
v_sub_f32 v167, 0, v226
v_sub_f32 v183, 0, v227
v_sub_f32 v168, 0, v226
v_sub_f32 v184, 0, v227
v_sub_f32 v169, 0, v226
v_sub_f32 v185, 0, v227
v_sub_f32 v170, 0, v226
v_sub_f32 v186, 0, v227
v_sub_f32 v171, 0, v226
v_sub_f32 v187, 0, v227
v_sub_f32 v172, 0, v226
v_sub_f32 v188, 0, v227
v_sub_f32 v173, 0, v226
v_sub_f32 v189, 0, v227
v_sub_f32 v174, 0, v226
v_sub_f32 v190, 0, v227
v_sub_f32 v175, 0, v226
v_sub_f32 v191, 0, v227
s_nop 1
s_waitcnt lgkmcnt(2)
v_mfma_f32_32x32x16_bf16 v[96:111], a[224:227], v[0:3], v[160:175]
s_add_u32 m0, s89, 0
s_nop 0
buffer_load_dwordx4 v214, s[12:15], s85 offen lds
ds_read_b128 a[240:243], v205 offset:4096
v_sub_f32 v64, v64, v226
v_sub_f32 v65, v65, v226
v_exp_f32 v192, v64
v_sub_f32 v66, v66, v226
v_exp_f32 v193, v65
v_sub_f32 v67, v67, v226
v_mfma_f32_32x32x16_bf16 v[112:127], a[224:227], v[32:35], v[176:191]
buffer_load_dwordx4 v215, s[12:15], s85 offen offset:1024 lds
s_add_u32 s85, s85, 57344
s_add_u32 m0, s89, 2048
s_nop 0
v_exp_f32 v194, v66
v_add_f32 v200, v192, v193
v_cvt_pk_bf16_f32 v128, v192, v193
v_sub_f32 v68, v68, v226
v_exp_f32 v195, v67
v_add_f32 v200, v200, v194
v_mfma_f32_32x32x16_bf16 v[96:111], a[228:231], v[4:7], v[96:111]
buffer_load_dwordx4 v216, s[60:63], s88 offen lds
buffer_load_dwordx4 v217, s[60:63], s88 offen offset:1024 lds
s_add_u32 s88, s88, 16384
ds_read_b128 a[244:247], v205 offset:5120
v_sub_f32 v69, v69, v226
v_exp_f32 v196, v68
v_add_f32 v200, v200, v195
v_cvt_pk_bf16_f32 v129, v194, v195
v_mfma_f32_32x32x16_bf16 v[112:127], a[228:231], v[36:39], v[112:127]
s_add_u32 m0, s89, 4096
s_nop 0
v_sub_f32 v70, v70, v226
v_exp_f32 v197, v69
v_add_f32 v200, v200, v196
v_sub_f32 v71, v71, v226
v_exp_f32 v198, v70
v_add_f32 v200, v200, v197
v_cvt_pk_bf16_f32 v130, v196, v197
v_sub_f32 v72, v72, v226
v_exp_f32 v199, v71
s_waitcnt lgkmcnt(2)
v_mfma_f32_32x32x16_bf16 v[96:111], a[232:235], v[8:11], v[96:111]
buffer_load_dwordx4 v214, s[12:15], s85 offen lds
buffer_load_dwordx4 v215, s[12:15], s85 offen offset:1024 lds
s_add_u32 s85, s85, 57344
ds_read_b128 a[248:251], v205 offset:6144
v_add_f32 v200, v200, v198
v_sub_f32 v73, v73, v226
v_exp_f32 v192, v72
v_add_f32 v200, v200, v199
v_cvt_pk_bf16_f32 v131, v198, v199
v_mfma_f32_32x32x16_bf16 v[112:127], a[232:235], v[40:43], v[112:127]
s_add_u32 m0, s89, 6144
s_nop 0
buffer_load_dwordx4 v216, s[60:63], s88 offen lds
v_sub_f32 v74, v74, v226
v_exp_f32 v193, v73
v_add_f32 v200, v200, v192
v_sub_f32 v75, v75, v226
v_exp_f32 v194, v74
v_add_f32 v200, v200, v193
v_cvt_pk_bf16_f32 v132, v192, v193
v_mfma_f32_32x32x16_bf16 v[96:111], a[236:239], v[12:15], v[96:111]
buffer_load_dwordx4 v217, s[60:63], s88 offen offset:1024 lds
s_add_u32 s88, s88, 16384
ds_read_b128 a[252:255], v205 offset:7168
v_sub_f32 v76, v76, v226
v_exp_f32 v195, v75
v_add_f32 v200, v200, v194
v_sub_f32 v77, v77, v226
v_exp_f32 v196, v76
v_add_f32 v200, v200, v195
v_mfma_f32_32x32x16_bf16 v[112:127], a[236:239], v[44:47], v[112:127]
v_cvt_pk_bf16_f32 v133, v194, v195
v_sub_f32 v78, v78, v226
v_exp_f32 v197, v77
v_add_f32 v200, v200, v196
v_sub_f32 v79, v79, v226
v_exp_f32 v198, v78
v_add_f32 v200, v200, v197
v_cvt_pk_bf16_f32 v134, v196, v197
v_exp_f32 v199, v79
v_add_f32 v200, v200, v198
v_add_f32 v200, v200, v199
s_waitcnt lgkmcnt(2)
v_mfma_f32_32x32x16_bf16 v[96:111], a[240:243], v[16:19], v[96:111]
s_waitcnt vmcnt(18)
s_barrier
v_add_u32 v205, 8192, v205
v_and_b32 v205, 0xffff, v205
ds_read_b128 a[192:195], v205 offset:0
v_cvt_pk_bf16_f32 v135, v198, v199
v_sub_f32 v80, v80, v227
v_sub_f32 v81, v81, v227
v_exp_f32 v192, v80
v_sub_f32 v82, v82, v227
v_exp_f32 v193, v81
s_and_b32 m0, s25, 0xffff
v_mfma_f32_32x32x16_bf16 v[112:127], a[240:243], v[48:51], v[112:127]
v_sub_f32 v83, v83, v227
v_exp_f32 v194, v82
v_add_f32 v201, v192, v193
v_cvt_pk_bf16_f32 v136, v192, v193
v_sub_f32 v84, v84, v227
v_exp_f32 v195, v83
v_add_f32 v201, v201, v194
v_sub_f32 v85, v85, v227
v_exp_f32 v196, v84
v_add_f32 v201, v201, v195
v_cvt_pk_bf16_f32 v137, v194, v195
v_mfma_f32_32x32x16_bf16 v[96:111], a[244:247], v[20:23], v[96:111]
ds_read_b128 a[196:199], v205 offset:1024
v_sub_f32 v86, v86, v227
v_exp_f32 v197, v85
v_add_f32 v201, v201, v196
v_sub_f32 v87, v87, v227
v_exp_f32 v198, v86
v_add_f32 v201, v201, v197
v_cvt_pk_bf16_f32 v138, v196, v197
v_sub_f32 v88, v88, v227
v_exp_f32 v199, v87
v_mfma_f32_32x32x16_bf16 v[112:127], a[244:247], v[52:55], v[112:127]
buffer_load_dwordx4 v204, s[4:7], s25 offen lds
v_add_f32 v201, v201, v198
v_sub_f32 v89, v89, v227
v_exp_f32 v192, v88
v_add_f32 v201, v201, v199
v_cvt_pk_bf16_f32 v139, v198, v199
v_sub_f32 v90, v90, v227
v_exp_f32 v193, v89
v_add_f32 v201, v201, v192
v_sub_f32 v91, v91, v227
s_waitcnt lgkmcnt(2)
v_mfma_f32_32x32x16_bf16 v[96:111], a[248:251], v[24:27], v[96:111]
ds_read_b128 a[200:203], v205 offset:2048
v_exp_f32 v194, v90
v_add_f32 v201, v201, v193
v_cvt_pk_bf16_f32 v140, v192, v193
v_sub_f32 v92, v92, v227
v_exp_f32 v195, v91
v_add_f32 v201, v201, v194
v_sub_f32 v93, v93, v227
v_exp_f32 v196, v92
v_add_f32 v201, v201, v195
v_cvt_pk_bf16_f32 v141, v194, v195
v_mfma_f32_32x32x16_bf16 v[112:127], a[248:251], v[56:59], v[112:127]
buffer_load_dwordx4 v204, s[4:7], s25 offen offset:1024 lds
s_add_u32 s25, s25, 8192
v_sub_f32 v94, v94, v227
v_exp_f32 v197, v93
v_add_f32 v201, v201, v196
v_sub_f32 v95, v95, v227
v_exp_f32 v198, v94
v_add_f32 v201, v201, v197
v_cvt_pk_bf16_f32 v142, v196, v197
v_mfma_f32_32x32x16_bf16 v[96:111], a[252:255], v[28:31], v[96:111]
ds_read_b128 a[204:207], v205 offset:3072
v_exp_f32 v199, v95
v_add_f32 v201, v201, v198
v_add_f32 v201, v201, v199
v_cvt_pk_bf16_f32 v143, v198, v199
v_mfma_f32_32x32x16_bf16 v[112:127], a[252:255], v[60:63], v[112:127]
v_mov_b32 v202, v200
v_mov_b32 v203, v201
s_cmp_eq_u32 s22, 0
s_cbranch_scc1 attn_trans
s_sub_u32 s24, s23, 6
s_lshr_b32 s24, s24, 1
.p2align 6
attn_p1loop:
s_waitcnt lgkmcnt(2)
v_mfma_f32_32x32x16_bf16 v[64:79], a[192:195], v[0:3], v[160:175]
s_and_b32 s27, s26, 0xffff
s_or_b32 m0, s27, 0x10000
ds_read_b128 a[208:211], v205 offset:4096
v_exp_f32 v192, v96
v_mfma_f32_32x32x16_bf16 v[80:95], a[192:195], v[32:35], v[176:191]
v_exp_f32 v193, v97
v_exp_f32 v194, v98
v_add_f32 v200, v192, v193
v_mfma_f32_32x32x16_bf16 v[64:79], a[196:199], v[4:7], v[64:79]
buffer_load_dwordx4 v204, s[8:11], s26 offen lds
ds_read_b128 a[212:215], v205 offset:5120
v_cvt_pk_bf16_f32 v144, v192, v193
v_mfma_f32_32x32x16_bf16 v[80:95], a[196:199], v[36:39], v[80:95]
v_exp_f32 v195, v99
v_add_f32 v200, v200, v194
v_exp_f32 v196, v100
s_waitcnt lgkmcnt(2)
v_mfma_f32_32x32x16_bf16 v[64:79], a[200:203], v[8:11], v[64:79]
buffer_load_dwordx4 v204, s[8:11], s26 offen offset:1024 lds
s_add_u32 s26, s26, 8192
ds_read_b128 a[216:219], v205 offset:6144
v_add_f32 v200, v200, v195
v_mfma_f32_32x32x16_bf16 v[80:95], a[200:203], v[40:43], v[80:95]
v_cvt_pk_bf16_f32 v145, v194, v195
v_exp_f32 v197, v101
v_add_f32 v200, v200, v196
v_mfma_f32_32x32x16_bf16 v[64:79], a[204:207], v[12:15], v[64:79]
ds_read_b128 a[220:223], v205 offset:7168
v_exp_f32 v198, v102
v_add_f32 v200, v200, v197
v_cvt_pk_bf16_f32 v146, v196, v197
v_mfma_f32_32x32x16_bf16 v[80:95], a[204:207], v[44:47], v[80:95]
v_exp_f32 v199, v103
v_add_f32 v200, v200, v198
v_exp_f32 v192, v104
v_add_f32 v200, v200, v199
s_waitcnt lgkmcnt(2)
v_mfma_f32_32x32x16_bf16 v[64:79], a[208:211], v[16:19], v[64:79]
s_waitcnt vmcnt(8)
ds_read_b64_tr_b16 v[236:237], v218 offset:0
ds_read_b64_tr_b16 v[238:239], v218 offset:512
v_cvt_pk_bf16_f32 v147, v198, v199
v_exp_f32 v193, v105
v_mfma_f32_32x32x16_bf16 v[80:95], a[208:211], v[48:51], v[80:95]
ds_read_b64_tr_b16 v[240:241], v219 offset:0
ds_read_b64_tr_b16 v[242:243], v219 offset:512
v_add_f32 v200, v200, v192
v_exp_f32 v194, v106
v_mfma_f32_32x32x16_bf16 v[64:79], a[212:215], v[20:23], v[64:79]
ds_read_b64_tr_b16 v[244:245], v218 offset:2048
ds_read_b64_tr_b16 v[246:247], v218 offset:2560
v_add_f32 v200, v200, v193
v_cvt_pk_bf16_f32 v148, v192, v193
v_mfma_f32_32x32x16_bf16 v[80:95], a[212:215], v[52:55], v[80:95]
ds_read_b64_tr_b16 v[248:249], v219 offset:2048
ds_read_b64_tr_b16 v[250:251], v219 offset:2560
v_exp_f32 v195, v107
v_add_f32 v200, v200, v194
s_waitcnt lgkmcnt(8)
v_mfma_f32_32x32x16_bf16 v[64:79], a[216:219], v[24:27], v[64:79]
ds_read_b128 a[224:227], v206 offset:0
v_exp_f32 v196, v108
v_add_f32 v200, v200, v195
v_cvt_pk_bf16_f32 v149, v194, v195
v_mfma_f32_32x32x16_bf16 v[80:95], a[216:219], v[56:59], v[80:95]
v_exp_f32 v197, v109
v_add_f32 v200, v200, v196
v_exp_f32 v198, v110
v_add_f32 v200, v200, v197
v_mfma_f32_32x32x16_bf16 v[64:79], a[220:223], v[28:31], v[64:79]
ds_read_b128 a[228:231], v206 offset:1024
v_cvt_pk_bf16_f32 v150, v196, v197
v_exp_f32 v199, v111
v_add_f32 v200, v200, v198
v_mfma_f32_32x32x16_bf16 v[80:95], a[220:223], v[60:63], v[80:95]
v_add_f32 v200, v200, v199
v_cvt_pk_bf16_f32 v151, v198, v199
v_exp_f32 v192, v112
s_waitcnt lgkmcnt(1)
v_mfma_f32_32x32x16_bf16 a[128:143], v[236:239], v[244:247], a[128:143]
ds_read_b128 a[232:235], v206 offset:2048
v_exp_f32 v193, v113
v_exp_f32 v194, v114
v_add_f32 v201, v192, v193
v_mfma_f32_32x32x16_bf16 a[144:159], v[236:239], v[248:251], a[144:159]
s_add_u32 m0, s89, 0
v_cvt_pk_bf16_f32 v152, v192, v193
v_exp_f32 v195, v115
v_add_f32 v201, v201, v194
v_mfma_f32_32x32x16_bf16 a[160:175], v[240:243], v[244:247], a[160:175]
buffer_load_dwordx4 v214, s[12:15], s85 offen lds
ds_read_b128 a[236:239], v206 offset:3072
v_exp_f32 v196, v116
v_mfma_f32_32x32x16_bf16 a[176:191], v[240:243], v[248:251], a[176:191]
v_add_f32 v201, v201, v195
v_cvt_pk_bf16_f32 v153, v194, v195
v_exp_f32 v197, v117
v_mfma_f32_32x32x16_bf16 a[0:15], a[224:227], v[128:131], a[0:15]
buffer_load_dwordx4 v215, s[12:15], s85 offen offset:1024 lds
s_add_u32 s85, s85, 57344
ds_read_b128 a[240:243], v206 offset:4096
v_mfma_f32_32x32x16_bf16 a[64:79], a[224:227], v[136:139], a[64:79]
v_add_f32 v201, v201, v196
v_exp_f32 v198, v118
v_add_f32 v201, v201, v197
v_cvt_pk_bf16_f32 v154, v196, v197
s_waitcnt lgkmcnt(2)
v_mfma_f32_32x32x16_bf16 a[16:31], a[228:231], v[128:131], a[16:31]
s_add_u32 m0, s89, 2048
ds_read_b128 a[244:247], v206 offset:5120
v_exp_f32 v199, v119
v_add_f32 v201, v201, v198
v_mfma_f32_32x32x16_bf16 a[80:95], a[228:231], v[136:139], a[80:95]
buffer_load_dwordx4 v216, s[60:63], s88 offen lds
v_exp_f32 v192, v120
v_add_f32 v201, v201, v199
v_mfma_f32_32x32x16_bf16 a[32:47], a[232:235], v[128:131], a[32:47]
ds_read_b128 a[248:251], v206 offset:6144
v_cvt_pk_bf16_f32 v155, v198, v199
v_exp_f32 v193, v121
v_add_f32 v201, v201, v192
v_mfma_f32_32x32x16_bf16 a[96:111], a[232:235], v[136:139], a[96:111]
buffer_load_dwordx4 v217, s[60:63], s88 offen offset:1024 lds
s_add_u32 s88, s88, 16384
v_exp_f32 v194, v122
s_waitcnt lgkmcnt(2)
v_mfma_f32_32x32x16_bf16 a[48:63], a[236:239], v[128:131], a[48:63]
ds_read_b128 a[252:255], v206 offset:7168
v_add_f32 v201, v201, v193
v_cvt_pk_bf16_f32 v156, v192, v193
v_exp_f32 v195, v123
v_mfma_f32_32x32x16_bf16 a[112:127], a[236:239], v[136:139], a[112:127]
v_add_f32 v201, v201, v194
v_exp_f32 v196, v124
v_add_f32 v201, v201, v195
v_mfma_f32_32x32x16_bf16 a[0:15], a[240:243], v[132:135], a[0:15]
s_waitcnt vmcnt(24)
s_barrier
v_add_u32 v205, 8192, v205
v_and_b32 v205, 0xffff, v205
v_add_u32 v206, 8192, v206
v_and_or_b32 v206, v206, v230, v231
ds_read_b128 a[192:195], v205 offset:0
s_and_b32 m0, s25, 0xffff
v_mfma_f32_32x32x16_bf16 a[64:79], a[240:243], v[140:143], a[64:79]
v_cvt_pk_bf16_f32 v157, v194, v195
v_exp_f32 v197, v125
s_waitcnt lgkmcnt(2)
v_mfma_f32_32x32x16_bf16 a[16:31], a[244:247], v[132:135], a[16:31]
ds_read_b128 a[196:199], v205 offset:1024
v_add_f32 v201, v201, v196
v_exp_f32 v198, v126
v_add_f32 v201, v201, v197
v_mfma_f32_32x32x16_bf16 a[80:95], a[244:247], v[140:143], a[80:95]
buffer_load_dwordx4 v204, s[4:7], s25 offen lds
v_cvt_pk_bf16_f32 v158, v196, v197
v_mfma_f32_32x32x16_bf16 a[32:47], a[248:251], v[132:135], a[32:47]
ds_read_b128 a[200:203], v205 offset:2048
v_exp_f32 v199, v127
v_add_f32 v201, v201, v198
v_add_f32 v201, v201, v199
v_cvt_pk_bf16_f32 v159, v198, v199
v_mfma_f32_32x32x16_bf16 a[96:111], a[248:251], v[140:143], a[96:111]
buffer_load_dwordx4 v204, s[4:7], s25 offen offset:1024 lds
s_add_u32 s25, s25, 8192
v_max_f32 v210, v200, v201
s_waitcnt lgkmcnt(2)
v_mfma_f32_32x32x16_bf16 a[48:63], a[252:255], v[132:135], a[48:63]
ds_read_b128 a[204:207], v205 offset:3072
v_cmp_lt_f32 vcc, s28, v210
v_mfma_f32_32x32x16_bf16 a[112:127], a[252:255], v[140:143], a[112:127]
s_cbranch_vccnz attn_slow1
attn_join1:
v_add_f32 v202, v202, v200
v_add_f32 v203, v203, v201
s_waitcnt lgkmcnt(2)
v_mfma_f32_32x32x16_bf16 v[96:111], a[192:195], v[0:3], v[160:175]
s_and_b32 s27, s26, 0xffff
s_or_b32 m0, s27, 0x10000
ds_read_b128 a[208:211], v205 offset:4096
v_exp_f32 v192, v64
v_mfma_f32_32x32x16_bf16 v[112:127], a[192:195], v[32:35], v[176:191]
v_exp_f32 v193, v65
v_exp_f32 v194, v66
v_add_f32 v200, v192, v193
v_mfma_f32_32x32x16_bf16 v[96:111], a[196:199], v[4:7], v[96:111]
buffer_load_dwordx4 v204, s[8:11], s26 offen lds
ds_read_b128 a[212:215], v205 offset:5120
v_cvt_pk_bf16_f32 v128, v192, v193
v_mfma_f32_32x32x16_bf16 v[112:127], a[196:199], v[36:39], v[112:127]
v_exp_f32 v195, v67
v_add_f32 v200, v200, v194
v_exp_f32 v196, v68
s_waitcnt lgkmcnt(2)
v_mfma_f32_32x32x16_bf16 v[96:111], a[200:203], v[8:11], v[96:111]
buffer_load_dwordx4 v204, s[8:11], s26 offen offset:1024 lds
s_add_u32 s26, s26, 8192
ds_read_b128 a[216:219], v205 offset:6144
v_add_f32 v200, v200, v195
v_mfma_f32_32x32x16_bf16 v[112:127], a[200:203], v[40:43], v[112:127]
v_cvt_pk_bf16_f32 v129, v194, v195
v_exp_f32 v197, v69
v_add_f32 v200, v200, v196
v_mfma_f32_32x32x16_bf16 v[96:111], a[204:207], v[12:15], v[96:111]
ds_read_b128 a[220:223], v205 offset:7168
v_exp_f32 v198, v70
v_add_f32 v200, v200, v197
v_cvt_pk_bf16_f32 v130, v196, v197
v_mfma_f32_32x32x16_bf16 v[112:127], a[204:207], v[44:47], v[112:127]
v_exp_f32 v199, v71
v_add_f32 v200, v200, v198
v_exp_f32 v192, v72
v_add_f32 v200, v200, v199
s_waitcnt lgkmcnt(2)
v_mfma_f32_32x32x16_bf16 v[96:111], a[208:211], v[16:19], v[96:111]
s_waitcnt vmcnt(12)
ds_read_b64_tr_b16 v[236:237], v218 offset:4096
ds_read_b64_tr_b16 v[238:239], v218 offset:4608
v_cvt_pk_bf16_f32 v131, v198, v199
v_exp_f32 v193, v73
v_mfma_f32_32x32x16_bf16 v[112:127], a[208:211], v[48:51], v[112:127]
ds_read_b64_tr_b16 v[240:241], v219 offset:4096
ds_read_b64_tr_b16 v[242:243], v219 offset:4608
v_add_f32 v200, v200, v192
v_exp_f32 v194, v74
v_mfma_f32_32x32x16_bf16 v[96:111], a[212:215], v[20:23], v[96:111]
ds_read_b64_tr_b16 v[244:245], v218 offset:6144
ds_read_b64_tr_b16 v[246:247], v218 offset:6656
v_add_f32 v200, v200, v193
v_cvt_pk_bf16_f32 v132, v192, v193
v_mfma_f32_32x32x16_bf16 v[112:127], a[212:215], v[52:55], v[112:127]
ds_read_b64_tr_b16 v[248:249], v219 offset:6144
ds_read_b64_tr_b16 v[250:251], v219 offset:6656
v_exp_f32 v195, v75
v_add_f32 v200, v200, v194
s_waitcnt lgkmcnt(8)
v_mfma_f32_32x32x16_bf16 v[96:111], a[216:219], v[24:27], v[96:111]
ds_read_b128 a[224:227], v206 offset:0
v_exp_f32 v196, v76
v_add_f32 v200, v200, v195
v_cvt_pk_bf16_f32 v133, v194, v195
v_mfma_f32_32x32x16_bf16 v[112:127], a[216:219], v[56:59], v[112:127]
v_exp_f32 v197, v77
v_add_f32 v200, v200, v196
v_exp_f32 v198, v78
v_add_f32 v200, v200, v197
v_mfma_f32_32x32x16_bf16 v[96:111], a[220:223], v[28:31], v[96:111]
ds_read_b128 a[228:231], v206 offset:1024
v_cvt_pk_bf16_f32 v134, v196, v197
v_exp_f32 v199, v79
v_add_f32 v200, v200, v198
v_mfma_f32_32x32x16_bf16 v[112:127], a[220:223], v[60:63], v[112:127]
v_add_f32 v200, v200, v199
v_cvt_pk_bf16_f32 v135, v198, v199
v_exp_f32 v192, v80
s_waitcnt lgkmcnt(1)
v_mfma_f32_32x32x16_bf16 a[128:143], v[236:239], v[244:247], a[128:143]
ds_read_b128 a[232:235], v206 offset:2048
v_exp_f32 v193, v81
v_exp_f32 v194, v82
v_add_f32 v201, v192, v193
v_mfma_f32_32x32x16_bf16 a[144:159], v[236:239], v[248:251], a[144:159]
s_add_u32 m0, s89, 4096
v_cvt_pk_bf16_f32 v136, v192, v193
v_exp_f32 v195, v83
v_add_f32 v201, v201, v194
v_mfma_f32_32x32x16_bf16 a[160:175], v[240:243], v[244:247], a[160:175]
buffer_load_dwordx4 v214, s[12:15], s85 offen lds
ds_read_b128 a[236:239], v206 offset:3072
v_exp_f32 v196, v84
v_mfma_f32_32x32x16_bf16 a[176:191], v[240:243], v[248:251], a[176:191]
v_add_f32 v201, v201, v195
v_cvt_pk_bf16_f32 v137, v194, v195
v_exp_f32 v197, v85
v_mfma_f32_32x32x16_bf16 a[0:15], a[224:227], v[144:147], a[0:15]
buffer_load_dwordx4 v215, s[12:15], s85 offen offset:1024 lds
s_add_u32 s85, s85, 57344
ds_read_b128 a[240:243], v206 offset:4096
v_mfma_f32_32x32x16_bf16 a[64:79], a[224:227], v[152:155], a[64:79]
v_add_f32 v201, v201, v196
v_exp_f32 v198, v86
v_add_f32 v201, v201, v197
v_cvt_pk_bf16_f32 v138, v196, v197
s_waitcnt lgkmcnt(2)
v_mfma_f32_32x32x16_bf16 a[16:31], a[228:231], v[144:147], a[16:31]
s_add_u32 m0, s89, 6144
ds_read_b128 a[244:247], v206 offset:5120
v_exp_f32 v199, v87
v_add_f32 v201, v201, v198
v_mfma_f32_32x32x16_bf16 a[80:95], a[228:231], v[152:155], a[80:95]
buffer_load_dwordx4 v216, s[60:63], s88 offen lds
v_exp_f32 v192, v88
v_add_f32 v201, v201, v199
v_mfma_f32_32x32x16_bf16 a[32:47], a[232:235], v[144:147], a[32:47]
ds_read_b128 a[248:251], v206 offset:6144
v_cvt_pk_bf16_f32 v139, v198, v199
v_exp_f32 v193, v89
v_add_f32 v201, v201, v192
v_mfma_f32_32x32x16_bf16 a[96:111], a[232:235], v[152:155], a[96:111]
buffer_load_dwordx4 v217, s[60:63], s88 offen offset:1024 lds
s_add_u32 s88, s88, 16384
v_exp_f32 v194, v90
s_waitcnt lgkmcnt(2)
v_mfma_f32_32x32x16_bf16 a[48:63], a[236:239], v[144:147], a[48:63]
ds_read_b128 a[252:255], v206 offset:7168
v_add_f32 v201, v201, v193
v_cvt_pk_bf16_f32 v140, v192, v193
v_exp_f32 v195, v91
v_mfma_f32_32x32x16_bf16 a[112:127], a[236:239], v[152:155], a[112:127]
v_add_f32 v201, v201, v194
v_exp_f32 v196, v92
v_add_f32 v201, v201, v195
v_mfma_f32_32x32x16_bf16 a[0:15], a[240:243], v[148:151], a[0:15]
s_waitcnt vmcnt(28)
s_barrier
v_add_u32 v205, 8192, v205
v_and_b32 v205, 0xffff, v205
v_add_u32 v206, 8192, v206
v_and_or_b32 v206, v206, v230, v231
ds_read_b128 a[192:195], v205 offset:0
s_and_b32 m0, s25, 0xffff
v_mfma_f32_32x32x16_bf16 a[64:79], a[240:243], v[156:159], a[64:79]
v_cvt_pk_bf16_f32 v141, v194, v195
v_exp_f32 v197, v93
s_waitcnt lgkmcnt(2)
v_mfma_f32_32x32x16_bf16 a[16:31], a[244:247], v[148:151], a[16:31]
ds_read_b128 a[196:199], v205 offset:1024
v_add_f32 v201, v201, v196
v_exp_f32 v198, v94
v_add_f32 v201, v201, v197
v_mfma_f32_32x32x16_bf16 a[80:95], a[244:247], v[156:159], a[80:95]
buffer_load_dwordx4 v204, s[4:7], s25 offen lds
v_cvt_pk_bf16_f32 v142, v196, v197
v_mfma_f32_32x32x16_bf16 a[32:47], a[248:251], v[148:151], a[32:47]
ds_read_b128 a[200:203], v205 offset:2048
v_exp_f32 v199, v95
v_add_f32 v201, v201, v198
v_add_f32 v201, v201, v199
v_cvt_pk_bf16_f32 v143, v198, v199
v_mfma_f32_32x32x16_bf16 a[96:111], a[248:251], v[156:159], a[96:111]
buffer_load_dwordx4 v204, s[4:7], s25 offen offset:1024 lds
s_add_u32 s25, s25, 8192
v_max_f32 v210, v200, v201
s_waitcnt lgkmcnt(2)
v_mfma_f32_32x32x16_bf16 a[48:63], a[252:255], v[148:151], a[48:63]
ds_read_b128 a[204:207], v205 offset:3072
v_cmp_lt_f32 vcc, s28, v210
v_mfma_f32_32x32x16_bf16 a[112:127], a[252:255], v[156:159], a[112:127]
s_cbranch_vccnz attn_slow2
attn_join2:
v_add_f32 v202, v202, v200
v_add_f32 v203, v203, v201
s_sub_u32 s24, s24, 1
s_cmp_lg_u32 s24, 0
s_cbranch_scc1 attn_p1loop
s_waitcnt lgkmcnt(2)
v_mfma_f32_32x32x16_bf16 v[64:79], a[192:195], v[0:3], v[160:175]
s_and_b32 s27, s26, 0xffff
s_or_b32 m0, s27, 0x10000
ds_read_b128 a[208:211], v205 offset:4096
v_exp_f32 v192, v96
v_mfma_f32_32x32x16_bf16 v[80:95], a[192:195], v[32:35], v[176:191]
v_exp_f32 v193, v97
v_exp_f32 v194, v98
v_add_f32 v200, v192, v193
v_mfma_f32_32x32x16_bf16 v[64:79], a[196:199], v[4:7], v[64:79]
buffer_load_dwordx4 v204, s[8:11], s26 offen lds
ds_read_b128 a[212:215], v205 offset:5120
v_cvt_pk_bf16_f32 v144, v192, v193
v_mfma_f32_32x32x16_bf16 v[80:95], a[196:199], v[36:39], v[80:95]
v_exp_f32 v195, v99
v_add_f32 v200, v200, v194
v_exp_f32 v196, v100
s_waitcnt lgkmcnt(2)
v_mfma_f32_32x32x16_bf16 v[64:79], a[200:203], v[8:11], v[64:79]
buffer_load_dwordx4 v204, s[8:11], s26 offen offset:1024 lds
s_add_u32 s26, s26, 8192
ds_read_b128 a[216:219], v205 offset:6144
v_add_f32 v200, v200, v195
v_mfma_f32_32x32x16_bf16 v[80:95], a[200:203], v[40:43], v[80:95]
v_cvt_pk_bf16_f32 v145, v194, v195
v_exp_f32 v197, v101
v_add_f32 v200, v200, v196
v_mfma_f32_32x32x16_bf16 v[64:79], a[204:207], v[12:15], v[64:79]
ds_read_b128 a[220:223], v205 offset:7168
v_exp_f32 v198, v102
v_add_f32 v200, v200, v197
v_cvt_pk_bf16_f32 v146, v196, v197
v_mfma_f32_32x32x16_bf16 v[80:95], a[204:207], v[44:47], v[80:95]
v_exp_f32 v199, v103
v_add_f32 v200, v200, v198
v_exp_f32 v192, v104
v_add_f32 v200, v200, v199
s_waitcnt lgkmcnt(2)
v_mfma_f32_32x32x16_bf16 v[64:79], a[208:211], v[16:19], v[64:79]
s_waitcnt vmcnt(12)
ds_read_b64_tr_b16 v[236:237], v218 offset:0
ds_read_b64_tr_b16 v[238:239], v218 offset:512
v_cvt_pk_bf16_f32 v147, v198, v199
v_exp_f32 v193, v105
v_mfma_f32_32x32x16_bf16 v[80:95], a[208:211], v[48:51], v[80:95]
ds_read_b64_tr_b16 v[240:241], v219 offset:0
ds_read_b64_tr_b16 v[242:243], v219 offset:512
v_add_f32 v200, v200, v192
v_exp_f32 v194, v106
v_mfma_f32_32x32x16_bf16 v[64:79], a[212:215], v[20:23], v[64:79]
ds_read_b64_tr_b16 v[244:245], v218 offset:2048
ds_read_b64_tr_b16 v[246:247], v218 offset:2560
v_add_f32 v200, v200, v193
v_cvt_pk_bf16_f32 v148, v192, v193
v_mfma_f32_32x32x16_bf16 v[80:95], a[212:215], v[52:55], v[80:95]
ds_read_b64_tr_b16 v[248:249], v219 offset:2048
ds_read_b64_tr_b16 v[250:251], v219 offset:2560
v_exp_f32 v195, v107
v_add_f32 v200, v200, v194
s_waitcnt lgkmcnt(8)
v_mfma_f32_32x32x16_bf16 v[64:79], a[216:219], v[24:27], v[64:79]
ds_read_b128 a[224:227], v206 offset:0
v_exp_f32 v196, v108
v_add_f32 v200, v200, v195
v_cvt_pk_bf16_f32 v149, v194, v195
v_mfma_f32_32x32x16_bf16 v[80:95], a[216:219], v[56:59], v[80:95]
v_exp_f32 v197, v109
v_add_f32 v200, v200, v196
v_exp_f32 v198, v110
v_add_f32 v200, v200, v197
v_mfma_f32_32x32x16_bf16 v[64:79], a[220:223], v[28:31], v[64:79]
ds_read_b128 a[228:231], v206 offset:1024
v_cvt_pk_bf16_f32 v150, v196, v197
v_exp_f32 v199, v111
v_add_f32 v200, v200, v198
v_mfma_f32_32x32x16_bf16 v[80:95], a[220:223], v[60:63], v[80:95]
v_add_f32 v200, v200, v199
v_cvt_pk_bf16_f32 v151, v198, v199
v_exp_f32 v192, v112
s_waitcnt lgkmcnt(1)
v_mfma_f32_32x32x16_bf16 a[128:143], v[236:239], v[244:247], a[128:143]
ds_read_b128 a[232:235], v206 offset:2048
v_exp_f32 v193, v113
v_exp_f32 v194, v114
v_add_f32 v201, v192, v193
v_mfma_f32_32x32x16_bf16 a[144:159], v[236:239], v[248:251], a[144:159]
s_add_u32 m0, s89, 0
v_cvt_pk_bf16_f32 v152, v192, v193
v_exp_f32 v195, v115
v_add_f32 v201, v201, v194
v_mfma_f32_32x32x16_bf16 a[160:175], v[240:243], v[244:247], a[160:175]
buffer_load_dwordx4 v214, s[12:15], s85 offen lds
ds_read_b128 a[236:239], v206 offset:3072
v_exp_f32 v196, v116
v_mfma_f32_32x32x16_bf16 a[176:191], v[240:243], v[248:251], a[176:191]
v_add_f32 v201, v201, v195
v_cvt_pk_bf16_f32 v153, v194, v195
v_exp_f32 v197, v117
v_mfma_f32_32x32x16_bf16 a[0:15], a[224:227], v[128:131], a[0:15]
buffer_load_dwordx4 v215, s[12:15], s85 offen offset:1024 lds
s_add_u32 s85, s85, 57344
ds_read_b128 a[240:243], v206 offset:4096
v_mfma_f32_32x32x16_bf16 a[64:79], a[224:227], v[136:139], a[64:79]
v_add_f32 v201, v201, v196
v_exp_f32 v198, v118
v_add_f32 v201, v201, v197
v_cvt_pk_bf16_f32 v154, v196, v197
s_waitcnt lgkmcnt(2)
v_mfma_f32_32x32x16_bf16 a[16:31], a[228:231], v[128:131], a[16:31]
s_add_u32 m0, s89, 2048
ds_read_b128 a[244:247], v206 offset:5120
v_exp_f32 v199, v119
v_add_f32 v201, v201, v198
v_mfma_f32_32x32x16_bf16 a[80:95], a[228:231], v[136:139], a[80:95]
buffer_load_dwordx4 v216, s[60:63], s88 offen lds
v_exp_f32 v192, v120
v_add_f32 v201, v201, v199
v_mfma_f32_32x32x16_bf16 a[32:47], a[232:235], v[128:131], a[32:47]
ds_read_b128 a[248:251], v206 offset:6144
v_cvt_pk_bf16_f32 v155, v198, v199
v_exp_f32 v193, v121
v_add_f32 v201, v201, v192
v_mfma_f32_32x32x16_bf16 a[96:111], a[232:235], v[136:139], a[96:111]
buffer_load_dwordx4 v217, s[60:63], s88 offen offset:1024 lds
s_add_u32 s88, s88, 16384
v_exp_f32 v194, v122
s_waitcnt lgkmcnt(2)
v_mfma_f32_32x32x16_bf16 a[48:63], a[236:239], v[128:131], a[48:63]
ds_read_b128 a[252:255], v206 offset:7168
v_add_f32 v201, v201, v193
v_cvt_pk_bf16_f32 v156, v192, v193
v_exp_f32 v195, v123
v_mfma_f32_32x32x16_bf16 a[112:127], a[236:239], v[136:139], a[112:127]
v_add_f32 v201, v201, v194
v_exp_f32 v196, v124
v_add_f32 v201, v201, v195
v_mfma_f32_32x32x16_bf16 a[0:15], a[240:243], v[132:135], a[0:15]
s_waitcnt vmcnt(28)
s_barrier
v_add_u32 v205, 8192, v205
v_and_b32 v205, 0xffff, v205
v_add_u32 v206, 8192, v206
v_and_or_b32 v206, v206, v230, v231
ds_read_b128 a[192:195], v205 offset:0
s_and_b32 m0, s25, 0xffff
v_mfma_f32_32x32x16_bf16 a[64:79], a[240:243], v[140:143], a[64:79]
v_cvt_pk_bf16_f32 v157, v194, v195
v_exp_f32 v197, v125
s_waitcnt lgkmcnt(2)
v_mfma_f32_32x32x16_bf16 a[16:31], a[244:247], v[132:135], a[16:31]
ds_read_b128 a[196:199], v205 offset:1024
v_add_f32 v201, v201, v196
v_exp_f32 v198, v126
v_add_f32 v201, v201, v197
v_mfma_f32_32x32x16_bf16 a[80:95], a[244:247], v[140:143], a[80:95]
buffer_load_dwordx4 v204, s[4:7], s25 offen lds
v_cvt_pk_bf16_f32 v158, v196, v197
v_mfma_f32_32x32x16_bf16 a[32:47], a[248:251], v[132:135], a[32:47]
ds_read_b128 a[200:203], v205 offset:2048
v_exp_f32 v199, v127
v_add_f32 v201, v201, v198
v_add_f32 v201, v201, v199
v_cvt_pk_bf16_f32 v159, v198, v199
v_mfma_f32_32x32x16_bf16 a[96:111], a[248:251], v[140:143], a[96:111]
buffer_load_dwordx4 v204, s[4:7], s25 offen offset:1024 lds
s_add_u32 s25, s25, 8192
v_max_f32 v210, v200, v201
s_waitcnt lgkmcnt(2)
v_mfma_f32_32x32x16_bf16 a[48:63], a[252:255], v[132:135], a[48:63]
ds_read_b128 a[204:207], v205 offset:3072
v_cmp_lt_f32 vcc, s28, v210
v_mfma_f32_32x32x16_bf16 a[112:127], a[252:255], v[140:143], a[112:127]
s_cbranch_vccnz attn_slow3
attn_join3:
v_add_f32 v202, v202, v200
v_add_f32 v203, v203, v201
s_sub_u32 s29, s23, 4
s_lshl_b32 s29, s29, 5
v_subrev_u32 v232, s29, v207
s_waitcnt lgkmcnt(2)
v_mfma_f32_32x32x16_bf16 v[96:111], a[192:195], v[0:3], v[160:175]
s_and_b32 s27, s26, 0xffff
s_or_b32 m0, s27, 0x10000
ds_read_b128 a[208:211], v205 offset:4096
v_cmp_ge_i32 s[40:41], v232, 0
v_cmp_ge_i32 s[42:43], v232, 1
v_cmp_ge_i32 s[44:45], v232, 2
v_mfma_f32_32x32x16_bf16 v[112:127], a[192:195], v[32:35], v[176:191]
v_cmp_ge_i32 s[46:47], v232, 3
v_cndmask_b32 v64, v209, v64, s[40:41]
v_cmp_ge_i32 s[48:49], v232, 8
v_cndmask_b32 v65, v209, v65, s[42:43]
v_exp_f32 v192, v64
v_mfma_f32_32x32x16_bf16 v[96:111], a[196:199], v[4:7], v[96:111]
buffer_load_dwordx4 v204, s[8:11], s26 offen lds
ds_read_b128 a[212:215], v205 offset:5120
v_cmp_ge_i32 s[50:51], v232, 9
v_cndmask_b32 v66, v209, v66, s[44:45]
v_mfma_f32_32x32x16_bf16 v[112:127], a[196:199], v[36:39], v[112:127]
v_exp_f32 v193, v65
v_cmp_ge_i32 s[52:53], v232, 10
v_cndmask_b32 v67, v209, v67, s[46:47]
v_exp_f32 v194, v66
s_waitcnt lgkmcnt(2)
v_mfma_f32_32x32x16_bf16 v[96:111], a[200:203], v[8:11], v[96:111]
buffer_load_dwordx4 v204, s[8:11], s26 offen offset:1024 lds
s_add_u32 s26, s26, 8192
ds_read_b128 a[216:219], v205 offset:6144
v_add_f32 v200, v192, v193
v_mfma_f32_32x32x16_bf16 v[112:127], a[200:203], v[40:43], v[112:127]
v_cvt_pk_bf16_f32 v128, v192, v193
v_cmp_ge_i32 s[54:55], v232, 11
v_cndmask_b32 v68, v209, v68, s[48:49]
v_exp_f32 v195, v67
v_add_f32 v200, v200, v194
v_mfma_f32_32x32x16_bf16 v[96:111], a[204:207], v[12:15], v[96:111]
ds_read_b128 a[220:223], v205 offset:7168
v_cmp_ge_i32 s[40:41], v232, 16
v_cndmask_b32 v69, v209, v69, s[50:51]
v_exp_f32 v196, v68
v_add_f32 v200, v200, v195
v_mfma_f32_32x32x16_bf16 v[112:127], a[204:207], v[44:47], v[112:127]
v_cvt_pk_bf16_f32 v129, v194, v195
v_cmp_ge_i32 s[42:43], v232, 17
v_cndmask_b32 v70, v209, v70, s[52:53]
v_exp_f32 v197, v69
v_add_f32 v200, v200, v196
s_waitcnt lgkmcnt(2)
v_mfma_f32_32x32x16_bf16 v[96:111], a[208:211], v[16:19], v[96:111]
s_waitcnt vmcnt(12)
ds_read_b64_tr_b16 v[236:237], v218 offset:4096
ds_read_b64_tr_b16 v[238:239], v218 offset:4608
v_cmp_ge_i32 s[44:45], v232, 18
v_cndmask_b32 v71, v209, v71, s[54:55]
v_exp_f32 v198, v70
v_mfma_f32_32x32x16_bf16 v[112:127], a[208:211], v[48:51], v[112:127]
ds_read_b64_tr_b16 v[240:241], v219 offset:4096
ds_read_b64_tr_b16 v[242:243], v219 offset:4608
v_add_f32 v200, v200, v197
v_cvt_pk_bf16_f32 v130, v196, v197
v_cmp_ge_i32 s[46:47], v232, 19
v_mfma_f32_32x32x16_bf16 v[96:111], a[212:215], v[20:23], v[96:111]
ds_read_b64_tr_b16 v[244:245], v218 offset:6144
ds_read_b64_tr_b16 v[246:247], v218 offset:6656
v_cndmask_b32 v72, v209, v72, s[40:41]
v_exp_f32 v199, v71
v_add_f32 v200, v200, v198
v_cmp_ge_i32 s[48:49], v232, 24
v_mfma_f32_32x32x16_bf16 v[112:127], a[212:215], v[52:55], v[112:127]
ds_read_b64_tr_b16 v[248:249], v219 offset:6144
ds_read_b64_tr_b16 v[250:251], v219 offset:6656
v_cndmask_b32 v73, v209, v73, s[42:43]
v_exp_f32 v192, v72
v_add_f32 v200, v200, v199
s_waitcnt lgkmcnt(8)
v_mfma_f32_32x32x16_bf16 v[96:111], a[216:219], v[24:27], v[96:111]
ds_read_b128 a[224:227], v206 offset:0
v_cvt_pk_bf16_f32 v131, v198, v199
v_cmp_ge_i32 s[50:51], v232, 25
v_cndmask_b32 v74, v209, v74, s[44:45]
v_exp_f32 v193, v73
v_mfma_f32_32x32x16_bf16 v[112:127], a[216:219], v[56:59], v[112:127]
v_add_f32 v200, v200, v192
v_cmp_ge_i32 s[52:53], v232, 26
v_cndmask_b32 v75, v209, v75, s[46:47]
v_exp_f32 v194, v74
v_add_f32 v200, v200, v193
v_mfma_f32_32x32x16_bf16 v[96:111], a[220:223], v[28:31], v[96:111]
ds_read_b128 a[228:231], v206 offset:1024
v_cvt_pk_bf16_f32 v132, v192, v193
v_cmp_ge_i32 s[54:55], v232, 27
v_cndmask_b32 v76, v209, v76, s[48:49]
v_exp_f32 v195, v75
v_mfma_f32_32x32x16_bf16 v[112:127], a[220:223], v[60:63], v[112:127]
v_add_f32 v200, v200, v194
v_cndmask_b32 v77, v209, v77, s[50:51]
v_exp_f32 v196, v76
v_add_f32 v200, v200, v195
v_cvt_pk_bf16_f32 v133, v194, v195
s_waitcnt lgkmcnt(1)
v_mfma_f32_32x32x16_bf16 a[128:143], v[236:239], v[244:247], a[128:143]
ds_read_b128 a[232:235], v206 offset:2048
v_cndmask_b32 v78, v209, v78, s[52:53]
v_exp_f32 v197, v77
v_add_f32 v200, v200, v196
v_cndmask_b32 v79, v209, v79, s[54:55]
v_mfma_f32_32x32x16_bf16 a[144:159], v[236:239], v[248:251], a[144:159]
s_add_u32 m0, s89, 4096
v_exp_f32 v198, v78
v_add_f32 v200, v200, v197
v_cvt_pk_bf16_f32 v134, v196, v197
v_mfma_f32_32x32x16_bf16 a[160:175], v[240:243], v[244:247], a[160:175]
buffer_load_dwordx4 v214, s[12:15], s85 offen lds
ds_read_b128 a[236:239], v206 offset:3072
v_exp_f32 v199, v79
v_add_f32 v200, v200, v198
v_mfma_f32_32x32x16_bf16 a[176:191], v[240:243], v[248:251], a[176:191]
v_add_f32 v200, v200, v199
v_cvt_pk_bf16_f32 v135, v198, v199
v_exp_f32 v192, v80
v_exp_f32 v193, v81
v_mfma_f32_32x32x16_bf16 a[0:15], a[224:227], v[144:147], a[0:15]
buffer_load_dwordx4 v215, s[12:15], s85 offen offset:1024 lds
s_add_u32 s85, s85, 57344
ds_read_b128 a[240:243], v206 offset:4096
v_mfma_f32_32x32x16_bf16 a[64:79], a[224:227], v[152:155], a[64:79]
v_exp_f32 v194, v82
v_add_f32 v201, v192, v193
v_cvt_pk_bf16_f32 v136, v192, v193
v_exp_f32 v195, v83
v_add_f32 v201, v201, v194
s_waitcnt lgkmcnt(2)
v_mfma_f32_32x32x16_bf16 a[16:31], a[228:231], v[144:147], a[16:31]
s_add_u32 m0, s89, 6144
ds_read_b128 a[244:247], v206 offset:5120
v_exp_f32 v196, v84
v_add_f32 v201, v201, v195
v_cvt_pk_bf16_f32 v137, v194, v195
v_mfma_f32_32x32x16_bf16 a[80:95], a[228:231], v[152:155], a[80:95]
buffer_load_dwordx4 v216, s[60:63], s88 offen lds
v_exp_f32 v197, v85
v_add_f32 v201, v201, v196
v_mfma_f32_32x32x16_bf16 a[32:47], a[232:235], v[144:147], a[32:47]
ds_read_b128 a[248:251], v206 offset:6144
v_exp_f32 v198, v86
v_add_f32 v201, v201, v197
v_cvt_pk_bf16_f32 v138, v196, v197
v_exp_f32 v199, v87
v_mfma_f32_32x32x16_bf16 a[96:111], a[232:235], v[152:155], a[96:111]
buffer_load_dwordx4 v217, s[60:63], s88 offen offset:1024 lds
s_add_u32 s88, s88, 16384
v_add_f32 v201, v201, v198
s_waitcnt lgkmcnt(2)
v_mfma_f32_32x32x16_bf16 a[48:63], a[236:239], v[144:147], a[48:63]
ds_read_b128 a[252:255], v206 offset:7168
v_exp_f32 v192, v88
v_add_f32 v201, v201, v199
v_cvt_pk_bf16_f32 v139, v198, v199
v_exp_f32 v193, v89
v_mfma_f32_32x32x16_bf16 a[112:127], a[236:239], v[152:155], a[112:127]
v_add_f32 v201, v201, v192
v_exp_f32 v194, v90
v_add_f32 v201, v201, v193
v_cvt_pk_bf16_f32 v140, v192, v193
v_mfma_f32_32x32x16_bf16 a[0:15], a[240:243], v[148:151], a[0:15]
s_waitcnt vmcnt(28)
s_barrier
v_add_u32 v205, 8192, v205
v_and_b32 v205, 0xffff, v205
v_add_u32 v206, 8192, v206
v_and_or_b32 v206, v206, v230, v231
ds_read_b128 a[192:195], v205 offset:0
s_and_b32 m0, s25, 0xffff
v_mfma_f32_32x32x16_bf16 a[64:79], a[240:243], v[156:159], a[64:79]
v_exp_f32 v195, v91
v_add_f32 v201, v201, v194
v_exp_f32 v196, v92
s_waitcnt lgkmcnt(2)
v_mfma_f32_32x32x16_bf16 a[16:31], a[244:247], v[148:151], a[16:31]
ds_read_b128 a[196:199], v205 offset:1024
v_add_f32 v201, v201, v195
v_cvt_pk_bf16_f32 v141, v194, v195
v_exp_f32 v197, v93
v_mfma_f32_32x32x16_bf16 a[80:95], a[244:247], v[156:159], a[80:95]
buffer_load_dwordx4 v204, s[4:7], s25 offen lds
v_add_f32 v201, v201, v196
v_exp_f32 v198, v94
v_mfma_f32_32x32x16_bf16 a[32:47], a[248:251], v[148:151], a[32:47]
ds_read_b128 a[200:203], v205 offset:2048
v_add_f32 v201, v201, v197
v_cvt_pk_bf16_f32 v142, v196, v197
v_exp_f32 v199, v95
v_add_f32 v201, v201, v198
v_add_f32 v201, v201, v199
v_mfma_f32_32x32x16_bf16 a[96:111], a[248:251], v[156:159], a[96:111]
buffer_load_dwordx4 v204, s[4:7], s25 offen offset:1024 lds
s_add_u32 s25, s25, 8192
v_cvt_pk_bf16_f32 v143, v198, v199
v_max_f32 v210, v200, v201
s_waitcnt lgkmcnt(2)
v_mfma_f32_32x32x16_bf16 a[48:63], a[252:255], v[148:151], a[48:63]
ds_read_b128 a[204:207], v205 offset:3072
v_cmp_lt_f32 vcc, s28, v210
v_mfma_f32_32x32x16_bf16 a[112:127], a[252:255], v[156:159], a[112:127]
s_mov_b32 s76, s72
s_and_b32 s77, s73, 0xffff
s_mov_b32 s78, 7340032
s_mov_b32 s79, 0x20000
buffer_load_dword v253, v252, s[76:79], s74 offen
s_cbranch_vccnz attn_slow4
attn_join4:
v_add_f32 v202, v202, v200
v_add_f32 v203, v203, v201
s_mov_b32 s76, s70
s_and_b32 s77, s71, 0xffff
s_mov_b32 s78, 4194304
s_mov_b32 s79, 0x20000
buffer_load_dword v253, v252, s[76:79], s75 offen
attn_trans:
s_sub_u32 s29, s23, 3
s_lshl_b32 s29, s29, 5
v_subrev_u32 v232, s29, v207
s_waitcnt lgkmcnt(2)
v_mfma_f32_32x32x16_bf16 v[64:79], a[192:195], v[0:3], v[160:175]
s_and_b32 s27, s26, 0xffff
s_or_b32 m0, s27, 0x10000
ds_read_b128 a[208:211], v205 offset:4096
v_cmp_ge_i32 s[40:41], v232, 0
v_cmp_ge_i32 s[42:43], v232, 1
v_cmp_ge_i32 s[44:45], v232, 2
v_mfma_f32_32x32x16_bf16 v[80:95], a[192:195], v[32:35], v[176:191]
v_cmp_ge_i32 s[46:47], v232, 3
v_cndmask_b32 v96, v209, v96, s[40:41]
v_cmp_ge_i32 s[48:49], v232, 8
v_cndmask_b32 v97, v209, v97, s[42:43]
v_exp_f32 v192, v96
v_mfma_f32_32x32x16_bf16 v[64:79], a[196:199], v[4:7], v[64:79]
buffer_load_dwordx4 v204, s[8:11], s26 offen lds
ds_read_b128 a[212:215], v205 offset:5120
v_cmp_ge_i32 s[50:51], v232, 9
v_cndmask_b32 v98, v209, v98, s[44:45]
v_mfma_f32_32x32x16_bf16 v[80:95], a[196:199], v[36:39], v[80:95]
v_exp_f32 v193, v97
v_cmp_ge_i32 s[52:53], v232, 10
v_cndmask_b32 v99, v209, v99, s[46:47]
v_exp_f32 v194, v98
s_waitcnt lgkmcnt(2)
v_mfma_f32_32x32x16_bf16 v[64:79], a[200:203], v[8:11], v[64:79]
buffer_load_dwordx4 v204, s[8:11], s26 offen offset:1024 lds
s_add_u32 s26, s26, 8192
ds_read_b128 a[216:219], v205 offset:6144
v_add_f32 v200, v192, v193
v_mfma_f32_32x32x16_bf16 v[80:95], a[200:203], v[40:43], v[80:95]
v_cvt_pk_bf16_f32 v144, v192, v193
v_cmp_ge_i32 s[54:55], v232, 11
v_cndmask_b32 v100, v209, v100, s[48:49]
v_exp_f32 v195, v99
v_add_f32 v200, v200, v194
v_mfma_f32_32x32x16_bf16 v[64:79], a[204:207], v[12:15], v[64:79]
ds_read_b128 a[220:223], v205 offset:7168
v_cmp_ge_i32 s[40:41], v232, 16
v_cndmask_b32 v101, v209, v101, s[50:51]
v_exp_f32 v196, v100
v_add_f32 v200, v200, v195
v_mfma_f32_32x32x16_bf16 v[80:95], a[204:207], v[44:47], v[80:95]
v_cvt_pk_bf16_f32 v145, v194, v195
v_cmp_ge_i32 s[42:43], v232, 17
v_cndmask_b32 v102, v209, v102, s[52:53]
v_exp_f32 v197, v101
v_add_f32 v200, v200, v196
s_waitcnt lgkmcnt(2)
v_mfma_f32_32x32x16_bf16 v[64:79], a[208:211], v[16:19], v[64:79]
s_waitcnt vmcnt(8)
ds_read_b64_tr_b16 v[236:237], v218 offset:0
ds_read_b64_tr_b16 v[238:239], v218 offset:512
v_cmp_ge_i32 s[44:45], v232, 18
v_cndmask_b32 v103, v209, v103, s[54:55]
v_exp_f32 v198, v102
v_mfma_f32_32x32x16_bf16 v[80:95], a[208:211], v[48:51], v[80:95]
ds_read_b64_tr_b16 v[240:241], v219 offset:0
ds_read_b64_tr_b16 v[242:243], v219 offset:512
v_add_f32 v200, v200, v197
v_cvt_pk_bf16_f32 v146, v196, v197
v_cmp_ge_i32 s[46:47], v232, 19
v_mfma_f32_32x32x16_bf16 v[64:79], a[212:215], v[20:23], v[64:79]
ds_read_b64_tr_b16 v[244:245], v218 offset:2048
ds_read_b64_tr_b16 v[246:247], v218 offset:2560
v_cndmask_b32 v104, v209, v104, s[40:41]
v_exp_f32 v199, v103
v_add_f32 v200, v200, v198
v_cmp_ge_i32 s[48:49], v232, 24
v_mfma_f32_32x32x16_bf16 v[80:95], a[212:215], v[52:55], v[80:95]
ds_read_b64_tr_b16 v[248:249], v219 offset:2048
ds_read_b64_tr_b16 v[250:251], v219 offset:2560
v_cndmask_b32 v105, v209, v105, s[42:43]
v_exp_f32 v192, v104
v_add_f32 v200, v200, v199
s_waitcnt lgkmcnt(8)
v_mfma_f32_32x32x16_bf16 v[64:79], a[216:219], v[24:27], v[64:79]
ds_read_b128 a[224:227], v206 offset:0
v_cvt_pk_bf16_f32 v147, v198, v199
v_cmp_ge_i32 s[50:51], v232, 25
v_cndmask_b32 v106, v209, v106, s[44:45]
v_exp_f32 v193, v105
v_mfma_f32_32x32x16_bf16 v[80:95], a[216:219], v[56:59], v[80:95]
v_add_f32 v200, v200, v192
v_cmp_ge_i32 s[52:53], v232, 26
v_cndmask_b32 v107, v209, v107, s[46:47]
v_exp_f32 v194, v106
v_add_f32 v200, v200, v193
v_mfma_f32_32x32x16_bf16 v[64:79], a[220:223], v[28:31], v[64:79]
ds_read_b128 a[228:231], v206 offset:1024
v_cvt_pk_bf16_f32 v148, v192, v193
v_cmp_ge_i32 s[54:55], v232, 27
v_cndmask_b32 v108, v209, v108, s[48:49]
v_exp_f32 v195, v107
v_mfma_f32_32x32x16_bf16 v[80:95], a[220:223], v[60:63], v[80:95]
v_add_f32 v200, v200, v194
v_cndmask_b32 v109, v209, v109, s[50:51]
v_exp_f32 v196, v108
v_add_f32 v200, v200, v195
v_cvt_pk_bf16_f32 v149, v194, v195
s_waitcnt lgkmcnt(1)
v_mfma_f32_32x32x16_bf16 a[128:143], v[236:239], v[244:247], a[128:143]
ds_read_b128 a[232:235], v206 offset:2048
v_cndmask_b32 v110, v209, v110, s[52:53]
v_exp_f32 v197, v109
v_add_f32 v200, v200, v196
v_cndmask_b32 v111, v209, v111, s[54:55]
v_mfma_f32_32x32x16_bf16 a[144:159], v[236:239], v[248:251], a[144:159]
s_add_u32 m0, s89, 0
v_exp_f32 v198, v110
v_add_f32 v200, v200, v197
v_cvt_pk_bf16_f32 v150, v196, v197
v_mfma_f32_32x32x16_bf16 a[160:175], v[240:243], v[244:247], a[160:175]
buffer_load_dwordx4 v214, s[12:15], s85 offen lds
ds_read_b128 a[236:239], v206 offset:3072
v_exp_f32 v199, v111
v_add_f32 v200, v200, v198
v_mfma_f32_32x32x16_bf16 a[176:191], v[240:243], v[248:251], a[176:191]
v_add_f32 v200, v200, v199
v_cvt_pk_bf16_f32 v151, v198, v199
v_exp_f32 v192, v112
v_exp_f32 v193, v113
v_mfma_f32_32x32x16_bf16 a[0:15], a[224:227], v[128:131], a[0:15]
buffer_load_dwordx4 v215, s[12:15], s85 offen offset:1024 lds
s_add_u32 s85, s85, 57344
ds_read_b128 a[240:243], v206 offset:4096
v_mfma_f32_32x32x16_bf16 a[64:79], a[224:227], v[136:139], a[64:79]
v_exp_f32 v194, v114
v_add_f32 v201, v192, v193
v_cvt_pk_bf16_f32 v152, v192, v193
v_exp_f32 v195, v115
v_add_f32 v201, v201, v194
s_waitcnt lgkmcnt(2)
v_mfma_f32_32x32x16_bf16 a[16:31], a[228:231], v[128:131], a[16:31]
s_add_u32 m0, s89, 2048
ds_read_b128 a[244:247], v206 offset:5120
v_exp_f32 v196, v116
v_add_f32 v201, v201, v195
v_cvt_pk_bf16_f32 v153, v194, v195
v_mfma_f32_32x32x16_bf16 a[80:95], a[228:231], v[136:139], a[80:95]
buffer_load_dwordx4 v216, s[60:63], s88 offen lds
v_exp_f32 v197, v117
v_add_f32 v201, v201, v196
v_mfma_f32_32x32x16_bf16 a[32:47], a[232:235], v[128:131], a[32:47]
ds_read_b128 a[248:251], v206 offset:6144
v_exp_f32 v198, v118
v_add_f32 v201, v201, v197
v_cvt_pk_bf16_f32 v154, v196, v197
v_exp_f32 v199, v119
v_mfma_f32_32x32x16_bf16 a[96:111], a[232:235], v[136:139], a[96:111]
buffer_load_dwordx4 v217, s[60:63], s88 offen offset:1024 lds
s_add_u32 s88, s88, 16384
v_add_f32 v201, v201, v198
s_waitcnt lgkmcnt(2)
v_mfma_f32_32x32x16_bf16 a[48:63], a[236:239], v[128:131], a[48:63]
ds_read_b128 a[252:255], v206 offset:7168
v_exp_f32 v192, v120
v_add_f32 v201, v201, v199
v_cvt_pk_bf16_f32 v155, v198, v199
v_exp_f32 v193, v121
v_mfma_f32_32x32x16_bf16 a[112:127], a[236:239], v[136:139], a[112:127]
v_add_f32 v201, v201, v192
v_exp_f32 v194, v122
v_add_f32 v201, v201, v193
v_cvt_pk_bf16_f32 v156, v192, v193
v_mfma_f32_32x32x16_bf16 a[0:15], a[240:243], v[132:135], a[0:15]
s_waitcnt vmcnt(24)
s_barrier
v_add_u32 v205, 8192, v205
v_and_b32 v205, 0xffff, v205
v_add_u32 v206, 8192, v206
v_and_or_b32 v206, v206, v230, v231
ds_read_b128 a[192:195], v205 offset:0
s_and_b32 m0, s25, 0xffff
v_mfma_f32_32x32x16_bf16 a[64:79], a[240:243], v[140:143], a[64:79]
v_exp_f32 v195, v123
v_add_f32 v201, v201, v194
v_exp_f32 v196, v124
s_waitcnt lgkmcnt(2)
v_mfma_f32_32x32x16_bf16 a[16:31], a[244:247], v[132:135], a[16:31]
ds_read_b128 a[196:199], v205 offset:1024
v_add_f32 v201, v201, v195
v_cvt_pk_bf16_f32 v157, v194, v195
v_exp_f32 v197, v125
v_mfma_f32_32x32x16_bf16 a[80:95], a[244:247], v[140:143], a[80:95]
buffer_load_dwordx4 v204, s[4:7], s25 offen lds
v_add_f32 v201, v201, v196
v_exp_f32 v198, v126
v_mfma_f32_32x32x16_bf16 a[32:47], a[248:251], v[132:135], a[32:47]
ds_read_b128 a[200:203], v205 offset:2048
v_add_f32 v201, v201, v197
v_cvt_pk_bf16_f32 v158, v196, v197
v_exp_f32 v199, v127
v_add_f32 v201, v201, v198
v_add_f32 v201, v201, v199
v_mfma_f32_32x32x16_bf16 a[96:111], a[248:251], v[140:143], a[96:111]
buffer_load_dwordx4 v204, s[4:7], s25 offen offset:1024 lds
s_add_u32 s25, s25, 8192
v_cvt_pk_bf16_f32 v159, v198, v199
v_max_f32 v210, v200, v201
s_waitcnt lgkmcnt(2)
v_mfma_f32_32x32x16_bf16 a[48:63], a[252:255], v[132:135], a[48:63]
ds_read_b128 a[204:207], v205 offset:3072
v_cmp_lt_f32 vcc, s28, v210
v_mfma_f32_32x32x16_bf16 a[112:127], a[252:255], v[140:143], a[112:127]
s_cbranch_vccnz attn_slow5
attn_join5:
v_add_f32 v202, v202, v200
v_add_f32 v203, v203, v201
s_sub_u32 s29, s23, 2
s_lshl_b32 s29, s29, 5
v_subrev_u32 v232, s29, v207
s_lshl_b32 s27, s20, 11
s_add_u32 s25, s25, s27
s_waitcnt lgkmcnt(2)
v_mfma_f32_32x32x16_bf16 v[96:111], a[192:195], v[0:3], v[160:175]
s_and_b32 s27, s26, 0xffff
s_or_b32 m0, s27, 0x10000
ds_read_b128 a[208:211], v205 offset:4096
v_cmp_ge_i32 s[40:41], v232, 0
v_cmp_ge_i32 s[42:43], v232, 1
v_cmp_ge_i32 s[44:45], v232, 2
v_mfma_f32_32x32x16_bf16 v[112:127], a[192:195], v[32:35], v[176:191]
v_cmp_ge_i32 s[46:47], v232, 3
v_cndmask_b32 v64, v209, v64, s[40:41]
v_cmp_ge_i32 s[48:49], v232, 8
v_cndmask_b32 v65, v209, v65, s[42:43]
v_exp_f32 v192, v64
v_cmp_ge_i32 s[50:51], v232, 9
v_mfma_f32_32x32x16_bf16 v[96:111], a[196:199], v[4:7], v[96:111]
buffer_load_dwordx4 v204, s[8:11], s26 offen lds
ds_read_b128 a[212:215], v205 offset:5120
v_cndmask_b32 v66, v209, v66, s[44:45]
v_exp_f32 v193, v65
v_mfma_f32_32x32x16_bf16 v[112:127], a[196:199], v[36:39], v[112:127]
v_cmp_ge_i32 s[52:53], v232, 10
v_cndmask_b32 v67, v209, v67, s[46:47]
v_exp_f32 v194, v66
v_add_f32 v200, v192, v193
s_waitcnt lgkmcnt(2)
v_mfma_f32_32x32x16_bf16 v[96:111], a[200:203], v[8:11], v[96:111]
buffer_load_dwordx4 v204, s[8:11], s26 offen offset:1024 lds
s_add_u32 s26, s26, 8192
ds_read_b128 a[216:219], v205 offset:6144
v_cvt_pk_bf16_f32 v128, v192, v193
v_cmp_ge_i32 s[54:55], v232, 11
v_mfma_f32_32x32x16_bf16 v[112:127], a[200:203], v[40:43], v[112:127]
v_cndmask_b32 v68, v209, v68, s[48:49]
v_exp_f32 v195, v67
v_add_f32 v200, v200, v194
v_cmp_ge_i32 s[40:41], v232, 16
v_cndmask_b32 v69, v209, v69, s[50:51]
v_mfma_f32_32x32x16_bf16 v[96:111], a[204:207], v[12:15], v[96:111]
ds_read_b128 a[220:223], v205 offset:7168
v_exp_f32 v196, v68
v_add_f32 v200, v200, v195
v_cvt_pk_bf16_f32 v129, v194, v195
v_cmp_ge_i32 s[42:43], v232, 17
v_mfma_f32_32x32x16_bf16 v[112:127], a[204:207], v[44:47], v[112:127]
v_cndmask_b32 v70, v209, v70, s[52:53]
v_exp_f32 v197, v69
v_add_f32 v200, v200, v196
v_cmp_ge_i32 s[44:45], v232, 18
v_cndmask_b32 v71, v209, v71, s[54:55]
s_waitcnt lgkmcnt(2)
v_mfma_f32_32x32x16_bf16 v[96:111], a[208:211], v[16:19], v[96:111]
s_waitcnt vmcnt(12)
ds_read_b64_tr_b16 v[236:237], v218 offset:4096
ds_read_b64_tr_b16 v[238:239], v218 offset:4608
v_exp_f32 v198, v70
v_add_f32 v200, v200, v197
v_cvt_pk_bf16_f32 v130, v196, v197
v_mfma_f32_32x32x16_bf16 v[112:127], a[208:211], v[48:51], v[112:127]
ds_read_b64_tr_b16 v[240:241], v219 offset:4096
ds_read_b64_tr_b16 v[242:243], v219 offset:4608
v_cmp_ge_i32 s[46:47], v232, 19
v_cndmask_b32 v72, v209, v72, s[40:41]
v_exp_f32 v199, v71
v_mfma_f32_32x32x16_bf16 v[96:111], a[212:215], v[20:23], v[96:111]
ds_read_b64_tr_b16 v[244:245], v218 offset:6144
ds_read_b64_tr_b16 v[246:247], v218 offset:6656
v_add_f32 v200, v200, v198
v_cmp_ge_i32 s[48:49], v232, 24
v_cndmask_b32 v73, v209, v73, s[42:43]
v_exp_f32 v192, v72
v_mfma_f32_32x32x16_bf16 v[112:127], a[212:215], v[52:55], v[112:127]
ds_read_b64_tr_b16 v[248:249], v219 offset:6144
ds_read_b64_tr_b16 v[250:251], v219 offset:6656
v_add_f32 v200, v200, v199
v_cvt_pk_bf16_f32 v131, v198, v199
v_cmp_ge_i32 s[50:51], v232, 25
v_cndmask_b32 v74, v209, v74, s[44:45]
s_waitcnt lgkmcnt(8)
v_mfma_f32_32x32x16_bf16 v[96:111], a[216:219], v[24:27], v[96:111]
ds_read_b128 a[224:227], v206 offset:0
v_exp_f32 v193, v73
v_add_f32 v200, v200, v192
v_cmp_ge_i32 s[52:53], v232, 26
v_cndmask_b32 v75, v209, v75, s[46:47]
v_mfma_f32_32x32x16_bf16 v[112:127], a[216:219], v[56:59], v[112:127]
v_exp_f32 v194, v74
v_add_f32 v200, v200, v193
v_cvt_pk_bf16_f32 v132, v192, v193
v_cmp_ge_i32 s[54:55], v232, 27
v_cndmask_b32 v76, v209, v76, s[48:49]
v_mfma_f32_32x32x16_bf16 v[96:111], a[220:223], v[28:31], v[96:111]
ds_read_b128 a[228:231], v206 offset:1024
v_exp_f32 v195, v75
v_add_f32 v200, v200, v194
v_cndmask_b32 v77, v209, v77, s[50:51]
v_exp_f32 v196, v76
v_mfma_f32_32x32x16_bf16 v[112:127], a[220:223], v[60:63], v[112:127]
v_add_f32 v200, v200, v195
v_cvt_pk_bf16_f32 v133, v194, v195
v_cndmask_b32 v78, v209, v78, s[52:53]
v_exp_f32 v197, v77
v_add_f32 v200, v200, v196
s_waitcnt lgkmcnt(1)
v_mfma_f32_32x32x16_bf16 a[128:143], v[236:239], v[244:247], a[128:143]
ds_read_b128 a[232:235], v206 offset:2048
v_cndmask_b32 v79, v209, v79, s[54:55]
v_exp_f32 v198, v78
v_add_f32 v200, v200, v197
v_cvt_pk_bf16_f32 v134, v196, v197
v_mfma_f32_32x32x16_bf16 a[144:159], v[236:239], v[248:251], a[144:159]
s_add_u32 m0, s89, 4096
v_exp_f32 v199, v79
v_add_f32 v200, v200, v198
v_add_f32 v200, v200, v199
v_cvt_pk_bf16_f32 v135, v198, v199
v_exp_f32 v192, v80
v_mfma_f32_32x32x16_bf16 a[160:175], v[240:243], v[244:247], a[160:175]
buffer_load_dwordx4 v214, s[12:15], s85 offen lds
ds_read_b128 a[236:239], v206 offset:3072
v_exp_f32 v193, v81
v_mfma_f32_32x32x16_bf16 a[176:191], v[240:243], v[248:251], a[176:191]
v_exp_f32 v194, v82
v_add_f32 v201, v192, v193
v_cvt_pk_bf16_f32 v136, v192, v193
v_exp_f32 v195, v83
v_mfma_f32_32x32x16_bf16 a[0:15], a[224:227], v[144:147], a[0:15]
buffer_load_dwordx4 v215, s[12:15], s85 offen offset:1024 lds
s_add_u32 s85, s85, 57344
ds_read_b128 a[240:243], v206 offset:4096
v_add_f32 v201, v201, v194
v_mfma_f32_32x32x16_bf16 a[64:79], a[224:227], v[152:155], a[64:79]
v_exp_f32 v196, v84
v_add_f32 v201, v201, v195
v_cvt_pk_bf16_f32 v137, v194, v195
v_exp_f32 v197, v85
s_waitcnt lgkmcnt(2)
v_mfma_f32_32x32x16_bf16 a[16:31], a[228:231], v[144:147], a[16:31]
s_add_u32 m0, s89, 6144
ds_read_b128 a[244:247], v206 offset:5120
v_add_f32 v201, v201, v196
v_exp_f32 v198, v86
v_add_f32 v201, v201, v197
v_cvt_pk_bf16_f32 v138, v196, v197
v_mfma_f32_32x32x16_bf16 a[80:95], a[228:231], v[152:155], a[80:95]
buffer_load_dwordx4 v216, s[60:63], s88 offen lds
v_exp_f32 v199, v87
v_add_f32 v201, v201, v198
v_mfma_f32_32x32x16_bf16 a[32:47], a[232:235], v[144:147], a[32:47]
ds_read_b128 a[248:251], v206 offset:6144
v_exp_f32 v192, v88
v_add_f32 v201, v201, v199
v_cvt_pk_bf16_f32 v139, v198, v199
v_exp_f32 v193, v89
v_mfma_f32_32x32x16_bf16 a[96:111], a[232:235], v[152:155], a[96:111]
buffer_load_dwordx4 v217, s[60:63], s88 offen offset:1024 lds
s_add_u32 s88, s88, 16384
v_add_f32 v201, v201, v192
s_waitcnt lgkmcnt(2)
v_mfma_f32_32x32x16_bf16 a[48:63], a[236:239], v[144:147], a[48:63]
ds_read_b128 a[252:255], v206 offset:7168
v_exp_f32 v194, v90
v_add_f32 v201, v201, v193
v_cvt_pk_bf16_f32 v140, v192, v193
v_exp_f32 v195, v91
v_mfma_f32_32x32x16_bf16 a[112:127], a[236:239], v[152:155], a[112:127]
v_add_f32 v201, v201, v194
v_exp_f32 v196, v92
v_add_f32 v201, v201, v195
v_cvt_pk_bf16_f32 v141, v194, v195
v_exp_f32 v197, v93
v_mfma_f32_32x32x16_bf16 a[0:15], a[240:243], v[148:151], a[0:15]
s_waitcnt vmcnt(28)
s_barrier
v_add_u32 v205, 8192, v205
v_and_b32 v205, 0xffff, v205
v_add_u32 v206, 8192, v206
v_and_or_b32 v206, v206, v230, v231
ds_read_b128 a[192:195], v205 offset:0
s_and_b32 m0, s25, 0xffff
v_mfma_f32_32x32x16_bf16 a[64:79], a[240:243], v[156:159], a[64:79]
buffer_load_dwordx4 v204, s[4:7], s25 offen lds
ds_read_b128 a[196:199], v205 offset:1024
s_waitcnt lgkmcnt(3)
v_mfma_f32_32x32x16_bf16 a[16:31], a[244:247], v[148:151], a[16:31]
ds_read_b128 a[200:203], v205 offset:2048
v_add_f32 v201, v201, v196
v_exp_f32 v198, v94
v_add_f32 v201, v201, v197
v_cvt_pk_bf16_f32 v142, v196, v197
v_mfma_f32_32x32x16_bf16 a[80:95], a[244:247], v[156:159], a[80:95]
buffer_load_dwordx4 v204, s[4:7], s25 offen offset:1024 lds
ds_read_b128 a[204:207], v205 offset:3072
v_exp_f32 v199, v95
v_add_f32 v201, v201, v198
v_mfma_f32_32x32x16_bf16 a[32:47], a[248:251], v[148:151], a[32:47]
ds_read_b128 a[208:211], v205 offset:4096
v_add_f32 v201, v201, v199
v_cvt_pk_bf16_f32 v143, v198, v199
v_max_f32 v210, v200, v201
v_cmp_lt_f32 vcc, s28, v210
v_mfma_f32_32x32x16_bf16 a[96:111], a[248:251], v[156:159], a[96:111]
buffer_load_dwordx4 v204, s[4:7], s25 offen offset:2048 lds
ds_read_b128 a[212:215], v205 offset:5120
s_waitcnt lgkmcnt(5)
v_mfma_f32_32x32x16_bf16 a[48:63], a[252:255], v[148:151], a[48:63]
ds_read_b128 a[216:219], v205 offset:6144
v_mfma_f32_32x32x16_bf16 a[112:127], a[252:255], v[156:159], a[112:127]
buffer_load_dwordx4 v204, s[4:7], s25 offen offset:3072 lds
s_add_u32 s25, s25, 16384
ds_read_b128 a[220:223], v205 offset:7168
s_cbranch_vccnz attn_slow6
attn_join6:
v_add_f32 v202, v202, v200
v_add_f32 v203, v203, v201
s_sub_u32 s29, s23, 1
s_lshl_b32 s29, s29, 5
v_subrev_u32 v232, s29, v207
s_waitcnt lgkmcnt(6)
v_mfma_f32_32x32x16_bf16 v[64:79], a[192:195], v[32:35], v[176:191]
s_and_b32 s27, s26, 0xffff
s_or_b32 m0, s27, 0x10000
ds_read_b128 a[224:227], v205 offset:8192
v_cmp_ge_i32 s[40:41], v232, 0
v_cmp_ge_i32 s[42:43], v232, 1
v_cmp_ge_i32 s[44:45], v232, 2
v_mfma_f32_32x32x16_bf16 v[64:79], a[196:199], v[36:39], v[64:79]
ds_read_b128 a[228:231], v205 offset:9216
v_cmp_ge_i32 s[46:47], v232, 3
v_cndmask_b32 v96, v209, v96, s[40:41]
v_cmp_ge_i32 s[48:49], v232, 8
v_cndmask_b32 v97, v209, v97, s[42:43]
v_exp_f32 v192, v96
s_waitcnt lgkmcnt(6)
v_mfma_f32_32x32x16_bf16 v[64:79], a[200:203], v[40:43], v[64:79]
buffer_load_dwordx4 v204, s[8:11], s26 offen lds
ds_read_b128 a[232:235], v205 offset:10240
v_cmp_ge_i32 s[50:51], v232, 9
v_cndmask_b32 v98, v209, v98, s[44:45]
v_mfma_f32_32x32x16_bf16 v[64:79], a[204:207], v[44:47], v[64:79]
ds_read_b128 a[236:239], v205 offset:11264
v_exp_f32 v193, v97
v_cmp_ge_i32 s[52:53], v232, 10
v_cndmask_b32 v99, v209, v99, s[46:47]
v_exp_f32 v194, v98
s_waitcnt lgkmcnt(6)
v_mfma_f32_32x32x16_bf16 v[64:79], a[208:211], v[48:51], v[64:79]
buffer_load_dwordx4 v204, s[8:11], s26 offen offset:1024 lds
s_add_u32 s26, s26, 8192
ds_read_b128 a[240:243], v205 offset:12288
v_add_f32 v200, v192, v193
v_mfma_f32_32x32x16_bf16 v[64:79], a[212:215], v[52:55], v[64:79]
ds_read_b128 a[244:247], v205 offset:13312
v_cvt_pk_bf16_f32 v144, v192, v193
v_cmp_ge_i32 s[54:55], v232, 11
v_cndmask_b32 v100, v209, v100, s[48:49]
v_exp_f32 v195, v99
v_add_f32 v200, v200, v194
s_waitcnt lgkmcnt(6)
v_mfma_f32_32x32x16_bf16 v[64:79], a[216:219], v[56:59], v[64:79]
ds_read_b128 a[248:251], v205 offset:14336
v_cmp_ge_i32 s[40:41], v232, 16
v_cndmask_b32 v101, v209, v101, s[50:51]
v_exp_f32 v196, v100
v_add_f32 v200, v200, v195
v_mfma_f32_32x32x16_bf16 v[64:79], a[220:223], v[60:63], v[64:79]
ds_read_b128 a[252:255], v205 offset:15360
v_cvt_pk_bf16_f32 v145, v194, v195
v_cmp_ge_i32 s[42:43], v232, 17
v_cndmask_b32 v102, v209, v102, s[52:53]
v_exp_f32 v197, v101
v_add_f32 v200, v200, v196
s_waitcnt lgkmcnt(6)
v_mfma_f32_32x32x16_bf16 v[80:95], a[224:227], v[32:35], v[176:191]
s_waitcnt vmcnt(14)
ds_read_b64_tr_b16 v[236:237], v218 offset:0
ds_read_b64_tr_b16 v[238:239], v218 offset:512
v_cmp_ge_i32 s[44:45], v232, 18
v_cndmask_b32 v103, v209, v103, s[54:55]
v_exp_f32 v198, v102
v_mfma_f32_32x32x16_bf16 v[80:95], a[228:231], v[36:39], v[80:95]
ds_read_b64_tr_b16 v[240:241], v219 offset:0
ds_read_b64_tr_b16 v[242:243], v219 offset:512
v_add_f32 v200, v200, v197
v_cvt_pk_bf16_f32 v146, v196, v197
v_cmp_ge_i32 s[46:47], v232, 19
v_cndmask_b32 v104, v209, v104, s[40:41]
s_waitcnt lgkmcnt(8)
v_mfma_f32_32x32x16_bf16 v[80:95], a[232:235], v[40:43], v[80:95]
ds_read_b64_tr_b16 v[244:245], v218 offset:2048
ds_read_b64_tr_b16 v[246:247], v218 offset:2560
v_exp_f32 v199, v103
v_add_f32 v200, v200, v198
v_cmp_ge_i32 s[48:49], v232, 24
v_mfma_f32_32x32x16_bf16 v[80:95], a[236:239], v[44:47], v[80:95]
ds_read_b64_tr_b16 v[248:249], v219 offset:2048
ds_read_b64_tr_b16 v[250:251], v219 offset:2560
v_cndmask_b32 v105, v209, v105, s[42:43]
v_exp_f32 v192, v104
v_add_f32 v200, v200, v199
s_waitcnt lgkmcnt(10)
v_mfma_f32_32x32x16_bf16 v[80:95], a[240:243], v[48:51], v[80:95]
ds_read_b128 a[192:195], v206 offset:0
v_cvt_pk_bf16_f32 v147, v198, v199
v_cmp_ge_i32 s[50:51], v232, 25
v_cndmask_b32 v106, v209, v106, s[44:45]
v_exp_f32 v193, v105
v_add_f32 v200, v200, v192
v_mfma_f32_32x32x16_bf16 v[80:95], a[244:247], v[52:55], v[80:95]
v_cmp_ge_i32 s[52:53], v232, 26
v_cndmask_b32 v107, v209, v107, s[46:47]
v_exp_f32 v194, v106
v_add_f32 v200, v200, v193
v_cvt_pk_bf16_f32 v148, v192, v193
s_waitcnt lgkmcnt(9)
v_mfma_f32_32x32x16_bf16 v[80:95], a[248:251], v[56:59], v[80:95]
ds_read_b128 a[196:199], v206 offset:1024
v_cmp_ge_i32 s[54:55], v232, 27
v_cndmask_b32 v108, v209, v108, s[48:49]
v_exp_f32 v195, v107
v_add_f32 v200, v200, v194
v_cndmask_b32 v109, v209, v109, s[50:51]
v_mfma_f32_32x32x16_bf16 v[80:95], a[252:255], v[60:63], v[80:95]
v_exp_f32 v196, v108
v_add_f32 v200, v200, v195
v_cvt_pk_bf16_f32 v149, v194, v195
v_cndmask_b32 v110, v209, v110, s[52:53]
v_exp_f32 v197, v109
s_waitcnt lgkmcnt(1)
v_mfma_f32_32x32x16_bf16 a[128:143], v[236:239], v[244:247], a[128:143]
ds_read_b128 a[200:203], v206 offset:2048
v_add_f32 v200, v200, v196
v_cndmask_b32 v111, v209, v111, s[54:55]
v_exp_f32 v198, v110
v_add_f32 v200, v200, v197
v_mfma_f32_32x32x16_bf16 a[144:159], v[236:239], v[248:251], a[144:159]
s_add_u32 m0, s89, 0
v_cvt_pk_bf16_f32 v150, v196, v197
v_exp_f32 v199, v111
v_add_f32 v200, v200, v198
v_add_f32 v200, v200, v199
v_mfma_f32_32x32x16_bf16 a[160:175], v[240:243], v[244:247], a[160:175]
buffer_load_dwordx4 v214, s[12:15], s85 offen lds
ds_read_b128 a[204:207], v206 offset:3072
v_cvt_pk_bf16_f32 v151, v198, v199
v_exp_f32 v192, v112
v_mfma_f32_32x32x16_bf16 a[176:191], v[240:243], v[248:251], a[176:191]
v_exp_f32 v193, v113
v_exp_f32 v194, v114
v_add_f32 v201, v192, v193
v_cvt_pk_bf16_f32 v152, v192, v193
v_mfma_f32_32x32x16_bf16 a[0:15], a[192:195], v[128:131], a[0:15]
buffer_load_dwordx4 v215, s[12:15], s85 offen offset:1024 lds
s_add_u32 s85, s85, 57344
ds_read_b128 a[208:211], v206 offset:4096
v_exp_f32 v195, v115
v_mfma_f32_32x32x16_bf16 a[64:79], a[192:195], v[136:139], a[64:79]
v_add_f32 v201, v201, v194
v_exp_f32 v196, v116
v_add_f32 v201, v201, v195
v_cvt_pk_bf16_f32 v153, v194, v195
s_waitcnt lgkmcnt(2)
v_mfma_f32_32x32x16_bf16 a[16:31], a[196:199], v[128:131], a[16:31]
s_add_u32 m0, s89, 2048
ds_read_b128 a[212:215], v206 offset:5120
v_exp_f32 v197, v117
v_add_f32 v201, v201, v196
v_exp_f32 v198, v118
v_mfma_f32_32x32x16_bf16 a[80:95], a[196:199], v[136:139], a[80:95]
buffer_load_dwordx4 v216, s[60:63], s88 offen lds
v_add_f32 v201, v201, v197
v_cvt_pk_bf16_f32 v154, v196, v197
v_exp_f32 v199, v119
v_mfma_f32_32x32x16_bf16 a[32:47], a[200:203], v[128:131], a[32:47]
ds_read_b128 a[216:219], v206 offset:6144
v_add_f32 v201, v201, v198
v_exp_f32 v192, v120
v_add_f32 v201, v201, v199
v_cvt_pk_bf16_f32 v155, v198, v199
v_mfma_f32_32x32x16_bf16 a[96:111], a[200:203], v[136:139], a[96:111]
buffer_load_dwordx4 v217, s[60:63], s88 offen offset:1024 lds
s_add_u32 s88, s88, 16384
v_exp_f32 v193, v121
v_add_f32 v201, v201, v192
s_waitcnt lgkmcnt(2)
v_mfma_f32_32x32x16_bf16 a[48:63], a[204:207], v[128:131], a[48:63]
ds_read_b128 a[220:223], v206 offset:7168
v_exp_f32 v194, v122
v_add_f32 v201, v201, v193
v_cvt_pk_bf16_f32 v156, v192, v193
v_exp_f32 v195, v123
v_mfma_f32_32x32x16_bf16 a[112:127], a[204:207], v[136:139], a[112:127]
v_add_f32 v201, v201, v194
v_exp_f32 v196, v124
v_add_f32 v201, v201, v195
v_cvt_pk_bf16_f32 v157, v194, v195
v_mfma_f32_32x32x16_bf16 a[0:15], a[208:211], v[132:135], a[0:15]
s_waitcnt vmcnt(30)
s_barrier
v_add_u32 v205, 16384, v205
v_and_b32 v205, 0xffff, v205
v_add_u32 v206, 8192, v206
v_and_or_b32 v206, v206, v230, v231
ds_read_b128 a[224:227], v205 offset:0
s_and_b32 m0, s25, 0xffff
v_mfma_f32_32x32x16_bf16 a[64:79], a[208:211], v[140:143], a[64:79]
buffer_load_dwordx4 v204, s[4:7], s25 offen lds
ds_read_b128 a[228:231], v205 offset:1024
v_exp_f32 v197, v125
s_waitcnt lgkmcnt(3)
v_mfma_f32_32x32x16_bf16 a[16:31], a[212:215], v[132:135], a[16:31]
ds_read_b128 a[232:235], v205 offset:2048
v_add_f32 v201, v201, v196
v_exp_f32 v198, v126
v_add_f32 v201, v201, v197
v_cvt_pk_bf16_f32 v158, v196, v197
v_mfma_f32_32x32x16_bf16 a[80:95], a[212:215], v[140:143], a[80:95]
buffer_load_dwordx4 v204, s[4:7], s25 offen offset:1024 lds
ds_read_b128 a[236:239], v205 offset:3072
v_exp_f32 v199, v127
v_add_f32 v201, v201, v198
v_mfma_f32_32x32x16_bf16 a[32:47], a[216:219], v[132:135], a[32:47]
ds_read_b128 a[240:243], v205 offset:4096
v_add_f32 v201, v201, v199
v_cvt_pk_bf16_f32 v159, v198, v199
v_max_f32 v210, v200, v201
v_cmp_lt_f32 vcc, s28, v210
v_mfma_f32_32x32x16_bf16 a[96:111], a[216:219], v[140:143], a[96:111]
buffer_load_dwordx4 v204, s[4:7], s25 offen offset:2048 lds
ds_read_b128 a[244:247], v205 offset:5120
s_waitcnt lgkmcnt(5)
v_mfma_f32_32x32x16_bf16 a[48:63], a[220:223], v[132:135], a[48:63]
ds_read_b128 a[248:251], v205 offset:6144
v_mfma_f32_32x32x16_bf16 a[112:127], a[220:223], v[140:143], a[112:127]
buffer_load_dwordx4 v204, s[4:7], s25 offen offset:3072 lds
s_add_u32 s25, s25, 16384
ds_read_b128 a[252:255], v205 offset:7168
s_cbranch_vccnz attn_slow7
attn_join7:
v_add_f32 v202, v202, v200
v_add_f32 v203, v203, v201
s_lshl_b32 s29, s23, 5
v_subrev_u32 v232, s29, v208
v_subrev_u32 v233, 32, v232
s_waitcnt lgkmcnt(6)
v_mfma_f32_32x32x16_bf16 v[96:111], a[224:227], v[32:35], v[176:191]
s_and_b32 s27, s26, 0xffff
s_or_b32 m0, s27, 0x10000
ds_read_b128 a[192:195], v205 offset:8192
v_cmp_ge_i32 s[40:41], v232, 0
v_cmp_ge_i32 s[42:43], v232, 1
v_cmp_ge_i32 s[44:45], v232, 2
v_cmp_ge_i32 s[46:47], v232, 3
v_mfma_f32_32x32x16_bf16 v[96:111], a[228:231], v[36:39], v[96:111]
ds_read_b128 a[196:199], v205 offset:9216
v_cndmask_b32 v64, v209, v64, s[40:41]
v_cmp_ge_i32 s[48:49], v232, 8
v_cndmask_b32 v65, v209, v65, s[42:43]
v_exp_f32 v192, v64
v_cmp_ge_i32 s[50:51], v232, 9
v_cndmask_b32 v66, v209, v66, s[44:45]
s_waitcnt lgkmcnt(6)
v_mfma_f32_32x32x16_bf16 v[96:111], a[232:235], v[40:43], v[96:111]
buffer_load_dwordx4 v204, s[8:11], s26 offen lds
ds_read_b128 a[200:203], v205 offset:10240
v_exp_f32 v193, v65
v_cmp_ge_i32 s[52:53], v232, 10
v_mfma_f32_32x32x16_bf16 v[96:111], a[236:239], v[44:47], v[96:111]
ds_read_b128 a[204:207], v205 offset:11264
v_cndmask_b32 v67, v209, v67, s[46:47]
v_exp_f32 v194, v66
v_add_f32 v200, v192, v193
v_cvt_pk_bf16_f32 v128, v192, v193
v_cmp_ge_i32 s[54:55], v232, 11
v_cndmask_b32 v68, v209, v68, s[48:49]
s_waitcnt lgkmcnt(6)
v_mfma_f32_32x32x16_bf16 v[96:111], a[240:243], v[48:51], v[96:111]
buffer_load_dwordx4 v204, s[8:11], s26 offen offset:1024 lds
s_add_u32 s26, s26, 8192
ds_read_b128 a[208:211], v205 offset:12288
v_exp_f32 v195, v67
v_mfma_f32_32x32x16_bf16 v[96:111], a[244:247], v[52:55], v[96:111]
ds_read_b128 a[212:215], v205 offset:13312
v_add_f32 v200, v200, v194
v_cmp_ge_i32 s[40:41], v232, 16
v_cndmask_b32 v69, v209, v69, s[50:51]
v_exp_f32 v196, v68
v_add_f32 v200, v200, v195
s_waitcnt lgkmcnt(6)
v_mfma_f32_32x32x16_bf16 v[96:111], a[248:251], v[56:59], v[96:111]
ds_read_b128 a[216:219], v205 offset:14336
v_cvt_pk_bf16_f32 v129, v194, v195
v_cmp_ge_i32 s[42:43], v232, 17
v_cndmask_b32 v70, v209, v70, s[52:53]
v_exp_f32 v197, v69
v_add_f32 v200, v200, v196
v_cmp_ge_i32 s[44:45], v232, 18
v_mfma_f32_32x32x16_bf16 v[96:111], a[252:255], v[60:63], v[96:111]
ds_read_b128 a[220:223], v205 offset:15360
v_cndmask_b32 v71, v209, v71, s[54:55]
v_exp_f32 v198, v70
v_add_f32 v200, v200, v197
v_cvt_pk_bf16_f32 v130, v196, v197
v_cmp_ge_i32 s[46:47], v232, 19
s_waitcnt lgkmcnt(6)
v_mfma_f32_32x32x16_bf16 v[112:127], a[192:195], v[32:35], v[176:191]
s_waitcnt vmcnt(16)
ds_read_b64_tr_b16 v[236:237], v218 offset:4096
ds_read_b64_tr_b16 v[238:239], v218 offset:4608
v_cndmask_b32 v72, v209, v72, s[40:41]
v_exp_f32 v199, v71
v_add_f32 v200, v200, v198
v_mfma_f32_32x32x16_bf16 v[112:127], a[196:199], v[36:39], v[112:127]
ds_read_b64_tr_b16 v[240:241], v219 offset:4096
ds_read_b64_tr_b16 v[242:243], v219 offset:4608
v_cmp_ge_i32 s[48:49], v232, 24
v_cndmask_b32 v73, v209, v73, s[42:43]
v_exp_f32 v192, v72
v_add_f32 v200, v200, v199
v_cvt_pk_bf16_f32 v131, v198, v199
s_waitcnt lgkmcnt(8)
v_mfma_f32_32x32x16_bf16 v[112:127], a[200:203], v[40:43], v[112:127]
ds_read_b64_tr_b16 v[244:245], v218 offset:6144
ds_read_b64_tr_b16 v[246:247], v218 offset:6656
v_cmp_ge_i32 s[50:51], v232, 25
v_cndmask_b32 v74, v209, v74, s[44:45]
v_exp_f32 v193, v73
v_add_f32 v200, v200, v192
v_mfma_f32_32x32x16_bf16 v[112:127], a[204:207], v[44:47], v[112:127]
ds_read_b64_tr_b16 v[248:249], v219 offset:6144
ds_read_b64_tr_b16 v[250:251], v219 offset:6656
v_cmp_ge_i32 s[52:53], v232, 26
v_cndmask_b32 v75, v209, v75, s[46:47]
v_exp_f32 v194, v74
v_add_f32 v200, v200, v193
v_cvt_pk_bf16_f32 v132, v192, v193
s_waitcnt lgkmcnt(10)
v_mfma_f32_32x32x16_bf16 v[112:127], a[208:211], v[48:51], v[112:127]
ds_read_b128 a[224:227], v206 offset:0
v_cmp_ge_i32 s[54:55], v232, 27
v_cndmask_b32 v76, v209, v76, s[48:49]
v_exp_f32 v195, v75
v_add_f32 v200, v200, v194
v_cndmask_b32 v77, v209, v77, s[50:51]
v_mfma_f32_32x32x16_bf16 v[112:127], a[212:215], v[52:55], v[112:127]
v_exp_f32 v196, v76
v_add_f32 v200, v200, v195
v_cvt_pk_bf16_f32 v133, v194, v195
v_cndmask_b32 v78, v209, v78, s[52:53]
v_exp_f32 v197, v77
s_waitcnt lgkmcnt(9)
v_mfma_f32_32x32x16_bf16 v[112:127], a[216:219], v[56:59], v[112:127]
ds_read_b128 a[228:231], v206 offset:1024
v_add_f32 v200, v200, v196
v_cndmask_b32 v79, v209, v79, s[54:55]
v_exp_f32 v198, v78
v_add_f32 v200, v200, v197
v_cvt_pk_bf16_f32 v134, v196, v197
v_mfma_f32_32x32x16_bf16 v[112:127], a[220:223], v[60:63], v[112:127]
v_exp_f32 v199, v79
v_add_f32 v200, v200, v198
v_add_f32 v200, v200, v199
v_cvt_pk_bf16_f32 v135, v198, v199
v_cmp_ge_i32 s[40:41], v233, 0
v_cmp_ge_i32 s[42:43], v233, 1
v_cmp_ge_i32 s[44:45], v233, 2
s_waitcnt lgkmcnt(1)
v_mfma_f32_32x32x16_bf16 a[128:143], v[236:239], v[244:247], a[128:143]
ds_read_b128 a[232:235], v206 offset:2048
v_cmp_ge_i32 s[46:47], v233, 3
v_cndmask_b32 v80, v209, v80, s[40:41]
v_cmp_ge_i32 s[48:49], v233, 8
v_cndmask_b32 v81, v209, v81, s[42:43]
v_exp_f32 v192, v80
v_cmp_ge_i32 s[50:51], v233, 9
v_mfma_f32_32x32x16_bf16 a[144:159], v[236:239], v[248:251], a[144:159]
s_add_u32 m0, s89, 4096
v_cndmask_b32 v82, v209, v82, s[44:45]
v_exp_f32 v193, v81
v_cmp_ge_i32 s[52:53], v233, 10
v_cndmask_b32 v83, v209, v83, s[46:47]
v_mfma_f32_32x32x16_bf16 a[160:175], v[240:243], v[244:247], a[160:175]
buffer_load_dwordx4 v214, s[12:15], s85 offen lds
ds_read_b128 a[236:239], v206 offset:3072
v_exp_f32 v194, v82
v_add_f32 v201, v192, v193
v_cvt_pk_bf16_f32 v136, v192, v193
v_mfma_f32_32x32x16_bf16 a[176:191], v[240:243], v[248:251], a[176:191]
v_cmp_ge_i32 s[54:55], v233, 11
v_cndmask_b32 v84, v209, v84, s[48:49]
v_exp_f32 v195, v83
v_add_f32 v201, v201, v194
v_cmp_ge_i32 s[40:41], v233, 16
v_cndmask_b32 v85, v209, v85, s[50:51]
v_mfma_f32_32x32x16_bf16 a[0:15], a[224:227], v[144:147], a[0:15]
buffer_load_dwordx4 v215, s[12:15], s85 offen offset:1024 lds
s_add_u32 s85, s85, 57344
ds_read_b128 a[240:243], v206 offset:4096
v_exp_f32 v196, v84
v_add_f32 v201, v201, v195
v_mfma_f32_32x32x16_bf16 a[64:79], a[224:227], v[152:155], a[64:79]
v_cvt_pk_bf16_f32 v137, v194, v195
v_cmp_ge_i32 s[42:43], v233, 17
v_cndmask_b32 v86, v209, v86, s[52:53]
v_exp_f32 v197, v85
v_add_f32 v201, v201, v196
v_cmp_ge_i32 s[44:45], v233, 18
s_waitcnt lgkmcnt(2)
v_mfma_f32_32x32x16_bf16 a[16:31], a[228:231], v[144:147], a[16:31]
s_add_u32 m0, s89, 6144
ds_read_b128 a[244:247], v206 offset:5120
v_cndmask_b32 v87, v209, v87, s[54:55]
v_exp_f32 v198, v86
v_add_f32 v201, v201, v197
v_cvt_pk_bf16_f32 v138, v196, v197
v_cmp_ge_i32 s[46:47], v233, 19
v_mfma_f32_32x32x16_bf16 a[80:95], a[228:231], v[152:155], a[80:95]
buffer_load_dwordx4 v216, s[60:63], s88 offen lds
v_cndmask_b32 v88, v209, v88, s[40:41]
v_exp_f32 v199, v87
v_add_f32 v201, v201, v198
v_mfma_f32_32x32x16_bf16 a[32:47], a[232:235], v[144:147], a[32:47]
ds_read_b128 a[248:251], v206 offset:6144
v_cmp_ge_i32 s[48:49], v233, 24
v_cndmask_b32 v89, v209, v89, s[42:43]
v_exp_f32 v192, v88
v_add_f32 v201, v201, v199
v_cvt_pk_bf16_f32 v139, v198, v199
v_cmp_ge_i32 s[50:51], v233, 25
v_mfma_f32_32x32x16_bf16 a[96:111], a[232:235], v[152:155], a[96:111]
buffer_load_dwordx4 v217, s[60:63], s88 offen offset:1024 lds
s_add_u32 s88, s88, 16384
v_cndmask_b32 v90, v209, v90, s[44:45]
v_exp_f32 v193, v89
s_waitcnt lgkmcnt(2)
v_mfma_f32_32x32x16_bf16 a[48:63], a[236:239], v[144:147], a[48:63]
ds_read_b128 a[252:255], v206 offset:7168
v_add_f32 v201, v201, v192
v_cmp_ge_i32 s[52:53], v233, 26
v_cndmask_b32 v91, v209, v91, s[46:47]
v_exp_f32 v194, v90
v_add_f32 v201, v201, v193
v_mfma_f32_32x32x16_bf16 a[112:127], a[236:239], v[152:155], a[112:127]
v_cvt_pk_bf16_f32 v140, v192, v193
v_cmp_ge_i32 s[54:55], v233, 27
v_cndmask_b32 v92, v209, v92, s[48:49]
v_exp_f32 v195, v91
v_add_f32 v201, v201, v194
v_cndmask_b32 v93, v209, v93, s[50:51]
v_mfma_f32_32x32x16_bf16 a[0:15], a[240:243], v[148:151], a[0:15]
s_waitcnt vmcnt(24)
s_barrier
v_add_u32 v205, 16384, v205
v_and_b32 v205, 0xffff, v205
v_add_u32 v206, 8192, v206
v_and_or_b32 v206, v206, v230, v231
ds_read_b128 a[192:195], v205 offset:0
s_and_b32 m0, s25, 0xffff
v_mfma_f32_32x32x16_bf16 a[64:79], a[240:243], v[156:159], a[64:79]
buffer_load_dwordx4 v204, s[4:7], s25 offen lds
ds_read_b128 a[196:199], v205 offset:1024
v_exp_f32 v196, v92
v_add_f32 v201, v201, v195
v_cvt_pk_bf16_f32 v141, v194, v195
s_waitcnt lgkmcnt(3)
v_mfma_f32_32x32x16_bf16 a[16:31], a[244:247], v[148:151], a[16:31]
ds_read_b128 a[200:203], v205 offset:2048
v_cndmask_b32 v94, v209, v94, s[52:53]
v_exp_f32 v197, v93
v_add_f32 v201, v201, v196
v_cndmask_b32 v95, v209, v95, s[54:55]
v_mfma_f32_32x32x16_bf16 a[80:95], a[244:247], v[156:159], a[80:95]
buffer_load_dwordx4 v204, s[4:7], s25 offen offset:1024 lds
ds_read_b128 a[204:207], v205 offset:3072
v_exp_f32 v198, v94
v_add_f32 v201, v201, v197
v_cvt_pk_bf16_f32 v142, v196, v197
v_mfma_f32_32x32x16_bf16 a[32:47], a[248:251], v[148:151], a[32:47]
ds_read_b128 a[208:211], v205 offset:4096
v_exp_f32 v199, v95
v_add_f32 v201, v201, v198
v_add_f32 v201, v201, v199
v_cvt_pk_bf16_f32 v143, v198, v199
v_max_f32 v210, v200, v201
v_cmp_lt_f32 vcc, s28, v210
v_mfma_f32_32x32x16_bf16 a[96:111], a[248:251], v[156:159], a[96:111]
buffer_load_dwordx4 v204, s[4:7], s25 offen offset:2048 lds
ds_read_b128 a[212:215], v205 offset:5120
s_waitcnt lgkmcnt(5)
v_mfma_f32_32x32x16_bf16 a[48:63], a[252:255], v[148:151], a[48:63]
ds_read_b128 a[216:219], v205 offset:6144
v_mfma_f32_32x32x16_bf16 a[112:127], a[252:255], v[156:159], a[112:127]
buffer_load_dwordx4 v204, s[4:7], s25 offen offset:3072 lds
s_add_u32 s25, s25, 16384
ds_read_b128 a[220:223], v205 offset:7168
s_cbranch_vccnz attn_slow8
attn_join8:
v_add_f32 v203, v203, v200
v_add_f32 v203, v203, v201
s_nop 12
v_mov_b32 v211, v202
s_nop 1
v_permlane32_swap_b32 v211, v202
s_nop 1
v_add_f32 v202, v202, v211
v_rcp_f32 v212, v202
s_nop 0
v_mov_b32 v213, v212
v_accvgpr_read_b32 v236, a0
v_accvgpr_read_b32 v237, a1
v_accvgpr_read_b32 v238, a2
v_accvgpr_read_b32 v239, a3
v_accvgpr_read_b32 v240, a4
v_accvgpr_read_b32 v241, a5
v_accvgpr_read_b32 v242, a6
v_accvgpr_read_b32 v243, a7
v_pk_mul_f32 v[236:237], v[236:237], v[212:213]
v_pk_mul_f32 v[238:239], v[238:239], v[212:213]
v_pk_mul_f32 v[240:241], v[240:241], v[212:213]
v_pk_mul_f32 v[242:243], v[242:243], v[212:213]
v_cvt_pk_bf16_f32 v236, v236, v237
v_cvt_pk_bf16_f32 v237, v238, v239
v_cvt_pk_bf16_f32 v238, v240, v241
v_cvt_pk_bf16_f32 v239, v242, v243
buffer_store_dwordx4 v[236:239], v204, s[16:19], s56 offen offset:0 sc1
v_accvgpr_read_b32 v244, a8
v_accvgpr_read_b32 v245, a9
v_accvgpr_read_b32 v246, a10
v_accvgpr_read_b32 v247, a11
v_accvgpr_read_b32 v248, a12
v_accvgpr_read_b32 v249, a13
v_accvgpr_read_b32 v250, a14
v_accvgpr_read_b32 v251, a15
v_pk_mul_f32 v[244:245], v[244:245], v[212:213]
v_pk_mul_f32 v[246:247], v[246:247], v[212:213]
v_pk_mul_f32 v[248:249], v[248:249], v[212:213]
v_pk_mul_f32 v[250:251], v[250:251], v[212:213]
v_cvt_pk_bf16_f32 v244, v244, v245
v_cvt_pk_bf16_f32 v245, v246, v247
v_cvt_pk_bf16_f32 v246, v248, v249
v_cvt_pk_bf16_f32 v247, v250, v251
buffer_store_dwordx4 v[244:247], v204, s[16:19], s56 offen offset:1024 sc1
v_accvgpr_read_b32 v236, a16
v_accvgpr_read_b32 v237, a17
v_accvgpr_read_b32 v238, a18
v_accvgpr_read_b32 v239, a19
v_accvgpr_read_b32 v240, a20
v_accvgpr_read_b32 v241, a21
v_accvgpr_read_b32 v242, a22
v_accvgpr_read_b32 v243, a23
v_pk_mul_f32 v[236:237], v[236:237], v[212:213]
v_pk_mul_f32 v[238:239], v[238:239], v[212:213]
v_pk_mul_f32 v[240:241], v[240:241], v[212:213]
v_pk_mul_f32 v[242:243], v[242:243], v[212:213]
v_cvt_pk_bf16_f32 v236, v236, v237
v_cvt_pk_bf16_f32 v237, v238, v239
v_cvt_pk_bf16_f32 v238, v240, v241
v_cvt_pk_bf16_f32 v239, v242, v243
buffer_store_dwordx4 v[236:239], v204, s[16:19], s56 offen offset:2048 sc1
v_accvgpr_read_b32 v244, a24
v_accvgpr_read_b32 v245, a25
v_accvgpr_read_b32 v246, a26
v_accvgpr_read_b32 v247, a27
v_accvgpr_read_b32 v248, a28
v_accvgpr_read_b32 v249, a29
v_accvgpr_read_b32 v250, a30
v_accvgpr_read_b32 v251, a31
v_pk_mul_f32 v[244:245], v[244:245], v[212:213]
v_pk_mul_f32 v[246:247], v[246:247], v[212:213]
v_pk_mul_f32 v[248:249], v[248:249], v[212:213]
v_pk_mul_f32 v[250:251], v[250:251], v[212:213]
v_cvt_pk_bf16_f32 v244, v244, v245
v_cvt_pk_bf16_f32 v245, v246, v247
v_cvt_pk_bf16_f32 v246, v248, v249
v_cvt_pk_bf16_f32 v247, v250, v251
buffer_store_dwordx4 v[244:247], v204, s[16:19], s56 offen offset:3072 sc1
v_accvgpr_read_b32 v236, a32
v_accvgpr_read_b32 v237, a33
v_accvgpr_read_b32 v238, a34
v_accvgpr_read_b32 v239, a35
v_accvgpr_read_b32 v240, a36
v_accvgpr_read_b32 v241, a37
v_accvgpr_read_b32 v242, a38
v_accvgpr_read_b32 v243, a39
v_pk_mul_f32 v[236:237], v[236:237], v[212:213]
v_pk_mul_f32 v[238:239], v[238:239], v[212:213]
v_pk_mul_f32 v[240:241], v[240:241], v[212:213]
v_pk_mul_f32 v[242:243], v[242:243], v[212:213]
v_cvt_pk_bf16_f32 v236, v236, v237
v_cvt_pk_bf16_f32 v237, v238, v239
v_cvt_pk_bf16_f32 v238, v240, v241
v_cvt_pk_bf16_f32 v239, v242, v243
buffer_store_dwordx4 v[236:239], v204, s[16:19], s57 offen offset:0 sc1
v_accvgpr_read_b32 v244, a40
v_accvgpr_read_b32 v245, a41
v_accvgpr_read_b32 v246, a42
v_accvgpr_read_b32 v247, a43
v_accvgpr_read_b32 v248, a44
v_accvgpr_read_b32 v249, a45
v_accvgpr_read_b32 v250, a46
v_accvgpr_read_b32 v251, a47
v_pk_mul_f32 v[244:245], v[244:245], v[212:213]
v_pk_mul_f32 v[246:247], v[246:247], v[212:213]
v_pk_mul_f32 v[248:249], v[248:249], v[212:213]
v_pk_mul_f32 v[250:251], v[250:251], v[212:213]
v_cvt_pk_bf16_f32 v244, v244, v245
v_cvt_pk_bf16_f32 v245, v246, v247
v_cvt_pk_bf16_f32 v246, v248, v249
v_cvt_pk_bf16_f32 v247, v250, v251
buffer_store_dwordx4 v[244:247], v204, s[16:19], s57 offen offset:1024 sc1
v_accvgpr_read_b32 v236, a48
v_accvgpr_read_b32 v237, a49
v_accvgpr_read_b32 v238, a50
v_accvgpr_read_b32 v239, a51
v_accvgpr_read_b32 v240, a52
v_accvgpr_read_b32 v241, a53
v_accvgpr_read_b32 v242, a54
v_accvgpr_read_b32 v243, a55
v_pk_mul_f32 v[236:237], v[236:237], v[212:213]
v_pk_mul_f32 v[238:239], v[238:239], v[212:213]
v_pk_mul_f32 v[240:241], v[240:241], v[212:213]
v_pk_mul_f32 v[242:243], v[242:243], v[212:213]
v_cvt_pk_bf16_f32 v236, v236, v237
v_cvt_pk_bf16_f32 v237, v238, v239
v_cvt_pk_bf16_f32 v238, v240, v241
v_cvt_pk_bf16_f32 v239, v242, v243
buffer_store_dwordx4 v[236:239], v204, s[16:19], s57 offen offset:2048 sc1
v_accvgpr_read_b32 v244, a56
v_accvgpr_read_b32 v245, a57
v_accvgpr_read_b32 v246, a58
v_accvgpr_read_b32 v247, a59
v_accvgpr_read_b32 v248, a60
v_accvgpr_read_b32 v249, a61
v_accvgpr_read_b32 v250, a62
v_accvgpr_read_b32 v251, a63
v_pk_mul_f32 v[244:245], v[244:245], v[212:213]
v_pk_mul_f32 v[246:247], v[246:247], v[212:213]
v_pk_mul_f32 v[248:249], v[248:249], v[212:213]
v_pk_mul_f32 v[250:251], v[250:251], v[212:213]
v_cvt_pk_bf16_f32 v244, v244, v245
v_cvt_pk_bf16_f32 v245, v246, v247
v_cvt_pk_bf16_f32 v246, v248, v249
v_cvt_pk_bf16_f32 v247, v250, v251
buffer_store_dwordx4 v[244:247], v204, s[16:19], s57 offen offset:3072 sc1
s_lshl_b32 s27, s20, 11
s_add_u32 s26, s26, s27
s_cmp_eq_u32 s22, 7
s_cbranch_scc1 attn_epi
s_sub_u32 s24, 30, s23
s_lshr_b32 s24, s24, 1
.p2align 6
attn_p2loop:
s_waitcnt lgkmcnt(6)
v_mfma_f32_32x32x16_bf16 v[64:79], a[192:195], v[32:35], v[176:191]
s_and_b32 s27, s26, 0xffff
s_or_b32 m0, s27, 0x10000
ds_read_b128 a[224:227], v205 offset:8192
v_exp_f32 v192, v96
v_mfma_f32_32x32x16_bf16 v[64:79], a[196:199], v[36:39], v[64:79]
buffer_load_dwordx4 v204, s[8:11], s26 offen lds
ds_read_b128 a[228:231], v205 offset:9216
v_exp_f32 v193, v97
s_waitcnt lgkmcnt(6)
v_mfma_f32_32x32x16_bf16 v[64:79], a[200:203], v[40:43], v[64:79]
ds_read_b128 a[232:235], v205 offset:10240
v_exp_f32 v194, v98
v_add_f32 v200, v192, v193
v_cvt_pk_bf16_f32 v144, v192, v193
v_exp_f32 v195, v99
v_mfma_f32_32x32x16_bf16 v[64:79], a[204:207], v[44:47], v[64:79]
buffer_load_dwordx4 v204, s[8:11], s26 offen offset:1024 lds
ds_read_b128 a[236:239], v205 offset:11264
v_add_f32 v200, v200, v194
s_waitcnt lgkmcnt(6)
v_mfma_f32_32x32x16_bf16 v[64:79], a[208:211], v[48:51], v[64:79]
ds_read_b128 a[240:243], v205 offset:12288
v_exp_f32 v196, v100
v_add_f32 v200, v200, v195
v_cvt_pk_bf16_f32 v145, v194, v195
v_exp_f32 v197, v101
v_mfma_f32_32x32x16_bf16 v[64:79], a[212:215], v[52:55], v[64:79]
buffer_load_dwordx4 v204, s[8:11], s26 offen offset:2048 lds
ds_read_b128 a[244:247], v205 offset:13312
v_add_f32 v200, v200, v196
s_waitcnt lgkmcnt(6)
v_mfma_f32_32x32x16_bf16 v[64:79], a[216:219], v[56:59], v[64:79]
ds_read_b128 a[248:251], v205 offset:14336
v_exp_f32 v198, v102
v_add_f32 v200, v200, v197
v_cvt_pk_bf16_f32 v146, v196, v197
v_exp_f32 v199, v103
v_mfma_f32_32x32x16_bf16 v[64:79], a[220:223], v[60:63], v[64:79]
buffer_load_dwordx4 v204, s[8:11], s26 offen offset:3072 lds
s_add_u32 s26, s26, 16384
ds_read_b128 a[252:255], v205 offset:15360
s_waitcnt lgkmcnt(6)
v_mfma_f32_32x32x16_bf16 v[80:95], a[224:227], v[32:35], v[176:191]
s_waitcnt vmcnt(20)
ds_read_b64_tr_b16 v[236:237], v218 offset:0
ds_read_b64_tr_b16 v[238:239], v218 offset:512
v_add_f32 v200, v200, v198
v_exp_f32 v192, v104
v_mfma_f32_32x32x16_bf16 v[80:95], a[228:231], v[36:39], v[80:95]
ds_read_b64_tr_b16 v[240:241], v219 offset:0
ds_read_b64_tr_b16 v[242:243], v219 offset:512
v_add_f32 v200, v200, v199
v_cvt_pk_bf16_f32 v147, v198, v199
v_exp_f32 v193, v105
s_waitcnt lgkmcnt(8)
v_mfma_f32_32x32x16_bf16 v[80:95], a[232:235], v[40:43], v[80:95]
ds_read_b64_tr_b16 v[244:245], v218 offset:2048
ds_read_b64_tr_b16 v[246:247], v218 offset:2560
v_add_f32 v200, v200, v192
v_exp_f32 v194, v106
v_add_f32 v200, v200, v193
v_mfma_f32_32x32x16_bf16 v[80:95], a[236:239], v[44:47], v[80:95]
ds_read_b64_tr_b16 v[248:249], v219 offset:2048
ds_read_b64_tr_b16 v[250:251], v219 offset:2560
v_cvt_pk_bf16_f32 v148, v192, v193
v_exp_f32 v195, v107
v_add_f32 v200, v200, v194
s_waitcnt lgkmcnt(10)
v_mfma_f32_32x32x16_bf16 v[80:95], a[240:243], v[48:51], v[80:95]
ds_read_b128 a[192:195], v206 offset:0
v_exp_f32 v196, v108
v_add_f32 v200, v200, v195
v_cvt_pk_bf16_f32 v149, v194, v195
v_exp_f32 v197, v109
v_mfma_f32_32x32x16_bf16 v[80:95], a[244:247], v[52:55], v[80:95]
ds_read_b128 a[196:199], v206 offset:1024
v_add_f32 v200, v200, v196
v_exp_f32 v198, v110
v_add_f32 v200, v200, v197
s_waitcnt lgkmcnt(10)
v_mfma_f32_32x32x16_bf16 v[80:95], a[248:251], v[56:59], v[80:95]
ds_read_b128 a[200:203], v206 offset:2048
v_cvt_pk_bf16_f32 v150, v196, v197
v_exp_f32 v199, v111
v_add_f32 v200, v200, v198
v_add_f32 v200, v200, v199
v_mfma_f32_32x32x16_bf16 v[80:95], a[252:255], v[60:63], v[80:95]
ds_read_b128 a[204:207], v206 offset:3072
v_cvt_pk_bf16_f32 v151, v198, v199
v_exp_f32 v192, v112
v_exp_f32 v193, v113
s_waitcnt lgkmcnt(3)
v_mfma_f32_32x32x16_bf16 a[128:143], v[236:239], v[244:247], a[128:143]
ds_read_b128 a[208:211], v206 offset:4096
v_exp_f32 v194, v114
v_add_f32 v201, v192, v193
v_cvt_pk_bf16_f32 v152, v192, v193
v_mfma_f32_32x32x16_bf16 a[144:159], v[236:239], v[248:251], a[144:159]
s_add_u32 m0, s89, 0
ds_read_b128 a[212:215], v206 offset:5120
v_exp_f32 v195, v115
v_add_f32 v201, v201, v194
v_exp_f32 v196, v116
v_mfma_f32_32x32x16_bf16 a[160:175], v[240:243], v[244:247], a[160:175]
buffer_load_dwordx4 v214, s[12:15], s85 offen lds
ds_read_b128 a[216:219], v206 offset:6144
v_add_f32 v201, v201, v195
v_cvt_pk_bf16_f32 v153, v194, v195
v_mfma_f32_32x32x16_bf16 a[176:191], v[240:243], v[248:251], a[176:191]
ds_read_b128 a[220:223], v206 offset:7168
v_exp_f32 v197, v117
v_add_f32 v201, v201, v196
v_exp_f32 v198, v118
v_mfma_f32_32x32x16_bf16 a[64:79], a[192:195], v[128:131], a[64:79]
buffer_load_dwordx4 v215, s[12:15], s85 offen offset:1024 lds
s_add_u32 s85, s85, 57344
ds_read_b128 a[224:227], v206 offset:8192
v_add_f32 v201, v201, v197
s_waitcnt lgkmcnt(7)
v_mfma_f32_32x32x16_bf16 a[80:95], a[196:199], v[128:131], a[80:95]
ds_read_b128 a[228:231], v206 offset:9216
v_cvt_pk_bf16_f32 v154, v196, v197
v_exp_f32 v199, v119
v_add_f32 v201, v201, v198
s_waitcnt lgkmcnt(6)
v_mfma_f32_32x32x16_bf16 a[96:111], a[200:203], v[128:131], a[96:111]
s_add_u32 m0, s89, 2048
ds_read_b128 a[232:235], v206 offset:10240
v_exp_f32 v192, v120
v_add_f32 v201, v201, v199
v_cvt_pk_bf16_f32 v155, v198, v199
v_mfma_f32_32x32x16_bf16 a[112:127], a[204:207], v[128:131], a[112:127]
buffer_load_dwordx4 v216, s[60:63], s88 offen lds
ds_read_b128 a[236:239], v206 offset:11264
v_exp_f32 v193, v121
s_waitcnt lgkmcnt(6)
v_mfma_f32_32x32x16_bf16 a[64:79], a[208:211], v[132:135], a[64:79]
ds_read_b128 a[240:243], v206 offset:12288
v_add_f32 v201, v201, v192
v_exp_f32 v194, v122
v_add_f32 v201, v201, v193
v_cvt_pk_bf16_f32 v156, v192, v193
v_mfma_f32_32x32x16_bf16 a[80:95], a[212:215], v[132:135], a[80:95]
buffer_load_dwordx4 v217, s[60:63], s88 offen offset:1024 lds
s_add_u32 s88, s88, 16384
ds_read_b128 a[244:247], v206 offset:13312
v_exp_f32 v195, v123
s_waitcnt lgkmcnt(6)
v_mfma_f32_32x32x16_bf16 a[96:111], a[216:219], v[132:135], a[96:111]
ds_read_b128 a[248:251], v206 offset:14336
v_add_f32 v201, v201, v194
v_exp_f32 v196, v124
v_add_f32 v201, v201, v195
v_mfma_f32_32x32x16_bf16 a[112:127], a[220:223], v[132:135], a[112:127]
ds_read_b128 a[252:255], v206 offset:15360
v_cvt_pk_bf16_f32 v157, v194, v195
v_exp_f32 v197, v125
v_add_f32 v201, v201, v196
v_exp_f32 v198, v126
s_waitcnt lgkmcnt(6)
v_mfma_f32_32x32x16_bf16 a[64:79], a[224:227], v[136:139], a[64:79]
s_waitcnt vmcnt(16)
s_barrier
v_add_u32 v205, 16384, v205
v_and_b32 v205, 0xffff, v205
v_add_u32 v206, 16384, v206
v_and_or_b32 v206, v206, v230, v231
ds_read_b128 a[192:195], v205 offset:0
s_and_b32 m0, s25, 0xffff
v_mfma_f32_32x32x16_bf16 a[80:95], a[228:231], v[136:139], a[80:95]
buffer_load_dwordx4 v204, s[4:7], s25 offen lds
ds_read_b128 a[196:199], v205 offset:1024
s_waitcnt lgkmcnt(6)
v_mfma_f32_32x32x16_bf16 a[96:111], a[232:235], v[136:139], a[96:111]
ds_read_b128 a[200:203], v205 offset:2048
v_add_f32 v201, v201, v197
v_cvt_pk_bf16_f32 v158, v196, v197
v_exp_f32 v199, v127
v_mfma_f32_32x32x16_bf16 a[112:127], a[236:239], v[136:139], a[112:127]
buffer_load_dwordx4 v204, s[4:7], s25 offen offset:1024 lds
ds_read_b128 a[204:207], v205 offset:3072
v_add_f32 v201, v201, v198
v_add_f32 v201, v201, v199
s_waitcnt lgkmcnt(6)
v_mfma_f32_32x32x16_bf16 a[64:79], a[240:243], v[140:143], a[64:79]
ds_read_b128 a[208:211], v205 offset:4096
v_cvt_pk_bf16_f32 v159, v198, v199
v_max_f32 v210, v200, v201
v_cmp_lt_f32 vcc, s28, v210
v_mfma_f32_32x32x16_bf16 a[80:95], a[244:247], v[140:143], a[80:95]
buffer_load_dwordx4 v204, s[4:7], s25 offen offset:2048 lds
ds_read_b128 a[212:215], v205 offset:5120
s_waitcnt lgkmcnt(6)
v_mfma_f32_32x32x16_bf16 a[96:111], a[248:251], v[140:143], a[96:111]
ds_read_b128 a[216:219], v205 offset:6144
v_mfma_f32_32x32x16_bf16 a[112:127], a[252:255], v[140:143], a[112:127]
buffer_load_dwordx4 v204, s[4:7], s25 offen offset:3072 lds
s_add_u32 s25, s25, 16384
ds_read_b128 a[220:223], v205 offset:7168
s_cbranch_vccnz attn_slow9
attn_join9:
v_add_f32 v203, v203, v200
v_add_f32 v203, v203, v201
s_waitcnt lgkmcnt(6)
v_mfma_f32_32x32x16_bf16 v[96:111], a[192:195], v[32:35], v[176:191]
s_and_b32 s27, s26, 0xffff
s_or_b32 m0, s27, 0x10000
ds_read_b128 a[224:227], v205 offset:8192
v_exp_f32 v192, v64
v_mfma_f32_32x32x16_bf16 v[96:111], a[196:199], v[36:39], v[96:111]
buffer_load_dwordx4 v204, s[8:11], s26 offen lds
ds_read_b128 a[228:231], v205 offset:9216
v_exp_f32 v193, v65
s_waitcnt lgkmcnt(6)
v_mfma_f32_32x32x16_bf16 v[96:111], a[200:203], v[40:43], v[96:111]
ds_read_b128 a[232:235], v205 offset:10240
v_exp_f32 v194, v66
v_add_f32 v200, v192, v193
v_cvt_pk_bf16_f32 v128, v192, v193
v_exp_f32 v195, v67
v_mfma_f32_32x32x16_bf16 v[96:111], a[204:207], v[44:47], v[96:111]
buffer_load_dwordx4 v204, s[8:11], s26 offen offset:1024 lds
ds_read_b128 a[236:239], v205 offset:11264
v_add_f32 v200, v200, v194
s_waitcnt lgkmcnt(6)
v_mfma_f32_32x32x16_bf16 v[96:111], a[208:211], v[48:51], v[96:111]
ds_read_b128 a[240:243], v205 offset:12288
v_exp_f32 v196, v68
v_add_f32 v200, v200, v195
v_cvt_pk_bf16_f32 v129, v194, v195
v_exp_f32 v197, v69
v_mfma_f32_32x32x16_bf16 v[96:111], a[212:215], v[52:55], v[96:111]
buffer_load_dwordx4 v204, s[8:11], s26 offen offset:2048 lds
ds_read_b128 a[244:247], v205 offset:13312
v_add_f32 v200, v200, v196
s_waitcnt lgkmcnt(6)
v_mfma_f32_32x32x16_bf16 v[96:111], a[216:219], v[56:59], v[96:111]
ds_read_b128 a[248:251], v205 offset:14336
v_exp_f32 v198, v70
v_add_f32 v200, v200, v197
v_cvt_pk_bf16_f32 v130, v196, v197
v_exp_f32 v199, v71
v_mfma_f32_32x32x16_bf16 v[96:111], a[220:223], v[60:63], v[96:111]
buffer_load_dwordx4 v204, s[8:11], s26 offen offset:3072 lds
s_add_u32 s26, s26, 16384
ds_read_b128 a[252:255], v205 offset:15360
s_waitcnt lgkmcnt(6)
v_mfma_f32_32x32x16_bf16 v[112:127], a[224:227], v[32:35], v[176:191]
s_waitcnt vmcnt(20)
ds_read_b64_tr_b16 v[236:237], v218 offset:4096
ds_read_b64_tr_b16 v[238:239], v218 offset:4608
v_add_f32 v200, v200, v198
v_exp_f32 v192, v72
v_mfma_f32_32x32x16_bf16 v[112:127], a[228:231], v[36:39], v[112:127]
ds_read_b64_tr_b16 v[240:241], v219 offset:4096
ds_read_b64_tr_b16 v[242:243], v219 offset:4608
v_add_f32 v200, v200, v199
v_cvt_pk_bf16_f32 v131, v198, v199
v_exp_f32 v193, v73
s_waitcnt lgkmcnt(8)
v_mfma_f32_32x32x16_bf16 v[112:127], a[232:235], v[40:43], v[112:127]
ds_read_b64_tr_b16 v[244:245], v218 offset:6144
ds_read_b64_tr_b16 v[246:247], v218 offset:6656
v_add_f32 v200, v200, v192
v_exp_f32 v194, v74
v_add_f32 v200, v200, v193
v_mfma_f32_32x32x16_bf16 v[112:127], a[236:239], v[44:47], v[112:127]
ds_read_b64_tr_b16 v[248:249], v219 offset:6144
ds_read_b64_tr_b16 v[250:251], v219 offset:6656
v_cvt_pk_bf16_f32 v132, v192, v193
v_exp_f32 v195, v75
v_add_f32 v200, v200, v194
s_waitcnt lgkmcnt(10)
v_mfma_f32_32x32x16_bf16 v[112:127], a[240:243], v[48:51], v[112:127]
ds_read_b128 a[192:195], v206 offset:0
v_exp_f32 v196, v76
v_add_f32 v200, v200, v195
v_cvt_pk_bf16_f32 v133, v194, v195
v_exp_f32 v197, v77
v_mfma_f32_32x32x16_bf16 v[112:127], a[244:247], v[52:55], v[112:127]
ds_read_b128 a[196:199], v206 offset:1024
v_add_f32 v200, v200, v196
v_exp_f32 v198, v78
v_add_f32 v200, v200, v197
s_waitcnt lgkmcnt(10)
v_mfma_f32_32x32x16_bf16 v[112:127], a[248:251], v[56:59], v[112:127]
ds_read_b128 a[200:203], v206 offset:2048
v_cvt_pk_bf16_f32 v134, v196, v197
v_exp_f32 v199, v79
v_add_f32 v200, v200, v198
v_add_f32 v200, v200, v199
v_mfma_f32_32x32x16_bf16 v[112:127], a[252:255], v[60:63], v[112:127]
ds_read_b128 a[204:207], v206 offset:3072
v_cvt_pk_bf16_f32 v135, v198, v199
v_exp_f32 v192, v80
v_exp_f32 v193, v81
s_waitcnt lgkmcnt(3)
v_mfma_f32_32x32x16_bf16 a[128:143], v[236:239], v[244:247], a[128:143]
ds_read_b128 a[208:211], v206 offset:4096
v_exp_f32 v194, v82
v_add_f32 v201, v192, v193
v_cvt_pk_bf16_f32 v136, v192, v193
v_mfma_f32_32x32x16_bf16 a[144:159], v[236:239], v[248:251], a[144:159]
s_add_u32 m0, s89, 4096
ds_read_b128 a[212:215], v206 offset:5120
v_exp_f32 v195, v83
v_add_f32 v201, v201, v194
v_exp_f32 v196, v84
v_mfma_f32_32x32x16_bf16 a[160:175], v[240:243], v[244:247], a[160:175]
buffer_load_dwordx4 v214, s[12:15], s85 offen lds
ds_read_b128 a[216:219], v206 offset:6144
v_add_f32 v201, v201, v195
v_cvt_pk_bf16_f32 v137, v194, v195
v_mfma_f32_32x32x16_bf16 a[176:191], v[240:243], v[248:251], a[176:191]
ds_read_b128 a[220:223], v206 offset:7168
v_exp_f32 v197, v85
v_add_f32 v201, v201, v196
v_exp_f32 v198, v86
v_mfma_f32_32x32x16_bf16 a[64:79], a[192:195], v[144:147], a[64:79]
buffer_load_dwordx4 v215, s[12:15], s85 offen offset:1024 lds
s_add_u32 s85, s85, 57344
ds_read_b128 a[224:227], v206 offset:8192
v_add_f32 v201, v201, v197
s_waitcnt lgkmcnt(7)
v_mfma_f32_32x32x16_bf16 a[80:95], a[196:199], v[144:147], a[80:95]
ds_read_b128 a[228:231], v206 offset:9216
v_cvt_pk_bf16_f32 v138, v196, v197
v_exp_f32 v199, v87
v_add_f32 v201, v201, v198
s_waitcnt lgkmcnt(6)
v_mfma_f32_32x32x16_bf16 a[96:111], a[200:203], v[144:147], a[96:111]
s_add_u32 m0, s89, 6144
ds_read_b128 a[232:235], v206 offset:10240
v_exp_f32 v192, v88
v_add_f32 v201, v201, v199
v_cvt_pk_bf16_f32 v139, v198, v199
v_mfma_f32_32x32x16_bf16 a[112:127], a[204:207], v[144:147], a[112:127]
buffer_load_dwordx4 v216, s[60:63], s88 offen lds
ds_read_b128 a[236:239], v206 offset:11264
v_exp_f32 v193, v89
s_waitcnt lgkmcnt(6)
v_mfma_f32_32x32x16_bf16 a[64:79], a[208:211], v[148:151], a[64:79]
ds_read_b128 a[240:243], v206 offset:12288
v_add_f32 v201, v201, v192
v_exp_f32 v194, v90
v_add_f32 v201, v201, v193
v_cvt_pk_bf16_f32 v140, v192, v193
v_mfma_f32_32x32x16_bf16 a[80:95], a[212:215], v[148:151], a[80:95]
buffer_load_dwordx4 v217, s[60:63], s88 offen offset:1024 lds
s_add_u32 s88, s88, 16384
ds_read_b128 a[244:247], v206 offset:13312
v_exp_f32 v195, v91
s_waitcnt lgkmcnt(6)
v_mfma_f32_32x32x16_bf16 a[96:111], a[216:219], v[148:151], a[96:111]
ds_read_b128 a[248:251], v206 offset:14336
v_add_f32 v201, v201, v194
v_exp_f32 v196, v92
v_add_f32 v201, v201, v195
v_mfma_f32_32x32x16_bf16 a[112:127], a[220:223], v[148:151], a[112:127]
ds_read_b128 a[252:255], v206 offset:15360
v_cvt_pk_bf16_f32 v141, v194, v195
v_exp_f32 v197, v93
v_add_f32 v201, v201, v196
v_exp_f32 v198, v94
s_waitcnt lgkmcnt(6)
v_mfma_f32_32x32x16_bf16 a[64:79], a[224:227], v[152:155], a[64:79]
s_waitcnt vmcnt(16)
s_barrier
v_add_u32 v205, 16384, v205
v_and_b32 v205, 0xffff, v205
v_add_u32 v206, 16384, v206
v_and_or_b32 v206, v206, v230, v231
ds_read_b128 a[192:195], v205 offset:0
s_and_b32 m0, s25, 0xffff
v_mfma_f32_32x32x16_bf16 a[80:95], a[228:231], v[152:155], a[80:95]
buffer_load_dwordx4 v204, s[4:7], s25 offen lds
ds_read_b128 a[196:199], v205 offset:1024
s_waitcnt lgkmcnt(6)
v_mfma_f32_32x32x16_bf16 a[96:111], a[232:235], v[152:155], a[96:111]
ds_read_b128 a[200:203], v205 offset:2048
v_add_f32 v201, v201, v197
v_cvt_pk_bf16_f32 v142, v196, v197
v_exp_f32 v199, v95
v_mfma_f32_32x32x16_bf16 a[112:127], a[236:239], v[152:155], a[112:127]
buffer_load_dwordx4 v204, s[4:7], s25 offen offset:1024 lds
ds_read_b128 a[204:207], v205 offset:3072
v_add_f32 v201, v201, v198
v_add_f32 v201, v201, v199
s_waitcnt lgkmcnt(6)
v_mfma_f32_32x32x16_bf16 a[64:79], a[240:243], v[156:159], a[64:79]
ds_read_b128 a[208:211], v205 offset:4096
v_cvt_pk_bf16_f32 v143, v198, v199
v_max_f32 v210, v200, v201
v_cmp_lt_f32 vcc, s28, v210
v_mfma_f32_32x32x16_bf16 a[80:95], a[244:247], v[156:159], a[80:95]
buffer_load_dwordx4 v204, s[4:7], s25 offen offset:2048 lds
ds_read_b128 a[212:215], v205 offset:5120
s_waitcnt lgkmcnt(6)
v_mfma_f32_32x32x16_bf16 a[96:111], a[248:251], v[156:159], a[96:111]
ds_read_b128 a[216:219], v205 offset:6144
v_mfma_f32_32x32x16_bf16 a[112:127], a[252:255], v[156:159], a[112:127]
buffer_load_dwordx4 v204, s[4:7], s25 offen offset:3072 lds
s_add_u32 s25, s25, 16384
ds_read_b128 a[220:223], v205 offset:7168
s_cbranch_vccnz attn_slow10
attn_join10:
v_add_f32 v203, v203, v200
v_add_f32 v203, v203, v201
s_sub_u32 s24, s24, 1
s_cmp_lg_u32 s24, 0
s_cbranch_scc1 attn_p2loop
attn_p2peel:
s_waitcnt lgkmcnt(6)
v_mfma_f32_32x32x16_bf16 v[64:79], a[192:195], v[32:35], v[176:191]
s_and_b32 s27, s26, 0xffff
s_or_b32 m0, s27, 0x10000
ds_read_b128 a[224:227], v205 offset:8192
v_exp_f32 v192, v96
v_mfma_f32_32x32x16_bf16 v[64:79], a[196:199], v[36:39], v[64:79]
buffer_load_dwordx4 v204, s[8:11], s26 offen lds
ds_read_b128 a[228:231], v205 offset:9216
v_exp_f32 v193, v97
s_waitcnt lgkmcnt(6)
v_mfma_f32_32x32x16_bf16 v[64:79], a[200:203], v[40:43], v[64:79]
ds_read_b128 a[232:235], v205 offset:10240
v_exp_f32 v194, v98
v_add_f32 v200, v192, v193
v_cvt_pk_bf16_f32 v144, v192, v193
v_mfma_f32_32x32x16_bf16 v[64:79], a[204:207], v[44:47], v[64:79]
buffer_load_dwordx4 v204, s[8:11], s26 offen offset:1024 lds
ds_read_b128 a[236:239], v205 offset:11264
v_exp_f32 v195, v99
s_waitcnt lgkmcnt(6)
v_mfma_f32_32x32x16_bf16 v[64:79], a[208:211], v[48:51], v[64:79]
ds_read_b128 a[240:243], v205 offset:12288
v_add_f32 v200, v200, v194
v_exp_f32 v196, v100
v_add_f32 v200, v200, v195
v_mfma_f32_32x32x16_bf16 v[64:79], a[212:215], v[52:55], v[64:79]
buffer_load_dwordx4 v204, s[8:11], s26 offen offset:2048 lds
ds_read_b128 a[244:247], v205 offset:13312
v_cvt_pk_bf16_f32 v145, v194, v195
s_waitcnt lgkmcnt(6)
v_mfma_f32_32x32x16_bf16 v[64:79], a[216:219], v[56:59], v[64:79]
ds_read_b128 a[248:251], v205 offset:14336
v_exp_f32 v197, v101
v_add_f32 v200, v200, v196
v_exp_f32 v198, v102
v_mfma_f32_32x32x16_bf16 v[64:79], a[220:223], v[60:63], v[64:79]
buffer_load_dwordx4 v204, s[8:11], s26 offen offset:3072 lds
s_add_u32 s26, s26, 16384
ds_read_b128 a[252:255], v205 offset:15360
v_add_f32 v200, v200, v197
s_waitcnt lgkmcnt(6)
v_mfma_f32_32x32x16_bf16 v[80:95], a[224:227], v[32:35], v[176:191]
s_waitcnt vmcnt(20)
ds_read_b64_tr_b16 v[236:237], v218 offset:0
ds_read_b64_tr_b16 v[238:239], v218 offset:512
v_cvt_pk_bf16_f32 v146, v196, v197
v_exp_f32 v199, v103
v_mfma_f32_32x32x16_bf16 v[80:95], a[228:231], v[36:39], v[80:95]
ds_read_b64_tr_b16 v[240:241], v219 offset:0
ds_read_b64_tr_b16 v[242:243], v219 offset:512
v_add_f32 v200, v200, v198
v_exp_f32 v192, v104
s_waitcnt lgkmcnt(8)
v_mfma_f32_32x32x16_bf16 v[80:95], a[232:235], v[40:43], v[80:95]
ds_read_b64_tr_b16 v[244:245], v218 offset:2048
ds_read_b64_tr_b16 v[246:247], v218 offset:2560
v_add_f32 v200, v200, v199
v_cvt_pk_bf16_f32 v147, v198, v199
v_exp_f32 v193, v105
v_mfma_f32_32x32x16_bf16 v[80:95], a[236:239], v[44:47], v[80:95]
ds_read_b64_tr_b16 v[248:249], v219 offset:2048
ds_read_b64_tr_b16 v[250:251], v219 offset:2560
v_add_f32 v200, v200, v192
v_exp_f32 v194, v106
s_waitcnt lgkmcnt(10)
v_mfma_f32_32x32x16_bf16 v[80:95], a[240:243], v[48:51], v[80:95]
ds_read_b128 a[192:195], v206 offset:0
v_add_f32 v200, v200, v193
v_cvt_pk_bf16_f32 v148, v192, v193
v_exp_f32 v195, v107
v_mfma_f32_32x32x16_bf16 v[80:95], a[244:247], v[52:55], v[80:95]
ds_read_b128 a[196:199], v206 offset:1024
v_add_f32 v200, v200, v194
v_exp_f32 v196, v108
v_add_f32 v200, v200, v195
v_cvt_pk_bf16_f32 v149, v194, v195
s_waitcnt lgkmcnt(10)
v_mfma_f32_32x32x16_bf16 v[80:95], a[248:251], v[56:59], v[80:95]
ds_read_b128 a[200:203], v206 offset:2048
v_exp_f32 v197, v109
v_add_f32 v200, v200, v196
v_mfma_f32_32x32x16_bf16 v[80:95], a[252:255], v[60:63], v[80:95]
ds_read_b128 a[204:207], v206 offset:3072
v_exp_f32 v198, v110
v_add_f32 v200, v200, v197
v_cvt_pk_bf16_f32 v150, v196, v197
v_exp_f32 v199, v111
s_waitcnt lgkmcnt(3)
v_mfma_f32_32x32x16_bf16 a[128:143], v[236:239], v[244:247], a[128:143]
ds_read_b128 a[208:211], v206 offset:4096
v_add_f32 v200, v200, v198
v_add_f32 v200, v200, v199
v_cvt_pk_bf16_f32 v151, v198, v199
v_mfma_f32_32x32x16_bf16 a[144:159], v[236:239], v[248:251], a[144:159]
ds_read_b128 a[212:215], v206 offset:5120
v_exp_f32 v192, v112
v_exp_f32 v193, v113
v_exp_f32 v194, v114
v_mfma_f32_32x32x16_bf16 a[160:175], v[240:243], v[244:247], a[160:175]
ds_read_b128 a[216:219], v206 offset:6144
v_add_f32 v201, v192, v193
v_cvt_pk_bf16_f32 v152, v192, v193
v_exp_f32 v195, v115
v_mfma_f32_32x32x16_bf16 a[176:191], v[240:243], v[248:251], a[176:191]
ds_read_b128 a[220:223], v206 offset:7168
v_add_f32 v201, v201, v194
v_exp_f32 v196, v116
v_add_f32 v201, v201, v195
v_mfma_f32_32x32x16_bf16 a[64:79], a[192:195], v[128:131], a[64:79]
ds_read_b128 a[224:227], v206 offset:8192
v_cvt_pk_bf16_f32 v153, v194, v195
v_exp_f32 v197, v117
v_add_f32 v201, v201, v196
s_waitcnt lgkmcnt(7)
v_mfma_f32_32x32x16_bf16 a[80:95], a[196:199], v[128:131], a[80:95]
ds_read_b128 a[228:231], v206 offset:9216
v_exp_f32 v198, v118
v_add_f32 v201, v201, v197
v_cvt_pk_bf16_f32 v154, v196, v197
v_exp_f32 v199, v119
s_waitcnt lgkmcnt(6)
v_mfma_f32_32x32x16_bf16 a[96:111], a[200:203], v[128:131], a[96:111]
ds_read_b128 a[232:235], v206 offset:10240
v_add_f32 v201, v201, v198
v_exp_f32 v192, v120
v_add_f32 v201, v201, v199
v_mfma_f32_32x32x16_bf16 a[112:127], a[204:207], v[128:131], a[112:127]
ds_read_b128 a[236:239], v206 offset:11264
v_cvt_pk_bf16_f32 v155, v198, v199
v_exp_f32 v193, v121
v_add_f32 v201, v201, v192
s_waitcnt lgkmcnt(6)
v_mfma_f32_32x32x16_bf16 a[64:79], a[208:211], v[132:135], a[64:79]
ds_read_b128 a[240:243], v206 offset:12288
v_exp_f32 v194, v122
v_add_f32 v201, v201, v193
v_cvt_pk_bf16_f32 v156, v192, v193
v_mfma_f32_32x32x16_bf16 a[80:95], a[212:215], v[132:135], a[80:95]
ds_read_b128 a[244:247], v206 offset:13312
v_exp_f32 v195, v123
v_add_f32 v201, v201, v194
v_exp_f32 v196, v124
s_waitcnt lgkmcnt(6)
v_mfma_f32_32x32x16_bf16 a[96:111], a[216:219], v[132:135], a[96:111]
ds_read_b128 a[248:251], v206 offset:14336
v_add_f32 v201, v201, v195
v_cvt_pk_bf16_f32 v157, v194, v195
v_exp_f32 v197, v125
v_add_f32 v201, v201, v196
v_mfma_f32_32x32x16_bf16 a[112:127], a[220:223], v[132:135], a[112:127]
ds_read_b128 a[252:255], v206 offset:15360
v_exp_f32 v198, v126
v_add_f32 v201, v201, v197
v_cvt_pk_bf16_f32 v158, v196, v197
s_waitcnt lgkmcnt(6)
v_mfma_f32_32x32x16_bf16 a[64:79], a[224:227], v[136:139], a[64:79]
s_waitcnt vmcnt(12)
s_barrier
v_add_u32 v205, 16384, v205
v_and_b32 v205, 0xffff, v205
v_add_u32 v206, 16384, v206
v_and_or_b32 v206, v206, v230, v231
ds_read_b128 a[192:195], v205 offset:0
s_and_b32 m0, s25, 0xffff
v_mfma_f32_32x32x16_bf16 a[80:95], a[228:231], v[136:139], a[80:95]
buffer_load_dwordx4 v204, s[4:7], s25 offen lds
ds_read_b128 a[196:199], v205 offset:1024
s_waitcnt lgkmcnt(6)
v_mfma_f32_32x32x16_bf16 a[96:111], a[232:235], v[136:139], a[96:111]
ds_read_b128 a[200:203], v205 offset:2048
v_exp_f32 v199, v127
v_add_f32 v201, v201, v198
v_mfma_f32_32x32x16_bf16 a[112:127], a[236:239], v[136:139], a[112:127]
buffer_load_dwordx4 v204, s[4:7], s25 offen offset:1024 lds
ds_read_b128 a[204:207], v205 offset:3072
v_add_f32 v201, v201, v199
v_cvt_pk_bf16_f32 v159, v198, v199
s_waitcnt lgkmcnt(6)
v_mfma_f32_32x32x16_bf16 a[64:79], a[240:243], v[140:143], a[64:79]
ds_read_b128 a[208:211], v205 offset:4096
v_max_f32 v210, v200, v201
v_cmp_lt_f32 vcc, s28, v210
v_mfma_f32_32x32x16_bf16 a[80:95], a[244:247], v[140:143], a[80:95]
buffer_load_dwordx4 v204, s[4:7], s25 offen offset:2048 lds
ds_read_b128 a[212:215], v205 offset:5120
s_waitcnt lgkmcnt(6)
v_mfma_f32_32x32x16_bf16 a[96:111], a[248:251], v[140:143], a[96:111]
ds_read_b128 a[216:219], v205 offset:6144
v_mfma_f32_32x32x16_bf16 a[112:127], a[252:255], v[140:143], a[112:127]
buffer_load_dwordx4 v204, s[4:7], s25 offen offset:3072 lds
s_add_u32 s25, s25, 16384
ds_read_b128 a[220:223], v205 offset:7168
s_cbranch_vccnz attn_slow11
attn_join11:
v_add_f32 v203, v203, v200
v_add_f32 v203, v203, v201
s_sub_u32 s29, 64, s23
s_lshl_b32 s29, s29, 5
v_subrev_u32 v232, s29, v208
v_subrev_u32 v233, 32, v232
s_waitcnt lgkmcnt(6)
v_mfma_f32_32x32x16_bf16 v[96:111], a[192:195], v[32:35], v[176:191]
s_and_b32 s27, s26, 0xffff
s_or_b32 m0, s27, 0x10000
ds_read_b128 a[224:227], v205 offset:8192
v_cmp_ge_i32 s[40:41], v232, 0
v_cmp_ge_i32 s[42:43], v232, 1
v_cmp_ge_i32 s[44:45], v232, 2
v_cmp_ge_i32 s[46:47], v232, 3
v_mfma_f32_32x32x16_bf16 v[96:111], a[196:199], v[36:39], v[96:111]
buffer_load_dwordx4 v204, s[8:11], s26 offen lds
ds_read_b128 a[228:231], v205 offset:9216
v_cndmask_b32 v64, v209, v64, s[40:41]
v_cmp_ge_i32 s[48:49], v232, 8
v_cndmask_b32 v65, v209, v65, s[42:43]
s_waitcnt lgkmcnt(6)
v_mfma_f32_32x32x16_bf16 v[96:111], a[200:203], v[40:43], v[96:111]
ds_read_b128 a[232:235], v205 offset:10240
v_exp_f32 v192, v64
v_cmp_ge_i32 s[50:51], v232, 9
v_cndmask_b32 v66, v209, v66, s[44:45]
v_exp_f32 v193, v65
v_cmp_ge_i32 s[52:53], v232, 10
v_mfma_f32_32x32x16_bf16 v[96:111], a[204:207], v[44:47], v[96:111]
buffer_load_dwordx4 v204, s[8:11], s26 offen offset:1024 lds
ds_read_b128 a[236:239], v205 offset:11264
v_cndmask_b32 v67, v209, v67, s[46:47]
v_exp_f32 v194, v66
s_waitcnt lgkmcnt(6)
v_mfma_f32_32x32x16_bf16 v[96:111], a[208:211], v[48:51], v[96:111]
ds_read_b128 a[240:243], v205 offset:12288
v_add_f32 v200, v192, v193
v_cvt_pk_bf16_f32 v128, v192, v193
v_cmp_ge_i32 s[54:55], v232, 11
v_cndmask_b32 v68, v209, v68, s[48:49]
v_exp_f32 v195, v67
v_add_f32 v200, v200, v194
v_mfma_f32_32x32x16_bf16 v[96:111], a[212:215], v[52:55], v[96:111]
buffer_load_dwordx4 v204, s[8:11], s26 offen offset:2048 lds
ds_read_b128 a[244:247], v205 offset:13312
v_cmp_ge_i32 s[40:41], v232, 16
v_cndmask_b32 v69, v209, v69, s[50:51]
s_waitcnt lgkmcnt(6)
v_mfma_f32_32x32x16_bf16 v[96:111], a[216:219], v[56:59], v[96:111]
ds_read_b128 a[248:251], v205 offset:14336
v_exp_f32 v196, v68
v_add_f32 v200, v200, v195
v_cvt_pk_bf16_f32 v129, v194, v195
v_cmp_ge_i32 s[42:43], v232, 17
v_cndmask_b32 v70, v209, v70, s[52:53]
v_exp_f32 v197, v69
v_mfma_f32_32x32x16_bf16 v[96:111], a[220:223], v[60:63], v[96:111]
buffer_load_dwordx4 v204, s[8:11], s26 offen offset:3072 lds
s_add_u32 s26, s26, 16384
ds_read_b128 a[252:255], v205 offset:15360
v_add_f32 v200, v200, v196
v_cmp_ge_i32 s[44:45], v232, 18
s_waitcnt lgkmcnt(6)
v_mfma_f32_32x32x16_bf16 v[112:127], a[224:227], v[32:35], v[176:191]
s_waitcnt vmcnt(16)
ds_read_b64_tr_b16 v[236:237], v218 offset:4096
ds_read_b64_tr_b16 v[238:239], v218 offset:4608
v_cndmask_b32 v71, v209, v71, s[54:55]
v_exp_f32 v198, v70
v_add_f32 v200, v200, v197
v_mfma_f32_32x32x16_bf16 v[112:127], a[228:231], v[36:39], v[112:127]
ds_read_b64_tr_b16 v[240:241], v219 offset:4096
ds_read_b64_tr_b16 v[242:243], v219 offset:4608
v_cvt_pk_bf16_f32 v130, v196, v197
v_cmp_ge_i32 s[46:47], v232, 19
v_cndmask_b32 v72, v209, v72, s[40:41]
v_exp_f32 v199, v71
s_waitcnt lgkmcnt(8)
v_mfma_f32_32x32x16_bf16 v[112:127], a[232:235], v[40:43], v[112:127]
ds_read_b64_tr_b16 v[244:245], v218 offset:6144
ds_read_b64_tr_b16 v[246:247], v218 offset:6656
v_add_f32 v200, v200, v198
v_cmp_ge_i32 s[48:49], v232, 24
v_cndmask_b32 v73, v209, v73, s[42:43]
v_exp_f32 v192, v72
v_add_f32 v200, v200, v199
v_mfma_f32_32x32x16_bf16 v[112:127], a[236:239], v[44:47], v[112:127]
ds_read_b64_tr_b16 v[248:249], v219 offset:6144
ds_read_b64_tr_b16 v[250:251], v219 offset:6656
v_cvt_pk_bf16_f32 v131, v198, v199
v_cmp_ge_i32 s[50:51], v232, 25
v_cndmask_b32 v74, v209, v74, s[44:45]
v_exp_f32 v193, v73
s_waitcnt lgkmcnt(10)
v_mfma_f32_32x32x16_bf16 v[112:127], a[240:243], v[48:51], v[112:127]
ds_read_b128 a[192:195], v206 offset:0
v_add_f32 v200, v200, v192
v_cmp_ge_i32 s[52:53], v232, 26
v_cndmask_b32 v75, v209, v75, s[46:47]
v_exp_f32 v194, v74
v_add_f32 v200, v200, v193
v_mfma_f32_32x32x16_bf16 v[112:127], a[244:247], v[52:55], v[112:127]
ds_read_b128 a[196:199], v206 offset:1024
v_cvt_pk_bf16_f32 v132, v192, v193
v_cmp_ge_i32 s[54:55], v232, 27
v_cndmask_b32 v76, v209, v76, s[48:49]
v_exp_f32 v195, v75
v_add_f32 v200, v200, v194
v_cndmask_b32 v77, v209, v77, s[50:51]
s_waitcnt lgkmcnt(10)
v_mfma_f32_32x32x16_bf16 v[112:127], a[248:251], v[56:59], v[112:127]
ds_read_b128 a[200:203], v206 offset:2048
v_exp_f32 v196, v76
v_add_f32 v200, v200, v195
v_cvt_pk_bf16_f32 v133, v194, v195
v_cndmask_b32 v78, v209, v78, s[52:53]
v_mfma_f32_32x32x16_bf16 v[112:127], a[252:255], v[60:63], v[112:127]
ds_read_b128 a[204:207], v206 offset:3072
v_exp_f32 v197, v77
v_add_f32 v200, v200, v196
v_cndmask_b32 v79, v209, v79, s[54:55]
v_exp_f32 v198, v78
v_add_f32 v200, v200, v197
s_waitcnt lgkmcnt(3)
v_mfma_f32_32x32x16_bf16 a[128:143], v[236:239], v[244:247], a[128:143]
ds_read_b128 a[208:211], v206 offset:4096
v_cvt_pk_bf16_f32 v134, v196, v197
v_exp_f32 v199, v79
v_add_f32 v200, v200, v198
v_add_f32 v200, v200, v199
v_cvt_pk_bf16_f32 v135, v198, v199
v_cmp_ge_i32 s[40:41], v233, 0
v_mfma_f32_32x32x16_bf16 a[144:159], v[236:239], v[248:251], a[144:159]
ds_read_b128 a[212:215], v206 offset:5120
v_cmp_ge_i32 s[42:43], v233, 1
v_cmp_ge_i32 s[44:45], v233, 2
v_cmp_ge_i32 s[46:47], v233, 3
v_cndmask_b32 v80, v209, v80, s[40:41]
v_cmp_ge_i32 s[48:49], v233, 8
v_cndmask_b32 v81, v209, v81, s[42:43]
v_mfma_f32_32x32x16_bf16 a[160:175], v[240:243], v[244:247], a[160:175]
ds_read_b128 a[216:219], v206 offset:6144
v_exp_f32 v192, v80
v_cmp_ge_i32 s[50:51], v233, 9
v_cndmask_b32 v82, v209, v82, s[44:45]
v_exp_f32 v193, v81
v_mfma_f32_32x32x16_bf16 a[176:191], v[240:243], v[248:251], a[176:191]
ds_read_b128 a[220:223], v206 offset:7168
v_cmp_ge_i32 s[52:53], v233, 10
v_cndmask_b32 v83, v209, v83, s[46:47]
v_exp_f32 v194, v82
v_add_f32 v201, v192, v193
v_cvt_pk_bf16_f32 v136, v192, v193
v_cmp_ge_i32 s[54:55], v233, 11
v_mfma_f32_32x32x16_bf16 a[64:79], a[192:195], v[144:147], a[64:79]
ds_read_b128 a[224:227], v206 offset:8192
v_cndmask_b32 v84, v209, v84, s[48:49]
v_exp_f32 v195, v83
v_add_f32 v201, v201, v194
v_cmp_ge_i32 s[40:41], v233, 16
v_cndmask_b32 v85, v209, v85, s[50:51]
s_waitcnt lgkmcnt(7)
v_mfma_f32_32x32x16_bf16 a[80:95], a[196:199], v[144:147], a[80:95]
ds_read_b128 a[228:231], v206 offset:9216
v_exp_f32 v196, v84
v_add_f32 v201, v201, v195
v_cvt_pk_bf16_f32 v137, v194, v195
v_cmp_ge_i32 s[42:43], v233, 17
v_cndmask_b32 v86, v209, v86, s[52:53]
s_waitcnt lgkmcnt(6)
v_mfma_f32_32x32x16_bf16 a[96:111], a[200:203], v[144:147], a[96:111]
ds_read_b128 a[232:235], v206 offset:10240
v_exp_f32 v197, v85
v_add_f32 v201, v201, v196
v_cmp_ge_i32 s[44:45], v233, 18
v_cndmask_b32 v87, v209, v87, s[54:55]
v_exp_f32 v198, v86
v_mfma_f32_32x32x16_bf16 a[112:127], a[204:207], v[144:147], a[112:127]
ds_read_b128 a[236:239], v206 offset:11264
v_add_f32 v201, v201, v197
v_cvt_pk_bf16_f32 v138, v196, v197
v_cmp_ge_i32 s[46:47], v233, 19
v_cndmask_b32 v88, v209, v88, s[40:41]
v_exp_f32 v199, v87
s_waitcnt lgkmcnt(6)
v_mfma_f32_32x32x16_bf16 a[64:79], a[208:211], v[148:151], a[64:79]
ds_read_b128 a[240:243], v206 offset:12288
v_add_f32 v201, v201, v198
v_cmp_ge_i32 s[48:49], v233, 24
v_cndmask_b32 v89, v209, v89, s[42:43]
v_exp_f32 v192, v88
v_add_f32 v201, v201, v199
v_mfma_f32_32x32x16_bf16 a[80:95], a[212:215], v[148:151], a[80:95]
ds_read_b128 a[244:247], v206 offset:13312
v_cvt_pk_bf16_f32 v139, v198, v199
v_cmp_ge_i32 s[50:51], v233, 25
v_cndmask_b32 v90, v209, v90, s[44:45]
v_exp_f32 v193, v89
v_add_f32 v201, v201, v192
s_waitcnt lgkmcnt(6)
v_mfma_f32_32x32x16_bf16 a[96:111], a[216:219], v[148:151], a[96:111]
ds_read_b128 a[248:251], v206 offset:14336
v_cmp_ge_i32 s[52:53], v233, 26
v_cndmask_b32 v91, v209, v91, s[46:47]
v_exp_f32 v194, v90
v_add_f32 v201, v201, v193
v_cvt_pk_bf16_f32 v140, v192, v193
v_cmp_ge_i32 s[54:55], v233, 27
v_mfma_f32_32x32x16_bf16 a[112:127], a[220:223], v[148:151], a[112:127]
ds_read_b128 a[252:255], v206 offset:15360
v_cndmask_b32 v92, v209, v92, s[48:49]
v_exp_f32 v195, v91
v_add_f32 v201, v201, v194
v_cndmask_b32 v93, v209, v93, s[50:51]
v_exp_f32 v196, v92
s_waitcnt lgkmcnt(6)
v_mfma_f32_32x32x16_bf16 a[64:79], a[224:227], v[152:155], a[64:79]
s_waitcnt vmcnt(8)
s_barrier
v_add_u32 v205, 16384, v205
v_and_b32 v205, 0xffff, v205
v_add_u32 v206, 16384, v206
v_and_or_b32 v206, v206, v230, v231
ds_read_b128 a[192:195], v205 offset:0
s_and_b32 m0, s25, 0xffff
v_mfma_f32_32x32x16_bf16 a[80:95], a[228:231], v[152:155], a[80:95]
buffer_load_dwordx4 v204, s[4:7], s25 offen lds
ds_read_b128 a[196:199], v205 offset:1024
v_add_f32 v201, v201, v195
v_cvt_pk_bf16_f32 v141, v194, v195
s_waitcnt lgkmcnt(6)
v_mfma_f32_32x32x16_bf16 a[96:111], a[232:235], v[152:155], a[96:111]
ds_read_b128 a[200:203], v205 offset:2048
v_cndmask_b32 v94, v209, v94, s[52:53]
v_exp_f32 v197, v93
v_add_f32 v201, v201, v196
v_cndmask_b32 v95, v209, v95, s[54:55]
v_exp_f32 v198, v94
v_mfma_f32_32x32x16_bf16 a[112:127], a[236:239], v[152:155], a[112:127]
buffer_load_dwordx4 v204, s[4:7], s25 offen offset:1024 lds
ds_read_b128 a[204:207], v205 offset:3072
v_add_f32 v201, v201, v197
v_cvt_pk_bf16_f32 v142, v196, v197
s_waitcnt lgkmcnt(6)
v_mfma_f32_32x32x16_bf16 a[64:79], a[240:243], v[156:159], a[64:79]
ds_read_b128 a[208:211], v205 offset:4096
v_exp_f32 v199, v95
v_add_f32 v201, v201, v198
v_add_f32 v201, v201, v199
v_cvt_pk_bf16_f32 v143, v198, v199
v_max_f32 v210, v200, v201
v_cmp_lt_f32 vcc, s28, v210
v_mfma_f32_32x32x16_bf16 a[80:95], a[244:247], v[156:159], a[80:95]
buffer_load_dwordx4 v204, s[4:7], s25 offen offset:2048 lds
ds_read_b128 a[212:215], v205 offset:5120
s_waitcnt lgkmcnt(6)
v_mfma_f32_32x32x16_bf16 a[96:111], a[248:251], v[156:159], a[96:111]
ds_read_b128 a[216:219], v205 offset:6144
v_mfma_f32_32x32x16_bf16 a[112:127], a[252:255], v[156:159], a[112:127]
buffer_load_dwordx4 v204, s[4:7], s25 offen offset:3072 lds
s_add_u32 s25, s25, 16384
ds_read_b128 a[220:223], v205 offset:7168
s_cbranch_vccnz attn_slow12
attn_join12:
v_add_f32 v203, v203, v200
v_add_f32 v203, v203, v201
attn_epi:
s_waitcnt lgkmcnt(0)
s_sub_u32 s29, 66, s23
s_lshl_b32 s29, s29, 5
v_subrev_u32 v232, s29, v208
v_subrev_u32 v233, 32, v232
ds_read_b128 a[192:195], v206 offset:0
ds_read_b128 a[196:199], v206 offset:1024
ds_read_b128 a[200:203], v206 offset:2048
ds_read_b128 a[204:207], v206 offset:3072
ds_read_b128 a[208:211], v206 offset:4096
ds_read_b128 a[212:215], v206 offset:5120
ds_read_b128 a[216:219], v206 offset:6144
ds_read_b128 a[220:223], v206 offset:7168
s_waitcnt lgkmcnt(6)
v_mfma_f32_32x32x16_bf16 a[64:79], a[192:195], v[128:131], a[64:79]
ds_read_b128 a[224:227], v206 offset:8192
v_cmp_ge_i32 s[40:41], v232, 0
v_cmp_ge_i32 s[42:43], v232, 1
v_cmp_ge_i32 s[44:45], v232, 2
v_cmp_ge_i32 s[46:47], v232, 3
v_cndmask_b32 v96, v209, v96, s[40:41]
v_cmp_ge_i32 s[48:49], v232, 8
v_cndmask_b32 v97, v209, v97, s[42:43]
v_exp_f32 v192, v96
v_cmp_ge_i32 s[50:51], v232, 9
v_cndmask_b32 v98, v209, v98, s[44:45]
v_exp_f32 v193, v97
v_mfma_f32_32x32x16_bf16 a[80:95], a[196:199], v[128:131], a[80:95]
ds_read_b128 a[228:231], v206 offset:9216
v_cmp_ge_i32 s[52:53], v232, 10
v_cndmask_b32 v99, v209, v99, s[46:47]
v_exp_f32 v194, v98
v_add_f32 v200, v192, v193
v_cvt_pk_bf16_f32 v144, v192, v193
v_cmp_ge_i32 s[54:55], v232, 11
v_cndmask_b32 v100, v209, v100, s[48:49]
v_exp_f32 v195, v99
v_add_f32 v200, v200, v194
s_waitcnt lgkmcnt(6)
v_mfma_f32_32x32x16_bf16 a[96:111], a[200:203], v[128:131], a[96:111]
ds_read_b128 a[232:235], v206 offset:10240
v_cmp_ge_i32 s[40:41], v232, 16
v_cndmask_b32 v101, v209, v101, s[50:51]
v_exp_f32 v196, v100
v_add_f32 v200, v200, v195
v_cvt_pk_bf16_f32 v145, v194, v195
v_cmp_ge_i32 s[42:43], v232, 17
v_cndmask_b32 v102, v209, v102, s[52:53]
v_exp_f32 v197, v101
v_add_f32 v200, v200, v196
v_cmp_ge_i32 s[44:45], v232, 18
v_mfma_f32_32x32x16_bf16 a[112:127], a[204:207], v[128:131], a[112:127]
ds_read_b128 a[236:239], v206 offset:11264
v_cndmask_b32 v103, v209, v103, s[54:55]
v_exp_f32 v198, v102
v_add_f32 v200, v200, v197
v_cvt_pk_bf16_f32 v146, v196, v197
v_cmp_ge_i32 s[46:47], v232, 19
v_cndmask_b32 v104, v209, v104, s[40:41]
v_exp_f32 v199, v103
v_add_f32 v200, v200, v198
v_cmp_ge_i32 s[48:49], v232, 24
v_cndmask_b32 v105, v209, v105, s[42:43]
s_waitcnt lgkmcnt(6)
v_mfma_f32_32x32x16_bf16 a[64:79], a[208:211], v[132:135], a[64:79]
ds_read_b128 a[240:243], v206 offset:12288
v_exp_f32 v192, v104
v_add_f32 v200, v200, v199
v_cvt_pk_bf16_f32 v147, v198, v199
v_cmp_ge_i32 s[50:51], v232, 25
v_cndmask_b32 v106, v209, v106, s[44:45]
v_exp_f32 v193, v105
v_add_f32 v200, v200, v192
v_cmp_ge_i32 s[52:53], v232, 26
v_cndmask_b32 v107, v209, v107, s[46:47]
v_exp_f32 v194, v106
v_mfma_f32_32x32x16_bf16 a[80:95], a[212:215], v[132:135], a[80:95]
ds_read_b128 a[244:247], v206 offset:13312
v_add_f32 v200, v200, v193
v_cvt_pk_bf16_f32 v148, v192, v193
v_cmp_ge_i32 s[54:55], v232, 27
v_cndmask_b32 v108, v209, v108, s[48:49]
v_exp_f32 v195, v107
v_add_f32 v200, v200, v194
v_cndmask_b32 v109, v209, v109, s[50:51]
v_exp_f32 v196, v108
v_add_f32 v200, v200, v195
s_waitcnt lgkmcnt(6)
v_mfma_f32_32x32x16_bf16 a[96:111], a[216:219], v[132:135], a[96:111]
ds_read_b128 a[248:251], v206 offset:14336
v_cvt_pk_bf16_f32 v149, v194, v195
v_cndmask_b32 v110, v209, v110, s[52:53]
v_exp_f32 v197, v109
v_add_f32 v200, v200, v196
v_cndmask_b32 v111, v209, v111, s[54:55]
v_exp_f32 v198, v110
v_add_f32 v200, v200, v197
v_cvt_pk_bf16_f32 v150, v196, v197
v_exp_f32 v199, v111
v_mfma_f32_32x32x16_bf16 a[112:127], a[220:223], v[132:135], a[112:127]
ds_read_b128 a[252:255], v206 offset:15360
v_add_f32 v200, v200, v198
v_add_f32 v200, v200, v199
v_cvt_pk_bf16_f32 v151, v198, v199
v_cmp_ge_i32 s[40:41], v233, 0
v_cmp_ge_i32 s[42:43], v233, 1
v_cmp_ge_i32 s[44:45], v233, 2
v_cmp_ge_i32 s[46:47], v233, 3
v_cndmask_b32 v112, v209, v112, s[40:41]
v_cmp_ge_i32 s[48:49], v233, 8
v_cndmask_b32 v113, v209, v113, s[42:43]
v_exp_f32 v192, v112
s_waitcnt lgkmcnt(6)
v_mfma_f32_32x32x16_bf16 a[64:79], a[224:227], v[136:139], a[64:79]
s_waitcnt vmcnt(0)
s_barrier
v_add_u32 v206, 16384, v206
v_and_or_b32 v206, v206, v230, v231
v_cmp_ge_i32 s[50:51], v233, 9
v_cndmask_b32 v114, v209, v114, s[44:45]
v_exp_f32 v193, v113
v_cmp_ge_i32 s[52:53], v233, 10
v_cndmask_b32 v115, v209, v115, s[46:47]
v_exp_f32 v194, v114
v_add_f32 v201, v192, v193
v_cvt_pk_bf16_f32 v152, v192, v193
v_mfma_f32_32x32x16_bf16 a[80:95], a[228:231], v[136:139], a[80:95]
v_cmp_ge_i32 s[54:55], v233, 11
v_cndmask_b32 v116, v209, v116, s[48:49]
v_exp_f32 v195, v115
v_add_f32 v201, v201, v194
v_cmp_ge_i32 s[40:41], v233, 16
v_cndmask_b32 v117, v209, v117, s[50:51]
v_exp_f32 v196, v116
v_add_f32 v201, v201, v195
v_cvt_pk_bf16_f32 v153, v194, v195
v_cmp_ge_i32 s[42:43], v233, 17
v_cndmask_b32 v118, v209, v118, s[52:53]
s_waitcnt lgkmcnt(4)
v_mfma_f32_32x32x16_bf16 a[96:111], a[232:235], v[136:139], a[96:111]
v_exp_f32 v197, v117
v_add_f32 v201, v201, v196
v_cmp_ge_i32 s[44:45], v233, 18
v_cndmask_b32 v119, v209, v119, s[54:55]
v_exp_f32 v198, v118
v_add_f32 v201, v201, v197
v_cvt_pk_bf16_f32 v154, v196, v197
v_cmp_ge_i32 s[46:47], v233, 19
v_cndmask_b32 v120, v209, v120, s[40:41]
v_exp_f32 v199, v119
v_mfma_f32_32x32x16_bf16 a[112:127], a[236:239], v[136:139], a[112:127]
v_add_f32 v201, v201, v198
v_cmp_ge_i32 s[48:49], v233, 24
v_cndmask_b32 v121, v209, v121, s[42:43]
v_exp_f32 v192, v120
v_add_f32 v201, v201, v199
v_cvt_pk_bf16_f32 v155, v198, v199
v_cmp_ge_i32 s[50:51], v233, 25
v_cndmask_b32 v122, v209, v122, s[44:45]
v_exp_f32 v193, v121
v_add_f32 v201, v201, v192
v_cmp_ge_i32 s[52:53], v233, 26
s_waitcnt lgkmcnt(2)
v_mfma_f32_32x32x16_bf16 a[64:79], a[240:243], v[140:143], a[64:79]
v_cndmask_b32 v123, v209, v123, s[46:47]
v_exp_f32 v194, v122
v_add_f32 v201, v201, v193
v_cvt_pk_bf16_f32 v156, v192, v193
v_cmp_ge_i32 s[54:55], v233, 27
v_cndmask_b32 v124, v209, v124, s[48:49]
v_exp_f32 v195, v123
v_add_f32 v201, v201, v194
v_cndmask_b32 v125, v209, v125, s[50:51]
v_exp_f32 v196, v124
v_mfma_f32_32x32x16_bf16 a[80:95], a[244:247], v[140:143], a[80:95]
v_add_f32 v201, v201, v195
v_cvt_pk_bf16_f32 v157, v194, v195
v_cndmask_b32 v126, v209, v126, s[52:53]
v_exp_f32 v197, v125
v_add_f32 v201, v201, v196
v_cndmask_b32 v127, v209, v127, s[54:55]
v_exp_f32 v198, v126
v_add_f32 v201, v201, v197
v_cvt_pk_bf16_f32 v158, v196, v197
v_exp_f32 v199, v127
s_waitcnt lgkmcnt(0)
v_mfma_f32_32x32x16_bf16 a[96:111], a[248:251], v[140:143], a[96:111]
v_add_f32 v201, v201, v198
v_add_f32 v201, v201, v199
v_cvt_pk_bf16_f32 v159, v198, v199
v_max_f32 v210, v200, v201
v_cmp_lt_f32 vcc, s28, v210
v_mfma_f32_32x32x16_bf16 a[112:127], a[252:255], v[140:143], a[112:127]
s_cbranch_vccnz attn_slow13
attn_join13:
v_add_f32 v203, v203, v200
v_add_f32 v203, v203, v201
s_nop 1
ds_read_b128 a[192:195], v206 offset:0
ds_read_b128 a[196:199], v206 offset:1024
ds_read_b128 a[200:203], v206 offset:2048
ds_read_b128 a[204:207], v206 offset:3072
ds_read_b128 a[208:211], v206 offset:4096
ds_read_b128 a[212:215], v206 offset:5120
ds_read_b128 a[216:219], v206 offset:6144
ds_read_b128 a[220:223], v206 offset:7168
s_waitcnt lgkmcnt(6)
v_mfma_f32_32x32x16_bf16 a[64:79], a[192:195], v[144:147], a[64:79]
ds_read_b128 a[224:227], v206 offset:8192
s_mov_b32 s4, s86
s_and_b32 s5, s87, 0xffff
s_mov_b32 s6, 3584
v_mfma_f32_32x32x16_bf16 a[80:95], a[196:199], v[144:147], a[80:95]
ds_read_b128 a[228:231], v206 offset:9216
s_mov_b32 s7, 0x20000
s_add_u32 s8, s34, 69206016
s_addc_u32 s9, s35, 0
s_waitcnt lgkmcnt(6)
v_mfma_f32_32x32x16_bf16 a[96:111], a[200:203], v[144:147], a[96:111]
ds_read_b128 a[232:235], v206 offset:10240
s_and_b32 s9, s9, 0xffff
s_mov_b32 s10, 1835008
v_mfma_f32_32x32x16_bf16 a[112:127], a[204:207], v[144:147], a[112:127]
ds_read_b128 a[236:239], v206 offset:11264
s_mov_b32 s11, 0x20000
s_lshr_b32 s29, s20, 1
s_lshl_b32 s29, s29, 5
s_waitcnt lgkmcnt(6)
v_mfma_f32_32x32x16_bf16 a[64:79], a[208:211], v[148:151], a[64:79]
ds_read_b128 a[240:243], v206 offset:12288
s_lshl_b32 s30, s80, 6
s_add_u32 s29, s29, s30
s_lshl_b32 s31, s29, 1
v_mfma_f32_32x32x16_bf16 a[80:95], a[212:215], v[148:151], a[80:95]
ds_read_b128 a[244:247], v206 offset:13312
v_lshrrev_b32 v20, 9, v204
v_lshlrev_b32 v48, 3, v20
s_waitcnt lgkmcnt(6)
v_mfma_f32_32x32x16_bf16 a[96:111], a[216:219], v[148:151], a[96:111]
ds_read_b128 a[248:251], v206 offset:14336
s_lshl_b32 s29, s20, 14
v_add_u32 v6, s29, v204
s_lshl_b32 s29, s20, 12
v_mfma_f32_32x32x16_bf16 a[112:127], a[220:223], v[148:151], a[112:127]
ds_read_b128 a[252:255], v206 offset:15360
v_add_u32 v7, s29, v204
v_mov_b32 v49, 0xc0135761
s_waitcnt lgkmcnt(6)
v_mfma_f32_32x32x16_bf16 a[64:79], a[224:227], v[152:155], a[64:79]
v_add_u32 v206, 16384, v206
v_and_or_b32 v206, v206, v230, v231
buffer_load_dwordx2 v[40:41], v48, s[4:7], s31 offen offset:0
v_mfma_f32_32x32x16_bf16 a[80:95], a[228:231], v[152:155], a[80:95]
buffer_load_dwordx2 v[42:43], v48, s[4:7], s31 offen offset:16
s_waitcnt lgkmcnt(4)
v_mfma_f32_32x32x16_bf16 a[96:111], a[232:235], v[152:155], a[96:111]
v_mfma_f32_32x32x16_bf16 a[112:127], a[236:239], v[152:155], a[112:127]
buffer_load_dwordx2 v[44:45], v48, s[4:7], s31 offen offset:32
s_waitcnt lgkmcnt(2)
v_mfma_f32_32x32x16_bf16 a[64:79], a[240:243], v[156:159], a[64:79]
buffer_load_dwordx2 v[46:47], v48, s[4:7], s31 offen offset:48
v_mfma_f32_32x32x16_bf16 a[80:95], a[244:247], v[156:159], a[80:95]
s_waitcnt lgkmcnt(0)
v_mfma_f32_32x32x16_bf16 a[96:111], a[248:251], v[156:159], a[96:111]
s_getpc_b64 s[54:55]
attn_pcc:
s_lshr_b32 s32, s2, 3
s_lshl_b32 s32, s32, 2
s_add_u32 s32, s32, s20
s_mul_i32 s32, s32, 128
v_lshrrev_b32 v60, 4, v204
v_min_u32 v60, 0, v60
v_lshlrev_b32 v60, 7, v60
v_add_u32 v60, s32, v60
v_add_u32 v60, attn_phasec-attn_pcc, v60
v_min_u32 v60, attn_end-attn_pcc, v60
v_mov_b32 v61, s55
v_add_co_u32 v60, s[52:53], s54, v60
s_nop 1
v_addc_co_u32 v61, s[52:53], 0, v61, s[52:53]
global_load_dword v253, v[60:61], off
v_mfma_f32_32x32x16_bf16 a[112:127], a[252:255], v[156:159], a[112:127]
s_load_dwordx2 s[64:65], s[0:1], 40
s_load_dwordx4 s[68:71], s[0:1], 72
s_load_dwordx4 s[72:75], s[0:1], 96
s_cmp_eq_u32 s22, 7
s_cbranch_scc1 attn_nomlp
ds_write_b128 v6, a[128:131] offset:0
ds_write_b128 v6, a[132:135] offset:1024
ds_write_b128 v6, a[136:139] offset:2048
ds_write_b128 v6, a[140:143] offset:3072
ds_write_b128 v6, a[144:147] offset:4096
ds_write_b128 v6, a[148:151] offset:5120
ds_write_b128 v6, a[152:155] offset:6144
ds_write_b128 v6, a[156:159] offset:7168
ds_write_b128 v6, a[160:163] offset:8192
ds_write_b128 v6, a[164:167] offset:9216
ds_write_b128 v6, a[168:171] offset:10240
ds_write_b128 v6, a[172:175] offset:11264
ds_write_b128 v6, a[176:179] offset:12288
ds_write_b128 v6, a[180:183] offset:13312
ds_write_b128 v6, a[184:187] offset:14336
ds_write_b128 v6, a[188:191] offset:15360
v_mov_b32 v211, v203
s_nop 1
v_permlane32_swap_b32 v211, v203
s_nop 1
v_add_f32 v203, v203, v211
v_rcp_f32 v212, v203
s_nop 0
v_mov_b32 v213, v212
v_accvgpr_read_b32 v236, a64
v_accvgpr_read_b32 v237, a65
v_accvgpr_read_b32 v238, a66
v_accvgpr_read_b32 v239, a67
v_accvgpr_read_b32 v240, a68
v_accvgpr_read_b32 v241, a69
v_accvgpr_read_b32 v242, a70
v_accvgpr_read_b32 v243, a71
v_pk_mul_f32 v[236:237], v[236:237], v[212:213]
v_pk_mul_f32 v[238:239], v[238:239], v[212:213]
v_pk_mul_f32 v[240:241], v[240:241], v[212:213]
v_pk_mul_f32 v[242:243], v[242:243], v[212:213]
v_cvt_pk_bf16_f32 v236, v236, v237
v_cvt_pk_bf16_f32 v237, v238, v239
v_cvt_pk_bf16_f32 v238, v240, v241
v_cvt_pk_bf16_f32 v239, v242, v243
buffer_store_dwordx4 v[236:239], v204, s[16:19], s58 offen offset:0 sc1
v_accvgpr_read_b32 v244, a72
v_accvgpr_read_b32 v245, a73
v_accvgpr_read_b32 v246, a74
v_accvgpr_read_b32 v247, a75
v_accvgpr_read_b32 v248, a76
v_accvgpr_read_b32 v249, a77
v_accvgpr_read_b32 v250, a78
v_accvgpr_read_b32 v251, a79
v_pk_mul_f32 v[244:245], v[244:245], v[212:213]
v_pk_mul_f32 v[246:247], v[246:247], v[212:213]
v_pk_mul_f32 v[248:249], v[248:249], v[212:213]
v_pk_mul_f32 v[250:251], v[250:251], v[212:213]
v_cvt_pk_bf16_f32 v244, v244, v245
v_cvt_pk_bf16_f32 v245, v246, v247
v_cvt_pk_bf16_f32 v246, v248, v249
v_cvt_pk_bf16_f32 v247, v250, v251
buffer_store_dwordx4 v[244:247], v204, s[16:19], s58 offen offset:1024 sc1
v_accvgpr_read_b32 v236, a80
v_accvgpr_read_b32 v237, a81
v_accvgpr_read_b32 v238, a82
v_accvgpr_read_b32 v239, a83
v_accvgpr_read_b32 v240, a84
v_accvgpr_read_b32 v241, a85
v_accvgpr_read_b32 v242, a86
v_accvgpr_read_b32 v243, a87
v_pk_mul_f32 v[236:237], v[236:237], v[212:213]
v_pk_mul_f32 v[238:239], v[238:239], v[212:213]
v_pk_mul_f32 v[240:241], v[240:241], v[212:213]
v_pk_mul_f32 v[242:243], v[242:243], v[212:213]
v_cvt_pk_bf16_f32 v236, v236, v237
v_cvt_pk_bf16_f32 v237, v238, v239
v_cvt_pk_bf16_f32 v238, v240, v241
v_cvt_pk_bf16_f32 v239, v242, v243
buffer_store_dwordx4 v[236:239], v204, s[16:19], s58 offen offset:2048 sc1
v_accvgpr_read_b32 v244, a88
v_accvgpr_read_b32 v245, a89
v_accvgpr_read_b32 v246, a90
v_accvgpr_read_b32 v247, a91
v_accvgpr_read_b32 v248, a92
v_accvgpr_read_b32 v249, a93
v_accvgpr_read_b32 v250, a94
v_accvgpr_read_b32 v251, a95
v_pk_mul_f32 v[244:245], v[244:245], v[212:213]
v_pk_mul_f32 v[246:247], v[246:247], v[212:213]
v_pk_mul_f32 v[248:249], v[248:249], v[212:213]
v_pk_mul_f32 v[250:251], v[250:251], v[212:213]
v_cvt_pk_bf16_f32 v244, v244, v245
v_cvt_pk_bf16_f32 v245, v246, v247
v_cvt_pk_bf16_f32 v246, v248, v249
v_cvt_pk_bf16_f32 v247, v250, v251
buffer_store_dwordx4 v[244:247], v204, s[16:19], s58 offen offset:3072 sc1
v_accvgpr_read_b32 v236, a96
v_accvgpr_read_b32 v237, a97
v_accvgpr_read_b32 v238, a98
v_accvgpr_read_b32 v239, a99
v_accvgpr_read_b32 v240, a100
v_accvgpr_read_b32 v241, a101
v_accvgpr_read_b32 v242, a102
v_accvgpr_read_b32 v243, a103
v_pk_mul_f32 v[236:237], v[236:237], v[212:213]
v_pk_mul_f32 v[238:239], v[238:239], v[212:213]
v_pk_mul_f32 v[240:241], v[240:241], v[212:213]
v_pk_mul_f32 v[242:243], v[242:243], v[212:213]
v_cvt_pk_bf16_f32 v236, v236, v237
v_cvt_pk_bf16_f32 v237, v238, v239
v_cvt_pk_bf16_f32 v238, v240, v241
v_cvt_pk_bf16_f32 v239, v242, v243
buffer_store_dwordx4 v[236:239], v204, s[16:19], s59 offen offset:0 sc1
v_accvgpr_read_b32 v244, a104
v_accvgpr_read_b32 v245, a105
v_accvgpr_read_b32 v246, a106
v_accvgpr_read_b32 v247, a107
v_accvgpr_read_b32 v248, a108
v_accvgpr_read_b32 v249, a109
v_accvgpr_read_b32 v250, a110
v_accvgpr_read_b32 v251, a111
v_pk_mul_f32 v[244:245], v[244:245], v[212:213]
v_pk_mul_f32 v[246:247], v[246:247], v[212:213]
v_pk_mul_f32 v[248:249], v[248:249], v[212:213]
v_pk_mul_f32 v[250:251], v[250:251], v[212:213]
v_cvt_pk_bf16_f32 v244, v244, v245
v_cvt_pk_bf16_f32 v245, v246, v247
v_cvt_pk_bf16_f32 v246, v248, v249
v_cvt_pk_bf16_f32 v247, v250, v251
buffer_store_dwordx4 v[244:247], v204, s[16:19], s59 offen offset:1024 sc1
v_accvgpr_read_b32 v236, a112
v_accvgpr_read_b32 v237, a113
v_accvgpr_read_b32 v238, a114
v_accvgpr_read_b32 v239, a115
v_accvgpr_read_b32 v240, a116
v_accvgpr_read_b32 v241, a117
v_accvgpr_read_b32 v242, a118
v_accvgpr_read_b32 v243, a119
v_pk_mul_f32 v[236:237], v[236:237], v[212:213]
v_pk_mul_f32 v[238:239], v[238:239], v[212:213]
v_pk_mul_f32 v[240:241], v[240:241], v[212:213]
v_pk_mul_f32 v[242:243], v[242:243], v[212:213]
v_cvt_pk_bf16_f32 v236, v236, v237
v_cvt_pk_bf16_f32 v237, v238, v239
v_cvt_pk_bf16_f32 v238, v240, v241
v_cvt_pk_bf16_f32 v239, v242, v243
buffer_store_dwordx4 v[236:239], v204, s[16:19], s59 offen offset:2048 sc1
v_accvgpr_read_b32 v244, a120
v_accvgpr_read_b32 v245, a121
v_accvgpr_read_b32 v246, a122
v_accvgpr_read_b32 v247, a123
v_accvgpr_read_b32 v248, a124
v_accvgpr_read_b32 v249, a125
v_accvgpr_read_b32 v250, a126
v_accvgpr_read_b32 v251, a127
v_pk_mul_f32 v[244:245], v[244:245], v[212:213]
v_pk_mul_f32 v[246:247], v[246:247], v[212:213]
v_pk_mul_f32 v[248:249], v[248:249], v[212:213]
v_pk_mul_f32 v[250:251], v[250:251], v[212:213]
v_cvt_pk_bf16_f32 v244, v244, v245
v_cvt_pk_bf16_f32 v245, v246, v247
v_cvt_pk_bf16_f32 v246, v248, v249
v_cvt_pk_bf16_f32 v247, v250, v251
buffer_store_dwordx4 v[244:247], v204, s[16:19], s59 offen offset:3072 sc1
s_waitcnt lgkmcnt(0)
s_barrier
ds_read_b128 v[64:67], v7 offset:0
ds_read_b128 v[68:71], v7 offset:1024
ds_read_b128 v[72:75], v7 offset:2048
ds_read_b128 v[76:79], v7 offset:3072
ds_read_b128 v[80:83], v7 offset:16384
ds_read_b128 v[84:87], v7 offset:17408
ds_read_b128 v[88:91], v7 offset:18432
ds_read_b128 v[92:95], v7 offset:19456
ds_read_b128 v[96:99], v7 offset:32768
ds_read_b128 v[100:103], v7 offset:33792
ds_read_b128 v[104:107], v7 offset:34816
ds_read_b128 v[108:111], v7 offset:35840
ds_read_b128 v[112:115], v7 offset:49152
ds_read_b128 v[116:119], v7 offset:50176
ds_read_b128 v[120:123], v7 offset:51200
ds_read_b128 v[124:127], v7 offset:52224
s_waitcnt vmcnt(9)
s_waitcnt lgkmcnt(0)
v_add_f32 v64, v64, v80
v_add_f32 v96, v96, v112
v_add_f32 v65, v65, v81
v_add_f32 v97, v97, v113
v_add_f32 v66, v66, v82
v_add_f32 v98, v98, v114
v_add_f32 v67, v67, v83
v_add_f32 v99, v99, v115
v_add_f32 v68, v68, v84
v_add_f32 v100, v100, v116
v_add_f32 v69, v69, v85
v_add_f32 v101, v101, v117
v_add_f32 v70, v70, v86
v_add_f32 v102, v102, v118
v_add_f32 v71, v71, v87
v_add_f32 v103, v103, v119
v_add_f32 v72, v72, v88
v_add_f32 v104, v104, v120
v_add_f32 v73, v73, v89
v_add_f32 v105, v105, v121
v_add_f32 v74, v74, v90
v_add_f32 v106, v106, v122
v_add_f32 v75, v75, v91
v_add_f32 v107, v107, v123
v_add_f32 v76, v76, v92
v_add_f32 v108, v108, v124
v_add_f32 v77, v77, v93
v_add_f32 v109, v109, v125
v_add_f32 v78, v78, v94
v_add_f32 v110, v110, v126
v_add_f32 v79, v79, v95
v_add_f32 v111, v111, v127
v_add_f32 v64, v64, v96
v_add_f32 v65, v65, v97
v_add_f32 v66, v66, v98
v_add_f32 v67, v67, v99
v_add_f32 v68, v68, v100
v_add_f32 v69, v69, v101
v_add_f32 v70, v70, v102
v_add_f32 v71, v71, v103
v_add_f32 v72, v72, v104
v_add_f32 v73, v73, v105
v_add_f32 v74, v74, v106
v_add_f32 v75, v75, v107
v_add_f32 v76, v76, v108
v_add_f32 v77, v77, v109
v_add_f32 v78, v78, v110
v_add_f32 v79, v79, v111
v_lshlrev_b32 v20, 16, v40
v_and_b32 v21, 0xffff0000, v40
v_lshlrev_b32 v22, 16, v41
v_and_b32 v23, 0xffff0000, v41
v_add_f32 v64, v64, v20
v_add_f32 v65, v65, v21
v_add_f32 v66, v66, v22
v_add_f32 v67, v67, v23
v_lshlrev_b32 v20, 16, v42
v_and_b32 v21, 0xffff0000, v42
v_lshlrev_b32 v22, 16, v43
v_and_b32 v23, 0xffff0000, v43
v_add_f32 v68, v68, v20
v_add_f32 v69, v69, v21
v_add_f32 v70, v70, v22
v_add_f32 v71, v71, v23
v_lshlrev_b32 v20, 16, v44
v_and_b32 v21, 0xffff0000, v44
v_lshlrev_b32 v22, 16, v45
v_and_b32 v23, 0xffff0000, v45
v_add_f32 v72, v72, v20
v_add_f32 v73, v73, v21
v_add_f32 v74, v74, v22
v_add_f32 v75, v75, v23
v_lshlrev_b32 v20, 16, v46
v_and_b32 v21, 0xffff0000, v46
v_lshlrev_b32 v22, 16, v47
v_and_b32 v23, 0xffff0000, v47
v_add_f32 v76, v76, v20
v_add_f32 v77, v77, v21
v_add_f32 v78, v78, v22
v_add_f32 v79, v79, v23
s_mov_b32 s29, 0xbdd2d3e8
v_mul_f32 v80, v64, v64
v_mul_f32 v81, v65, v65
v_mul_f32 v82, v66, v66
v_mul_f32 v83, v67, v67
v_mul_f32 v84, v68, v68
v_mul_f32 v85, v69, v69
v_mul_f32 v86, v70, v70
v_mul_f32 v87, v71, v71
v_mul_f32 v88, v72, v72
v_mul_f32 v89, v73, v73
v_mul_f32 v90, v74, v74
v_mul_f32 v91, v75, v75
v_mul_f32 v92, v76, v76
v_mul_f32 v93, v77, v77
v_mul_f32 v94, v78, v78
v_mul_f32 v95, v79, v79
v_fma_f32 v96, s29, v80, v49
v_fma_f32 v97, s29, v81, v49
v_fma_f32 v98, s29, v82, v49
v_fma_f32 v99, s29, v83, v49
v_fma_f32 v100, s29, v84, v49
v_fma_f32 v101, s29, v85, v49
v_fma_f32 v102, s29, v86, v49
v_fma_f32 v103, s29, v87, v49
v_fma_f32 v104, s29, v88, v49
v_fma_f32 v105, s29, v89, v49
v_fma_f32 v106, s29, v90, v49
v_fma_f32 v107, s29, v91, v49
v_fma_f32 v108, s29, v92, v49
v_fma_f32 v109, s29, v93, v49
v_fma_f32 v110, s29, v94, v49
v_fma_f32 v111, s29, v95, v49
v_mul_f32 v80, v96, v64
v_mul_f32 v81, v97, v65
v_mul_f32 v82, v98, v66
v_mul_f32 v83, v99, v67
v_mul_f32 v84, v100, v68
v_mul_f32 v85, v101, v69
v_mul_f32 v86, v102, v70
v_mul_f32 v87, v103, v71
v_mul_f32 v88, v104, v72
v_mul_f32 v89, v105, v73
v_mul_f32 v90, v106, v74
v_mul_f32 v91, v107, v75
v_mul_f32 v92, v108, v76
v_mul_f32 v93, v109, v77
v_mul_f32 v94, v110, v78
v_mul_f32 v95, v111, v79
v_exp_f32 v80, v80
v_exp_f32 v81, v81
v_exp_f32 v82, v82
v_exp_f32 v83, v83
v_exp_f32 v84, v84
v_exp_f32 v85, v85
v_exp_f32 v86, v86
v_exp_f32 v87, v87
v_exp_f32 v88, v88
v_exp_f32 v89, v89
v_exp_f32 v90, v90
v_exp_f32 v91, v91
v_exp_f32 v92, v92
v_exp_f32 v93, v93
v_exp_f32 v94, v94
v_exp_f32 v95, v95
v_add_f32 v80, 1.0, v80
v_add_f32 v81, 1.0, v81
v_add_f32 v82, 1.0, v82
v_add_f32 v83, 1.0, v83
v_add_f32 v84, 1.0, v84
v_add_f32 v85, 1.0, v85
v_add_f32 v86, 1.0, v86
v_add_f32 v87, 1.0, v87
v_add_f32 v88, 1.0, v88
v_add_f32 v89, 1.0, v89
v_add_f32 v90, 1.0, v90
v_add_f32 v91, 1.0, v91
v_add_f32 v92, 1.0, v92
v_add_f32 v93, 1.0, v93
v_add_f32 v94, 1.0, v94
v_add_f32 v95, 1.0, v95
v_rcp_f32 v80, v80
v_rcp_f32 v81, v81
v_rcp_f32 v82, v82
v_rcp_f32 v83, v83
v_rcp_f32 v84, v84
v_rcp_f32 v85, v85
v_rcp_f32 v86, v86
v_rcp_f32 v87, v87
v_rcp_f32 v88, v88
v_rcp_f32 v89, v89
v_rcp_f32 v90, v90
v_rcp_f32 v91, v91
v_rcp_f32 v92, v92
v_rcp_f32 v93, v93
v_rcp_f32 v94, v94
v_rcp_f32 v95, v95
s_and_b32 s29, s20, 1
s_lshl_b32 s30, s81, 1
s_add_u32 s29, s29, s30
s_mul_i32 s29, s29, 112
s_lshr_b32 s30, s20, 1
s_lshl_b32 s30, s30, 1
s_add_u32 s29, s29, s30
s_lshl_b32 s30, s80, 2
s_add_u32 s29, s29, s30
s_lshl_b32 s29, s29, 10
v_mul_f32 v64, v64, v80
v_mul_f32 v65, v65, v81
v_mul_f32 v66, v66, v82
v_mul_f32 v67, v67, v83
v_mul_f32 v68, v68, v84
v_mul_f32 v69, v69, v85
v_mul_f32 v70, v70, v86
v_mul_f32 v71, v71, v87
v_cvt_pk_bf16_f32 v64, v64, v65
v_cvt_pk_bf16_f32 v65, v66, v67
v_cvt_pk_bf16_f32 v66, v68, v69
v_cvt_pk_bf16_f32 v67, v70, v71
v_mul_f32 v72, v72, v88
v_mul_f32 v73, v73, v89
v_mul_f32 v74, v74, v90
v_mul_f32 v75, v75, v91
v_mul_f32 v76, v76, v92
v_mul_f32 v77, v77, v93
v_mul_f32 v78, v78, v94
v_mul_f32 v79, v79, v95
v_cvt_pk_bf16_f32 v72, v72, v73
v_cvt_pk_bf16_f32 v73, v74, v75
v_cvt_pk_bf16_f32 v74, v76, v77
v_cvt_pk_bf16_f32 v75, v78, v79
s_mov_b32 s61, s29
s_waitcnt vmcnt(0)
s_branch attn_phasec
attn_nomlp:
s_mov_b32 s61, 0x7ffff000
s_cmp_eq_u32 s20, 0
s_cbranch_scc0 attn_nowb
buffer_wbl2 sc1
attn_nowb:
s_nop 15
v_mov_b32 v211, v203
s_nop 1
v_permlane32_swap_b32 v211, v203
s_nop 1
v_add_f32 v203, v203, v211
v_rcp_f32 v212, v203
s_nop 0
v_mov_b32 v213, v212
v_accvgpr_read_b32 v236, a64
v_accvgpr_read_b32 v237, a65
v_accvgpr_read_b32 v238, a66
v_accvgpr_read_b32 v239, a67
v_accvgpr_read_b32 v240, a68
v_accvgpr_read_b32 v241, a69
v_accvgpr_read_b32 v242, a70
v_accvgpr_read_b32 v243, a71
v_pk_mul_f32 v[236:237], v[236:237], v[212:213]
v_pk_mul_f32 v[238:239], v[238:239], v[212:213]
v_pk_mul_f32 v[240:241], v[240:241], v[212:213]
v_pk_mul_f32 v[242:243], v[242:243], v[212:213]
v_cvt_pk_bf16_f32 v236, v236, v237
v_cvt_pk_bf16_f32 v237, v238, v239
v_cvt_pk_bf16_f32 v238, v240, v241
v_cvt_pk_bf16_f32 v239, v242, v243
buffer_store_dwordx4 v[236:239], v204, s[16:19], s58 offen offset:0 sc1
v_accvgpr_read_b32 v244, a72
v_accvgpr_read_b32 v245, a73
v_accvgpr_read_b32 v246, a74
v_accvgpr_read_b32 v247, a75
v_accvgpr_read_b32 v248, a76
v_accvgpr_read_b32 v249, a77
v_accvgpr_read_b32 v250, a78
v_accvgpr_read_b32 v251, a79
v_pk_mul_f32 v[244:245], v[244:245], v[212:213]
v_pk_mul_f32 v[246:247], v[246:247], v[212:213]
v_pk_mul_f32 v[248:249], v[248:249], v[212:213]
v_pk_mul_f32 v[250:251], v[250:251], v[212:213]
v_cvt_pk_bf16_f32 v244, v244, v245
v_cvt_pk_bf16_f32 v245, v246, v247
v_cvt_pk_bf16_f32 v246, v248, v249
v_cvt_pk_bf16_f32 v247, v250, v251
buffer_store_dwordx4 v[244:247], v204, s[16:19], s58 offen offset:1024 sc1
v_accvgpr_read_b32 v236, a80
v_accvgpr_read_b32 v237, a81
v_accvgpr_read_b32 v238, a82
v_accvgpr_read_b32 v239, a83
v_accvgpr_read_b32 v240, a84
v_accvgpr_read_b32 v241, a85
v_accvgpr_read_b32 v242, a86
v_accvgpr_read_b32 v243, a87
v_pk_mul_f32 v[236:237], v[236:237], v[212:213]
v_pk_mul_f32 v[238:239], v[238:239], v[212:213]
v_pk_mul_f32 v[240:241], v[240:241], v[212:213]
v_pk_mul_f32 v[242:243], v[242:243], v[212:213]
v_cvt_pk_bf16_f32 v236, v236, v237
v_cvt_pk_bf16_f32 v237, v238, v239
v_cvt_pk_bf16_f32 v238, v240, v241
v_cvt_pk_bf16_f32 v239, v242, v243
buffer_store_dwordx4 v[236:239], v204, s[16:19], s58 offen offset:2048 sc1
v_accvgpr_read_b32 v244, a88
v_accvgpr_read_b32 v245, a89
v_accvgpr_read_b32 v246, a90
v_accvgpr_read_b32 v247, a91
v_accvgpr_read_b32 v248, a92
v_accvgpr_read_b32 v249, a93
v_accvgpr_read_b32 v250, a94
v_accvgpr_read_b32 v251, a95
v_pk_mul_f32 v[244:245], v[244:245], v[212:213]
v_pk_mul_f32 v[246:247], v[246:247], v[212:213]
v_pk_mul_f32 v[248:249], v[248:249], v[212:213]
v_pk_mul_f32 v[250:251], v[250:251], v[212:213]
v_cvt_pk_bf16_f32 v244, v244, v245
v_cvt_pk_bf16_f32 v245, v246, v247
v_cvt_pk_bf16_f32 v246, v248, v249
v_cvt_pk_bf16_f32 v247, v250, v251
buffer_store_dwordx4 v[244:247], v204, s[16:19], s58 offen offset:3072 sc1
v_accvgpr_read_b32 v236, a96
v_accvgpr_read_b32 v237, a97
v_accvgpr_read_b32 v238, a98
v_accvgpr_read_b32 v239, a99
v_accvgpr_read_b32 v240, a100
v_accvgpr_read_b32 v241, a101
v_accvgpr_read_b32 v242, a102
v_accvgpr_read_b32 v243, a103
v_pk_mul_f32 v[236:237], v[236:237], v[212:213]
v_pk_mul_f32 v[238:239], v[238:239], v[212:213]
v_pk_mul_f32 v[240:241], v[240:241], v[212:213]
v_pk_mul_f32 v[242:243], v[242:243], v[212:213]
v_cvt_pk_bf16_f32 v236, v236, v237
v_cvt_pk_bf16_f32 v237, v238, v239
v_cvt_pk_bf16_f32 v238, v240, v241
v_cvt_pk_bf16_f32 v239, v242, v243
buffer_store_dwordx4 v[236:239], v204, s[16:19], s59 offen offset:0 sc1
v_accvgpr_read_b32 v244, a104
v_accvgpr_read_b32 v245, a105
v_accvgpr_read_b32 v246, a106
v_accvgpr_read_b32 v247, a107
v_accvgpr_read_b32 v248, a108
v_accvgpr_read_b32 v249, a109
v_accvgpr_read_b32 v250, a110
v_accvgpr_read_b32 v251, a111
v_pk_mul_f32 v[244:245], v[244:245], v[212:213]
v_pk_mul_f32 v[246:247], v[246:247], v[212:213]
v_pk_mul_f32 v[248:249], v[248:249], v[212:213]
v_pk_mul_f32 v[250:251], v[250:251], v[212:213]
v_cvt_pk_bf16_f32 v244, v244, v245
v_cvt_pk_bf16_f32 v245, v246, v247
v_cvt_pk_bf16_f32 v246, v248, v249
v_cvt_pk_bf16_f32 v247, v250, v251
buffer_store_dwordx4 v[244:247], v204, s[16:19], s59 offen offset:1024 sc1
v_accvgpr_read_b32 v236, a112
v_accvgpr_read_b32 v237, a113
v_accvgpr_read_b32 v238, a114
v_accvgpr_read_b32 v239, a115
v_accvgpr_read_b32 v240, a116
v_accvgpr_read_b32 v241, a117
v_accvgpr_read_b32 v242, a118
v_accvgpr_read_b32 v243, a119
v_pk_mul_f32 v[236:237], v[236:237], v[212:213]
v_pk_mul_f32 v[238:239], v[238:239], v[212:213]
v_pk_mul_f32 v[240:241], v[240:241], v[212:213]
v_pk_mul_f32 v[242:243], v[242:243], v[212:213]
v_cvt_pk_bf16_f32 v236, v236, v237
v_cvt_pk_bf16_f32 v237, v238, v239
v_cvt_pk_bf16_f32 v238, v240, v241
v_cvt_pk_bf16_f32 v239, v242, v243
buffer_store_dwordx4 v[236:239], v204, s[16:19], s59 offen offset:2048 sc1
v_accvgpr_read_b32 v244, a120
v_accvgpr_read_b32 v245, a121
v_accvgpr_read_b32 v246, a122
v_accvgpr_read_b32 v247, a123
v_accvgpr_read_b32 v248, a124
v_accvgpr_read_b32 v249, a125
v_accvgpr_read_b32 v250, a126
v_accvgpr_read_b32 v251, a127
v_pk_mul_f32 v[244:245], v[244:245], v[212:213]
v_pk_mul_f32 v[246:247], v[246:247], v[212:213]
v_pk_mul_f32 v[248:249], v[248:249], v[212:213]
v_pk_mul_f32 v[250:251], v[250:251], v[212:213]
v_cvt_pk_bf16_f32 v244, v244, v245
v_cvt_pk_bf16_f32 v245, v246, v247
v_cvt_pk_bf16_f32 v246, v248, v249
v_cvt_pk_bf16_f32 v247, v250, v251
buffer_store_dwordx4 v[244:247], v204, s[16:19], s59 offen offset:3072 sc1
s_add_u32 s76, s34, 75497472
s_addc_u32 s77, s35, 0
s_and_b32 s77, s77, 0xffff
s_mov_b32 s78, 8388608
s_mov_b32 s79, 0x20000
s_sub_u32 s27, s2, 224
s_lshl_b32 s27, s27, 2
s_add_u32 s27, s27, s20
s_lshl_b32 s27, s27, 16
v_mov_b32 v214, -1
v_mov_b32 v215, -1
v_mov_b32 v216, -1
v_mov_b32 v217, -1
s_mov_b32 s24, 16
attn_fill:
buffer_store_dwordx4 v[214:217], v204, s[76:79], s27 offen offset:0 sc1
buffer_store_dwordx4 v[214:217], v204, s[76:79], s27 offen offset:1024 sc1
buffer_store_dwordx4 v[214:217], v204, s[76:79], s27 offen offset:2048 sc1
buffer_store_dwordx4 v[214:217], v204, s[76:79], s27 offen offset:3072 sc1
s_waitcnt vmcnt(40)
s_add_u32 s27, s27, 4096
s_sub_u32 s24, s24, 1
s_cmp_lg_u32 s24, 0
s_cbranch_scc1 attn_fill
s_waitcnt vmcnt(0)
attn_phasec:
s_barrier
s_add_u32 s76, s34, 71434240
s_addc_u32 s77, s35, 0
s_and_b32 s77, s77, 0xffff
s_mov_b32 s78, 14336
s_mov_b32 s79, 0x20000
s_lshr_b32 s27, s21, 3
s_lshl_b32 s27, s27, 3
s_add_u32 s27, s27, s22
s_lshl_b32 s27, s27, 7
s_and_b32 s29, s21, 7
s_lshl_b32 s29, s29, 2
s_add_u32 s27, s27, s29
v_mov_b32 v41, s27
s_mov_b32 s60, 0x7fffff00
s_mov_b32 s30, 1
s_cmp_eq_u32 s22, 7
s_cbranch_scc1 attn_cnou
s_mul_i32 s27, s80, 37
s_lshr_b32 s27, s27, 8
s_mul_i32 s29, s27, 7
s_sub_u32 s29, s80, s29
s_lshl_b32 s29, s29, 1
s_and_b32 s31, s81, 1
s_add_u32 s29, s29, s31
s_lshl_b32 s29, s29, 2
s_lshl_b32 s27, s27, 2
s_lshr_b32 s31, s81, 1
s_add_u32 s27, s27, s31
s_add_u32 s27, s27, 32
s_lshl_b32 s27, s27, 7
s_add_u32 s27, s27, s29
s_mov_b32 s60, s27
attn_cnou:
s_cmp_eq_u32 s22, 7
s_cbranch_scc0 attn_cflag
s_sub_u32 s27, s2, 224
s_lshl_b32 s27, s27, 1
s_add_u32 s27, s27, 48
s_lshl_b32 s27, s27, 7
v_writelane_b32 v41, s27, 2
s_add_u32 s27, s27, 128
v_writelane_b32 v41, s27, 3
s_or_b32 s30, s30, 12
attn_cflag:
v_mov_b32 v42, 1
s_cmp_eq_u32 s20, 0
s_cselect_b32 exec_lo, s30, 0
s_mov_b32 exec_hi, 0
buffer_store_dword v42, v41, s[76:79], 0 offen sc1
s_mov_b64 exec, -1
s_mov_b64 s[76:77], s[34:35]
v_mbcnt_lo_u32_b32 v1, -1, 0
v_mbcnt_hi_u32_b32 v1, -1, v1
s_and_b32 s45, s2, 7
s_lshr_b32 s46, s2, 3
s_lshr_b32 s23, s45, 1
s_and_b32 s45, s45, 1
s_lshl_b32 s45, s45, 3
s_lshr_b32 s47, s46, 2
s_add_u32 s21, s45, s47
s_and_b32 s22, s46, 3
s_lshl_b32 s48, s21, 2
s_add_u32 s48, s48, s22
v_lshlrev_b32 v2, 4, v1
s_lshl_b32 s44, s20, 12
s_mov_b32 s42, 0
s_mov_b32 s43, 0
v_lshrrev_b32 v32, 4, v1
v_bfe_u32 v33, v1, 2, 2
v_xor_b32 v33, v33, v32
v_lshlrev_b32 v33, 6, v33
v_and_b32 v34, 3, v1
v_lshl_add_u32 v33, v34, 4, v33
v_lshl_add_u32 v35, v32, 12, v33
v_lshl_add_u32 v36, v32, 10, v33
v_add_u32 v28, 0, v35
v_add_u32 v24, 0, v36
v_add_u32 v29, 15360, v35
v_add_u32 v25, 3072, v36
v_add_u32 v30, 30720, v35
v_add_u32 v26, 6144, v36
v_add_u32 v31, 46080, v35
v_add_u32 v27, 9216, v36
v_lshrrev_b32 v32, 5, v1
v_bfe_u32 v33, v1, 2, 2
v_lshl_add_u32 v34, v32, 2, v33
v_lshlrev_b32 v34, 8, v34
v_bfe_u32 v35, v1, 4, 1
v_lshl_add_u32 v34, v35, 5, v34
v_and_b32 v35, 3, v1
v_lshl_add_u32 v34, v35, 3, v34
v_xor_b32 v35, 0, v33
v_lshl_add_u32 v8, v35, 6, v34
v_xor_b32 v35, 1, v33
v_lshl_add_u32 v9, v35, 6, v34
v_xor_b32 v35, 2, v33
v_lshl_add_u32 v10, v35, 6, v34
v_xor_b32 v35, 3, v33
v_lshl_add_u32 v11, v35, 6, v34
v_xor_b32 v35, s20, v33
v_lshl_add_u32 v12, v35, 6, v34
v_and_b32 v36, 31, v1
v_lshlrev_b32 v37, 2, v36
v_lshlrev_b32 v38, 1, v36
v_lshlrev_b32 v42, 10, v36
v_lshl_add_u32 v42, v32, 4, v42
s_waitcnt lgkmcnt(0)
s_mov_b32 s4, s64
s_and_b32 s5, s65, 0xffff
s_mov_b32 s6, 4194304
s_mov_b32 s7, 0x20000
s_mov_b32 s8, s68
s_and_b32 s9, s69, 0xffff
s_mov_b32 s10, 7340032
s_mov_b32 s11, 0x20000
s_mov_b32 s28, s70
s_and_b32 s29, s71, 0xffff
s_mov_b32 s30, 4096
s_mov_b32 s31, 0x20000
s_mov_b32 s32, s72
s_and_b32 s33, s73, 0xffff
s_mov_b32 s34, 2097152
s_mov_b32 s35, 0x20000
s_add_u32 s12, s76, 50331648
s_addc_u32 s13, s77, 0
s_and_b32 s13, s13, 0xffff
s_mov_b32 s14, 16777216
s_mov_b32 s15, 0x20000
s_add_u32 s16, s76, 69206016
s_addc_u32 s17, s77, 0
s_and_b32 s17, s17, 0xffff
s_mov_b32 s18, 1835008
s_mov_b32 s19, 0x20000
s_add_u32 s24, s76, 71303168
s_addc_u32 s25, s77, 0
s_and_b32 s25, s25, 0xffff
s_mov_b32 s26, 8192
s_mov_b32 s27, 0x20000
s_add_u32 s36, s76, 75497472
s_addc_u32 s37, s77, 0
s_and_b32 s37, s37, 0xffff
s_mov_b32 s38, 16777216
s_mov_b32 s39, 0x20000
s_lshl_b32 s45, s21, 2
s_add_u32 s45, s45, s20
s_lshl_b32 s46, s45, 7
s_lshl_b32 s47, s45, 6
buffer_load_dword v40, v37, s[24:27], s46 offen
buffer_load_ushort v41, v38, s[28:31], s47 offen
s_lshl_b32 s40, s23, 20
s_lshl_b32 s45, s20, 14
s_add_u32 s40, s40, s45
s_lshl_b32 s45, s22, 8
s_add_u32 s40, s40, s45
s_lshl_b32 s45, s21, 2
s_add_u32 s45, s45, s20
s_lshl_b32 s41, s45, 18
s_lshl_b32 s45, s23, 16
s_add_u32 s41, s41, s45
s_add_u32 m0, s44, 0
s_nop 0
buffer_load_dwordx4 v24, s[4:7], s40 offen lds
buffer_load_dwordx4 v25, s[4:7], s40 offen offset:1024 lds
buffer_load_dwordx4 v26, s[4:7], s40 offen offset:2048 lds
buffer_load_dwordx4 v27, s[4:7], s40 offen offset:3072 lds
s_add_u32 s40, s40, 65536
s_add_u32 m0, s44, 32768
s_nop 0
buffer_load_dwordx4 v24, s[4:7], s40 offen lds
buffer_load_dwordx4 v25, s[4:7], s40 offen offset:1024 lds
buffer_load_dwordx4 v26, s[4:7], s40 offen offset:2048 lds
buffer_load_dwordx4 v27, s[4:7], s40 offen offset:3072 lds
s_add_u32 s40, s40, 65536
s_add_u32 m0, s44, 65536
s_nop 0
buffer_load_dwordx4 v24, s[4:7], s40 offen lds
buffer_load_dwordx4 v25, s[4:7], s40 offen offset:1024 lds
buffer_load_dwordx4 v26, s[4:7], s40 offen offset:2048 lds
buffer_load_dwordx4 v27, s[4:7], s40 offen offset:3072 lds
s_add_u32 s40, s40, 65536
s_add_u32 s56, s76, 71434240
s_addc_u32 s57, s77, 0
s_and_b32 s57, s57, 0xffff
s_mov_b32 s58, 14336
s_mov_b32 s59, 0x20000
s_sub_u32 s49, 15, s21
s_min_u32 s49, s49, s21
s_lshl_b32 s50, s23, 3
s_add_u32 s49, s49, s50
s_lshl_b32 s49, s49, 7
s_lshl_b32 s50, s23, 2
s_add_u32 s50, s50, s22
s_add_u32 s50, s50, 32
s_lshl_b32 s50, s50, 7
s_sub_u32 s50, s50, 32
s_add_u32 s51, s48, 48
s_lshl_b32 s51, s51, 7
v_lshrrev_b32 v45, 2, v2
v_mov_b32 v46, s50
v_mov_b32 v47, s49
v_cmp_gt_u32 vcc, 32, v45
s_nop 1
v_cndmask_b32 v46, v46, v47, vcc
v_add_u32 v45, v45, v46
v_writelane_b32 v45, s51, 22
s_cmp_eq_u32 s20, 1
s_cbranch_scc0 attn_cpolled
s_mov_b32 s49, 0
attn_cpoll:
buffer_load_dword v44, v45, s[56:59], 0 offen sc1
s_waitcnt vmcnt(0)
v_cmp_ne_u32 vcc, 1, v44
s_nop 3
s_and_b32 s50, vcc_lo, 255
s_cmp_eq_u32 s50, 0
s_cbranch_scc1 attn_cpolled
s_add_u32 s49, s49, 1
s_cmp_ge_u32 s49, 0x20000
s_cbranch_scc1 attn_cpolled
s_branch attn_cpoll
attn_cpolled:
s_barrier
s_add_u32 m0, s44, 16384
s_nop 0
buffer_load_dwordx4 v2, s[12:15], s41 offen lds
buffer_load_dwordx4 v2, s[12:15], s41 offen offset:1024 lds
buffer_load_dwordx4 v2, s[12:15], s41 offen offset:2048 lds
buffer_load_dwordx4 v2, s[12:15], s41 offen offset:3072 lds
s_add_u32 s41, s41, 4096
s_add_u32 m0, s44, 49152
s_nop 0
buffer_load_dwordx4 v2, s[12:15], s41 offen lds
buffer_load_dwordx4 v2, s[12:15], s41 offen offset:1024 lds
buffer_load_dwordx4 v2, s[12:15], s41 offen offset:2048 lds
buffer_load_dwordx4 v2, s[12:15], s41 offen offset:3072 lds
s_add_u32 s41, s41, 4096
s_add_u32 m0, s44, 81920
s_nop 0
buffer_load_dwordx4 v2, s[12:15], s41 offen lds
buffer_load_dwordx4 v2, s[12:15], s41 offen offset:1024 lds
buffer_load_dwordx4 v2, s[12:15], s41 offen offset:2048 lds
buffer_load_dwordx4 v2, s[12:15], s41 offen offset:3072 lds
s_add_u32 s41, s41, 4096
s_mov_b32 s42, 98304
s_waitcnt vmcnt(8)
s_barrier
s_add_u32 s46, s44, 16384
s_add_u32 s46, s46, s43
v_add_u32 v22, s46, v2
v_add_u32 v16, s43, v8
v_add_u32 v17, s43, v9
v_add_u32 v18, s43, v10
v_add_u32 v19, s43, v11
v_add_u32 v20, s43, v12
v_add_u32 v21, s43, v2
s_add_u32 s43, s43, 32768
s_cmp_ge_u32 s43, 131072
s_cselect_b32 s43, 0, s43
ds_read_b128 v[208:211], v22 offset:0
ds_read_b64_tr_b16 v[192:193], v16 offset:0
ds_read_b64_tr_b16 v[194:195], v16 offset:2048
ds_read_b64_tr_b16 v[196:197], v17 offset:0
ds_read_b64_tr_b16 v[198:199], v17 offset:2048
ds_read_b64_tr_b16 v[200:201], v18 offset:0
ds_read_b64_tr_b16 v[202:203], v18 offset:2048
ds_read_b64_tr_b16 v[204:205], v19 offset:0
ds_read_b64_tr_b16 v[206:207], v19 offset:2048
s_waitcnt lgkmcnt(0)
v_mfma_f32_32x32x16_bf16 v[128:143], v[192:195], v[208:211], 0
ds_read_b128 v[228:231], v22 offset:1024
ds_read_b64_tr_b16 v[212:213], v16 offset:4096
ds_read_b64_tr_b16 v[214:215], v16 offset:6144
s_add_u32 s47, s42, s44
s_mov_b32 m0, s47
s_nop 0
buffer_load_dwordx4 v24, s[4:7], s40 offen lds
v_mfma_f32_32x32x16_bf16 v[144:159], v[196:199], v[208:211], 0
ds_read_b64_tr_b16 v[216:217], v17 offset:4096
ds_read_b64_tr_b16 v[218:219], v17 offset:6144
ds_read_b64_tr_b16 v[220:221], v18 offset:4096
buffer_load_dwordx4 v25, s[4:7], s40 offen offset:1024 lds
v_mfma_f32_32x32x16_bf16 v[160:175], v[200:203], v[208:211], 0
ds_read_b64_tr_b16 v[222:223], v18 offset:6144
ds_read_b64_tr_b16 v[224:225], v19 offset:4096
ds_read_b64_tr_b16 v[226:227], v19 offset:6144
v_mfma_f32_32x32x16_bf16 v[176:191], v[204:207], v[208:211], 0
buffer_load_dwordx4 v26, s[4:7], s40 offen offset:2048 lds
s_waitcnt lgkmcnt(0)
v_mfma_f32_32x32x16_bf16 v[128:143], v[212:215], v[228:231], v[128:143]
ds_read_b128 v[208:211], v22 offset:2048
ds_read_b64_tr_b16 v[192:193], v16 offset:8192
ds_read_b64_tr_b16 v[194:195], v16 offset:10240
buffer_load_dwordx4 v27, s[4:7], s40 offen offset:3072 lds
s_add_u32 s40, s40, 65536
v_mfma_f32_32x32x16_bf16 v[144:159], v[216:219], v[228:231], v[144:159]
ds_read_b64_tr_b16 v[196:197], v17 offset:8192
ds_read_b64_tr_b16 v[198:199], v17 offset:10240
ds_read_b64_tr_b16 v[200:201], v18 offset:8192
v_mfma_f32_32x32x16_bf16 v[160:175], v[220:223], v[228:231], v[160:175]
ds_read_b64_tr_b16 v[202:203], v18 offset:10240
ds_read_b64_tr_b16 v[204:205], v19 offset:8192
ds_read_b64_tr_b16 v[206:207], v19 offset:10240
s_add_u32 m0, s47, 16384
s_nop 0
buffer_load_dwordx4 v2, s[12:15], s41 offen lds
v_mfma_f32_32x32x16_bf16 v[176:191], v[224:227], v[228:231], v[176:191]
buffer_load_dwordx4 v2, s[12:15], s41 offen offset:1024 lds
s_waitcnt lgkmcnt(0)
v_mfma_f32_32x32x16_bf16 v[128:143], v[192:195], v[208:211], v[128:143]
ds_read_b128 v[228:231], v22 offset:3072
ds_read_b64_tr_b16 v[212:213], v16 offset:12288
ds_read_b64_tr_b16 v[214:215], v16 offset:14336
v_mfma_f32_32x32x16_bf16 v[144:159], v[196:199], v[208:211], v[144:159]
ds_read_b64_tr_b16 v[216:217], v17 offset:12288
ds_read_b64_tr_b16 v[218:219], v17 offset:14336
ds_read_b64_tr_b16 v[220:221], v18 offset:12288
buffer_load_dwordx4 v2, s[12:15], s41 offen offset:2048 lds
v_mfma_f32_32x32x16_bf16 v[160:175], v[200:203], v[208:211], v[160:175]
ds_read_b64_tr_b16 v[222:223], v18 offset:14336
ds_read_b64_tr_b16 v[224:225], v19 offset:12288
ds_read_b64_tr_b16 v[226:227], v19 offset:14336
buffer_load_dwordx4 v2, s[12:15], s41 offen offset:3072 lds
s_add_u32 s41, s41, 4096
s_add_u32 s42, s42, 32768
s_cmp_ge_u32 s42, 131072
s_cselect_b32 s42, 0, s42
v_mfma_f32_32x32x16_bf16 v[176:191], v[204:207], v[208:211], v[176:191]
s_waitcnt lgkmcnt(0)
s_waitcnt vmcnt(12)
s_barrier
v_mfma_f32_32x32x16_bf16 v[128:143], v[212:215], v[228:231], v[128:143]
s_add_u32 s46, s44, 16384
s_add_u32 s46, s46, s43
v_add_u32 v22, s46, v2
v_add_u32 v16, s43, v8
v_add_u32 v17, s43, v9
v_add_u32 v18, s43, v10
v_add_u32 v19, s43, v11
v_add_u32 v20, s43, v12
v_add_u32 v21, s43, v2
s_add_u32 s43, s43, 32768
s_cmp_ge_u32 s43, 131072
s_cselect_b32 s43, 0, s43
ds_read_b128 v[208:211], v22 offset:0
ds_read_b64_tr_b16 v[192:193], v16 offset:0
ds_read_b64_tr_b16 v[194:195], v16 offset:2048
v_mfma_f32_32x32x16_bf16 v[144:159], v[216:219], v[228:231], v[144:159]
ds_read_b64_tr_b16 v[196:197], v17 offset:0
ds_read_b64_tr_b16 v[198:199], v17 offset:2048
ds_read_b64_tr_b16 v[200:201], v18 offset:0
v_mfma_f32_32x32x16_bf16 v[160:175], v[220:223], v[228:231], v[160:175]
ds_read_b64_tr_b16 v[202:203], v18 offset:2048
ds_read_b64_tr_b16 v[204:205], v19 offset:0
ds_read_b64_tr_b16 v[206:207], v19 offset:2048
v_mfma_f32_32x32x16_bf16 v[176:191], v[224:227], v[228:231], v[176:191]
buffer_store_dwordx4 v[64:67], v2, s[16:19], s61 offen offset:0 sc1
buffer_store_dwordx4 v[72:75], v2, s[16:19], s61 offen offset:1024 sc1
s_waitcnt lgkmcnt(0)
v_mfma_f32_32x32x16_bf16 v[128:143], v[192:195], v[208:211], v[128:143]
ds_read_b128 v[228:231], v22 offset:1024
ds_read_b64_tr_b16 v[212:213], v16 offset:4096
ds_read_b64_tr_b16 v[214:215], v16 offset:6144
s_add_u32 s47, s42, s44
s_mov_b32 m0, s47
s_nop 0
buffer_load_dwordx4 v24, s[4:7], s40 offen lds
v_mfma_f32_32x32x16_bf16 v[144:159], v[196:199], v[208:211], v[144:159]
ds_read_b64_tr_b16 v[216:217], v17 offset:4096
ds_read_b64_tr_b16 v[218:219], v17 offset:6144
ds_read_b64_tr_b16 v[220:221], v18 offset:4096
buffer_load_dwordx4 v25, s[4:7], s40 offen offset:1024 lds
v_mfma_f32_32x32x16_bf16 v[160:175], v[200:203], v[208:211], v[160:175]
ds_read_b64_tr_b16 v[222:223], v18 offset:6144
ds_read_b64_tr_b16 v[224:225], v19 offset:4096
ds_read_b64_tr_b16 v[226:227], v19 offset:6144
v_mfma_f32_32x32x16_bf16 v[176:191], v[204:207], v[208:211], v[176:191]
buffer_load_dwordx4 v26, s[4:7], s40 offen offset:2048 lds
s_waitcnt lgkmcnt(0)
v_mfma_f32_32x32x16_bf16 v[128:143], v[212:215], v[228:231], v[128:143]
ds_read_b128 v[208:211], v22 offset:2048
ds_read_b64_tr_b16 v[192:193], v16 offset:8192
ds_read_b64_tr_b16 v[194:195], v16 offset:10240
buffer_load_dwordx4 v27, s[4:7], s40 offen offset:3072 lds
s_add_u32 s40, s40, 65536
v_mfma_f32_32x32x16_bf16 v[144:159], v[216:219], v[228:231], v[144:159]
ds_read_b64_tr_b16 v[196:197], v17 offset:8192
ds_read_b64_tr_b16 v[198:199], v17 offset:10240
ds_read_b64_tr_b16 v[200:201], v18 offset:8192
v_mfma_f32_32x32x16_bf16 v[160:175], v[220:223], v[228:231], v[160:175]
ds_read_b64_tr_b16 v[202:203], v18 offset:10240
ds_read_b64_tr_b16 v[204:205], v19 offset:8192
ds_read_b64_tr_b16 v[206:207], v19 offset:10240
s_add_u32 m0, s47, 16384
s_nop 0
buffer_load_dwordx4 v2, s[12:15], s41 offen lds
v_mfma_f32_32x32x16_bf16 v[176:191], v[224:227], v[228:231], v[176:191]
buffer_load_dwordx4 v2, s[12:15], s41 offen offset:1024 lds
s_waitcnt lgkmcnt(0)
v_mfma_f32_32x32x16_bf16 v[128:143], v[192:195], v[208:211], v[128:143]
ds_read_b128 v[228:231], v22 offset:3072
ds_read_b64_tr_b16 v[212:213], v16 offset:12288
ds_read_b64_tr_b16 v[214:215], v16 offset:14336
v_mfma_f32_32x32x16_bf16 v[144:159], v[196:199], v[208:211], v[144:159]
ds_read_b64_tr_b16 v[216:217], v17 offset:12288
ds_read_b64_tr_b16 v[218:219], v17 offset:14336
ds_read_b64_tr_b16 v[220:221], v18 offset:12288
buffer_load_dwordx4 v2, s[12:15], s41 offen offset:2048 lds
v_mfma_f32_32x32x16_bf16 v[160:175], v[200:203], v[208:211], v[160:175]
ds_read_b64_tr_b16 v[222:223], v18 offset:14336
ds_read_b64_tr_b16 v[224:225], v19 offset:12288
ds_read_b64_tr_b16 v[226:227], v19 offset:14336
buffer_load_dwordx4 v2, s[12:15], s41 offen offset:3072 lds
s_add_u32 s41, s41, 4096
s_add_u32 s42, s42, 32768
s_cmp_ge_u32 s42, 131072
s_cselect_b32 s42, 0, s42
v_mfma_f32_32x32x16_bf16 v[176:191], v[204:207], v[208:211], v[176:191]
s_waitcnt lgkmcnt(0)
s_waitcnt vmcnt(18)
s_barrier
v_mfma_f32_32x32x16_bf16 v[128:143], v[212:215], v[228:231], v[128:143]
s_add_u32 s46, s44, 16384
s_add_u32 s46, s46, s43
v_add_u32 v22, s46, v2
v_add_u32 v16, s43, v8
v_add_u32 v17, s43, v9
v_add_u32 v18, s43, v10
v_add_u32 v19, s43, v11
v_add_u32 v20, s43, v12
v_add_u32 v21, s43, v2
s_add_u32 s43, s43, 32768
s_cmp_ge_u32 s43, 131072
s_cselect_b32 s43, 0, s43
ds_read_b128 v[208:211], v22 offset:0
ds_read_b64_tr_b16 v[192:193], v16 offset:0
ds_read_b64_tr_b16 v[194:195], v16 offset:2048
v_mfma_f32_32x32x16_bf16 v[144:159], v[216:219], v[228:231], v[144:159]
ds_read_b64_tr_b16 v[196:197], v17 offset:0
ds_read_b64_tr_b16 v[198:199], v17 offset:2048
ds_read_b64_tr_b16 v[200:201], v18 offset:0
v_mfma_f32_32x32x16_bf16 v[160:175], v[220:223], v[228:231], v[160:175]
ds_read_b64_tr_b16 v[202:203], v18 offset:2048
ds_read_b64_tr_b16 v[204:205], v19 offset:0
ds_read_b64_tr_b16 v[206:207], v19 offset:2048
v_mfma_f32_32x32x16_bf16 v[176:191], v[224:227], v[228:231], v[176:191]
s_waitcnt lgkmcnt(0)
v_mfma_f32_32x32x16_bf16 v[128:143], v[192:195], v[208:211], v[128:143]
ds_read_b128 v[228:231], v22 offset:1024
ds_read_b64_tr_b16 v[212:213], v16 offset:4096
ds_read_b64_tr_b16 v[214:215], v16 offset:6144
s_add_u32 s47, s42, s44
s_mov_b32 m0, s47
s_nop 0
buffer_load_dwordx4 v24, s[4:7], s40 offen lds
v_mfma_f32_32x32x16_bf16 v[144:159], v[196:199], v[208:211], v[144:159]
ds_read_b64_tr_b16 v[216:217], v17 offset:4096
ds_read_b64_tr_b16 v[218:219], v17 offset:6144
ds_read_b64_tr_b16 v[220:221], v18 offset:4096
buffer_load_dwordx4 v25, s[4:7], s40 offen offset:1024 lds
v_mfma_f32_32x32x16_bf16 v[160:175], v[200:203], v[208:211], v[160:175]
ds_read_b64_tr_b16 v[222:223], v18 offset:6144
ds_read_b64_tr_b16 v[224:225], v19 offset:4096
ds_read_b64_tr_b16 v[226:227], v19 offset:6144
v_mfma_f32_32x32x16_bf16 v[176:191], v[204:207], v[208:211], v[176:191]
buffer_load_dwordx4 v26, s[4:7], s40 offen offset:2048 lds
s_waitcnt lgkmcnt(0)
v_mfma_f32_32x32x16_bf16 v[128:143], v[212:215], v[228:231], v[128:143]
ds_read_b128 v[208:211], v22 offset:2048
ds_read_b64_tr_b16 v[192:193], v16 offset:8192
ds_read_b64_tr_b16 v[194:195], v16 offset:10240
buffer_load_dwordx4 v27, s[4:7], s40 offen offset:3072 lds
s_add_u32 s40, s40, 65536
v_mfma_f32_32x32x16_bf16 v[144:159], v[216:219], v[228:231], v[144:159]
ds_read_b64_tr_b16 v[196:197], v17 offset:8192
ds_read_b64_tr_b16 v[198:199], v17 offset:10240
ds_read_b64_tr_b16 v[200:201], v18 offset:8192
v_mfma_f32_32x32x16_bf16 v[160:175], v[220:223], v[228:231], v[160:175]
ds_read_b64_tr_b16 v[202:203], v18 offset:10240
ds_read_b64_tr_b16 v[204:205], v19 offset:8192
ds_read_b64_tr_b16 v[206:207], v19 offset:10240
s_add_u32 m0, s47, 16384
s_nop 0
buffer_load_dwordx4 v2, s[12:15], s41 offen lds
v_mfma_f32_32x32x16_bf16 v[176:191], v[224:227], v[228:231], v[176:191]
buffer_load_dwordx4 v2, s[12:15], s41 offen offset:1024 lds
s_waitcnt lgkmcnt(0)
v_mfma_f32_32x32x16_bf16 v[128:143], v[192:195], v[208:211], v[128:143]
ds_read_b128 v[228:231], v22 offset:3072
ds_read_b64_tr_b16 v[212:213], v16 offset:12288
ds_read_b64_tr_b16 v[214:215], v16 offset:14336
v_mfma_f32_32x32x16_bf16 v[144:159], v[196:199], v[208:211], v[144:159]
ds_read_b64_tr_b16 v[216:217], v17 offset:12288
ds_read_b64_tr_b16 v[218:219], v17 offset:14336
ds_read_b64_tr_b16 v[220:221], v18 offset:12288
buffer_load_dwordx4 v2, s[12:15], s41 offen offset:2048 lds
v_mfma_f32_32x32x16_bf16 v[160:175], v[200:203], v[208:211], v[160:175]
ds_read_b64_tr_b16 v[222:223], v18 offset:14336
ds_read_b64_tr_b16 v[224:225], v19 offset:12288
ds_read_b64_tr_b16 v[226:227], v19 offset:14336
buffer_load_dwordx4 v2, s[12:15], s41 offen offset:3072 lds
s_add_u32 s41, s41, 4096
s_add_u32 s42, s42, 32768
s_cmp_ge_u32 s42, 131072
s_cselect_b32 s42, 0, s42
v_mfma_f32_32x32x16_bf16 v[176:191], v[204:207], v[208:211], v[176:191]
s_waitcnt lgkmcnt(0)
s_waitcnt vmcnt(18)
s_barrier
v_mfma_f32_32x32x16_bf16 v[128:143], v[212:215], v[228:231], v[128:143]
s_add_u32 s46, s44, 16384
s_add_u32 s46, s46, s43
v_add_u32 v22, s46, v2
v_add_u32 v16, s43, v8
v_add_u32 v17, s43, v9
v_add_u32 v18, s43, v10
v_add_u32 v19, s43, v11
v_add_u32 v20, s43, v12
v_add_u32 v21, s43, v2
s_add_u32 s43, s43, 32768
s_cmp_ge_u32 s43, 131072
s_cselect_b32 s43, 0, s43
ds_read_b128 v[208:211], v22 offset:0
ds_read_b64_tr_b16 v[192:193], v16 offset:0
ds_read_b64_tr_b16 v[194:195], v16 offset:2048
v_mfma_f32_32x32x16_bf16 v[144:159], v[216:219], v[228:231], v[144:159]
ds_read_b64_tr_b16 v[196:197], v17 offset:0
ds_read_b64_tr_b16 v[198:199], v17 offset:2048
ds_read_b64_tr_b16 v[200:201], v18 offset:0
v_mfma_f32_32x32x16_bf16 v[160:175], v[220:223], v[228:231], v[160:175]
ds_read_b64_tr_b16 v[202:203], v18 offset:2048
ds_read_b64_tr_b16 v[204:205], v19 offset:0
ds_read_b64_tr_b16 v[206:207], v19 offset:2048
v_mfma_f32_32x32x16_bf16 v[176:191], v[224:227], v[228:231], v[176:191]
s_waitcnt lgkmcnt(0)
v_mfma_f32_32x32x16_bf16 v[128:143], v[192:195], v[208:211], v[128:143]
ds_read_b128 v[228:231], v22 offset:1024
ds_read_b64_tr_b16 v[212:213], v16 offset:4096
ds_read_b64_tr_b16 v[214:215], v16 offset:6144
s_add_u32 s47, s42, s44
s_mov_b32 m0, s47
s_nop 0
buffer_load_dwordx4 v24, s[4:7], s40 offen lds
v_mfma_f32_32x32x16_bf16 v[144:159], v[196:199], v[208:211], v[144:159]
ds_read_b64_tr_b16 v[216:217], v17 offset:4096
ds_read_b64_tr_b16 v[218:219], v17 offset:6144
ds_read_b64_tr_b16 v[220:221], v18 offset:4096
buffer_load_dwordx4 v25, s[4:7], s40 offen offset:1024 lds
v_mfma_f32_32x32x16_bf16 v[160:175], v[200:203], v[208:211], v[160:175]
ds_read_b64_tr_b16 v[222:223], v18 offset:6144
ds_read_b64_tr_b16 v[224:225], v19 offset:4096
ds_read_b64_tr_b16 v[226:227], v19 offset:6144
v_mfma_f32_32x32x16_bf16 v[176:191], v[204:207], v[208:211], v[176:191]
buffer_load_dwordx4 v26, s[4:7], s40 offen offset:2048 lds
s_waitcnt lgkmcnt(0)
v_mfma_f32_32x32x16_bf16 v[128:143], v[212:215], v[228:231], v[128:143]
ds_read_b128 v[208:211], v22 offset:2048
ds_read_b64_tr_b16 v[192:193], v16 offset:8192
ds_read_b64_tr_b16 v[194:195], v16 offset:10240
buffer_load_dwordx4 v27, s[4:7], s40 offen offset:3072 lds
s_add_u32 s40, s40, 65536
v_mfma_f32_32x32x16_bf16 v[144:159], v[216:219], v[228:231], v[144:159]
ds_read_b64_tr_b16 v[196:197], v17 offset:8192
ds_read_b64_tr_b16 v[198:199], v17 offset:10240
ds_read_b64_tr_b16 v[200:201], v18 offset:8192
v_mfma_f32_32x32x16_bf16 v[160:175], v[220:223], v[228:231], v[160:175]
ds_read_b64_tr_b16 v[202:203], v18 offset:10240
ds_read_b64_tr_b16 v[204:205], v19 offset:8192
ds_read_b64_tr_b16 v[206:207], v19 offset:10240
s_add_u32 m0, s47, 16384
s_nop 0
buffer_load_dwordx4 v2, s[12:15], s41 offen lds
v_mfma_f32_32x32x16_bf16 v[176:191], v[224:227], v[228:231], v[176:191]
buffer_load_dwordx4 v2, s[12:15], s41 offen offset:1024 lds
s_waitcnt lgkmcnt(0)
v_mfma_f32_32x32x16_bf16 v[128:143], v[192:195], v[208:211], v[128:143]
ds_read_b128 v[228:231], v22 offset:3072
ds_read_b64_tr_b16 v[212:213], v16 offset:12288
ds_read_b64_tr_b16 v[214:215], v16 offset:14336
v_mfma_f32_32x32x16_bf16 v[144:159], v[196:199], v[208:211], v[144:159]
ds_read_b64_tr_b16 v[216:217], v17 offset:12288
ds_read_b64_tr_b16 v[218:219], v17 offset:14336
ds_read_b64_tr_b16 v[220:221], v18 offset:12288
buffer_load_dwordx4 v2, s[12:15], s41 offen offset:2048 lds
v_mfma_f32_32x32x16_bf16 v[160:175], v[200:203], v[208:211], v[160:175]
ds_read_b64_tr_b16 v[222:223], v18 offset:14336
ds_read_b64_tr_b16 v[224:225], v19 offset:12288
ds_read_b64_tr_b16 v[226:227], v19 offset:14336
buffer_load_dwordx4 v2, s[12:15], s41 offen offset:3072 lds
s_add_u32 s41, s41, 4096
s_add_u32 s42, s42, 32768
s_cmp_ge_u32 s42, 131072
s_cselect_b32 s42, 0, s42
v_mfma_f32_32x32x16_bf16 v[176:191], v[204:207], v[208:211], v[176:191]
s_waitcnt lgkmcnt(0)
s_waitcnt vmcnt(16)
s_barrier
v_mfma_f32_32x32x16_bf16 v[128:143], v[212:215], v[228:231], v[128:143]
s_add_u32 s46, s44, 16384
s_add_u32 s46, s46, s43
v_add_u32 v22, s46, v2
v_add_u32 v16, s43, v8
v_add_u32 v17, s43, v9
v_add_u32 v18, s43, v10
v_add_u32 v19, s43, v11
v_add_u32 v20, s43, v12
v_add_u32 v21, s43, v2
s_add_u32 s43, s43, 32768
s_cmp_ge_u32 s43, 131072
s_cselect_b32 s43, 0, s43
ds_read_b128 v[208:211], v22 offset:0
ds_read_b64_tr_b16 v[192:193], v16 offset:0
ds_read_b64_tr_b16 v[194:195], v16 offset:2048
v_mfma_f32_32x32x16_bf16 v[144:159], v[216:219], v[228:231], v[144:159]
ds_read_b64_tr_b16 v[196:197], v17 offset:0
ds_read_b64_tr_b16 v[198:199], v17 offset:2048
ds_read_b64_tr_b16 v[200:201], v18 offset:0
v_mfma_f32_32x32x16_bf16 v[160:175], v[220:223], v[228:231], v[160:175]
ds_read_b64_tr_b16 v[202:203], v18 offset:2048
ds_read_b64_tr_b16 v[204:205], v19 offset:0
ds_read_b64_tr_b16 v[206:207], v19 offset:2048
v_mfma_f32_32x32x16_bf16 v[176:191], v[224:227], v[228:231], v[176:191]
s_waitcnt lgkmcnt(0)
v_mfma_f32_32x32x16_bf16 v[128:143], v[192:195], v[208:211], v[128:143]
ds_read_b128 v[228:231], v22 offset:1024
ds_read_b64_tr_b16 v[212:213], v16 offset:4096
ds_read_b64_tr_b16 v[214:215], v16 offset:6144
s_add_u32 s47, s42, s44
s_mov_b32 m0, s47
s_nop 0
buffer_load_dwordx4 v24, s[4:7], s40 offen lds
v_mfma_f32_32x32x16_bf16 v[144:159], v[196:199], v[208:211], v[144:159]
ds_read_b64_tr_b16 v[216:217], v17 offset:4096
ds_read_b64_tr_b16 v[218:219], v17 offset:6144
ds_read_b64_tr_b16 v[220:221], v18 offset:4096
buffer_load_dwordx4 v25, s[4:7], s40 offen offset:1024 lds
v_mfma_f32_32x32x16_bf16 v[160:175], v[200:203], v[208:211], v[160:175]
ds_read_b64_tr_b16 v[222:223], v18 offset:6144
ds_read_b64_tr_b16 v[224:225], v19 offset:4096
ds_read_b64_tr_b16 v[226:227], v19 offset:6144
v_mfma_f32_32x32x16_bf16 v[176:191], v[204:207], v[208:211], v[176:191]
buffer_load_dwordx4 v26, s[4:7], s40 offen offset:2048 lds
s_waitcnt lgkmcnt(0)
v_mfma_f32_32x32x16_bf16 v[128:143], v[212:215], v[228:231], v[128:143]
ds_read_b128 v[208:211], v22 offset:2048
ds_read_b64_tr_b16 v[192:193], v16 offset:8192
ds_read_b64_tr_b16 v[194:195], v16 offset:10240
buffer_load_dwordx4 v27, s[4:7], s40 offen offset:3072 lds
s_add_u32 s40, s40, 65536
v_mfma_f32_32x32x16_bf16 v[144:159], v[216:219], v[228:231], v[144:159]
ds_read_b64_tr_b16 v[196:197], v17 offset:8192
ds_read_b64_tr_b16 v[198:199], v17 offset:10240
ds_read_b64_tr_b16 v[200:201], v18 offset:8192
v_mfma_f32_32x32x16_bf16 v[160:175], v[220:223], v[228:231], v[160:175]
ds_read_b64_tr_b16 v[202:203], v18 offset:10240
ds_read_b64_tr_b16 v[204:205], v19 offset:8192
ds_read_b64_tr_b16 v[206:207], v19 offset:10240
s_add_u32 m0, s47, 16384
s_nop 0
buffer_load_dwordx4 v2, s[12:15], s41 offen lds
v_mfma_f32_32x32x16_bf16 v[176:191], v[224:227], v[228:231], v[176:191]
buffer_load_dwordx4 v2, s[12:15], s41 offen offset:1024 lds
s_waitcnt lgkmcnt(0)
v_mfma_f32_32x32x16_bf16 v[128:143], v[192:195], v[208:211], v[128:143]
ds_read_b128 v[228:231], v22 offset:3072
ds_read_b64_tr_b16 v[212:213], v16 offset:12288
ds_read_b64_tr_b16 v[214:215], v16 offset:14336
v_mfma_f32_32x32x16_bf16 v[144:159], v[196:199], v[208:211], v[144:159]
ds_read_b64_tr_b16 v[216:217], v17 offset:12288
ds_read_b64_tr_b16 v[218:219], v17 offset:14336
ds_read_b64_tr_b16 v[220:221], v18 offset:12288
buffer_load_dwordx4 v2, s[12:15], s41 offen offset:2048 lds
v_mfma_f32_32x32x16_bf16 v[160:175], v[200:203], v[208:211], v[160:175]
ds_read_b64_tr_b16 v[222:223], v18 offset:14336
ds_read_b64_tr_b16 v[224:225], v19 offset:12288
ds_read_b64_tr_b16 v[226:227], v19 offset:14336
buffer_load_dwordx4 v2, s[12:15], s41 offen offset:3072 lds
s_add_u32 s41, s41, 4096
s_add_u32 s42, s42, 32768
s_cmp_ge_u32 s42, 131072
s_cselect_b32 s42, 0, s42
v_mfma_f32_32x32x16_bf16 v[176:191], v[204:207], v[208:211], v[176:191]
s_waitcnt lgkmcnt(0)
s_waitcnt vmcnt(16)
s_barrier
v_mfma_f32_32x32x16_bf16 v[128:143], v[212:215], v[228:231], v[128:143]
s_add_u32 s46, s44, 16384
s_add_u32 s46, s46, s43
v_add_u32 v22, s46, v2
v_add_u32 v16, s43, v8
v_add_u32 v17, s43, v9
v_add_u32 v18, s43, v10
v_add_u32 v19, s43, v11
v_add_u32 v20, s43, v12
v_add_u32 v21, s43, v2
s_add_u32 s43, s43, 32768
s_cmp_ge_u32 s43, 131072
s_cselect_b32 s43, 0, s43
ds_read_b128 v[208:211], v22 offset:0
ds_read_b64_tr_b16 v[192:193], v16 offset:0
ds_read_b64_tr_b16 v[194:195], v16 offset:2048
v_mfma_f32_32x32x16_bf16 v[144:159], v[216:219], v[228:231], v[144:159]
ds_read_b64_tr_b16 v[196:197], v17 offset:0
ds_read_b64_tr_b16 v[198:199], v17 offset:2048
ds_read_b64_tr_b16 v[200:201], v18 offset:0
v_mfma_f32_32x32x16_bf16 v[160:175], v[220:223], v[228:231], v[160:175]
ds_read_b64_tr_b16 v[202:203], v18 offset:2048
ds_read_b64_tr_b16 v[204:205], v19 offset:0
ds_read_b64_tr_b16 v[206:207], v19 offset:2048
v_mfma_f32_32x32x16_bf16 v[176:191], v[224:227], v[228:231], v[176:191]
v_mov_b32 v46, 0
v_mov_b32 v47, 1
s_cmp_eq_u32 s20, 0
s_cselect_b64 exec, 1, 0
buffer_store_dword v47, v46, s[56:59], s60 offen sc1
s_mov_b64 exec, -1
s_waitcnt lgkmcnt(0)
v_mfma_f32_32x32x16_bf16 v[128:143], v[192:195], v[208:211], v[128:143]
ds_read_b128 v[228:231], v22 offset:1024
ds_read_b64_tr_b16 v[212:213], v16 offset:4096
ds_read_b64_tr_b16 v[214:215], v16 offset:6144
s_add_u32 s47, s42, s44
s_mov_b32 m0, s47
s_nop 0
buffer_load_dwordx4 v24, s[4:7], s40 offen lds
v_mfma_f32_32x32x16_bf16 v[144:159], v[196:199], v[208:211], v[144:159]
ds_read_b64_tr_b16 v[216:217], v17 offset:4096
ds_read_b64_tr_b16 v[218:219], v17 offset:6144
ds_read_b64_tr_b16 v[220:221], v18 offset:4096
buffer_load_dwordx4 v25, s[4:7], s40 offen offset:1024 lds
v_mfma_f32_32x32x16_bf16 v[160:175], v[200:203], v[208:211], v[160:175]
ds_read_b64_tr_b16 v[222:223], v18 offset:6144
ds_read_b64_tr_b16 v[224:225], v19 offset:4096
ds_read_b64_tr_b16 v[226:227], v19 offset:6144
v_mfma_f32_32x32x16_bf16 v[176:191], v[204:207], v[208:211], v[176:191]
buffer_load_dwordx4 v26, s[4:7], s40 offen offset:2048 lds
s_waitcnt lgkmcnt(0)
v_mfma_f32_32x32x16_bf16 v[128:143], v[212:215], v[228:231], v[128:143]
ds_read_b128 v[208:211], v22 offset:2048
ds_read_b64_tr_b16 v[192:193], v16 offset:8192
ds_read_b64_tr_b16 v[194:195], v16 offset:10240
buffer_load_dwordx4 v27, s[4:7], s40 offen offset:3072 lds
s_add_u32 s40, s40, 65536
v_mfma_f32_32x32x16_bf16 v[144:159], v[216:219], v[228:231], v[144:159]
ds_read_b64_tr_b16 v[196:197], v17 offset:8192
ds_read_b64_tr_b16 v[198:199], v17 offset:10240
ds_read_b64_tr_b16 v[200:201], v18 offset:8192
v_mfma_f32_32x32x16_bf16 v[160:175], v[220:223], v[228:231], v[160:175]
ds_read_b64_tr_b16 v[202:203], v18 offset:10240
ds_read_b64_tr_b16 v[204:205], v19 offset:8192
ds_read_b64_tr_b16 v[206:207], v19 offset:10240
s_add_u32 m0, s47, 16384
s_nop 0
buffer_load_dwordx4 v2, s[12:15], s41 offen lds
v_mfma_f32_32x32x16_bf16 v[176:191], v[224:227], v[228:231], v[176:191]
buffer_load_dwordx4 v2, s[12:15], s41 offen offset:1024 lds
s_waitcnt lgkmcnt(0)
v_mfma_f32_32x32x16_bf16 v[128:143], v[192:195], v[208:211], v[128:143]
ds_read_b128 v[228:231], v22 offset:3072
ds_read_b64_tr_b16 v[212:213], v16 offset:12288
ds_read_b64_tr_b16 v[214:215], v16 offset:14336
v_mfma_f32_32x32x16_bf16 v[144:159], v[196:199], v[208:211], v[144:159]
ds_read_b64_tr_b16 v[216:217], v17 offset:12288
ds_read_b64_tr_b16 v[218:219], v17 offset:14336
ds_read_b64_tr_b16 v[220:221], v18 offset:12288
buffer_load_dwordx4 v2, s[12:15], s41 offen offset:2048 lds
v_mfma_f32_32x32x16_bf16 v[160:175], v[200:203], v[208:211], v[160:175]
ds_read_b64_tr_b16 v[222:223], v18 offset:14336
ds_read_b64_tr_b16 v[224:225], v19 offset:12288
ds_read_b64_tr_b16 v[226:227], v19 offset:14336
buffer_load_dwordx4 v2, s[12:15], s41 offen offset:3072 lds
s_add_u32 s41, s41, 4096
s_add_u32 s42, s42, 32768
s_cmp_ge_u32 s42, 131072
s_cselect_b32 s42, 0, s42
v_mfma_f32_32x32x16_bf16 v[176:191], v[204:207], v[208:211], v[176:191]
s_waitcnt lgkmcnt(0)
s_waitcnt vmcnt(17)
s_barrier
v_mfma_f32_32x32x16_bf16 v[128:143], v[212:215], v[228:231], v[128:143]
s_add_u32 s46, s44, 16384
s_add_u32 s46, s46, s43
v_add_u32 v22, s46, v2
v_add_u32 v16, s43, v8
v_add_u32 v17, s43, v9
v_add_u32 v18, s43, v10
v_add_u32 v19, s43, v11
v_add_u32 v20, s43, v12
v_add_u32 v21, s43, v2
s_add_u32 s43, s43, 32768
s_cmp_ge_u32 s43, 131072
s_cselect_b32 s43, 0, s43
ds_read_b128 v[208:211], v22 offset:0
ds_read_b64_tr_b16 v[192:193], v16 offset:0
ds_read_b64_tr_b16 v[194:195], v16 offset:2048
v_mfma_f32_32x32x16_bf16 v[144:159], v[216:219], v[228:231], v[144:159]
ds_read_b64_tr_b16 v[196:197], v17 offset:0
ds_read_b64_tr_b16 v[198:199], v17 offset:2048
ds_read_b64_tr_b16 v[200:201], v18 offset:0
v_mfma_f32_32x32x16_bf16 v[160:175], v[220:223], v[228:231], v[160:175]
ds_read_b64_tr_b16 v[202:203], v18 offset:2048
ds_read_b64_tr_b16 v[204:205], v19 offset:0
ds_read_b64_tr_b16 v[206:207], v19 offset:2048
v_mfma_f32_32x32x16_bf16 v[176:191], v[224:227], v[228:231], v[176:191]
s_waitcnt lgkmcnt(0)
v_mfma_f32_32x32x16_bf16 v[128:143], v[192:195], v[208:211], v[128:143]
ds_read_b128 v[228:231], v22 offset:1024
ds_read_b64_tr_b16 v[212:213], v16 offset:4096
ds_read_b64_tr_b16 v[214:215], v16 offset:6144
s_add_u32 s47, s42, s44
s_mov_b32 m0, s47
s_nop 0
buffer_load_dwordx4 v24, s[4:7], s40 offen lds
v_mfma_f32_32x32x16_bf16 v[144:159], v[196:199], v[208:211], v[144:159]
ds_read_b64_tr_b16 v[216:217], v17 offset:4096
ds_read_b64_tr_b16 v[218:219], v17 offset:6144
ds_read_b64_tr_b16 v[220:221], v18 offset:4096
buffer_load_dwordx4 v25, s[4:7], s40 offen offset:1024 lds
v_mfma_f32_32x32x16_bf16 v[160:175], v[200:203], v[208:211], v[160:175]
ds_read_b64_tr_b16 v[222:223], v18 offset:6144
ds_read_b64_tr_b16 v[224:225], v19 offset:4096
ds_read_b64_tr_b16 v[226:227], v19 offset:6144
v_mfma_f32_32x32x16_bf16 v[176:191], v[204:207], v[208:211], v[176:191]
buffer_load_dwordx4 v26, s[4:7], s40 offen offset:2048 lds
s_waitcnt lgkmcnt(0)
v_mfma_f32_32x32x16_bf16 v[128:143], v[212:215], v[228:231], v[128:143]
ds_read_b128 v[208:211], v22 offset:2048
ds_read_b64_tr_b16 v[192:193], v16 offset:8192
ds_read_b64_tr_b16 v[194:195], v16 offset:10240
buffer_load_dwordx4 v27, s[4:7], s40 offen offset:3072 lds
s_add_u32 s40, s40, 65536
v_mfma_f32_32x32x16_bf16 v[144:159], v[216:219], v[228:231], v[144:159]
ds_read_b64_tr_b16 v[196:197], v17 offset:8192
ds_read_b64_tr_b16 v[198:199], v17 offset:10240
ds_read_b64_tr_b16 v[200:201], v18 offset:8192
v_mfma_f32_32x32x16_bf16 v[160:175], v[220:223], v[228:231], v[160:175]
ds_read_b64_tr_b16 v[202:203], v18 offset:10240
ds_read_b64_tr_b16 v[204:205], v19 offset:8192
ds_read_b64_tr_b16 v[206:207], v19 offset:10240
s_add_u32 m0, s47, 16384
s_nop 0
buffer_load_dwordx4 v2, s[12:15], s41 offen lds
v_mfma_f32_32x32x16_bf16 v[176:191], v[224:227], v[228:231], v[176:191]
buffer_load_dwordx4 v2, s[12:15], s41 offen offset:1024 lds
s_waitcnt lgkmcnt(0)
v_mfma_f32_32x32x16_bf16 v[128:143], v[192:195], v[208:211], v[128:143]
ds_read_b128 v[228:231], v22 offset:3072
ds_read_b64_tr_b16 v[212:213], v16 offset:12288
ds_read_b64_tr_b16 v[214:215], v16 offset:14336
v_mfma_f32_32x32x16_bf16 v[144:159], v[196:199], v[208:211], v[144:159]
ds_read_b64_tr_b16 v[216:217], v17 offset:12288
ds_read_b64_tr_b16 v[218:219], v17 offset:14336
ds_read_b64_tr_b16 v[220:221], v18 offset:12288
buffer_load_dwordx4 v2, s[12:15], s41 offen offset:2048 lds
v_mfma_f32_32x32x16_bf16 v[160:175], v[200:203], v[208:211], v[160:175]
ds_read_b64_tr_b16 v[222:223], v18 offset:14336
ds_read_b64_tr_b16 v[224:225], v19 offset:12288
ds_read_b64_tr_b16 v[226:227], v19 offset:14336
buffer_load_dwordx4 v2, s[12:15], s41 offen offset:3072 lds
s_add_u32 s41, s41, 4096
s_add_u32 s42, s42, 32768
s_cmp_ge_u32 s42, 131072
s_cselect_b32 s42, 0, s42
v_mfma_f32_32x32x16_bf16 v[176:191], v[204:207], v[208:211], v[176:191]
s_waitcnt lgkmcnt(0)
s_waitcnt vmcnt(17)
s_barrier
v_mfma_f32_32x32x16_bf16 v[128:143], v[212:215], v[228:231], v[128:143]
s_add_u32 s46, s44, 16384
s_add_u32 s46, s46, s43
v_add_u32 v22, s46, v2
v_add_u32 v16, s43, v8
v_add_u32 v17, s43, v9
v_add_u32 v18, s43, v10
v_add_u32 v19, s43, v11
v_add_u32 v20, s43, v12
v_add_u32 v21, s43, v2
s_add_u32 s43, s43, 32768
s_cmp_ge_u32 s43, 131072
s_cselect_b32 s43, 0, s43
ds_read_b128 v[208:211], v22 offset:0
ds_read_b64_tr_b16 v[192:193], v16 offset:0
ds_read_b64_tr_b16 v[194:195], v16 offset:2048
v_mfma_f32_32x32x16_bf16 v[144:159], v[216:219], v[228:231], v[144:159]
ds_read_b64_tr_b16 v[196:197], v17 offset:0
ds_read_b64_tr_b16 v[198:199], v17 offset:2048
ds_read_b64_tr_b16 v[200:201], v18 offset:0
v_mfma_f32_32x32x16_bf16 v[160:175], v[220:223], v[228:231], v[160:175]
ds_read_b64_tr_b16 v[202:203], v18 offset:2048
ds_read_b64_tr_b16 v[204:205], v19 offset:0
ds_read_b64_tr_b16 v[206:207], v19 offset:2048
v_mfma_f32_32x32x16_bf16 v[176:191], v[224:227], v[228:231], v[176:191]
s_waitcnt lgkmcnt(0)
v_mfma_f32_32x32x16_bf16 v[128:143], v[192:195], v[208:211], v[128:143]
ds_read_b128 v[228:231], v22 offset:1024
ds_read_b64_tr_b16 v[212:213], v16 offset:4096
ds_read_b64_tr_b16 v[214:215], v16 offset:6144
s_add_u32 s47, s42, s44
s_mov_b32 m0, s47
s_nop 0
buffer_load_dwordx4 v24, s[4:7], s40 offen lds
v_mfma_f32_32x32x16_bf16 v[144:159], v[196:199], v[208:211], v[144:159]
ds_read_b64_tr_b16 v[216:217], v17 offset:4096
ds_read_b64_tr_b16 v[218:219], v17 offset:6144
ds_read_b64_tr_b16 v[220:221], v18 offset:4096
buffer_load_dwordx4 v25, s[4:7], s40 offen offset:1024 lds
v_mfma_f32_32x32x16_bf16 v[160:175], v[200:203], v[208:211], v[160:175]
ds_read_b64_tr_b16 v[222:223], v18 offset:6144
ds_read_b64_tr_b16 v[224:225], v19 offset:4096
ds_read_b64_tr_b16 v[226:227], v19 offset:6144
v_mfma_f32_32x32x16_bf16 v[176:191], v[204:207], v[208:211], v[176:191]
buffer_load_dwordx4 v26, s[4:7], s40 offen offset:2048 lds
s_waitcnt lgkmcnt(0)
v_mfma_f32_32x32x16_bf16 v[128:143], v[212:215], v[228:231], v[128:143]
ds_read_b128 v[208:211], v22 offset:2048
ds_read_b64_tr_b16 v[192:193], v16 offset:8192
ds_read_b64_tr_b16 v[194:195], v16 offset:10240
buffer_load_dwordx4 v27, s[4:7], s40 offen offset:3072 lds
s_add_u32 s40, s40, 65536
v_mfma_f32_32x32x16_bf16 v[144:159], v[216:219], v[228:231], v[144:159]
ds_read_b64_tr_b16 v[196:197], v17 offset:8192
ds_read_b64_tr_b16 v[198:199], v17 offset:10240
ds_read_b64_tr_b16 v[200:201], v18 offset:8192
v_mfma_f32_32x32x16_bf16 v[160:175], v[220:223], v[228:231], v[160:175]
ds_read_b64_tr_b16 v[202:203], v18 offset:10240
ds_read_b64_tr_b16 v[204:205], v19 offset:8192
ds_read_b64_tr_b16 v[206:207], v19 offset:10240
s_add_u32 m0, s47, 16384
s_nop 0
buffer_load_dwordx4 v2, s[12:15], s41 offen lds
v_mfma_f32_32x32x16_bf16 v[176:191], v[224:227], v[228:231], v[176:191]
buffer_load_dwordx4 v2, s[12:15], s41 offen offset:1024 lds
s_waitcnt lgkmcnt(0)
v_mfma_f32_32x32x16_bf16 v[128:143], v[192:195], v[208:211], v[128:143]
ds_read_b128 v[228:231], v22 offset:3072
ds_read_b64_tr_b16 v[212:213], v16 offset:12288
ds_read_b64_tr_b16 v[214:215], v16 offset:14336
v_mfma_f32_32x32x16_bf16 v[144:159], v[196:199], v[208:211], v[144:159]
ds_read_b64_tr_b16 v[216:217], v17 offset:12288
ds_read_b64_tr_b16 v[218:219], v17 offset:14336
ds_read_b64_tr_b16 v[220:221], v18 offset:12288
buffer_load_dwordx4 v2, s[12:15], s41 offen offset:2048 lds
v_mfma_f32_32x32x16_bf16 v[160:175], v[200:203], v[208:211], v[160:175]
ds_read_b64_tr_b16 v[222:223], v18 offset:14336
ds_read_b64_tr_b16 v[224:225], v19 offset:12288
ds_read_b64_tr_b16 v[226:227], v19 offset:14336
buffer_load_dwordx4 v2, s[12:15], s41 offen offset:3072 lds
s_add_u32 s41, s41, 4096
s_add_u32 s42, s42, 32768
s_cmp_ge_u32 s42, 131072
s_cselect_b32 s42, 0, s42
v_mfma_f32_32x32x16_bf16 v[176:191], v[204:207], v[208:211], v[176:191]
s_waitcnt lgkmcnt(0)
s_waitcnt vmcnt(16)
s_barrier
v_mfma_f32_32x32x16_bf16 v[128:143], v[212:215], v[228:231], v[128:143]
s_add_u32 s46, s44, 16384
s_add_u32 s46, s46, s43
v_add_u32 v22, s46, v2
v_add_u32 v16, s43, v8
v_add_u32 v17, s43, v9
v_add_u32 v18, s43, v10
v_add_u32 v19, s43, v11
v_add_u32 v20, s43, v12
v_add_u32 v21, s43, v2
s_add_u32 s43, s43, 32768
s_cmp_ge_u32 s43, 131072
s_cselect_b32 s43, 0, s43
ds_read_b128 v[208:211], v22 offset:0
ds_read_b64_tr_b16 v[192:193], v16 offset:0
ds_read_b64_tr_b16 v[194:195], v16 offset:2048
v_mfma_f32_32x32x16_bf16 v[144:159], v[216:219], v[228:231], v[144:159]
ds_read_b64_tr_b16 v[196:197], v17 offset:0
ds_read_b64_tr_b16 v[198:199], v17 offset:2048
ds_read_b64_tr_b16 v[200:201], v18 offset:0
v_mfma_f32_32x32x16_bf16 v[160:175], v[220:223], v[228:231], v[160:175]
ds_read_b64_tr_b16 v[202:203], v18 offset:2048
ds_read_b64_tr_b16 v[204:205], v19 offset:0
ds_read_b64_tr_b16 v[206:207], v19 offset:2048
v_mfma_f32_32x32x16_bf16 v[176:191], v[224:227], v[228:231], v[176:191]
s_waitcnt lgkmcnt(0)
v_mfma_f32_32x32x16_bf16 v[128:143], v[192:195], v[208:211], v[128:143]
ds_read_b128 v[228:231], v22 offset:1024
ds_read_b64_tr_b16 v[212:213], v16 offset:4096
ds_read_b64_tr_b16 v[214:215], v16 offset:6144
s_add_u32 s47, s42, s44
s_mov_b32 m0, s47
s_nop 0
buffer_load_dwordx4 v24, s[4:7], s40 offen lds
v_mfma_f32_32x32x16_bf16 v[144:159], v[196:199], v[208:211], v[144:159]
ds_read_b64_tr_b16 v[216:217], v17 offset:4096
ds_read_b64_tr_b16 v[218:219], v17 offset:6144
ds_read_b64_tr_b16 v[220:221], v18 offset:4096
buffer_load_dwordx4 v25, s[4:7], s40 offen offset:1024 lds
v_mfma_f32_32x32x16_bf16 v[160:175], v[200:203], v[208:211], v[160:175]
ds_read_b64_tr_b16 v[222:223], v18 offset:6144
ds_read_b64_tr_b16 v[224:225], v19 offset:4096
ds_read_b64_tr_b16 v[226:227], v19 offset:6144
v_mfma_f32_32x32x16_bf16 v[176:191], v[204:207], v[208:211], v[176:191]
buffer_load_dwordx4 v26, s[4:7], s40 offen offset:2048 lds
s_waitcnt lgkmcnt(0)
v_mfma_f32_32x32x16_bf16 v[128:143], v[212:215], v[228:231], v[128:143]
ds_read_b128 v[208:211], v22 offset:2048
ds_read_b64_tr_b16 v[192:193], v16 offset:8192
ds_read_b64_tr_b16 v[194:195], v16 offset:10240
buffer_load_dwordx4 v27, s[4:7], s40 offen offset:3072 lds
s_add_u32 s40, s40, 65536
v_mfma_f32_32x32x16_bf16 v[144:159], v[216:219], v[228:231], v[144:159]
ds_read_b64_tr_b16 v[196:197], v17 offset:8192
ds_read_b64_tr_b16 v[198:199], v17 offset:10240
ds_read_b64_tr_b16 v[200:201], v18 offset:8192
v_mfma_f32_32x32x16_bf16 v[160:175], v[220:223], v[228:231], v[160:175]
ds_read_b64_tr_b16 v[202:203], v18 offset:10240
ds_read_b64_tr_b16 v[204:205], v19 offset:8192
ds_read_b64_tr_b16 v[206:207], v19 offset:10240
s_add_u32 m0, s47, 16384
s_nop 0
buffer_load_dwordx4 v2, s[12:15], s41 offen lds
v_mfma_f32_32x32x16_bf16 v[176:191], v[224:227], v[228:231], v[176:191]
buffer_load_dwordx4 v2, s[12:15], s41 offen offset:1024 lds
s_waitcnt lgkmcnt(0)
v_mfma_f32_32x32x16_bf16 v[128:143], v[192:195], v[208:211], v[128:143]
ds_read_b128 v[228:231], v22 offset:3072
ds_read_b64_tr_b16 v[212:213], v16 offset:12288
ds_read_b64_tr_b16 v[214:215], v16 offset:14336
v_mfma_f32_32x32x16_bf16 v[144:159], v[196:199], v[208:211], v[144:159]
ds_read_b64_tr_b16 v[216:217], v17 offset:12288
ds_read_b64_tr_b16 v[218:219], v17 offset:14336
ds_read_b64_tr_b16 v[220:221], v18 offset:12288
buffer_load_dwordx4 v2, s[12:15], s41 offen offset:2048 lds
v_mfma_f32_32x32x16_bf16 v[160:175], v[200:203], v[208:211], v[160:175]
ds_read_b64_tr_b16 v[222:223], v18 offset:14336
ds_read_b64_tr_b16 v[224:225], v19 offset:12288
ds_read_b64_tr_b16 v[226:227], v19 offset:14336
buffer_load_dwordx4 v2, s[12:15], s41 offen offset:3072 lds
s_add_u32 s41, s41, 4096
s_add_u32 s42, s42, 32768
s_cmp_ge_u32 s42, 131072
s_cselect_b32 s42, 0, s42
v_mfma_f32_32x32x16_bf16 v[176:191], v[204:207], v[208:211], v[176:191]
s_waitcnt lgkmcnt(0)
s_waitcnt vmcnt(16)
s_barrier
v_mfma_f32_32x32x16_bf16 v[128:143], v[212:215], v[228:231], v[128:143]
s_add_u32 s46, s44, 16384
s_add_u32 s46, s46, s43
v_add_u32 v22, s46, v2
v_add_u32 v16, s43, v8
v_add_u32 v17, s43, v9
v_add_u32 v18, s43, v10
v_add_u32 v19, s43, v11
v_add_u32 v20, s43, v12
v_add_u32 v21, s43, v2
s_add_u32 s43, s43, 32768
s_cmp_ge_u32 s43, 131072
s_cselect_b32 s43, 0, s43
ds_read_b128 v[208:211], v22 offset:0
ds_read_b64_tr_b16 v[192:193], v16 offset:0
ds_read_b64_tr_b16 v[194:195], v16 offset:2048
v_mfma_f32_32x32x16_bf16 v[144:159], v[216:219], v[228:231], v[144:159]
ds_read_b64_tr_b16 v[196:197], v17 offset:0
ds_read_b64_tr_b16 v[198:199], v17 offset:2048
ds_read_b64_tr_b16 v[200:201], v18 offset:0
v_mfma_f32_32x32x16_bf16 v[160:175], v[220:223], v[228:231], v[160:175]
ds_read_b64_tr_b16 v[202:203], v18 offset:2048
ds_read_b64_tr_b16 v[204:205], v19 offset:0
ds_read_b64_tr_b16 v[206:207], v19 offset:2048
v_mfma_f32_32x32x16_bf16 v[176:191], v[224:227], v[228:231], v[176:191]
s_waitcnt lgkmcnt(0)
v_mfma_f32_32x32x16_bf16 v[128:143], v[192:195], v[208:211], v[128:143]
ds_read_b128 v[228:231], v22 offset:1024
ds_read_b64_tr_b16 v[212:213], v16 offset:4096
ds_read_b64_tr_b16 v[214:215], v16 offset:6144
s_add_u32 s47, s42, s44
s_mov_b32 m0, s47
s_nop 0
buffer_load_dwordx4 v24, s[4:7], s40 offen lds
v_mfma_f32_32x32x16_bf16 v[144:159], v[196:199], v[208:211], v[144:159]
ds_read_b64_tr_b16 v[216:217], v17 offset:4096
ds_read_b64_tr_b16 v[218:219], v17 offset:6144
ds_read_b64_tr_b16 v[220:221], v18 offset:4096
buffer_load_dwordx4 v25, s[4:7], s40 offen offset:1024 lds
v_mfma_f32_32x32x16_bf16 v[160:175], v[200:203], v[208:211], v[160:175]
ds_read_b64_tr_b16 v[222:223], v18 offset:6144
ds_read_b64_tr_b16 v[224:225], v19 offset:4096
ds_read_b64_tr_b16 v[226:227], v19 offset:6144
v_mfma_f32_32x32x16_bf16 v[176:191], v[204:207], v[208:211], v[176:191]
buffer_load_dwordx4 v26, s[4:7], s40 offen offset:2048 lds
s_waitcnt lgkmcnt(0)
v_mfma_f32_32x32x16_bf16 v[128:143], v[212:215], v[228:231], v[128:143]
ds_read_b128 v[208:211], v22 offset:2048
ds_read_b64_tr_b16 v[192:193], v16 offset:8192
ds_read_b64_tr_b16 v[194:195], v16 offset:10240
buffer_load_dwordx4 v27, s[4:7], s40 offen offset:3072 lds
s_add_u32 s40, s40, 65536
v_mfma_f32_32x32x16_bf16 v[144:159], v[216:219], v[228:231], v[144:159]
ds_read_b64_tr_b16 v[196:197], v17 offset:8192
ds_read_b64_tr_b16 v[198:199], v17 offset:10240
ds_read_b64_tr_b16 v[200:201], v18 offset:8192
v_mfma_f32_32x32x16_bf16 v[160:175], v[220:223], v[228:231], v[160:175]
ds_read_b64_tr_b16 v[202:203], v18 offset:10240
ds_read_b64_tr_b16 v[204:205], v19 offset:8192
ds_read_b64_tr_b16 v[206:207], v19 offset:10240
s_add_u32 m0, s47, 16384
s_nop 0
buffer_load_dwordx4 v2, s[12:15], s41 offen lds
v_mfma_f32_32x32x16_bf16 v[176:191], v[224:227], v[228:231], v[176:191]
buffer_load_dwordx4 v2, s[12:15], s41 offen offset:1024 lds
s_waitcnt lgkmcnt(0)
v_mfma_f32_32x32x16_bf16 v[128:143], v[192:195], v[208:211], v[128:143]
ds_read_b128 v[228:231], v22 offset:3072
ds_read_b64_tr_b16 v[212:213], v16 offset:12288
ds_read_b64_tr_b16 v[214:215], v16 offset:14336
v_mfma_f32_32x32x16_bf16 v[144:159], v[196:199], v[208:211], v[144:159]
ds_read_b64_tr_b16 v[216:217], v17 offset:12288
ds_read_b64_tr_b16 v[218:219], v17 offset:14336
ds_read_b64_tr_b16 v[220:221], v18 offset:12288
buffer_load_dwordx4 v2, s[12:15], s41 offen offset:2048 lds
v_mfma_f32_32x32x16_bf16 v[160:175], v[200:203], v[208:211], v[160:175]
ds_read_b64_tr_b16 v[222:223], v18 offset:14336
ds_read_b64_tr_b16 v[224:225], v19 offset:12288
ds_read_b64_tr_b16 v[226:227], v19 offset:14336
buffer_load_dwordx4 v2, s[12:15], s41 offen offset:3072 lds
s_add_u32 s41, s41, 4096
s_add_u32 s42, s42, 32768
s_cmp_ge_u32 s42, 131072
s_cselect_b32 s42, 0, s42
v_mfma_f32_32x32x16_bf16 v[176:191], v[204:207], v[208:211], v[176:191]
s_waitcnt lgkmcnt(0)
s_waitcnt vmcnt(16)
s_barrier
v_mfma_f32_32x32x16_bf16 v[128:143], v[212:215], v[228:231], v[128:143]
s_add_u32 s46, s44, 16384
s_add_u32 s46, s46, s43
v_add_u32 v22, s46, v2
v_add_u32 v16, s43, v8
v_add_u32 v17, s43, v9
v_add_u32 v18, s43, v10
v_add_u32 v19, s43, v11
v_add_u32 v20, s43, v12
v_add_u32 v21, s43, v2
s_add_u32 s43, s43, 32768
s_cmp_ge_u32 s43, 131072
s_cselect_b32 s43, 0, s43
ds_read_b128 v[208:211], v22 offset:0
ds_read_b64_tr_b16 v[192:193], v16 offset:0
ds_read_b64_tr_b16 v[194:195], v16 offset:2048
v_mfma_f32_32x32x16_bf16 v[144:159], v[216:219], v[228:231], v[144:159]
ds_read_b64_tr_b16 v[196:197], v17 offset:0
ds_read_b64_tr_b16 v[198:199], v17 offset:2048
ds_read_b64_tr_b16 v[200:201], v18 offset:0
v_mfma_f32_32x32x16_bf16 v[160:175], v[220:223], v[228:231], v[160:175]
ds_read_b64_tr_b16 v[202:203], v18 offset:2048
ds_read_b64_tr_b16 v[204:205], v19 offset:0
ds_read_b64_tr_b16 v[206:207], v19 offset:2048
v_mfma_f32_32x32x16_bf16 v[176:191], v[224:227], v[228:231], v[176:191]
buffer_load_dword v44, v45, s[56:59], 0 offen sc1
s_waitcnt lgkmcnt(0)
v_mfma_f32_32x32x16_bf16 v[128:143], v[192:195], v[208:211], v[128:143]
ds_read_b128 v[228:231], v22 offset:1024
ds_read_b64_tr_b16 v[212:213], v16 offset:4096
ds_read_b64_tr_b16 v[214:215], v16 offset:6144
s_add_u32 s47, s42, s44
s_mov_b32 m0, s47
s_nop 0
buffer_load_dwordx4 v24, s[4:7], s40 offen lds
v_mfma_f32_32x32x16_bf16 v[144:159], v[196:199], v[208:211], v[144:159]
ds_read_b64_tr_b16 v[216:217], v17 offset:4096
ds_read_b64_tr_b16 v[218:219], v17 offset:6144
ds_read_b64_tr_b16 v[220:221], v18 offset:4096
buffer_load_dwordx4 v25, s[4:7], s40 offen offset:1024 lds
v_mfma_f32_32x32x16_bf16 v[160:175], v[200:203], v[208:211], v[160:175]
ds_read_b64_tr_b16 v[222:223], v18 offset:6144
ds_read_b64_tr_b16 v[224:225], v19 offset:4096
ds_read_b64_tr_b16 v[226:227], v19 offset:6144
v_mfma_f32_32x32x16_bf16 v[176:191], v[204:207], v[208:211], v[176:191]
buffer_load_dwordx4 v26, s[4:7], s40 offen offset:2048 lds
s_waitcnt lgkmcnt(0)
v_mfma_f32_32x32x16_bf16 v[128:143], v[212:215], v[228:231], v[128:143]
ds_read_b128 v[208:211], v22 offset:2048
ds_read_b64_tr_b16 v[192:193], v16 offset:8192
ds_read_b64_tr_b16 v[194:195], v16 offset:10240
buffer_load_dwordx4 v27, s[4:7], s40 offen offset:3072 lds
s_add_u32 s40, s40, 65536
v_mfma_f32_32x32x16_bf16 v[144:159], v[216:219], v[228:231], v[144:159]
ds_read_b64_tr_b16 v[196:197], v17 offset:8192
ds_read_b64_tr_b16 v[198:199], v17 offset:10240
ds_read_b64_tr_b16 v[200:201], v18 offset:8192
v_mfma_f32_32x32x16_bf16 v[160:175], v[220:223], v[228:231], v[160:175]
ds_read_b64_tr_b16 v[202:203], v18 offset:10240
ds_read_b64_tr_b16 v[204:205], v19 offset:8192
ds_read_b64_tr_b16 v[206:207], v19 offset:10240
s_add_u32 m0, s47, 16384
s_nop 0
buffer_load_dwordx4 v2, s[12:15], s41 offen lds
v_mfma_f32_32x32x16_bf16 v[176:191], v[224:227], v[228:231], v[176:191]
buffer_load_dwordx4 v2, s[12:15], s41 offen offset:1024 lds
s_waitcnt lgkmcnt(0)
v_mfma_f32_32x32x16_bf16 v[128:143], v[192:195], v[208:211], v[128:143]
ds_read_b128 v[228:231], v22 offset:3072
ds_read_b64_tr_b16 v[212:213], v16 offset:12288
ds_read_b64_tr_b16 v[214:215], v16 offset:14336
v_mfma_f32_32x32x16_bf16 v[144:159], v[196:199], v[208:211], v[144:159]
ds_read_b64_tr_b16 v[216:217], v17 offset:12288
ds_read_b64_tr_b16 v[218:219], v17 offset:14336
ds_read_b64_tr_b16 v[220:221], v18 offset:12288
buffer_load_dwordx4 v2, s[12:15], s41 offen offset:2048 lds
v_mfma_f32_32x32x16_bf16 v[160:175], v[200:203], v[208:211], v[160:175]
ds_read_b64_tr_b16 v[222:223], v18 offset:14336
ds_read_b64_tr_b16 v[224:225], v19 offset:12288
ds_read_b64_tr_b16 v[226:227], v19 offset:14336
buffer_load_dwordx4 v2, s[12:15], s41 offen offset:3072 lds
s_add_u32 s41, s41, 4096
s_add_u32 s42, s42, 32768
s_cmp_ge_u32 s42, 131072
s_cselect_b32 s42, 0, s42
v_mfma_f32_32x32x16_bf16 v[176:191], v[204:207], v[208:211], v[176:191]
s_waitcnt lgkmcnt(0)
s_waitcnt vmcnt(17)
s_barrier
v_mfma_f32_32x32x16_bf16 v[128:143], v[212:215], v[228:231], v[128:143]
s_add_u32 s46, s44, 16384
s_add_u32 s46, s46, s43
v_add_u32 v22, s46, v2
v_add_u32 v16, s43, v8
v_add_u32 v17, s43, v9
v_add_u32 v18, s43, v10
v_add_u32 v19, s43, v11
v_add_u32 v20, s43, v12
v_add_u32 v21, s43, v2
s_add_u32 s43, s43, 32768
s_cmp_ge_u32 s43, 131072
s_cselect_b32 s43, 0, s43
ds_read_b128 v[208:211], v22 offset:0
ds_read_b64_tr_b16 v[192:193], v16 offset:0
ds_read_b64_tr_b16 v[194:195], v16 offset:2048
v_mfma_f32_32x32x16_bf16 v[144:159], v[216:219], v[228:231], v[144:159]
ds_read_b64_tr_b16 v[196:197], v17 offset:0
ds_read_b64_tr_b16 v[198:199], v17 offset:2048
ds_read_b64_tr_b16 v[200:201], v18 offset:0
v_mfma_f32_32x32x16_bf16 v[160:175], v[220:223], v[228:231], v[160:175]
ds_read_b64_tr_b16 v[202:203], v18 offset:2048
ds_read_b64_tr_b16 v[204:205], v19 offset:0
ds_read_b64_tr_b16 v[206:207], v19 offset:2048
v_mfma_f32_32x32x16_bf16 v[176:191], v[224:227], v[228:231], v[176:191]
s_waitcnt lgkmcnt(0)
v_mfma_f32_32x32x16_bf16 v[128:143], v[192:195], v[208:211], v[128:143]
ds_read_b128 v[228:231], v22 offset:1024
ds_read_b64_tr_b16 v[212:213], v16 offset:4096
ds_read_b64_tr_b16 v[214:215], v16 offset:6144
s_add_u32 s47, s42, s44
s_mov_b32 m0, s47
s_nop 0
buffer_load_dwordx4 v24, s[4:7], s40 offen lds
v_mfma_f32_32x32x16_bf16 v[144:159], v[196:199], v[208:211], v[144:159]
ds_read_b64_tr_b16 v[216:217], v17 offset:4096
ds_read_b64_tr_b16 v[218:219], v17 offset:6144
ds_read_b64_tr_b16 v[220:221], v18 offset:4096
buffer_load_dwordx4 v25, s[4:7], s40 offen offset:1024 lds
v_mfma_f32_32x32x16_bf16 v[160:175], v[200:203], v[208:211], v[160:175]
ds_read_b64_tr_b16 v[222:223], v18 offset:6144
ds_read_b64_tr_b16 v[224:225], v19 offset:4096
ds_read_b64_tr_b16 v[226:227], v19 offset:6144
v_mfma_f32_32x32x16_bf16 v[176:191], v[204:207], v[208:211], v[176:191]
buffer_load_dwordx4 v26, s[4:7], s40 offen offset:2048 lds
s_waitcnt lgkmcnt(0)
v_mfma_f32_32x32x16_bf16 v[128:143], v[212:215], v[228:231], v[128:143]
ds_read_b128 v[208:211], v22 offset:2048
ds_read_b64_tr_b16 v[192:193], v16 offset:8192
ds_read_b64_tr_b16 v[194:195], v16 offset:10240
buffer_load_dwordx4 v27, s[4:7], s40 offen offset:3072 lds
s_add_u32 s40, s40, 65536
v_mfma_f32_32x32x16_bf16 v[144:159], v[216:219], v[228:231], v[144:159]
ds_read_b64_tr_b16 v[196:197], v17 offset:8192
ds_read_b64_tr_b16 v[198:199], v17 offset:10240
ds_read_b64_tr_b16 v[200:201], v18 offset:8192
v_mfma_f32_32x32x16_bf16 v[160:175], v[220:223], v[228:231], v[160:175]
ds_read_b64_tr_b16 v[202:203], v18 offset:10240
ds_read_b64_tr_b16 v[204:205], v19 offset:8192
ds_read_b64_tr_b16 v[206:207], v19 offset:10240
s_add_u32 m0, s47, 16384
s_nop 0
buffer_load_dwordx4 v2, s[12:15], s41 offen lds
v_mfma_f32_32x32x16_bf16 v[176:191], v[224:227], v[228:231], v[176:191]
buffer_load_dwordx4 v2, s[12:15], s41 offen offset:1024 lds
s_waitcnt lgkmcnt(0)
v_mfma_f32_32x32x16_bf16 v[128:143], v[192:195], v[208:211], v[128:143]
ds_read_b128 v[228:231], v22 offset:3072
ds_read_b64_tr_b16 v[212:213], v16 offset:12288
ds_read_b64_tr_b16 v[214:215], v16 offset:14336
v_mfma_f32_32x32x16_bf16 v[144:159], v[196:199], v[208:211], v[144:159]
ds_read_b64_tr_b16 v[216:217], v17 offset:12288
ds_read_b64_tr_b16 v[218:219], v17 offset:14336
ds_read_b64_tr_b16 v[220:221], v18 offset:12288
buffer_load_dwordx4 v2, s[12:15], s41 offen offset:2048 lds
v_mfma_f32_32x32x16_bf16 v[160:175], v[200:203], v[208:211], v[160:175]
ds_read_b64_tr_b16 v[222:223], v18 offset:14336
ds_read_b64_tr_b16 v[224:225], v19 offset:12288
ds_read_b64_tr_b16 v[226:227], v19 offset:14336
buffer_load_dwordx4 v2, s[12:15], s41 offen offset:3072 lds
s_add_u32 s41, s41, 4096
s_add_u32 s42, s42, 32768
s_cmp_ge_u32 s42, 131072
s_cselect_b32 s42, 0, s42
v_mfma_f32_32x32x16_bf16 v[176:191], v[204:207], v[208:211], v[176:191]
s_waitcnt lgkmcnt(0)
s_waitcnt vmcnt(17)
s_barrier
v_mfma_f32_32x32x16_bf16 v[128:143], v[212:215], v[228:231], v[128:143]
s_add_u32 s46, s44, 16384
s_add_u32 s46, s46, s43
v_add_u32 v22, s46, v2
v_add_u32 v16, s43, v8
v_add_u32 v17, s43, v9
v_add_u32 v18, s43, v10
v_add_u32 v19, s43, v11
v_add_u32 v20, s43, v12
v_add_u32 v21, s43, v2
s_add_u32 s43, s43, 32768
s_cmp_ge_u32 s43, 131072
s_cselect_b32 s43, 0, s43
ds_read_b128 v[208:211], v22 offset:0
ds_read_b64_tr_b16 v[192:193], v16 offset:0
ds_read_b64_tr_b16 v[194:195], v16 offset:2048
v_mfma_f32_32x32x16_bf16 v[144:159], v[216:219], v[228:231], v[144:159]
ds_read_b64_tr_b16 v[196:197], v17 offset:0
ds_read_b64_tr_b16 v[198:199], v17 offset:2048
ds_read_b64_tr_b16 v[200:201], v18 offset:0
v_mfma_f32_32x32x16_bf16 v[160:175], v[220:223], v[228:231], v[160:175]
ds_read_b64_tr_b16 v[202:203], v18 offset:2048
ds_read_b64_tr_b16 v[204:205], v19 offset:0
ds_read_b64_tr_b16 v[206:207], v19 offset:2048
v_mfma_f32_32x32x16_bf16 v[176:191], v[224:227], v[228:231], v[176:191]
s_waitcnt lgkmcnt(0)
v_mfma_f32_32x32x16_bf16 v[128:143], v[192:195], v[208:211], v[128:143]
ds_read_b128 v[228:231], v22 offset:1024
ds_read_b64_tr_b16 v[212:213], v16 offset:4096
ds_read_b64_tr_b16 v[214:215], v16 offset:6144
s_add_u32 s47, s42, s44
s_mov_b32 m0, s47
s_nop 0
buffer_load_dwordx4 v24, s[4:7], s40 offen lds
v_mfma_f32_32x32x16_bf16 v[144:159], v[196:199], v[208:211], v[144:159]
ds_read_b64_tr_b16 v[216:217], v17 offset:4096
ds_read_b64_tr_b16 v[218:219], v17 offset:6144
ds_read_b64_tr_b16 v[220:221], v18 offset:4096
buffer_load_dwordx4 v25, s[4:7], s40 offen offset:1024 lds
v_mfma_f32_32x32x16_bf16 v[160:175], v[200:203], v[208:211], v[160:175]
ds_read_b64_tr_b16 v[222:223], v18 offset:6144
ds_read_b64_tr_b16 v[224:225], v19 offset:4096
ds_read_b64_tr_b16 v[226:227], v19 offset:6144
v_mfma_f32_32x32x16_bf16 v[176:191], v[204:207], v[208:211], v[176:191]
buffer_load_dwordx4 v26, s[4:7], s40 offen offset:2048 lds
s_waitcnt lgkmcnt(0)
v_mfma_f32_32x32x16_bf16 v[128:143], v[212:215], v[228:231], v[128:143]
ds_read_b128 v[208:211], v22 offset:2048
ds_read_b64_tr_b16 v[192:193], v16 offset:8192
ds_read_b64_tr_b16 v[194:195], v16 offset:10240
buffer_load_dwordx4 v27, s[4:7], s40 offen offset:3072 lds
s_add_u32 s40, s40, 65536
v_mfma_f32_32x32x16_bf16 v[144:159], v[216:219], v[228:231], v[144:159]
ds_read_b64_tr_b16 v[196:197], v17 offset:8192
ds_read_b64_tr_b16 v[198:199], v17 offset:10240
ds_read_b64_tr_b16 v[200:201], v18 offset:8192
v_mfma_f32_32x32x16_bf16 v[160:175], v[220:223], v[228:231], v[160:175]
ds_read_b64_tr_b16 v[202:203], v18 offset:10240
ds_read_b64_tr_b16 v[204:205], v19 offset:8192
ds_read_b64_tr_b16 v[206:207], v19 offset:10240
s_add_u32 m0, s47, 16384
s_nop 0
buffer_load_dwordx4 v2, s[12:15], s41 offen lds
v_mfma_f32_32x32x16_bf16 v[176:191], v[224:227], v[228:231], v[176:191]
buffer_load_dwordx4 v2, s[12:15], s41 offen offset:1024 lds
s_waitcnt lgkmcnt(0)
v_mfma_f32_32x32x16_bf16 v[128:143], v[192:195], v[208:211], v[128:143]
ds_read_b128 v[228:231], v22 offset:3072
ds_read_b64_tr_b16 v[212:213], v16 offset:12288
ds_read_b64_tr_b16 v[214:215], v16 offset:14336
v_mfma_f32_32x32x16_bf16 v[144:159], v[196:199], v[208:211], v[144:159]
ds_read_b64_tr_b16 v[216:217], v17 offset:12288
ds_read_b64_tr_b16 v[218:219], v17 offset:14336
ds_read_b64_tr_b16 v[220:221], v18 offset:12288
buffer_load_dwordx4 v2, s[12:15], s41 offen offset:2048 lds
v_mfma_f32_32x32x16_bf16 v[160:175], v[200:203], v[208:211], v[160:175]
ds_read_b64_tr_b16 v[222:223], v18 offset:14336
ds_read_b64_tr_b16 v[224:225], v19 offset:12288
ds_read_b64_tr_b16 v[226:227], v19 offset:14336
buffer_load_dwordx4 v2, s[12:15], s41 offen offset:3072 lds
s_add_u32 s41, s41, 4096
s_add_u32 s42, s42, 32768
s_cmp_ge_u32 s42, 131072
s_cselect_b32 s42, 0, s42
v_mfma_f32_32x32x16_bf16 v[176:191], v[204:207], v[208:211], v[176:191]
s_waitcnt lgkmcnt(0)
s_waitcnt vmcnt(16)
s_barrier
v_mfma_f32_32x32x16_bf16 v[128:143], v[212:215], v[228:231], v[128:143]
s_add_u32 s46, s44, 16384
s_add_u32 s46, s46, s43
v_add_u32 v22, s46, v2
v_add_u32 v16, s43, v8
v_add_u32 v17, s43, v9
v_add_u32 v18, s43, v10
v_add_u32 v19, s43, v11
v_add_u32 v20, s43, v12
v_add_u32 v21, s43, v2
s_add_u32 s43, s43, 32768
s_cmp_ge_u32 s43, 131072
s_cselect_b32 s43, 0, s43
ds_read_b128 v[208:211], v22 offset:0
ds_read_b64_tr_b16 v[192:193], v16 offset:0
ds_read_b64_tr_b16 v[194:195], v16 offset:2048
v_mfma_f32_32x32x16_bf16 v[144:159], v[216:219], v[228:231], v[144:159]
ds_read_b64_tr_b16 v[196:197], v17 offset:0
ds_read_b64_tr_b16 v[198:199], v17 offset:2048
ds_read_b64_tr_b16 v[200:201], v18 offset:0
v_mfma_f32_32x32x16_bf16 v[160:175], v[220:223], v[228:231], v[160:175]
ds_read_b64_tr_b16 v[202:203], v18 offset:2048
ds_read_b64_tr_b16 v[204:205], v19 offset:0
ds_read_b64_tr_b16 v[206:207], v19 offset:2048
v_mfma_f32_32x32x16_bf16 v[176:191], v[224:227], v[228:231], v[176:191]
s_mov_b32 s49, 0
attn_fin_upoll:
v_cmp_ne_u32 vcc, 1, v44
s_nop 3
s_and_b32 s50, vcc_lo, 0x7fff00
s_cmp_eq_u32 s50, 0
s_cbranch_scc1 attn_fin_upolled
s_add_u32 s49, s49, 1
s_cmp_ge_u32 s49, 0x20000
s_cbranch_scc1 attn_fin_upolled
buffer_load_dword v44, v45, s[56:59], 0 offen sc1
s_waitcnt vmcnt(0)
s_branch attn_fin_upoll
attn_fin_upolled:
s_waitcnt lgkmcnt(0)
v_mfma_f32_32x32x16_bf16 v[128:143], v[192:195], v[208:211], v[128:143]
ds_read_b128 v[228:231], v22 offset:1024
ds_read_b64_tr_b16 v[212:213], v16 offset:4096
ds_read_b64_tr_b16 v[214:215], v16 offset:6144
s_mul_i32 s40, s23, 1835008
s_lshl_b32 s45, s20, 16
s_add_u32 s40, s40, s45
s_lshl_b32 s45, s21, 8
s_add_u32 s40, s40, s45
s_lshl_b32 s45, s22, 2
s_add_u32 s45, s45, s20
s_mul_i32 s41, s45, 114688
s_mul_i32 s45, s23, 28672
s_add_u32 s41, s41, s45
s_add_u32 s47, s42, s44
s_mov_b32 m0, s47
s_nop 0
buffer_load_dwordx4 v28, s[8:11], s40 offen lds
v_mfma_f32_32x32x16_bf16 v[144:159], v[196:199], v[208:211], v[144:159]
ds_read_b64_tr_b16 v[216:217], v17 offset:4096
ds_read_b64_tr_b16 v[218:219], v17 offset:6144
ds_read_b64_tr_b16 v[220:221], v18 offset:4096
buffer_load_dwordx4 v29, s[8:11], s40 offen offset:1024 lds
v_mfma_f32_32x32x16_bf16 v[160:175], v[200:203], v[208:211], v[160:175]
ds_read_b64_tr_b16 v[222:223], v18 offset:6144
ds_read_b64_tr_b16 v[224:225], v19 offset:4096
ds_read_b64_tr_b16 v[226:227], v19 offset:6144
v_mfma_f32_32x32x16_bf16 v[176:191], v[204:207], v[208:211], v[176:191]
buffer_load_dwordx4 v30, s[8:11], s40 offen offset:2048 lds
s_waitcnt lgkmcnt(0)
v_mfma_f32_32x32x16_bf16 v[128:143], v[212:215], v[228:231], v[128:143]
ds_read_b128 v[208:211], v22 offset:2048
ds_read_b64_tr_b16 v[192:193], v16 offset:8192
ds_read_b64_tr_b16 v[194:195], v16 offset:10240
buffer_load_dwordx4 v31, s[8:11], s40 offen offset:3072 lds
s_add_u32 s40, s40, 262144
v_mfma_f32_32x32x16_bf16 v[144:159], v[216:219], v[228:231], v[144:159]
ds_read_b64_tr_b16 v[196:197], v17 offset:8192
ds_read_b64_tr_b16 v[198:199], v17 offset:10240
ds_read_b64_tr_b16 v[200:201], v18 offset:8192
v_mfma_f32_32x32x16_bf16 v[160:175], v[220:223], v[228:231], v[160:175]
ds_read_b64_tr_b16 v[202:203], v18 offset:10240
ds_read_b64_tr_b16 v[204:205], v19 offset:8192
ds_read_b64_tr_b16 v[206:207], v19 offset:10240
s_add_u32 m0, s47, 16384
s_nop 0
buffer_load_dwordx4 v2, s[16:19], s41 offen lds
v_mfma_f32_32x32x16_bf16 v[176:191], v[224:227], v[228:231], v[176:191]
buffer_load_dwordx4 v2, s[16:19], s41 offen offset:1024 lds
s_waitcnt lgkmcnt(0)
v_mfma_f32_32x32x16_bf16 v[128:143], v[192:195], v[208:211], v[128:143]
ds_read_b128 v[228:231], v22 offset:3072
ds_read_b64_tr_b16 v[212:213], v16 offset:12288
ds_read_b64_tr_b16 v[214:215], v16 offset:14336
v_mfma_f32_32x32x16_bf16 v[144:159], v[196:199], v[208:211], v[144:159]
ds_read_b64_tr_b16 v[216:217], v17 offset:12288
ds_read_b64_tr_b16 v[218:219], v17 offset:14336
ds_read_b64_tr_b16 v[220:221], v18 offset:12288
buffer_load_dwordx4 v2, s[16:19], s41 offen offset:2048 lds
v_mfma_f32_32x32x16_bf16 v[160:175], v[200:203], v[208:211], v[160:175]
ds_read_b64_tr_b16 v[222:223], v18 offset:14336
ds_read_b64_tr_b16 v[224:225], v19 offset:12288
ds_read_b64_tr_b16 v[226:227], v19 offset:14336
buffer_load_dwordx4 v2, s[16:19], s41 offen offset:3072 lds
s_add_u32 s41, s41, 4096
s_add_u32 s42, s42, 32768
s_cmp_ge_u32 s42, 131072
s_cselect_b32 s42, 0, s42
v_mfma_f32_32x32x16_bf16 v[176:191], v[204:207], v[208:211], v[176:191]
s_waitcnt lgkmcnt(0)
s_waitcnt vmcnt(16)
s_barrier
v_mfma_f32_32x32x16_bf16 v[128:143], v[212:215], v[228:231], v[128:143]
s_add_u32 s46, s44, 16384
s_add_u32 s46, s46, s43
v_add_u32 v22, s46, v2
v_add_u32 v16, s43, v8
v_add_u32 v17, s43, v9
v_add_u32 v18, s43, v10
v_add_u32 v19, s43, v11
v_add_u32 v20, s43, v12
v_add_u32 v21, s43, v2
s_add_u32 s43, s43, 32768
s_cmp_ge_u32 s43, 131072
s_cselect_b32 s43, 0, s43
ds_read_b128 v[208:211], v22 offset:0
ds_read_b64_tr_b16 v[192:193], v16 offset:0
ds_read_b64_tr_b16 v[194:195], v16 offset:2048
v_mfma_f32_32x32x16_bf16 v[144:159], v[216:219], v[228:231], v[144:159]
ds_read_b64_tr_b16 v[196:197], v17 offset:0
ds_read_b64_tr_b16 v[198:199], v17 offset:2048
ds_read_b64_tr_b16 v[200:201], v18 offset:0
v_mfma_f32_32x32x16_bf16 v[160:175], v[220:223], v[228:231], v[160:175]
ds_read_b64_tr_b16 v[202:203], v18 offset:2048
ds_read_b64_tr_b16 v[204:205], v19 offset:0
ds_read_b64_tr_b16 v[206:207], v19 offset:2048
v_mfma_f32_32x32x16_bf16 v[176:191], v[224:227], v[228:231], v[176:191]
s_waitcnt lgkmcnt(0)
v_mfma_f32_32x32x16_bf16 v[128:143], v[192:195], v[208:211], v[128:143]
ds_read_b128 v[228:231], v22 offset:1024
ds_read_b64_tr_b16 v[212:213], v16 offset:4096
ds_read_b64_tr_b16 v[214:215], v16 offset:6144
s_add_u32 s47, s42, s44
s_mov_b32 m0, s47
s_nop 0
buffer_load_dwordx4 v28, s[8:11], s40 offen lds
v_mfma_f32_32x32x16_bf16 v[144:159], v[196:199], v[208:211], v[144:159]
ds_read_b64_tr_b16 v[216:217], v17 offset:4096
ds_read_b64_tr_b16 v[218:219], v17 offset:6144
ds_read_b64_tr_b16 v[220:221], v18 offset:4096
buffer_load_dwordx4 v29, s[8:11], s40 offen offset:1024 lds
v_mfma_f32_32x32x16_bf16 v[160:175], v[200:203], v[208:211], v[160:175]
ds_read_b64_tr_b16 v[222:223], v18 offset:6144
ds_read_b64_tr_b16 v[224:225], v19 offset:4096
ds_read_b64_tr_b16 v[226:227], v19 offset:6144
v_mfma_f32_32x32x16_bf16 v[176:191], v[204:207], v[208:211], v[176:191]
buffer_load_dwordx4 v30, s[8:11], s40 offen offset:2048 lds
s_waitcnt lgkmcnt(0)
v_mfma_f32_32x32x16_bf16 v[128:143], v[212:215], v[228:231], v[128:143]
ds_read_b128 v[208:211], v22 offset:2048
ds_read_b64_tr_b16 v[192:193], v16 offset:8192
ds_read_b64_tr_b16 v[194:195], v16 offset:10240
buffer_load_dwordx4 v31, s[8:11], s40 offen offset:3072 lds
s_add_u32 s40, s40, 262144
v_mfma_f32_32x32x16_bf16 v[144:159], v[216:219], v[228:231], v[144:159]
ds_read_b64_tr_b16 v[196:197], v17 offset:8192
ds_read_b64_tr_b16 v[198:199], v17 offset:10240
ds_read_b64_tr_b16 v[200:201], v18 offset:8192
v_mfma_f32_32x32x16_bf16 v[160:175], v[220:223], v[228:231], v[160:175]
ds_read_b64_tr_b16 v[202:203], v18 offset:10240
ds_read_b64_tr_b16 v[204:205], v19 offset:8192
ds_read_b64_tr_b16 v[206:207], v19 offset:10240
s_add_u32 m0, s47, 16384
s_nop 0
buffer_load_dwordx4 v2, s[16:19], s41 offen lds
v_mfma_f32_32x32x16_bf16 v[176:191], v[224:227], v[228:231], v[176:191]
buffer_load_dwordx4 v2, s[16:19], s41 offen offset:1024 lds
s_waitcnt lgkmcnt(0)
v_mfma_f32_32x32x16_bf16 v[128:143], v[192:195], v[208:211], v[128:143]
ds_read_b128 v[228:231], v22 offset:3072
ds_read_b64_tr_b16 v[212:213], v16 offset:12288
ds_read_b64_tr_b16 v[214:215], v16 offset:14336
v_mfma_f32_32x32x16_bf16 v[144:159], v[196:199], v[208:211], v[144:159]
ds_read_b64_tr_b16 v[216:217], v17 offset:12288
ds_read_b64_tr_b16 v[218:219], v17 offset:14336
ds_read_b64_tr_b16 v[220:221], v18 offset:12288
buffer_load_dwordx4 v2, s[16:19], s41 offen offset:2048 lds
v_mfma_f32_32x32x16_bf16 v[160:175], v[200:203], v[208:211], v[160:175]
ds_read_b64_tr_b16 v[222:223], v18 offset:14336
ds_read_b64_tr_b16 v[224:225], v19 offset:12288
ds_read_b64_tr_b16 v[226:227], v19 offset:14336
buffer_load_dwordx4 v2, s[16:19], s41 offen offset:3072 lds
s_add_u32 s41, s41, 4096
s_add_u32 s42, s42, 32768
s_cmp_ge_u32 s42, 131072
s_cselect_b32 s42, 0, s42
v_mfma_f32_32x32x16_bf16 v[176:191], v[204:207], v[208:211], v[176:191]
s_waitcnt lgkmcnt(0)
s_waitcnt vmcnt(16)
s_barrier
v_mfma_f32_32x32x16_bf16 v[128:143], v[212:215], v[228:231], v[128:143]
s_add_u32 s46, s44, 16384
s_add_u32 s46, s46, s43
v_add_u32 v22, s46, v2
v_add_u32 v16, s43, v8
v_add_u32 v17, s43, v9
v_add_u32 v18, s43, v10
v_add_u32 v19, s43, v11
v_add_u32 v20, s43, v12
v_add_u32 v21, s43, v2
s_add_u32 s43, s43, 32768
s_cmp_ge_u32 s43, 131072
s_cselect_b32 s43, 0, s43
ds_read_b128 v[208:211], v22 offset:0
ds_read_b64_tr_b16 v[192:193], v16 offset:0
ds_read_b64_tr_b16 v[194:195], v16 offset:2048
v_mfma_f32_32x32x16_bf16 v[144:159], v[216:219], v[228:231], v[144:159]
ds_read_b64_tr_b16 v[196:197], v17 offset:0
ds_read_b64_tr_b16 v[198:199], v17 offset:2048
ds_read_b64_tr_b16 v[200:201], v18 offset:0
v_mfma_f32_32x32x16_bf16 v[160:175], v[220:223], v[228:231], v[160:175]
ds_read_b64_tr_b16 v[202:203], v18 offset:2048
ds_read_b64_tr_b16 v[204:205], v19 offset:0
ds_read_b64_tr_b16 v[206:207], v19 offset:2048
v_mfma_f32_32x32x16_bf16 v[176:191], v[224:227], v[228:231], v[176:191]
s_waitcnt lgkmcnt(0)
v_mfma_f32_32x32x16_bf16 v[128:143], v[192:195], v[208:211], v[128:143]
ds_read_b128 v[228:231], v22 offset:1024
ds_read_b64_tr_b16 v[212:213], v16 offset:4096
ds_read_b64_tr_b16 v[214:215], v16 offset:6144
s_add_u32 s47, s42, s44
s_mov_b32 m0, s47
s_nop 0
buffer_load_dwordx4 v28, s[8:11], s40 offen lds
v_mfma_f32_32x32x16_bf16 v[144:159], v[196:199], v[208:211], v[144:159]
ds_read_b64_tr_b16 v[216:217], v17 offset:4096
ds_read_b64_tr_b16 v[218:219], v17 offset:6144
ds_read_b64_tr_b16 v[220:221], v18 offset:4096
buffer_load_dwordx4 v29, s[8:11], s40 offen offset:1024 lds
v_mfma_f32_32x32x16_bf16 v[160:175], v[200:203], v[208:211], v[160:175]
ds_read_b64_tr_b16 v[222:223], v18 offset:6144
ds_read_b64_tr_b16 v[224:225], v19 offset:4096
ds_read_b64_tr_b16 v[226:227], v19 offset:6144
v_mfma_f32_32x32x16_bf16 v[176:191], v[204:207], v[208:211], v[176:191]
buffer_load_dwordx4 v30, s[8:11], s40 offen offset:2048 lds
s_waitcnt lgkmcnt(0)
v_mfma_f32_32x32x16_bf16 v[128:143], v[212:215], v[228:231], v[128:143]
ds_read_b128 v[208:211], v22 offset:2048
ds_read_b64_tr_b16 v[192:193], v16 offset:8192
ds_read_b64_tr_b16 v[194:195], v16 offset:10240
buffer_load_dwordx4 v31, s[8:11], s40 offen offset:3072 lds
s_add_u32 s40, s40, 262144
v_mfma_f32_32x32x16_bf16 v[144:159], v[216:219], v[228:231], v[144:159]
ds_read_b64_tr_b16 v[196:197], v17 offset:8192
ds_read_b64_tr_b16 v[198:199], v17 offset:10240
ds_read_b64_tr_b16 v[200:201], v18 offset:8192
v_mfma_f32_32x32x16_bf16 v[160:175], v[220:223], v[228:231], v[160:175]
ds_read_b64_tr_b16 v[202:203], v18 offset:10240
ds_read_b64_tr_b16 v[204:205], v19 offset:8192
ds_read_b64_tr_b16 v[206:207], v19 offset:10240
s_add_u32 m0, s47, 16384
s_nop 0
buffer_load_dwordx4 v2, s[16:19], s41 offen lds
v_mfma_f32_32x32x16_bf16 v[176:191], v[224:227], v[228:231], v[176:191]
buffer_load_dwordx4 v2, s[16:19], s41 offen offset:1024 lds
s_waitcnt lgkmcnt(0)
v_mfma_f32_32x32x16_bf16 v[128:143], v[192:195], v[208:211], v[128:143]
ds_read_b128 v[228:231], v22 offset:3072
ds_read_b64_tr_b16 v[212:213], v16 offset:12288
ds_read_b64_tr_b16 v[214:215], v16 offset:14336
v_mfma_f32_32x32x16_bf16 v[144:159], v[196:199], v[208:211], v[144:159]
ds_read_b64_tr_b16 v[216:217], v17 offset:12288
ds_read_b64_tr_b16 v[218:219], v17 offset:14336
ds_read_b64_tr_b16 v[220:221], v18 offset:12288
buffer_load_dwordx4 v2, s[16:19], s41 offen offset:2048 lds
v_mfma_f32_32x32x16_bf16 v[160:175], v[200:203], v[208:211], v[160:175]
ds_read_b64_tr_b16 v[222:223], v18 offset:14336
ds_read_b64_tr_b16 v[224:225], v19 offset:12288
ds_read_b64_tr_b16 v[226:227], v19 offset:14336
buffer_load_dwordx4 v2, s[16:19], s41 offen offset:3072 lds
s_add_u32 s41, s41, 4096
s_add_u32 s42, s42, 32768
s_cmp_ge_u32 s42, 131072
s_cselect_b32 s42, 0, s42
v_mfma_f32_32x32x16_bf16 v[176:191], v[204:207], v[208:211], v[176:191]
s_waitcnt lgkmcnt(0)
s_waitcnt vmcnt(16)
s_barrier
v_mfma_f32_32x32x16_bf16 v[128:143], v[212:215], v[228:231], v[128:143]
s_add_u32 s46, s44, 16384
s_add_u32 s46, s46, s43
v_add_u32 v22, s46, v2
v_add_u32 v16, s43, v8
v_add_u32 v17, s43, v9
v_add_u32 v18, s43, v10
v_add_u32 v19, s43, v11
v_add_u32 v20, s43, v12
v_add_u32 v21, s43, v2
s_add_u32 s43, s43, 32768
s_cmp_ge_u32 s43, 131072
s_cselect_b32 s43, 0, s43
ds_read_b64_tr_b16 v[208:209], v20 offset:0
ds_read_b64_tr_b16 v[210:211], v20 offset:2048
v_mfma_f32_32x32x16_bf16 v[144:159], v[216:219], v[228:231], v[144:159]
ds_read_b128 v[192:195], v21 offset:16384
ds_read_b128 v[196:199], v21 offset:20480
v_mfma_f32_32x32x16_bf16 v[160:175], v[220:223], v[228:231], v[160:175]
ds_read_b128 v[200:203], v21 offset:24576
ds_read_b128 v[204:207], v21 offset:28672
v_mfma_f32_32x32x16_bf16 v[176:191], v[224:227], v[228:231], v[176:191]
s_waitcnt lgkmcnt(0)
v_mfma_f32_32x32x16_bf16 v[64:79], v[192:195], v[208:211], 0
ds_read_b64_tr_b16 v[228:229], v20 offset:4096
ds_read_b64_tr_b16 v[230:231], v20 offset:6144
s_add_u32 s47, s42, s44
s_mov_b32 m0, s47
s_nop 0
buffer_load_dwordx4 v28, s[8:11], s40 offen lds
v_mfma_f32_32x32x16_bf16 v[80:95], v[196:199], v[208:211], 0
ds_read_b128 v[212:215], v21 offset:17408
ds_read_b128 v[216:219], v21 offset:21504
buffer_load_dwordx4 v29, s[8:11], s40 offen offset:1024 lds
v_mfma_f32_32x32x16_bf16 v[96:111], v[200:203], v[208:211], 0
ds_read_b128 v[220:223], v21 offset:25600
ds_read_b128 v[224:227], v21 offset:29696
v_mfma_f32_32x32x16_bf16 v[112:127], v[204:207], v[208:211], 0
buffer_load_dwordx4 v30, s[8:11], s40 offen offset:2048 lds
s_waitcnt lgkmcnt(0)
v_mfma_f32_32x32x16_bf16 v[64:79], v[212:215], v[228:231], v[64:79]
ds_read_b64_tr_b16 v[208:209], v20 offset:8192
ds_read_b64_tr_b16 v[210:211], v20 offset:10240
buffer_load_dwordx4 v31, s[8:11], s40 offen offset:3072 lds
s_add_u32 s40, s40, 262144
v_mfma_f32_32x32x16_bf16 v[80:95], v[216:219], v[228:231], v[80:95]
ds_read_b128 v[192:195], v21 offset:18432
ds_read_b128 v[196:199], v21 offset:22528
v_mfma_f32_32x32x16_bf16 v[96:111], v[220:223], v[228:231], v[96:111]
ds_read_b128 v[200:203], v21 offset:26624
ds_read_b128 v[204:207], v21 offset:30720
s_add_u32 m0, s47, 16384
s_nop 0
buffer_load_dwordx4 v2, s[16:19], s41 offen lds
v_mfma_f32_32x32x16_bf16 v[112:127], v[224:227], v[228:231], v[112:127]
buffer_load_dwordx4 v2, s[16:19], s41 offen offset:1024 lds
s_waitcnt lgkmcnt(0)
v_mfma_f32_32x32x16_bf16 v[64:79], v[192:195], v[208:211], v[64:79]
ds_read_b64_tr_b16 v[228:229], v20 offset:12288
ds_read_b64_tr_b16 v[230:231], v20 offset:14336
v_mfma_f32_32x32x16_bf16 v[80:95], v[196:199], v[208:211], v[80:95]
ds_read_b128 v[212:215], v21 offset:19456
ds_read_b128 v[216:219], v21 offset:23552
buffer_load_dwordx4 v2, s[16:19], s41 offen offset:2048 lds
v_mfma_f32_32x32x16_bf16 v[96:111], v[200:203], v[208:211], v[96:111]
ds_read_b128 v[220:223], v21 offset:27648
ds_read_b128 v[224:227], v21 offset:31744
buffer_load_dwordx4 v2, s[16:19], s41 offen offset:3072 lds
s_add_u32 s41, s41, 4096
s_add_u32 s42, s42, 32768
s_cmp_ge_u32 s42, 131072
s_cselect_b32 s42, 0, s42
v_mfma_f32_32x32x16_bf16 v[112:127], v[204:207], v[208:211], v[112:127]
s_waitcnt lgkmcnt(0)
s_waitcnt vmcnt(16)
s_barrier
v_mfma_f32_32x32x16_bf16 v[64:79], v[212:215], v[228:231], v[64:79]
s_add_u32 s46, s44, 16384
s_add_u32 s46, s46, s43
v_add_u32 v22, s46, v2
v_add_u32 v16, s43, v8
v_add_u32 v17, s43, v9
v_add_u32 v18, s43, v10
v_add_u32 v19, s43, v11
v_add_u32 v20, s43, v12
v_add_u32 v21, s43, v2
s_add_u32 s43, s43, 32768
s_cmp_ge_u32 s43, 131072
s_cselect_b32 s43, 0, s43
ds_read_b64_tr_b16 v[208:209], v20 offset:0
ds_read_b64_tr_b16 v[210:211], v20 offset:2048
v_mfma_f32_32x32x16_bf16 v[80:95], v[216:219], v[228:231], v[80:95]
ds_read_b128 v[192:195], v21 offset:16384
ds_read_b128 v[196:199], v21 offset:20480
v_mfma_f32_32x32x16_bf16 v[96:111], v[220:223], v[228:231], v[96:111]
ds_read_b128 v[200:203], v21 offset:24576
ds_read_b128 v[204:207], v21 offset:28672
v_mfma_f32_32x32x16_bf16 v[112:127], v[224:227], v[228:231], v[112:127]
s_waitcnt lgkmcnt(0)
v_mfma_f32_32x32x16_bf16 v[64:79], v[192:195], v[208:211], v[64:79]
ds_read_b64_tr_b16 v[228:229], v20 offset:4096
ds_read_b64_tr_b16 v[230:231], v20 offset:6144
s_add_u32 s47, s42, s44
s_mov_b32 m0, s47
s_nop 0
buffer_load_dwordx4 v28, s[8:11], s40 offen lds
v_mfma_f32_32x32x16_bf16 v[80:95], v[196:199], v[208:211], v[80:95]
ds_read_b128 v[212:215], v21 offset:17408
ds_read_b128 v[216:219], v21 offset:21504
buffer_load_dwordx4 v29, s[8:11], s40 offen offset:1024 lds
v_mfma_f32_32x32x16_bf16 v[96:111], v[200:203], v[208:211], v[96:111]
ds_read_b128 v[220:223], v21 offset:25600
ds_read_b128 v[224:227], v21 offset:29696
v_mfma_f32_32x32x16_bf16 v[112:127], v[204:207], v[208:211], v[112:127]
buffer_load_dwordx4 v30, s[8:11], s40 offen offset:2048 lds
s_waitcnt lgkmcnt(0)
v_mfma_f32_32x32x16_bf16 v[64:79], v[212:215], v[228:231], v[64:79]
ds_read_b64_tr_b16 v[208:209], v20 offset:8192
ds_read_b64_tr_b16 v[210:211], v20 offset:10240
buffer_load_dwordx4 v31, s[8:11], s40 offen offset:3072 lds
s_add_u32 s40, s40, 262144
v_mfma_f32_32x32x16_bf16 v[80:95], v[216:219], v[228:231], v[80:95]
ds_read_b128 v[192:195], v21 offset:18432
ds_read_b128 v[196:199], v21 offset:22528
v_mfma_f32_32x32x16_bf16 v[96:111], v[220:223], v[228:231], v[96:111]
ds_read_b128 v[200:203], v21 offset:26624
ds_read_b128 v[204:207], v21 offset:30720
s_add_u32 m0, s47, 16384
s_nop 0
buffer_load_dwordx4 v2, s[16:19], s41 offen lds
v_mfma_f32_32x32x16_bf16 v[112:127], v[224:227], v[228:231], v[112:127]
buffer_load_dwordx4 v2, s[16:19], s41 offen offset:1024 lds
s_waitcnt lgkmcnt(0)
v_mfma_f32_32x32x16_bf16 v[64:79], v[192:195], v[208:211], v[64:79]
ds_read_b64_tr_b16 v[228:229], v20 offset:12288
ds_read_b64_tr_b16 v[230:231], v20 offset:14336
v_mfma_f32_32x32x16_bf16 v[80:95], v[196:199], v[208:211], v[80:95]
ds_read_b128 v[212:215], v21 offset:19456
ds_read_b128 v[216:219], v21 offset:23552
buffer_load_dwordx4 v2, s[16:19], s41 offen offset:2048 lds
v_mfma_f32_32x32x16_bf16 v[96:111], v[200:203], v[208:211], v[96:111]
ds_read_b128 v[220:223], v21 offset:27648
ds_read_b128 v[224:227], v21 offset:31744
buffer_load_dwordx4 v2, s[16:19], s41 offen offset:3072 lds
s_add_u32 s41, s41, 4096
s_add_u32 s42, s42, 32768
s_cmp_ge_u32 s42, 131072
s_cselect_b32 s42, 0, s42
v_mfma_f32_32x32x16_bf16 v[112:127], v[204:207], v[208:211], v[112:127]
s_waitcnt lgkmcnt(0)
s_waitcnt vmcnt(16)
s_barrier
v_mfma_f32_32x32x16_bf16 v[64:79], v[212:215], v[228:231], v[64:79]
s_add_u32 s46, s44, 16384
s_add_u32 s46, s46, s43
v_add_u32 v22, s46, v2
v_add_u32 v16, s43, v8
v_add_u32 v17, s43, v9
v_add_u32 v18, s43, v10
v_add_u32 v19, s43, v11
v_add_u32 v20, s43, v12
v_add_u32 v21, s43, v2
s_add_u32 s43, s43, 32768
s_cmp_ge_u32 s43, 131072
s_cselect_b32 s43, 0, s43
ds_read_b64_tr_b16 v[208:209], v20 offset:0
ds_read_b64_tr_b16 v[210:211], v20 offset:2048
v_mfma_f32_32x32x16_bf16 v[80:95], v[216:219], v[228:231], v[80:95]
ds_read_b128 v[192:195], v21 offset:16384
ds_read_b128 v[196:199], v21 offset:20480
v_mfma_f32_32x32x16_bf16 v[96:111], v[220:223], v[228:231], v[96:111]
ds_read_b128 v[200:203], v21 offset:24576
ds_read_b128 v[204:207], v21 offset:28672
v_mfma_f32_32x32x16_bf16 v[112:127], v[224:227], v[228:231], v[112:127]
s_waitcnt lgkmcnt(0)
v_mfma_f32_32x32x16_bf16 v[64:79], v[192:195], v[208:211], v[64:79]
ds_read_b64_tr_b16 v[228:229], v20 offset:4096
ds_read_b64_tr_b16 v[230:231], v20 offset:6144
s_add_u32 s47, s42, s44
s_mov_b32 m0, s47
s_nop 0
buffer_load_dwordx4 v28, s[8:11], s40 offen lds
v_mfma_f32_32x32x16_bf16 v[80:95], v[196:199], v[208:211], v[80:95]
ds_read_b128 v[212:215], v21 offset:17408
ds_read_b128 v[216:219], v21 offset:21504
buffer_load_dwordx4 v29, s[8:11], s40 offen offset:1024 lds
v_mfma_f32_32x32x16_bf16 v[96:111], v[200:203], v[208:211], v[96:111]
ds_read_b128 v[220:223], v21 offset:25600
ds_read_b128 v[224:227], v21 offset:29696
v_mfma_f32_32x32x16_bf16 v[112:127], v[204:207], v[208:211], v[112:127]
buffer_load_dwordx4 v30, s[8:11], s40 offen offset:2048 lds
s_waitcnt lgkmcnt(0)
v_mfma_f32_32x32x16_bf16 v[64:79], v[212:215], v[228:231], v[64:79]
ds_read_b64_tr_b16 v[208:209], v20 offset:8192
ds_read_b64_tr_b16 v[210:211], v20 offset:10240
buffer_load_dwordx4 v31, s[8:11], s40 offen offset:3072 lds
s_add_u32 s40, s40, 262144
v_mfma_f32_32x32x16_bf16 v[80:95], v[216:219], v[228:231], v[80:95]
ds_read_b128 v[192:195], v21 offset:18432
ds_read_b128 v[196:199], v21 offset:22528
v_mfma_f32_32x32x16_bf16 v[96:111], v[220:223], v[228:231], v[96:111]
ds_read_b128 v[200:203], v21 offset:26624
ds_read_b128 v[204:207], v21 offset:30720
s_add_u32 m0, s47, 16384
s_nop 0
buffer_load_dwordx4 v2, s[16:19], s41 offen lds
v_mfma_f32_32x32x16_bf16 v[112:127], v[224:227], v[228:231], v[112:127]
buffer_load_dwordx4 v2, s[16:19], s41 offen offset:1024 lds
s_waitcnt lgkmcnt(0)
v_mfma_f32_32x32x16_bf16 v[64:79], v[192:195], v[208:211], v[64:79]
ds_read_b64_tr_b16 v[228:229], v20 offset:12288
ds_read_b64_tr_b16 v[230:231], v20 offset:14336
v_mfma_f32_32x32x16_bf16 v[80:95], v[196:199], v[208:211], v[80:95]
ds_read_b128 v[212:215], v21 offset:19456
ds_read_b128 v[216:219], v21 offset:23552
buffer_load_dwordx4 v2, s[16:19], s41 offen offset:2048 lds
v_mfma_f32_32x32x16_bf16 v[96:111], v[200:203], v[208:211], v[96:111]
ds_read_b128 v[220:223], v21 offset:27648
ds_read_b128 v[224:227], v21 offset:31744
buffer_load_dwordx4 v2, s[16:19], s41 offen offset:3072 lds
s_add_u32 s41, s41, 4096
s_add_u32 s42, s42, 32768
s_cmp_ge_u32 s42, 131072
s_cselect_b32 s42, 0, s42
v_mfma_f32_32x32x16_bf16 v[112:127], v[204:207], v[208:211], v[112:127]
s_waitcnt lgkmcnt(0)
s_waitcnt vmcnt(16)
s_barrier
v_mfma_f32_32x32x16_bf16 v[64:79], v[212:215], v[228:231], v[64:79]
s_add_u32 s46, s44, 16384
s_add_u32 s46, s46, s43
v_add_u32 v22, s46, v2
v_add_u32 v16, s43, v8
v_add_u32 v17, s43, v9
v_add_u32 v18, s43, v10
v_add_u32 v19, s43, v11
v_add_u32 v20, s43, v12
v_add_u32 v21, s43, v2
s_add_u32 s43, s43, 32768
s_cmp_ge_u32 s43, 131072
s_cselect_b32 s43, 0, s43
ds_read_b64_tr_b16 v[208:209], v20 offset:0
ds_read_b64_tr_b16 v[210:211], v20 offset:2048
v_mfma_f32_32x32x16_bf16 v[80:95], v[216:219], v[228:231], v[80:95]
ds_read_b128 v[192:195], v21 offset:16384
ds_read_b128 v[196:199], v21 offset:20480
v_mfma_f32_32x32x16_bf16 v[96:111], v[220:223], v[228:231], v[96:111]
ds_read_b128 v[200:203], v21 offset:24576
ds_read_b128 v[204:207], v21 offset:28672
v_mfma_f32_32x32x16_bf16 v[112:127], v[224:227], v[228:231], v[112:127]
s_waitcnt lgkmcnt(0)
v_mfma_f32_32x32x16_bf16 v[64:79], v[192:195], v[208:211], v[64:79]
ds_read_b64_tr_b16 v[228:229], v20 offset:4096
ds_read_b64_tr_b16 v[230:231], v20 offset:6144
s_add_u32 s47, s42, s44
s_mov_b32 m0, s47
s_nop 0
buffer_load_dwordx4 v28, s[8:11], s40 offen lds
v_mfma_f32_32x32x16_bf16 v[80:95], v[196:199], v[208:211], v[80:95]
ds_read_b128 v[212:215], v21 offset:17408
ds_read_b128 v[216:219], v21 offset:21504
buffer_load_dwordx4 v29, s[8:11], s40 offen offset:1024 lds
v_mfma_f32_32x32x16_bf16 v[96:111], v[200:203], v[208:211], v[96:111]
ds_read_b128 v[220:223], v21 offset:25600
ds_read_b128 v[224:227], v21 offset:29696
v_mfma_f32_32x32x16_bf16 v[112:127], v[204:207], v[208:211], v[112:127]
buffer_load_dwordx4 v30, s[8:11], s40 offen offset:2048 lds
s_waitcnt lgkmcnt(0)
v_mfma_f32_32x32x16_bf16 v[64:79], v[212:215], v[228:231], v[64:79]
ds_read_b64_tr_b16 v[208:209], v20 offset:8192
ds_read_b64_tr_b16 v[210:211], v20 offset:10240
buffer_load_dwordx4 v31, s[8:11], s40 offen offset:3072 lds
s_add_u32 s40, s40, 262144
v_mfma_f32_32x32x16_bf16 v[80:95], v[216:219], v[228:231], v[80:95]
ds_read_b128 v[192:195], v21 offset:18432
ds_read_b128 v[196:199], v21 offset:22528
v_mfma_f32_32x32x16_bf16 v[96:111], v[220:223], v[228:231], v[96:111]
ds_read_b128 v[200:203], v21 offset:26624
ds_read_b128 v[204:207], v21 offset:30720
s_add_u32 m0, s47, 16384
s_nop 0
buffer_load_dwordx4 v2, s[16:19], s41 offen lds
v_mfma_f32_32x32x16_bf16 v[112:127], v[224:227], v[228:231], v[112:127]
buffer_load_dwordx4 v2, s[16:19], s41 offen offset:1024 lds
s_waitcnt lgkmcnt(0)
v_mfma_f32_32x32x16_bf16 v[64:79], v[192:195], v[208:211], v[64:79]
ds_read_b64_tr_b16 v[228:229], v20 offset:12288
ds_read_b64_tr_b16 v[230:231], v20 offset:14336
v_mfma_f32_32x32x16_bf16 v[80:95], v[196:199], v[208:211], v[80:95]
ds_read_b128 v[212:215], v21 offset:19456
ds_read_b128 v[216:219], v21 offset:23552
buffer_load_dwordx4 v2, s[16:19], s41 offen offset:2048 lds
v_mfma_f32_32x32x16_bf16 v[96:111], v[200:203], v[208:211], v[96:111]
ds_read_b128 v[220:223], v21 offset:27648
ds_read_b128 v[224:227], v21 offset:31744
buffer_load_dwordx4 v2, s[16:19], s41 offen offset:3072 lds
s_add_u32 s41, s41, 4096
s_add_u32 s42, s42, 32768
s_cmp_ge_u32 s42, 131072
s_cselect_b32 s42, 0, s42
v_mfma_f32_32x32x16_bf16 v[112:127], v[204:207], v[208:211], v[112:127]
s_waitcnt lgkmcnt(0)
s_waitcnt vmcnt(16)
s_barrier
v_mfma_f32_32x32x16_bf16 v[64:79], v[212:215], v[228:231], v[64:79]
s_add_u32 s46, s44, 16384
s_add_u32 s46, s46, s43
v_add_u32 v22, s46, v2
v_add_u32 v16, s43, v8
v_add_u32 v17, s43, v9
v_add_u32 v18, s43, v10
v_add_u32 v19, s43, v11
v_add_u32 v20, s43, v12
v_add_u32 v21, s43, v2
s_add_u32 s43, s43, 32768
s_cmp_ge_u32 s43, 131072
s_cselect_b32 s43, 0, s43
ds_read_b64_tr_b16 v[208:209], v20 offset:0
ds_read_b64_tr_b16 v[210:211], v20 offset:2048
v_mfma_f32_32x32x16_bf16 v[80:95], v[216:219], v[228:231], v[80:95]
ds_read_b128 v[192:195], v21 offset:16384
ds_read_b128 v[196:199], v21 offset:20480
v_mfma_f32_32x32x16_bf16 v[96:111], v[220:223], v[228:231], v[96:111]
ds_read_b128 v[200:203], v21 offset:24576
ds_read_b128 v[204:207], v21 offset:28672
v_mfma_f32_32x32x16_bf16 v[112:127], v[224:227], v[228:231], v[112:127]
s_waitcnt lgkmcnt(0)
v_mfma_f32_32x32x16_bf16 v[64:79], v[192:195], v[208:211], v[64:79]
ds_read_b64_tr_b16 v[228:229], v20 offset:4096
ds_read_b64_tr_b16 v[230:231], v20 offset:6144
v_mfma_f32_32x32x16_bf16 v[80:95], v[196:199], v[208:211], v[80:95]
ds_read_b128 v[212:215], v21 offset:17408
ds_read_b128 v[216:219], v21 offset:21504
v_mfma_f32_32x32x16_bf16 v[96:111], v[200:203], v[208:211], v[96:111]
ds_read_b128 v[220:223], v21 offset:25600
ds_read_b128 v[224:227], v21 offset:29696
v_mfma_f32_32x32x16_bf16 v[112:127], v[204:207], v[208:211], v[112:127]
s_waitcnt lgkmcnt(0)
v_mfma_f32_32x32x16_bf16 v[64:79], v[212:215], v[228:231], v[64:79]
ds_read_b64_tr_b16 v[208:209], v20 offset:8192
ds_read_b64_tr_b16 v[210:211], v20 offset:10240
v_mfma_f32_32x32x16_bf16 v[80:95], v[216:219], v[228:231], v[80:95]
ds_read_b128 v[192:195], v21 offset:18432
ds_read_b128 v[196:199], v21 offset:22528
v_mfma_f32_32x32x16_bf16 v[96:111], v[220:223], v[228:231], v[96:111]
ds_read_b128 v[200:203], v21 offset:26624
ds_read_b128 v[204:207], v21 offset:30720
v_mfma_f32_32x32x16_bf16 v[112:127], v[224:227], v[228:231], v[112:127]
s_waitcnt lgkmcnt(0)
v_mfma_f32_32x32x16_bf16 v[64:79], v[192:195], v[208:211], v[64:79]
ds_read_b64_tr_b16 v[228:229], v20 offset:12288
ds_read_b64_tr_b16 v[230:231], v20 offset:14336
v_mfma_f32_32x32x16_bf16 v[80:95], v[196:199], v[208:211], v[80:95]
ds_read_b128 v[212:215], v21 offset:19456
ds_read_b128 v[216:219], v21 offset:23552
v_mfma_f32_32x32x16_bf16 v[96:111], v[200:203], v[208:211], v[96:111]
ds_read_b128 v[220:223], v21 offset:27648
ds_read_b128 v[224:227], v21 offset:31744
v_mfma_f32_32x32x16_bf16 v[112:127], v[204:207], v[208:211], v[112:127]
s_waitcnt lgkmcnt(0)
s_waitcnt vmcnt(8)
s_barrier
v_mfma_f32_32x32x16_bf16 v[64:79], v[212:215], v[228:231], v[64:79]
s_add_u32 s46, s44, 16384
s_add_u32 s46, s46, s43
v_add_u32 v22, s46, v2
v_add_u32 v16, s43, v8
v_add_u32 v17, s43, v9
v_add_u32 v18, s43, v10
v_add_u32 v19, s43, v11
v_add_u32 v20, s43, v12
v_add_u32 v21, s43, v2
s_add_u32 s43, s43, 32768
s_cmp_ge_u32 s43, 131072
s_cselect_b32 s43, 0, s43
ds_read_b64_tr_b16 v[208:209], v20 offset:0
ds_read_b64_tr_b16 v[210:211], v20 offset:2048
v_mfma_f32_32x32x16_bf16 v[80:95], v[216:219], v[228:231], v[80:95]
ds_read_b128 v[192:195], v21 offset:16384
ds_read_b128 v[196:199], v21 offset:20480
v_mfma_f32_32x32x16_bf16 v[96:111], v[220:223], v[228:231], v[96:111]
ds_read_b128 v[200:203], v21 offset:24576
ds_read_b128 v[204:207], v21 offset:28672
v_mfma_f32_32x32x16_bf16 v[112:127], v[224:227], v[228:231], v[112:127]
s_waitcnt lgkmcnt(0)
v_mfma_f32_32x32x16_bf16 v[64:79], v[192:195], v[208:211], v[64:79]
ds_read_b64_tr_b16 v[228:229], v20 offset:4096
ds_read_b64_tr_b16 v[230:231], v20 offset:6144
v_mfma_f32_32x32x16_bf16 v[80:95], v[196:199], v[208:211], v[80:95]
ds_read_b128 v[212:215], v21 offset:17408
ds_read_b128 v[216:219], v21 offset:21504
v_mfma_f32_32x32x16_bf16 v[96:111], v[200:203], v[208:211], v[96:111]
ds_read_b128 v[220:223], v21 offset:25600
ds_read_b128 v[224:227], v21 offset:29696
v_mfma_f32_32x32x16_bf16 v[112:127], v[204:207], v[208:211], v[112:127]
s_waitcnt lgkmcnt(0)
v_mfma_f32_32x32x16_bf16 v[64:79], v[212:215], v[228:231], v[64:79]
ds_read_b64_tr_b16 v[208:209], v20 offset:8192
ds_read_b64_tr_b16 v[210:211], v20 offset:10240
v_mfma_f32_32x32x16_bf16 v[80:95], v[216:219], v[228:231], v[80:95]
ds_read_b128 v[192:195], v21 offset:18432
ds_read_b128 v[196:199], v21 offset:22528
v_mfma_f32_32x32x16_bf16 v[96:111], v[220:223], v[228:231], v[96:111]
ds_read_b128 v[200:203], v21 offset:26624
ds_read_b128 v[204:207], v21 offset:30720
v_mfma_f32_32x32x16_bf16 v[112:127], v[224:227], v[228:231], v[112:127]
s_waitcnt lgkmcnt(0)
v_mfma_f32_32x32x16_bf16 v[64:79], v[192:195], v[208:211], v[64:79]
ds_read_b64_tr_b16 v[228:229], v20 offset:12288
ds_read_b64_tr_b16 v[230:231], v20 offset:14336
v_mfma_f32_32x32x16_bf16 v[80:95], v[196:199], v[208:211], v[80:95]
ds_read_b128 v[212:215], v21 offset:19456
ds_read_b128 v[216:219], v21 offset:23552
v_mfma_f32_32x32x16_bf16 v[96:111], v[200:203], v[208:211], v[96:111]
ds_read_b128 v[220:223], v21 offset:27648
ds_read_b128 v[224:227], v21 offset:31744
v_mfma_f32_32x32x16_bf16 v[112:127], v[204:207], v[208:211], v[112:127]
s_waitcnt lgkmcnt(0)
s_waitcnt vmcnt(0)
s_barrier
v_mfma_f32_32x32x16_bf16 v[64:79], v[212:215], v[228:231], v[64:79]
s_add_u32 s46, s44, 16384
s_add_u32 s46, s46, s43
v_add_u32 v22, s46, v2
v_add_u32 v16, s43, v8
v_add_u32 v17, s43, v9
v_add_u32 v18, s43, v10
v_add_u32 v19, s43, v11
v_add_u32 v20, s43, v12
v_add_u32 v21, s43, v2
s_add_u32 s43, s43, 32768
s_cmp_ge_u32 s43, 131072
s_cselect_b32 s43, 0, s43
ds_read_b64_tr_b16 v[208:209], v20 offset:0
ds_read_b64_tr_b16 v[210:211], v20 offset:2048
v_mfma_f32_32x32x16_bf16 v[80:95], v[216:219], v[228:231], v[80:95]
ds_read_b128 v[192:195], v21 offset:16384
ds_read_b128 v[196:199], v21 offset:20480
v_mfma_f32_32x32x16_bf16 v[96:111], v[220:223], v[228:231], v[96:111]
ds_read_b128 v[200:203], v21 offset:24576
ds_read_b128 v[204:207], v21 offset:28672
v_mfma_f32_32x32x16_bf16 v[112:127], v[224:227], v[228:231], v[112:127]
s_waitcnt lgkmcnt(0)
v_mfma_f32_32x32x16_bf16 v[64:79], v[192:195], v[208:211], v[64:79]
ds_read_b64_tr_b16 v[228:229], v20 offset:4096
ds_read_b64_tr_b16 v[230:231], v20 offset:6144
v_mfma_f32_32x32x16_bf16 v[80:95], v[196:199], v[208:211], v[80:95]
ds_read_b128 v[212:215], v21 offset:17408
ds_read_b128 v[216:219], v21 offset:21504
v_mfma_f32_32x32x16_bf16 v[96:111], v[200:203], v[208:211], v[96:111]
ds_read_b128 v[220:223], v21 offset:25600
ds_read_b128 v[224:227], v21 offset:29696
v_mfma_f32_32x32x16_bf16 v[112:127], v[204:207], v[208:211], v[112:127]
s_waitcnt lgkmcnt(0)
v_mfma_f32_32x32x16_bf16 v[64:79], v[212:215], v[228:231], v[64:79]
ds_read_b64_tr_b16 v[208:209], v20 offset:8192
ds_read_b64_tr_b16 v[210:211], v20 offset:10240
v_mfma_f32_32x32x16_bf16 v[80:95], v[216:219], v[228:231], v[80:95]
ds_read_b128 v[192:195], v21 offset:18432
ds_read_b128 v[196:199], v21 offset:22528
v_mfma_f32_32x32x16_bf16 v[96:111], v[220:223], v[228:231], v[96:111]
ds_read_b128 v[200:203], v21 offset:26624
ds_read_b128 v[204:207], v21 offset:30720
v_mfma_f32_32x32x16_bf16 v[112:127], v[224:227], v[228:231], v[112:127]
s_waitcnt lgkmcnt(0)
v_mfma_f32_32x32x16_bf16 v[64:79], v[192:195], v[208:211], v[64:79]
ds_read_b64_tr_b16 v[228:229], v20 offset:12288
ds_read_b64_tr_b16 v[230:231], v20 offset:14336
v_mfma_f32_32x32x16_bf16 v[80:95], v[196:199], v[208:211], v[80:95]
ds_read_b128 v[212:215], v21 offset:19456
ds_read_b128 v[216:219], v21 offset:23552
v_mfma_f32_32x32x16_bf16 v[96:111], v[200:203], v[208:211], v[96:111]
ds_read_b128 v[220:223], v21 offset:27648
ds_read_b128 v[224:227], v21 offset:31744
v_mfma_f32_32x32x16_bf16 v[112:127], v[204:207], v[208:211], v[112:127]
s_waitcnt lgkmcnt(0)
v_mfma_f32_32x32x16_bf16 v[64:79], v[212:215], v[228:231], v[64:79]
v_mfma_f32_32x32x16_bf16 v[80:95], v[216:219], v[228:231], v[80:95]
v_mfma_f32_32x32x16_bf16 v[96:111], v[220:223], v[228:231], v[96:111]
v_mfma_f32_32x32x16_bf16 v[112:127], v[224:227], v[228:231], v[112:127]
v_sub_f32 v43, 1.0, v40
s_lshl_b32 s45, s48, 17
s_lshl_b32 s46, s23, 13
s_lshl_b32 s47, s20, 11
s_add_u32 s46, s46, s47
s_add_u32 s46, s46, s45
s_nop 4
v_mul_f32 v128, v128, v40
v_mul_f32 v129, v129, v40
v_mul_f32 v130, v130, v40
v_mul_f32 v131, v131, v40
v_mul_f32 v132, v132, v40
v_mul_f32 v133, v133, v40
v_mul_f32 v134, v134, v40
v_mul_f32 v135, v135, v40
v_mul_f32 v136, v136, v40
v_mul_f32 v137, v137, v40
v_mul_f32 v138, v138, v40
v_mul_f32 v139, v139, v40
v_mul_f32 v140, v140, v40
v_mul_f32 v141, v141, v40
v_mul_f32 v142, v142, v40
v_mul_f32 v143, v143, v40
v_fmac_f32 v128, v64, v43
v_fmac_f32 v129, v65, v43
v_fmac_f32 v130, v66, v43
v_fmac_f32 v131, v67, v43
v_fmac_f32 v132, v68, v43
v_fmac_f32 v133, v69, v43
v_fmac_f32 v134, v70, v43
v_fmac_f32 v135, v71, v43
v_fmac_f32 v136, v72, v43
v_fmac_f32 v137, v73, v43
v_fmac_f32 v138, v74, v43
v_fmac_f32 v139, v75, v43
v_fmac_f32 v140, v76, v43
v_fmac_f32 v141, v77, v43
v_fmac_f32 v142, v78, v43
v_fmac_f32 v143, v79, v43
s_cmp_eq_u32 s23, 0
s_cbranch_scc1 attn_fin_own0
s_add_u32 s47, s46, 0
v_cvt_pk_bf16_f32 v128, v128, v129
v_cvt_pk_bf16_f32 v129, v130, v131
v_cvt_pk_bf16_f32 v130, v132, v133
v_cvt_pk_bf16_f32 v131, v134, v135
v_cvt_pk_bf16_f32 v132, v136, v137
v_cvt_pk_bf16_f32 v133, v138, v139
v_cvt_pk_bf16_f32 v134, v140, v141
v_cvt_pk_bf16_f32 v135, v142, v143
buffer_store_dwordx4 v[128:131], v2, s[36:39], s47 offen offset:0 sc1
buffer_store_dwordx4 v[132:135], v2, s[36:39], s47 offen offset:1024 sc1
s_branch attn_fin_next0
attn_fin_own0:
v_mov_b32 v192, v128
v_mov_b32 v193, v129
v_mov_b32 v194, v130
v_mov_b32 v195, v131
v_mov_b32 v196, v132
v_mov_b32 v197, v133
v_mov_b32 v198, v134
v_mov_b32 v199, v135
v_mov_b32 v200, v136
v_mov_b32 v201, v137
v_mov_b32 v202, v138
v_mov_b32 v203, v139
v_mov_b32 v204, v140
v_mov_b32 v205, v141
v_mov_b32 v206, v142
v_mov_b32 v207, v143
attn_fin_next0:
v_mul_f32 v144, v144, v40
v_mul_f32 v145, v145, v40
v_mul_f32 v146, v146, v40
v_mul_f32 v147, v147, v40
v_mul_f32 v148, v148, v40
v_mul_f32 v149, v149, v40
v_mul_f32 v150, v150, v40
v_mul_f32 v151, v151, v40
v_mul_f32 v152, v152, v40
v_mul_f32 v153, v153, v40
v_mul_f32 v154, v154, v40
v_mul_f32 v155, v155, v40
v_mul_f32 v156, v156, v40
v_mul_f32 v157, v157, v40
v_mul_f32 v158, v158, v40
v_mul_f32 v159, v159, v40
v_fmac_f32 v144, v80, v43
v_fmac_f32 v145, v81, v43
v_fmac_f32 v146, v82, v43
v_fmac_f32 v147, v83, v43
v_fmac_f32 v148, v84, v43
v_fmac_f32 v149, v85, v43
v_fmac_f32 v150, v86, v43
v_fmac_f32 v151, v87, v43
v_fmac_f32 v152, v88, v43
v_fmac_f32 v153, v89, v43
v_fmac_f32 v154, v90, v43
v_fmac_f32 v155, v91, v43
v_fmac_f32 v156, v92, v43
v_fmac_f32 v157, v93, v43
v_fmac_f32 v158, v94, v43
v_fmac_f32 v159, v95, v43
s_cmp_eq_u32 s23, 1
s_cbranch_scc1 attn_fin_own1
s_add_u32 s47, s46, 32768
v_cvt_pk_bf16_f32 v144, v144, v145
v_cvt_pk_bf16_f32 v145, v146, v147
v_cvt_pk_bf16_f32 v146, v148, v149
v_cvt_pk_bf16_f32 v147, v150, v151
v_cvt_pk_bf16_f32 v148, v152, v153
v_cvt_pk_bf16_f32 v149, v154, v155
v_cvt_pk_bf16_f32 v150, v156, v157
v_cvt_pk_bf16_f32 v151, v158, v159
buffer_store_dwordx4 v[144:147], v2, s[36:39], s47 offen offset:0 sc1
buffer_store_dwordx4 v[148:151], v2, s[36:39], s47 offen offset:1024 sc1
s_branch attn_fin_next1
attn_fin_own1:
v_mov_b32 v192, v144
v_mov_b32 v193, v145
v_mov_b32 v194, v146
v_mov_b32 v195, v147
v_mov_b32 v196, v148
v_mov_b32 v197, v149
v_mov_b32 v198, v150
v_mov_b32 v199, v151
v_mov_b32 v200, v152
v_mov_b32 v201, v153
v_mov_b32 v202, v154
v_mov_b32 v203, v155
v_mov_b32 v204, v156
v_mov_b32 v205, v157
v_mov_b32 v206, v158
v_mov_b32 v207, v159
attn_fin_next1:
v_mul_f32 v160, v160, v40
v_mul_f32 v161, v161, v40
v_mul_f32 v162, v162, v40
v_mul_f32 v163, v163, v40
v_mul_f32 v164, v164, v40
v_mul_f32 v165, v165, v40
v_mul_f32 v166, v166, v40
v_mul_f32 v167, v167, v40
v_mul_f32 v168, v168, v40
v_mul_f32 v169, v169, v40
v_mul_f32 v170, v170, v40
v_mul_f32 v171, v171, v40
v_mul_f32 v172, v172, v40
v_mul_f32 v173, v173, v40
v_mul_f32 v174, v174, v40
v_mul_f32 v175, v175, v40
v_fmac_f32 v160, v96, v43
v_fmac_f32 v161, v97, v43
v_fmac_f32 v162, v98, v43
v_fmac_f32 v163, v99, v43
v_fmac_f32 v164, v100, v43
v_fmac_f32 v165, v101, v43
v_fmac_f32 v166, v102, v43
v_fmac_f32 v167, v103, v43
v_fmac_f32 v168, v104, v43
v_fmac_f32 v169, v105, v43
v_fmac_f32 v170, v106, v43
v_fmac_f32 v171, v107, v43
v_fmac_f32 v172, v108, v43
v_fmac_f32 v173, v109, v43
v_fmac_f32 v174, v110, v43
v_fmac_f32 v175, v111, v43
s_cmp_eq_u32 s23, 2
s_cbranch_scc1 attn_fin_own2
s_add_u32 s47, s46, 65536
v_cvt_pk_bf16_f32 v160, v160, v161
v_cvt_pk_bf16_f32 v161, v162, v163
v_cvt_pk_bf16_f32 v162, v164, v165
v_cvt_pk_bf16_f32 v163, v166, v167
v_cvt_pk_bf16_f32 v164, v168, v169
v_cvt_pk_bf16_f32 v165, v170, v171
v_cvt_pk_bf16_f32 v166, v172, v173
v_cvt_pk_bf16_f32 v167, v174, v175
buffer_store_dwordx4 v[160:163], v2, s[36:39], s47 offen offset:0 sc1
buffer_store_dwordx4 v[164:167], v2, s[36:39], s47 offen offset:1024 sc1
s_branch attn_fin_next2
attn_fin_own2:
v_mov_b32 v192, v160
v_mov_b32 v193, v161
v_mov_b32 v194, v162
v_mov_b32 v195, v163
v_mov_b32 v196, v164
v_mov_b32 v197, v165
v_mov_b32 v198, v166
v_mov_b32 v199, v167
v_mov_b32 v200, v168
v_mov_b32 v201, v169
v_mov_b32 v202, v170
v_mov_b32 v203, v171
v_mov_b32 v204, v172
v_mov_b32 v205, v173
v_mov_b32 v206, v174
v_mov_b32 v207, v175
attn_fin_next2:
v_mul_f32 v176, v176, v40
v_mul_f32 v177, v177, v40
v_mul_f32 v178, v178, v40
v_mul_f32 v179, v179, v40
v_mul_f32 v180, v180, v40
v_mul_f32 v181, v181, v40
v_mul_f32 v182, v182, v40
v_mul_f32 v183, v183, v40
v_mul_f32 v184, v184, v40
v_mul_f32 v185, v185, v40
v_mul_f32 v186, v186, v40
v_mul_f32 v187, v187, v40
v_mul_f32 v188, v188, v40
v_mul_f32 v189, v189, v40
v_mul_f32 v190, v190, v40
v_mul_f32 v191, v191, v40
v_fmac_f32 v176, v112, v43
v_fmac_f32 v177, v113, v43
v_fmac_f32 v178, v114, v43
v_fmac_f32 v179, v115, v43
v_fmac_f32 v180, v116, v43
v_fmac_f32 v181, v117, v43
v_fmac_f32 v182, v118, v43
v_fmac_f32 v183, v119, v43
v_fmac_f32 v184, v120, v43
v_fmac_f32 v185, v121, v43
v_fmac_f32 v186, v122, v43
v_fmac_f32 v187, v123, v43
v_fmac_f32 v188, v124, v43
v_fmac_f32 v189, v125, v43
v_fmac_f32 v190, v126, v43
v_fmac_f32 v191, v127, v43
s_cmp_eq_u32 s23, 3
s_cbranch_scc1 attn_fin_own3
s_add_u32 s47, s46, 98304
v_cvt_pk_bf16_f32 v176, v176, v177
v_cvt_pk_bf16_f32 v177, v178, v179
v_cvt_pk_bf16_f32 v178, v180, v181
v_cvt_pk_bf16_f32 v179, v182, v183
v_cvt_pk_bf16_f32 v180, v184, v185
v_cvt_pk_bf16_f32 v181, v186, v187
v_cvt_pk_bf16_f32 v182, v188, v189
v_cvt_pk_bf16_f32 v183, v190, v191
buffer_store_dwordx4 v[176:179], v2, s[36:39], s47 offen offset:0 sc1
buffer_store_dwordx4 v[180:183], v2, s[36:39], s47 offen offset:1024 sc1
s_branch attn_fin_next3
attn_fin_own3:
v_mov_b32 v192, v176
v_mov_b32 v193, v177
v_mov_b32 v194, v178
v_mov_b32 v195, v179
v_mov_b32 v196, v180
v_mov_b32 v197, v181
v_mov_b32 v198, v182
v_mov_b32 v199, v183
v_mov_b32 v200, v184
v_mov_b32 v201, v185
v_mov_b32 v202, v186
v_mov_b32 v203, v187
v_mov_b32 v204, v188
v_mov_b32 v205, v189
v_mov_b32 v206, v190
v_mov_b32 v207, v191
attn_fin_next3:
s_lshl_b32 s45, s48, 17
s_lshl_b32 s46, s23, 15
s_add_u32 s45, s45, s46
s_lshl_b32 s46, s20, 11
s_add_u32 s45, s45, s46
s_add_u32 s46, s23, 1
s_and_b32 s46, s46, 3
s_lshl_b32 s46, s46, 13
s_add_u32 s51, s46, s45
s_add_u32 s46, s23, 2
s_and_b32 s46, s46, 3
s_lshl_b32 s46, s46, 13
s_add_u32 s52, s46, s45
s_add_u32 s46, s23, 3
s_and_b32 s46, s46, 3
s_lshl_b32 s46, s46, 13
s_add_u32 s53, s46, s45
s_mov_b32 s54, 0
attn_fin_poll:
buffer_load_dwordx4 v[72:75], v2, s[36:39], s51 offen offset:0 sc1
buffer_load_dwordx4 v[76:79], v2, s[36:39], s51 offen offset:1024 sc1
buffer_load_dwordx4 v[80:83], v2, s[36:39], s52 offen offset:0 sc1
buffer_load_dwordx4 v[84:87], v2, s[36:39], s52 offen offset:1024 sc1
buffer_load_dwordx4 v[88:91], v2, s[36:39], s53 offen offset:0 sc1
buffer_load_dwordx4 v[92:95], v2, s[36:39], s53 offen offset:1024 sc1
s_add_u32 s54, s54, 1
s_waitcnt vmcnt(0)
v_max3_u32 v32, v72, v73, v74
v_max3_u32 v32, v32, v75, v76
v_max3_u32 v32, v32, v77, v78
v_max3_u32 v32, v32, v79, v80
v_max3_u32 v32, v32, v81, v82
v_max3_u32 v32, v32, v83, v84
v_max3_u32 v32, v32, v85, v86
v_max3_u32 v32, v32, v87, v88
v_max3_u32 v32, v32, v89, v90
v_max3_u32 v32, v32, v91, v92
v_max3_u32 v32, v32, v93, v94
v_max_u32 v32, v32, v95
v_cmp_eq_u32 vcc, -1, v32
s_cmp_ge_u32 s54, 0x20000
s_cbranch_scc1 attn_fin_poll_end
s_cbranch_vccnz attn_fin_poll
attn_fin_poll_end:
v_lshlrev_b32 v41, 16, v41
v_mul_f32 v41, v41, v43
v_add_f32 v192, v192, v41
v_add_f32 v193, v193, v41
v_add_f32 v194, v194, v41
v_add_f32 v195, v195, v41
v_add_f32 v196, v196, v41
v_add_f32 v197, v197, v41
v_add_f32 v198, v198, v41
v_add_f32 v199, v199, v41
v_add_f32 v200, v200, v41
v_add_f32 v201, v201, v41
v_add_f32 v202, v202, v41
v_add_f32 v203, v203, v41
v_add_f32 v204, v204, v41
v_add_f32 v205, v205, v41
v_add_f32 v206, v206, v41
v_add_f32 v207, v207, v41
v_lshlrev_b32 v32, 16, v72
v_and_b32 v33, 0xffff0000, v72
v_add_f32 v192, v192, v32
v_add_f32 v193, v193, v33
v_lshlrev_b32 v32, 16, v73
v_and_b32 v33, 0xffff0000, v73
v_add_f32 v194, v194, v32
v_add_f32 v195, v195, v33
v_lshlrev_b32 v32, 16, v74
v_and_b32 v33, 0xffff0000, v74
v_add_f32 v196, v196, v32
v_add_f32 v197, v197, v33
v_lshlrev_b32 v32, 16, v75
v_and_b32 v33, 0xffff0000, v75
v_add_f32 v198, v198, v32
v_add_f32 v199, v199, v33
v_lshlrev_b32 v32, 16, v76
v_and_b32 v33, 0xffff0000, v76
v_add_f32 v200, v200, v32
v_add_f32 v201, v201, v33
v_lshlrev_b32 v32, 16, v77
v_and_b32 v33, 0xffff0000, v77
v_add_f32 v202, v202, v32
v_add_f32 v203, v203, v33
v_lshlrev_b32 v32, 16, v78
v_and_b32 v33, 0xffff0000, v78
v_add_f32 v204, v204, v32
v_add_f32 v205, v205, v33
v_lshlrev_b32 v32, 16, v79
v_and_b32 v33, 0xffff0000, v79
v_add_f32 v206, v206, v32
v_add_f32 v207, v207, v33
v_lshlrev_b32 v32, 16, v80
v_and_b32 v33, 0xffff0000, v80
v_add_f32 v192, v192, v32
v_add_f32 v193, v193, v33
v_lshlrev_b32 v32, 16, v81
v_and_b32 v33, 0xffff0000, v81
v_add_f32 v194, v194, v32
v_add_f32 v195, v195, v33
v_lshlrev_b32 v32, 16, v82
v_and_b32 v33, 0xffff0000, v82
v_add_f32 v196, v196, v32
v_add_f32 v197, v197, v33
v_lshlrev_b32 v32, 16, v83
v_and_b32 v33, 0xffff0000, v83
v_add_f32 v198, v198, v32
v_add_f32 v199, v199, v33
v_lshlrev_b32 v32, 16, v84
v_and_b32 v33, 0xffff0000, v84
v_add_f32 v200, v200, v32
v_add_f32 v201, v201, v33
v_lshlrev_b32 v32, 16, v85
v_and_b32 v33, 0xffff0000, v85
v_add_f32 v202, v202, v32
v_add_f32 v203, v203, v33
v_lshlrev_b32 v32, 16, v86
v_and_b32 v33, 0xffff0000, v86
v_add_f32 v204, v204, v32
v_add_f32 v205, v205, v33
v_lshlrev_b32 v32, 16, v87
v_and_b32 v33, 0xffff0000, v87
v_add_f32 v206, v206, v32
v_add_f32 v207, v207, v33
v_lshlrev_b32 v32, 16, v88
v_and_b32 v33, 0xffff0000, v88
v_add_f32 v192, v192, v32
v_add_f32 v193, v193, v33
v_lshlrev_b32 v32, 16, v89
v_and_b32 v33, 0xffff0000, v89
v_add_f32 v194, v194, v32
v_add_f32 v195, v195, v33
v_lshlrev_b32 v32, 16, v90
v_and_b32 v33, 0xffff0000, v90
v_add_f32 v196, v196, v32
v_add_f32 v197, v197, v33
v_lshlrev_b32 v32, 16, v91
v_and_b32 v33, 0xffff0000, v91
v_add_f32 v198, v198, v32
v_add_f32 v199, v199, v33
v_lshlrev_b32 v32, 16, v92
v_and_b32 v33, 0xffff0000, v92
v_add_f32 v200, v200, v32
v_add_f32 v201, v201, v33
v_lshlrev_b32 v32, 16, v93
v_and_b32 v33, 0xffff0000, v93
v_add_f32 v202, v202, v32
v_add_f32 v203, v203, v33
v_lshlrev_b32 v32, 16, v94
v_and_b32 v33, 0xffff0000, v94
v_add_f32 v204, v204, v32
v_add_f32 v205, v205, v33
v_lshlrev_b32 v32, 16, v95
v_and_b32 v33, 0xffff0000, v95
v_add_f32 v206, v206, v32
v_add_f32 v207, v207, v33
v_cvt_pk_bf16_f32 v128, v192, v193
v_cvt_pk_bf16_f32 v129, v194, v195
v_cvt_pk_bf16_f32 v130, v196, v197
v_cvt_pk_bf16_f32 v131, v198, v199
v_cvt_pk_bf16_f32 v132, v200, v201
v_cvt_pk_bf16_f32 v133, v202, v203
v_cvt_pk_bf16_f32 v134, v204, v205
v_cvt_pk_bf16_f32 v135, v206, v207
s_lshl_b32 s45, s21, 17
s_lshl_b32 s46, s20, 15
s_add_u32 s45, s45, s46
s_lshl_b32 s46, s22, 8
s_add_u32 s45, s45, s46
s_lshl_b32 s46, s23, 6
s_add_u32 s45, s45, s46
v_permlane32_swap_b32 v128, v130
v_permlane32_swap_b32 v129, v131
s_nop 1
buffer_store_dwordx4 v[128:131], v42, s[32:35], s45 offen offset:0
v_permlane32_swap_b32 v132, v134
v_permlane32_swap_b32 v133, v135
s_nop 1
buffer_store_dwordx4 v[132:135], v42, s[32:35], s45 offen offset:32
s_waitcnt vmcnt(0)
attn_end:
s_endpgm
attn_slow1:
s_nop 15
s_nop 7
v_max3_f32 v226, v96, v97, v98
v_max3_f32 v226, v226, v99, v100
v_max3_f32 v226, v226, v101, v102
v_max3_f32 v226, v226, v103, v104
v_max3_f32 v226, v226, v105, v106
v_max3_f32 v226, v226, v107, v108
v_max3_f32 v226, v226, v109, v110
v_max_f32 v226, v226, v111
v_mov_b32 v211, v226
s_nop 1
v_permlane32_swap_b32 v211, v226
s_nop 1
v_max_f32 v226, v226, v211
v_max3_f32 v227, v112, v113, v114
v_max3_f32 v227, v227, v115, v116
v_max3_f32 v227, v227, v117, v118
v_max3_f32 v227, v227, v119, v120
v_max3_f32 v227, v227, v121, v122
v_max3_f32 v227, v227, v123, v124
v_max3_f32 v227, v227, v125, v126
v_max_f32 v227, v227, v127
v_mov_b32 v211, v227
s_nop 1
v_permlane32_swap_b32 v211, v227
s_nop 1
v_max_f32 v227, v227, v211
v_max_f32 v226, 0, v226
v_max_f32 v227, 0, v227
s_call_b64 s[30:31], attn_rescale
v_sub_f32 v96, v96, v226
v_sub_f32 v97, v97, v226
v_sub_f32 v98, v98, v226
v_sub_f32 v99, v99, v226
v_sub_f32 v100, v100, v226
v_sub_f32 v101, v101, v226
v_sub_f32 v102, v102, v226
v_sub_f32 v103, v103, v226
v_sub_f32 v104, v104, v226
v_sub_f32 v105, v105, v226
v_sub_f32 v106, v106, v226
v_sub_f32 v107, v107, v226
v_sub_f32 v108, v108, v226
v_sub_f32 v109, v109, v226
v_sub_f32 v110, v110, v226
v_sub_f32 v111, v111, v226
v_sub_f32 v112, v112, v227
v_sub_f32 v113, v113, v227
v_sub_f32 v114, v114, v227
v_sub_f32 v115, v115, v227
v_sub_f32 v116, v116, v227
v_sub_f32 v117, v117, v227
v_sub_f32 v118, v118, v227
v_sub_f32 v119, v119, v227
v_sub_f32 v120, v120, v227
v_sub_f32 v121, v121, v227
v_sub_f32 v122, v122, v227
v_sub_f32 v123, v123, v227
v_sub_f32 v124, v124, v227
v_sub_f32 v125, v125, v227
v_sub_f32 v126, v126, v227
v_sub_f32 v127, v127, v227
v_sub_f32 v64, v64, v226
v_sub_f32 v65, v65, v226
v_sub_f32 v66, v66, v226
v_sub_f32 v67, v67, v226
v_sub_f32 v68, v68, v226
v_sub_f32 v69, v69, v226
v_sub_f32 v70, v70, v226
v_sub_f32 v71, v71, v226
v_sub_f32 v72, v72, v226
v_sub_f32 v73, v73, v226
v_sub_f32 v74, v74, v226
v_sub_f32 v75, v75, v226
v_sub_f32 v76, v76, v226
v_sub_f32 v77, v77, v226
v_sub_f32 v78, v78, v226
v_sub_f32 v79, v79, v226
v_sub_f32 v80, v80, v227
v_sub_f32 v81, v81, v227
v_sub_f32 v82, v82, v227
v_sub_f32 v83, v83, v227
v_sub_f32 v84, v84, v227
v_sub_f32 v85, v85, v227
v_sub_f32 v86, v86, v227
v_sub_f32 v87, v87, v227
v_sub_f32 v88, v88, v227
v_sub_f32 v89, v89, v227
v_sub_f32 v90, v90, v227
v_sub_f32 v91, v91, v227
v_sub_f32 v92, v92, v227
v_sub_f32 v93, v93, v227
v_sub_f32 v94, v94, v227
v_sub_f32 v95, v95, v227
v_exp_f32 v192, v96
v_exp_f32 v193, v97
s_nop 0
v_cvt_pk_bf16_f32 v144, v192, v193
v_add_f32 v200, v192, v193
v_exp_f32 v192, v98
v_exp_f32 v193, v99
s_nop 0
v_cvt_pk_bf16_f32 v145, v192, v193
v_add_f32 v200, v200, v192
v_add_f32 v200, v200, v193
v_exp_f32 v192, v100
v_exp_f32 v193, v101
s_nop 0
v_cvt_pk_bf16_f32 v146, v192, v193
v_add_f32 v200, v200, v192
v_add_f32 v200, v200, v193
v_exp_f32 v192, v102
v_exp_f32 v193, v103
s_nop 0
v_cvt_pk_bf16_f32 v147, v192, v193
v_add_f32 v200, v200, v192
v_add_f32 v200, v200, v193
v_exp_f32 v192, v104
v_exp_f32 v193, v105
s_nop 0
v_cvt_pk_bf16_f32 v148, v192, v193
v_add_f32 v200, v200, v192
v_add_f32 v200, v200, v193
v_exp_f32 v192, v106
v_exp_f32 v193, v107
s_nop 0
v_cvt_pk_bf16_f32 v149, v192, v193
v_add_f32 v200, v200, v192
v_add_f32 v200, v200, v193
v_exp_f32 v192, v108
v_exp_f32 v193, v109
s_nop 0
v_cvt_pk_bf16_f32 v150, v192, v193
v_add_f32 v200, v200, v192
v_add_f32 v200, v200, v193
v_exp_f32 v192, v110
v_exp_f32 v193, v111
s_nop 0
v_cvt_pk_bf16_f32 v151, v192, v193
v_add_f32 v200, v200, v192
v_add_f32 v200, v200, v193
v_exp_f32 v192, v112
v_exp_f32 v193, v113
s_nop 0
v_cvt_pk_bf16_f32 v152, v192, v193
v_add_f32 v201, v192, v193
v_exp_f32 v192, v114
v_exp_f32 v193, v115
s_nop 0
v_cvt_pk_bf16_f32 v153, v192, v193
v_add_f32 v201, v201, v192
v_add_f32 v201, v201, v193
v_exp_f32 v192, v116
v_exp_f32 v193, v117
s_nop 0
v_cvt_pk_bf16_f32 v154, v192, v193
v_add_f32 v201, v201, v192
v_add_f32 v201, v201, v193
v_exp_f32 v192, v118
v_exp_f32 v193, v119
s_nop 0
v_cvt_pk_bf16_f32 v155, v192, v193
v_add_f32 v201, v201, v192
v_add_f32 v201, v201, v193
v_exp_f32 v192, v120
v_exp_f32 v193, v121
s_nop 0
v_cvt_pk_bf16_f32 v156, v192, v193
v_add_f32 v201, v201, v192
v_add_f32 v201, v201, v193
v_exp_f32 v192, v122
v_exp_f32 v193, v123
s_nop 0
v_cvt_pk_bf16_f32 v157, v192, v193
v_add_f32 v201, v201, v192
v_add_f32 v201, v201, v193
v_exp_f32 v192, v124
v_exp_f32 v193, v125
s_nop 0
v_cvt_pk_bf16_f32 v158, v192, v193
v_add_f32 v201, v201, v192
v_add_f32 v201, v201, v193
v_exp_f32 v192, v126
v_exp_f32 v193, v127
s_nop 0
v_cvt_pk_bf16_f32 v159, v192, v193
v_add_f32 v201, v201, v192
v_add_f32 v201, v201, v193
s_branch attn_join1
attn_slow2:
s_nop 15
s_nop 7
v_max3_f32 v226, v64, v65, v66
v_max3_f32 v226, v226, v67, v68
v_max3_f32 v226, v226, v69, v70
v_max3_f32 v226, v226, v71, v72
v_max3_f32 v226, v226, v73, v74
v_max3_f32 v226, v226, v75, v76
v_max3_f32 v226, v226, v77, v78
v_max_f32 v226, v226, v79
v_mov_b32 v211, v226
s_nop 1
v_permlane32_swap_b32 v211, v226
s_nop 1
v_max_f32 v226, v226, v211
v_max3_f32 v227, v80, v81, v82
v_max3_f32 v227, v227, v83, v84
v_max3_f32 v227, v227, v85, v86
v_max3_f32 v227, v227, v87, v88
v_max3_f32 v227, v227, v89, v90
v_max3_f32 v227, v227, v91, v92
v_max3_f32 v227, v227, v93, v94
v_max_f32 v227, v227, v95
v_mov_b32 v211, v227
s_nop 1
v_permlane32_swap_b32 v211, v227
s_nop 1
v_max_f32 v227, v227, v211
v_max_f32 v226, 0, v226
v_max_f32 v227, 0, v227
s_call_b64 s[30:31], attn_rescale
v_sub_f32 v64, v64, v226
v_sub_f32 v65, v65, v226
v_sub_f32 v66, v66, v226
v_sub_f32 v67, v67, v226
v_sub_f32 v68, v68, v226
v_sub_f32 v69, v69, v226
v_sub_f32 v70, v70, v226
v_sub_f32 v71, v71, v226
v_sub_f32 v72, v72, v226
v_sub_f32 v73, v73, v226
v_sub_f32 v74, v74, v226
v_sub_f32 v75, v75, v226
v_sub_f32 v76, v76, v226
v_sub_f32 v77, v77, v226
v_sub_f32 v78, v78, v226
v_sub_f32 v79, v79, v226
v_sub_f32 v80, v80, v227
v_sub_f32 v81, v81, v227
v_sub_f32 v82, v82, v227
v_sub_f32 v83, v83, v227
v_sub_f32 v84, v84, v227
v_sub_f32 v85, v85, v227
v_sub_f32 v86, v86, v227
v_sub_f32 v87, v87, v227
v_sub_f32 v88, v88, v227
v_sub_f32 v89, v89, v227
v_sub_f32 v90, v90, v227
v_sub_f32 v91, v91, v227
v_sub_f32 v92, v92, v227
v_sub_f32 v93, v93, v227
v_sub_f32 v94, v94, v227
v_sub_f32 v95, v95, v227
v_sub_f32 v96, v96, v226
v_sub_f32 v97, v97, v226
v_sub_f32 v98, v98, v226
v_sub_f32 v99, v99, v226
v_sub_f32 v100, v100, v226
v_sub_f32 v101, v101, v226
v_sub_f32 v102, v102, v226
v_sub_f32 v103, v103, v226
v_sub_f32 v104, v104, v226
v_sub_f32 v105, v105, v226
v_sub_f32 v106, v106, v226
v_sub_f32 v107, v107, v226
v_sub_f32 v108, v108, v226
v_sub_f32 v109, v109, v226
v_sub_f32 v110, v110, v226
v_sub_f32 v111, v111, v226
v_sub_f32 v112, v112, v227
v_sub_f32 v113, v113, v227
v_sub_f32 v114, v114, v227
v_sub_f32 v115, v115, v227
v_sub_f32 v116, v116, v227
v_sub_f32 v117, v117, v227
v_sub_f32 v118, v118, v227
v_sub_f32 v119, v119, v227
v_sub_f32 v120, v120, v227
v_sub_f32 v121, v121, v227
v_sub_f32 v122, v122, v227
v_sub_f32 v123, v123, v227
v_sub_f32 v124, v124, v227
v_sub_f32 v125, v125, v227
v_sub_f32 v126, v126, v227
v_sub_f32 v127, v127, v227
v_exp_f32 v192, v64
v_exp_f32 v193, v65
s_nop 0
v_cvt_pk_bf16_f32 v128, v192, v193
v_add_f32 v200, v192, v193
v_exp_f32 v192, v66
v_exp_f32 v193, v67
s_nop 0
v_cvt_pk_bf16_f32 v129, v192, v193
v_add_f32 v200, v200, v192
v_add_f32 v200, v200, v193
v_exp_f32 v192, v68
v_exp_f32 v193, v69
s_nop 0
v_cvt_pk_bf16_f32 v130, v192, v193
v_add_f32 v200, v200, v192
v_add_f32 v200, v200, v193
v_exp_f32 v192, v70
v_exp_f32 v193, v71
s_nop 0
v_cvt_pk_bf16_f32 v131, v192, v193
v_add_f32 v200, v200, v192
v_add_f32 v200, v200, v193
v_exp_f32 v192, v72
v_exp_f32 v193, v73
s_nop 0
v_cvt_pk_bf16_f32 v132, v192, v193
v_add_f32 v200, v200, v192
v_add_f32 v200, v200, v193
v_exp_f32 v192, v74
v_exp_f32 v193, v75
s_nop 0
v_cvt_pk_bf16_f32 v133, v192, v193
v_add_f32 v200, v200, v192
v_add_f32 v200, v200, v193
v_exp_f32 v192, v76
v_exp_f32 v193, v77
s_nop 0
v_cvt_pk_bf16_f32 v134, v192, v193
v_add_f32 v200, v200, v192
v_add_f32 v200, v200, v193
v_exp_f32 v192, v78
v_exp_f32 v193, v79
s_nop 0
v_cvt_pk_bf16_f32 v135, v192, v193
v_add_f32 v200, v200, v192
v_add_f32 v200, v200, v193
v_exp_f32 v192, v80
v_exp_f32 v193, v81
s_nop 0
v_cvt_pk_bf16_f32 v136, v192, v193
v_add_f32 v201, v192, v193
v_exp_f32 v192, v82
v_exp_f32 v193, v83
s_nop 0
v_cvt_pk_bf16_f32 v137, v192, v193
v_add_f32 v201, v201, v192
v_add_f32 v201, v201, v193
v_exp_f32 v192, v84
v_exp_f32 v193, v85
s_nop 0
v_cvt_pk_bf16_f32 v138, v192, v193
v_add_f32 v201, v201, v192
v_add_f32 v201, v201, v193
v_exp_f32 v192, v86
v_exp_f32 v193, v87
s_nop 0
v_cvt_pk_bf16_f32 v139, v192, v193
v_add_f32 v201, v201, v192
v_add_f32 v201, v201, v193
v_exp_f32 v192, v88
v_exp_f32 v193, v89
s_nop 0
v_cvt_pk_bf16_f32 v140, v192, v193
v_add_f32 v201, v201, v192
v_add_f32 v201, v201, v193
v_exp_f32 v192, v90
v_exp_f32 v193, v91
s_nop 0
v_cvt_pk_bf16_f32 v141, v192, v193
v_add_f32 v201, v201, v192
v_add_f32 v201, v201, v193
v_exp_f32 v192, v92
v_exp_f32 v193, v93
s_nop 0
v_cvt_pk_bf16_f32 v142, v192, v193
v_add_f32 v201, v201, v192
v_add_f32 v201, v201, v193
v_exp_f32 v192, v94
v_exp_f32 v193, v95
s_nop 0
v_cvt_pk_bf16_f32 v143, v192, v193
v_add_f32 v201, v201, v192
v_add_f32 v201, v201, v193
s_branch attn_join2
attn_slow3:
s_nop 15
s_nop 7
v_max3_f32 v226, v96, v97, v98
v_max3_f32 v226, v226, v99, v100
v_max3_f32 v226, v226, v101, v102
v_max3_f32 v226, v226, v103, v104
v_max3_f32 v226, v226, v105, v106
v_max3_f32 v226, v226, v107, v108
v_max3_f32 v226, v226, v109, v110
v_max_f32 v226, v226, v111
v_mov_b32 v211, v226
s_nop 1
v_permlane32_swap_b32 v211, v226
s_nop 1
v_max_f32 v226, v226, v211
v_max3_f32 v227, v112, v113, v114
v_max3_f32 v227, v227, v115, v116
v_max3_f32 v227, v227, v117, v118
v_max3_f32 v227, v227, v119, v120
v_max3_f32 v227, v227, v121, v122
v_max3_f32 v227, v227, v123, v124
v_max3_f32 v227, v227, v125, v126
v_max_f32 v227, v227, v127
v_mov_b32 v211, v227
s_nop 1
v_permlane32_swap_b32 v211, v227
s_nop 1
v_max_f32 v227, v227, v211
v_max_f32 v226, 0, v226
v_max_f32 v227, 0, v227
s_call_b64 s[30:31], attn_rescale
v_sub_f32 v96, v96, v226
v_sub_f32 v97, v97, v226
v_sub_f32 v98, v98, v226
v_sub_f32 v99, v99, v226
v_sub_f32 v100, v100, v226
v_sub_f32 v101, v101, v226
v_sub_f32 v102, v102, v226
v_sub_f32 v103, v103, v226
v_sub_f32 v104, v104, v226
v_sub_f32 v105, v105, v226
v_sub_f32 v106, v106, v226
v_sub_f32 v107, v107, v226
v_sub_f32 v108, v108, v226
v_sub_f32 v109, v109, v226
v_sub_f32 v110, v110, v226
v_sub_f32 v111, v111, v226
v_sub_f32 v112, v112, v227
v_sub_f32 v113, v113, v227
v_sub_f32 v114, v114, v227
v_sub_f32 v115, v115, v227
v_sub_f32 v116, v116, v227
v_sub_f32 v117, v117, v227
v_sub_f32 v118, v118, v227
v_sub_f32 v119, v119, v227
v_sub_f32 v120, v120, v227
v_sub_f32 v121, v121, v227
v_sub_f32 v122, v122, v227
v_sub_f32 v123, v123, v227
v_sub_f32 v124, v124, v227
v_sub_f32 v125, v125, v227
v_sub_f32 v126, v126, v227
v_sub_f32 v127, v127, v227
v_sub_f32 v64, v64, v226
v_sub_f32 v65, v65, v226
v_sub_f32 v66, v66, v226
v_sub_f32 v67, v67, v226
v_sub_f32 v68, v68, v226
v_sub_f32 v69, v69, v226
v_sub_f32 v70, v70, v226
v_sub_f32 v71, v71, v226
v_sub_f32 v72, v72, v226
v_sub_f32 v73, v73, v226
v_sub_f32 v74, v74, v226
v_sub_f32 v75, v75, v226
v_sub_f32 v76, v76, v226
v_sub_f32 v77, v77, v226
v_sub_f32 v78, v78, v226
v_sub_f32 v79, v79, v226
v_sub_f32 v80, v80, v227
v_sub_f32 v81, v81, v227
v_sub_f32 v82, v82, v227
v_sub_f32 v83, v83, v227
v_sub_f32 v84, v84, v227
v_sub_f32 v85, v85, v227
v_sub_f32 v86, v86, v227
v_sub_f32 v87, v87, v227
v_sub_f32 v88, v88, v227
v_sub_f32 v89, v89, v227
v_sub_f32 v90, v90, v227
v_sub_f32 v91, v91, v227
v_sub_f32 v92, v92, v227
v_sub_f32 v93, v93, v227
v_sub_f32 v94, v94, v227
v_sub_f32 v95, v95, v227
v_exp_f32 v192, v96
v_exp_f32 v193, v97
s_nop 0
v_cvt_pk_bf16_f32 v144, v192, v193
v_add_f32 v200, v192, v193
v_exp_f32 v192, v98
v_exp_f32 v193, v99
s_nop 0
v_cvt_pk_bf16_f32 v145, v192, v193
v_add_f32 v200, v200, v192
v_add_f32 v200, v200, v193
v_exp_f32 v192, v100
v_exp_f32 v193, v101
s_nop 0
v_cvt_pk_bf16_f32 v146, v192, v193
v_add_f32 v200, v200, v192
v_add_f32 v200, v200, v193
v_exp_f32 v192, v102
v_exp_f32 v193, v103
s_nop 0
v_cvt_pk_bf16_f32 v147, v192, v193
v_add_f32 v200, v200, v192
v_add_f32 v200, v200, v193
v_exp_f32 v192, v104
v_exp_f32 v193, v105
s_nop 0
v_cvt_pk_bf16_f32 v148, v192, v193
v_add_f32 v200, v200, v192
v_add_f32 v200, v200, v193
v_exp_f32 v192, v106
v_exp_f32 v193, v107
s_nop 0
v_cvt_pk_bf16_f32 v149, v192, v193
v_add_f32 v200, v200, v192
v_add_f32 v200, v200, v193
v_exp_f32 v192, v108
v_exp_f32 v193, v109
s_nop 0
v_cvt_pk_bf16_f32 v150, v192, v193
v_add_f32 v200, v200, v192
v_add_f32 v200, v200, v193
v_exp_f32 v192, v110
v_exp_f32 v193, v111
s_nop 0
v_cvt_pk_bf16_f32 v151, v192, v193
v_add_f32 v200, v200, v192
v_add_f32 v200, v200, v193
v_exp_f32 v192, v112
v_exp_f32 v193, v113
s_nop 0
v_cvt_pk_bf16_f32 v152, v192, v193
v_add_f32 v201, v192, v193
v_exp_f32 v192, v114
v_exp_f32 v193, v115
s_nop 0
v_cvt_pk_bf16_f32 v153, v192, v193
v_add_f32 v201, v201, v192
v_add_f32 v201, v201, v193
v_exp_f32 v192, v116
v_exp_f32 v193, v117
s_nop 0
v_cvt_pk_bf16_f32 v154, v192, v193
v_add_f32 v201, v201, v192
v_add_f32 v201, v201, v193
v_exp_f32 v192, v118
v_exp_f32 v193, v119
s_nop 0
v_cvt_pk_bf16_f32 v155, v192, v193
v_add_f32 v201, v201, v192
v_add_f32 v201, v201, v193
v_exp_f32 v192, v120
v_exp_f32 v193, v121
s_nop 0
v_cvt_pk_bf16_f32 v156, v192, v193
v_add_f32 v201, v201, v192
v_add_f32 v201, v201, v193
v_exp_f32 v192, v122
v_exp_f32 v193, v123
s_nop 0
v_cvt_pk_bf16_f32 v157, v192, v193
v_add_f32 v201, v201, v192
v_add_f32 v201, v201, v193
v_exp_f32 v192, v124
v_exp_f32 v193, v125
s_nop 0
v_cvt_pk_bf16_f32 v158, v192, v193
v_add_f32 v201, v201, v192
v_add_f32 v201, v201, v193
v_exp_f32 v192, v126
v_exp_f32 v193, v127
s_nop 0
v_cvt_pk_bf16_f32 v159, v192, v193
v_add_f32 v201, v201, v192
v_add_f32 v201, v201, v193
s_branch attn_join3
attn_slow4:
s_nop 15
s_nop 7
v_max3_f32 v226, v64, v65, v66
v_max3_f32 v226, v226, v67, v68
v_max3_f32 v226, v226, v69, v70
v_max3_f32 v226, v226, v71, v72
v_max3_f32 v226, v226, v73, v74
v_max3_f32 v226, v226, v75, v76
v_max3_f32 v226, v226, v77, v78
v_max_f32 v226, v226, v79
v_mov_b32 v211, v226
s_nop 1
v_permlane32_swap_b32 v211, v226
s_nop 1
v_max_f32 v226, v226, v211
v_max3_f32 v227, v80, v81, v82
v_max3_f32 v227, v227, v83, v84
v_max3_f32 v227, v227, v85, v86
v_max3_f32 v227, v227, v87, v88
v_max3_f32 v227, v227, v89, v90
v_max3_f32 v227, v227, v91, v92
v_max3_f32 v227, v227, v93, v94
v_max_f32 v227, v227, v95
v_mov_b32 v211, v227
s_nop 1
v_permlane32_swap_b32 v211, v227
s_nop 1
v_max_f32 v227, v227, v211
v_max_f32 v226, 0, v226
v_max_f32 v227, 0, v227
s_call_b64 s[30:31], attn_rescale
v_sub_f32 v64, v64, v226
v_sub_f32 v65, v65, v226
v_sub_f32 v66, v66, v226
v_sub_f32 v67, v67, v226
v_sub_f32 v68, v68, v226
v_sub_f32 v69, v69, v226
v_sub_f32 v70, v70, v226
v_sub_f32 v71, v71, v226
v_sub_f32 v72, v72, v226
v_sub_f32 v73, v73, v226
v_sub_f32 v74, v74, v226
v_sub_f32 v75, v75, v226
v_sub_f32 v76, v76, v226
v_sub_f32 v77, v77, v226
v_sub_f32 v78, v78, v226
v_sub_f32 v79, v79, v226
v_sub_f32 v80, v80, v227
v_sub_f32 v81, v81, v227
v_sub_f32 v82, v82, v227
v_sub_f32 v83, v83, v227
v_sub_f32 v84, v84, v227
v_sub_f32 v85, v85, v227
v_sub_f32 v86, v86, v227
v_sub_f32 v87, v87, v227
v_sub_f32 v88, v88, v227
v_sub_f32 v89, v89, v227
v_sub_f32 v90, v90, v227
v_sub_f32 v91, v91, v227
v_sub_f32 v92, v92, v227
v_sub_f32 v93, v93, v227
v_sub_f32 v94, v94, v227
v_sub_f32 v95, v95, v227
v_sub_f32 v96, v96, v226
v_sub_f32 v97, v97, v226
v_sub_f32 v98, v98, v226
v_sub_f32 v99, v99, v226
v_sub_f32 v100, v100, v226
v_sub_f32 v101, v101, v226
v_sub_f32 v102, v102, v226
v_sub_f32 v103, v103, v226
v_sub_f32 v104, v104, v226
v_sub_f32 v105, v105, v226
v_sub_f32 v106, v106, v226
v_sub_f32 v107, v107, v226
v_sub_f32 v108, v108, v226
v_sub_f32 v109, v109, v226
v_sub_f32 v110, v110, v226
v_sub_f32 v111, v111, v226
v_sub_f32 v112, v112, v227
v_sub_f32 v113, v113, v227
v_sub_f32 v114, v114, v227
v_sub_f32 v115, v115, v227
v_sub_f32 v116, v116, v227
v_sub_f32 v117, v117, v227
v_sub_f32 v118, v118, v227
v_sub_f32 v119, v119, v227
v_sub_f32 v120, v120, v227
v_sub_f32 v121, v121, v227
v_sub_f32 v122, v122, v227
v_sub_f32 v123, v123, v227
v_sub_f32 v124, v124, v227
v_sub_f32 v125, v125, v227
v_sub_f32 v126, v126, v227
v_sub_f32 v127, v127, v227
v_exp_f32 v192, v64
v_exp_f32 v193, v65
s_nop 0
v_cvt_pk_bf16_f32 v128, v192, v193
v_add_f32 v200, v192, v193
v_exp_f32 v192, v66
v_exp_f32 v193, v67
s_nop 0
v_cvt_pk_bf16_f32 v129, v192, v193
v_add_f32 v200, v200, v192
v_add_f32 v200, v200, v193
v_exp_f32 v192, v68
v_exp_f32 v193, v69
s_nop 0
v_cvt_pk_bf16_f32 v130, v192, v193
v_add_f32 v200, v200, v192
v_add_f32 v200, v200, v193
v_exp_f32 v192, v70
v_exp_f32 v193, v71
s_nop 0
v_cvt_pk_bf16_f32 v131, v192, v193
v_add_f32 v200, v200, v192
v_add_f32 v200, v200, v193
v_exp_f32 v192, v72
v_exp_f32 v193, v73
s_nop 0
v_cvt_pk_bf16_f32 v132, v192, v193
v_add_f32 v200, v200, v192
v_add_f32 v200, v200, v193
v_exp_f32 v192, v74
v_exp_f32 v193, v75
s_nop 0
v_cvt_pk_bf16_f32 v133, v192, v193
v_add_f32 v200, v200, v192
v_add_f32 v200, v200, v193
v_exp_f32 v192, v76
v_exp_f32 v193, v77
s_nop 0
v_cvt_pk_bf16_f32 v134, v192, v193
v_add_f32 v200, v200, v192
v_add_f32 v200, v200, v193
v_exp_f32 v192, v78
v_exp_f32 v193, v79
s_nop 0
v_cvt_pk_bf16_f32 v135, v192, v193
v_add_f32 v200, v200, v192
v_add_f32 v200, v200, v193
v_exp_f32 v192, v80
v_exp_f32 v193, v81
s_nop 0
v_cvt_pk_bf16_f32 v136, v192, v193
v_add_f32 v201, v192, v193
v_exp_f32 v192, v82
v_exp_f32 v193, v83
s_nop 0
v_cvt_pk_bf16_f32 v137, v192, v193
v_add_f32 v201, v201, v192
v_add_f32 v201, v201, v193
v_exp_f32 v192, v84
v_exp_f32 v193, v85
s_nop 0
v_cvt_pk_bf16_f32 v138, v192, v193
v_add_f32 v201, v201, v192
v_add_f32 v201, v201, v193
v_exp_f32 v192, v86
v_exp_f32 v193, v87
s_nop 0
v_cvt_pk_bf16_f32 v139, v192, v193
v_add_f32 v201, v201, v192
v_add_f32 v201, v201, v193
v_exp_f32 v192, v88
v_exp_f32 v193, v89
s_nop 0
v_cvt_pk_bf16_f32 v140, v192, v193
v_add_f32 v201, v201, v192
v_add_f32 v201, v201, v193
v_exp_f32 v192, v90
v_exp_f32 v193, v91
s_nop 0
v_cvt_pk_bf16_f32 v141, v192, v193
v_add_f32 v201, v201, v192
v_add_f32 v201, v201, v193
v_exp_f32 v192, v92
v_exp_f32 v193, v93
s_nop 0
v_cvt_pk_bf16_f32 v142, v192, v193
v_add_f32 v201, v201, v192
v_add_f32 v201, v201, v193
v_exp_f32 v192, v94
v_exp_f32 v193, v95
s_nop 0
v_cvt_pk_bf16_f32 v143, v192, v193
v_add_f32 v201, v201, v192
v_add_f32 v201, v201, v193
s_branch attn_join4
attn_slow5:
s_nop 15
s_nop 7
v_max3_f32 v226, v96, v97, v98
v_max3_f32 v226, v226, v99, v100
v_max3_f32 v226, v226, v101, v102
v_max3_f32 v226, v226, v103, v104
v_max3_f32 v226, v226, v105, v106
v_max3_f32 v226, v226, v107, v108
v_max3_f32 v226, v226, v109, v110
v_max_f32 v226, v226, v111
v_mov_b32 v211, v226
s_nop 1
v_permlane32_swap_b32 v211, v226
s_nop 1
v_max_f32 v226, v226, v211
v_max3_f32 v227, v112, v113, v114
v_max3_f32 v227, v227, v115, v116
v_max3_f32 v227, v227, v117, v118
v_max3_f32 v227, v227, v119, v120
v_max3_f32 v227, v227, v121, v122
v_max3_f32 v227, v227, v123, v124
v_max3_f32 v227, v227, v125, v126
v_max_f32 v227, v227, v127
v_mov_b32 v211, v227
s_nop 1
v_permlane32_swap_b32 v211, v227
s_nop 1
v_max_f32 v227, v227, v211
v_max_f32 v226, 0, v226
v_max_f32 v227, 0, v227
s_call_b64 s[30:31], attn_rescale
v_sub_f32 v96, v96, v226
v_sub_f32 v97, v97, v226
v_sub_f32 v98, v98, v226
v_sub_f32 v99, v99, v226
v_sub_f32 v100, v100, v226
v_sub_f32 v101, v101, v226
v_sub_f32 v102, v102, v226
v_sub_f32 v103, v103, v226
v_sub_f32 v104, v104, v226
v_sub_f32 v105, v105, v226
v_sub_f32 v106, v106, v226
v_sub_f32 v107, v107, v226
v_sub_f32 v108, v108, v226
v_sub_f32 v109, v109, v226
v_sub_f32 v110, v110, v226
v_sub_f32 v111, v111, v226
v_sub_f32 v112, v112, v227
v_sub_f32 v113, v113, v227
v_sub_f32 v114, v114, v227
v_sub_f32 v115, v115, v227
v_sub_f32 v116, v116, v227
v_sub_f32 v117, v117, v227
v_sub_f32 v118, v118, v227
v_sub_f32 v119, v119, v227
v_sub_f32 v120, v120, v227
v_sub_f32 v121, v121, v227
v_sub_f32 v122, v122, v227
v_sub_f32 v123, v123, v227
v_sub_f32 v124, v124, v227
v_sub_f32 v125, v125, v227
v_sub_f32 v126, v126, v227
v_sub_f32 v127, v127, v227
v_sub_f32 v64, v64, v226
v_sub_f32 v65, v65, v226
v_sub_f32 v66, v66, v226
v_sub_f32 v67, v67, v226
v_sub_f32 v68, v68, v226
v_sub_f32 v69, v69, v226
v_sub_f32 v70, v70, v226
v_sub_f32 v71, v71, v226
v_sub_f32 v72, v72, v226
v_sub_f32 v73, v73, v226
v_sub_f32 v74, v74, v226
v_sub_f32 v75, v75, v226
v_sub_f32 v76, v76, v226
v_sub_f32 v77, v77, v226
v_sub_f32 v78, v78, v226
v_sub_f32 v79, v79, v226
v_sub_f32 v80, v80, v227
v_sub_f32 v81, v81, v227
v_sub_f32 v82, v82, v227
v_sub_f32 v83, v83, v227
v_sub_f32 v84, v84, v227
v_sub_f32 v85, v85, v227
v_sub_f32 v86, v86, v227
v_sub_f32 v87, v87, v227
v_sub_f32 v88, v88, v227
v_sub_f32 v89, v89, v227
v_sub_f32 v90, v90, v227
v_sub_f32 v91, v91, v227
v_sub_f32 v92, v92, v227
v_sub_f32 v93, v93, v227
v_sub_f32 v94, v94, v227
v_sub_f32 v95, v95, v227
v_exp_f32 v192, v96
v_exp_f32 v193, v97
s_nop 0
v_cvt_pk_bf16_f32 v144, v192, v193
v_add_f32 v200, v192, v193
v_exp_f32 v192, v98
v_exp_f32 v193, v99
s_nop 0
v_cvt_pk_bf16_f32 v145, v192, v193
v_add_f32 v200, v200, v192
v_add_f32 v200, v200, v193
v_exp_f32 v192, v100
v_exp_f32 v193, v101
s_nop 0
v_cvt_pk_bf16_f32 v146, v192, v193
v_add_f32 v200, v200, v192
v_add_f32 v200, v200, v193
v_exp_f32 v192, v102
v_exp_f32 v193, v103
s_nop 0
v_cvt_pk_bf16_f32 v147, v192, v193
v_add_f32 v200, v200, v192
v_add_f32 v200, v200, v193
v_exp_f32 v192, v104
v_exp_f32 v193, v105
s_nop 0
v_cvt_pk_bf16_f32 v148, v192, v193
v_add_f32 v200, v200, v192
v_add_f32 v200, v200, v193
v_exp_f32 v192, v106
v_exp_f32 v193, v107
s_nop 0
v_cvt_pk_bf16_f32 v149, v192, v193
v_add_f32 v200, v200, v192
v_add_f32 v200, v200, v193
v_exp_f32 v192, v108
v_exp_f32 v193, v109
s_nop 0
v_cvt_pk_bf16_f32 v150, v192, v193
v_add_f32 v200, v200, v192
v_add_f32 v200, v200, v193
v_exp_f32 v192, v110
v_exp_f32 v193, v111
s_nop 0
v_cvt_pk_bf16_f32 v151, v192, v193
v_add_f32 v200, v200, v192
v_add_f32 v200, v200, v193
v_exp_f32 v192, v112
v_exp_f32 v193, v113
s_nop 0
v_cvt_pk_bf16_f32 v152, v192, v193
v_add_f32 v201, v192, v193
v_exp_f32 v192, v114
v_exp_f32 v193, v115
s_nop 0
v_cvt_pk_bf16_f32 v153, v192, v193
v_add_f32 v201, v201, v192
v_add_f32 v201, v201, v193
v_exp_f32 v192, v116
v_exp_f32 v193, v117
s_nop 0
v_cvt_pk_bf16_f32 v154, v192, v193
v_add_f32 v201, v201, v192
v_add_f32 v201, v201, v193
v_exp_f32 v192, v118
v_exp_f32 v193, v119
s_nop 0
v_cvt_pk_bf16_f32 v155, v192, v193
v_add_f32 v201, v201, v192
v_add_f32 v201, v201, v193
v_exp_f32 v192, v120
v_exp_f32 v193, v121
s_nop 0
v_cvt_pk_bf16_f32 v156, v192, v193
v_add_f32 v201, v201, v192
v_add_f32 v201, v201, v193
v_exp_f32 v192, v122
v_exp_f32 v193, v123
s_nop 0
v_cvt_pk_bf16_f32 v157, v192, v193
v_add_f32 v201, v201, v192
v_add_f32 v201, v201, v193
v_exp_f32 v192, v124
v_exp_f32 v193, v125
s_nop 0
v_cvt_pk_bf16_f32 v158, v192, v193
v_add_f32 v201, v201, v192
v_add_f32 v201, v201, v193
v_exp_f32 v192, v126
v_exp_f32 v193, v127
s_nop 0
v_cvt_pk_bf16_f32 v159, v192, v193
v_add_f32 v201, v201, v192
v_add_f32 v201, v201, v193
s_branch attn_join5
attn_slow6:
s_nop 15
s_nop 7
v_max3_f32 v226, v64, v65, v66
v_max3_f32 v226, v226, v67, v68
v_max3_f32 v226, v226, v69, v70
v_max3_f32 v226, v226, v71, v72
v_max3_f32 v226, v226, v73, v74
v_max3_f32 v226, v226, v75, v76
v_max3_f32 v226, v226, v77, v78
v_max_f32 v226, v226, v79
v_mov_b32 v211, v226
s_nop 1
v_permlane32_swap_b32 v211, v226
s_nop 1
v_max_f32 v226, v226, v211
v_max3_f32 v227, v80, v81, v82
v_max3_f32 v227, v227, v83, v84
v_max3_f32 v227, v227, v85, v86
v_max3_f32 v227, v227, v87, v88
v_max3_f32 v227, v227, v89, v90
v_max3_f32 v227, v227, v91, v92
v_max3_f32 v227, v227, v93, v94
v_max_f32 v227, v227, v95
v_mov_b32 v211, v227
s_nop 1
v_permlane32_swap_b32 v211, v227
s_nop 1
v_max_f32 v227, v227, v211
v_max_f32 v226, 0, v226
v_max_f32 v227, 0, v227
s_call_b64 s[30:31], attn_rescale
v_sub_f32 v64, v64, v226
v_sub_f32 v65, v65, v226
v_sub_f32 v66, v66, v226
v_sub_f32 v67, v67, v226
v_sub_f32 v68, v68, v226
v_sub_f32 v69, v69, v226
v_sub_f32 v70, v70, v226
v_sub_f32 v71, v71, v226
v_sub_f32 v72, v72, v226
v_sub_f32 v73, v73, v226
v_sub_f32 v74, v74, v226
v_sub_f32 v75, v75, v226
v_sub_f32 v76, v76, v226
v_sub_f32 v77, v77, v226
v_sub_f32 v78, v78, v226
v_sub_f32 v79, v79, v226
v_sub_f32 v80, v80, v227
v_sub_f32 v81, v81, v227
v_sub_f32 v82, v82, v227
v_sub_f32 v83, v83, v227
v_sub_f32 v84, v84, v227
v_sub_f32 v85, v85, v227
v_sub_f32 v86, v86, v227
v_sub_f32 v87, v87, v227
v_sub_f32 v88, v88, v227
v_sub_f32 v89, v89, v227
v_sub_f32 v90, v90, v227
v_sub_f32 v91, v91, v227
v_sub_f32 v92, v92, v227
v_sub_f32 v93, v93, v227
v_sub_f32 v94, v94, v227
v_sub_f32 v95, v95, v227
v_sub_f32 v96, v96, v226
v_sub_f32 v97, v97, v226
v_sub_f32 v98, v98, v226
v_sub_f32 v99, v99, v226
v_sub_f32 v100, v100, v226
v_sub_f32 v101, v101, v226
v_sub_f32 v102, v102, v226
v_sub_f32 v103, v103, v226
v_sub_f32 v104, v104, v226
v_sub_f32 v105, v105, v226
v_sub_f32 v106, v106, v226
v_sub_f32 v107, v107, v226
v_sub_f32 v108, v108, v226
v_sub_f32 v109, v109, v226
v_sub_f32 v110, v110, v226
v_sub_f32 v111, v111, v226
v_sub_f32 v112, v112, v227
v_sub_f32 v113, v113, v227
v_sub_f32 v114, v114, v227
v_sub_f32 v115, v115, v227
v_sub_f32 v116, v116, v227
v_sub_f32 v117, v117, v227
v_sub_f32 v118, v118, v227
v_sub_f32 v119, v119, v227
v_sub_f32 v120, v120, v227
v_sub_f32 v121, v121, v227
v_sub_f32 v122, v122, v227
v_sub_f32 v123, v123, v227
v_sub_f32 v124, v124, v227
v_sub_f32 v125, v125, v227
v_sub_f32 v126, v126, v227
v_sub_f32 v127, v127, v227
v_exp_f32 v192, v64
v_exp_f32 v193, v65
s_nop 0
v_cvt_pk_bf16_f32 v128, v192, v193
v_add_f32 v200, v192, v193
v_exp_f32 v192, v66
v_exp_f32 v193, v67
s_nop 0
v_cvt_pk_bf16_f32 v129, v192, v193
v_add_f32 v200, v200, v192
v_add_f32 v200, v200, v193
v_exp_f32 v192, v68
v_exp_f32 v193, v69
s_nop 0
v_cvt_pk_bf16_f32 v130, v192, v193
v_add_f32 v200, v200, v192
v_add_f32 v200, v200, v193
v_exp_f32 v192, v70
v_exp_f32 v193, v71
s_nop 0
v_cvt_pk_bf16_f32 v131, v192, v193
v_add_f32 v200, v200, v192
v_add_f32 v200, v200, v193
v_exp_f32 v192, v72
v_exp_f32 v193, v73
s_nop 0
v_cvt_pk_bf16_f32 v132, v192, v193
v_add_f32 v200, v200, v192
v_add_f32 v200, v200, v193
v_exp_f32 v192, v74
v_exp_f32 v193, v75
s_nop 0
v_cvt_pk_bf16_f32 v133, v192, v193
v_add_f32 v200, v200, v192
v_add_f32 v200, v200, v193
v_exp_f32 v192, v76
v_exp_f32 v193, v77
s_nop 0
v_cvt_pk_bf16_f32 v134, v192, v193
v_add_f32 v200, v200, v192
v_add_f32 v200, v200, v193
v_exp_f32 v192, v78
v_exp_f32 v193, v79
s_nop 0
v_cvt_pk_bf16_f32 v135, v192, v193
v_add_f32 v200, v200, v192
v_add_f32 v200, v200, v193
v_exp_f32 v192, v80
v_exp_f32 v193, v81
s_nop 0
v_cvt_pk_bf16_f32 v136, v192, v193
v_add_f32 v201, v192, v193
v_exp_f32 v192, v82
v_exp_f32 v193, v83
s_nop 0
v_cvt_pk_bf16_f32 v137, v192, v193
v_add_f32 v201, v201, v192
v_add_f32 v201, v201, v193
v_exp_f32 v192, v84
v_exp_f32 v193, v85
s_nop 0
v_cvt_pk_bf16_f32 v138, v192, v193
v_add_f32 v201, v201, v192
v_add_f32 v201, v201, v193
v_exp_f32 v192, v86
v_exp_f32 v193, v87
s_nop 0
v_cvt_pk_bf16_f32 v139, v192, v193
v_add_f32 v201, v201, v192
v_add_f32 v201, v201, v193
v_exp_f32 v192, v88
v_exp_f32 v193, v89
s_nop 0
v_cvt_pk_bf16_f32 v140, v192, v193
v_add_f32 v201, v201, v192
v_add_f32 v201, v201, v193
v_exp_f32 v192, v90
v_exp_f32 v193, v91
s_nop 0
v_cvt_pk_bf16_f32 v141, v192, v193
v_add_f32 v201, v201, v192
v_add_f32 v201, v201, v193
v_exp_f32 v192, v92
v_exp_f32 v193, v93
s_nop 0
v_cvt_pk_bf16_f32 v142, v192, v193
v_add_f32 v201, v201, v192
v_add_f32 v201, v201, v193
v_exp_f32 v192, v94
v_exp_f32 v193, v95
s_nop 0
v_cvt_pk_bf16_f32 v143, v192, v193
v_add_f32 v201, v201, v192
v_add_f32 v201, v201, v193
s_branch attn_join6
attn_slow7:
s_nop 15
s_nop 7
v_max3_f32 v226, v96, v97, v98
v_max3_f32 v226, v226, v99, v100
v_max3_f32 v226, v226, v101, v102
v_max3_f32 v226, v226, v103, v104
v_max3_f32 v226, v226, v105, v106
v_max3_f32 v226, v226, v107, v108
v_max3_f32 v226, v226, v109, v110
v_max_f32 v226, v226, v111
v_mov_b32 v211, v226
s_nop 1
v_permlane32_swap_b32 v211, v226
s_nop 1
v_max_f32 v226, v226, v211
v_max3_f32 v227, v112, v113, v114
v_max3_f32 v227, v227, v115, v116
v_max3_f32 v227, v227, v117, v118
v_max3_f32 v227, v227, v119, v120
v_max3_f32 v227, v227, v121, v122
v_max3_f32 v227, v227, v123, v124
v_max3_f32 v227, v227, v125, v126
v_max_f32 v227, v227, v127
v_mov_b32 v211, v227
s_nop 1
v_permlane32_swap_b32 v211, v227
s_nop 1
v_max_f32 v227, v227, v211
v_max_f32 v226, 0, v226
v_max_f32 v227, 0, v227
s_call_b64 s[30:31], attn_rescale
v_sub_f32 v96, v96, v226
v_sub_f32 v97, v97, v226
v_sub_f32 v98, v98, v226
v_sub_f32 v99, v99, v226
v_sub_f32 v100, v100, v226
v_sub_f32 v101, v101, v226
v_sub_f32 v102, v102, v226
v_sub_f32 v103, v103, v226
v_sub_f32 v104, v104, v226
v_sub_f32 v105, v105, v226
v_sub_f32 v106, v106, v226
v_sub_f32 v107, v107, v226
v_sub_f32 v108, v108, v226
v_sub_f32 v109, v109, v226
v_sub_f32 v110, v110, v226
v_sub_f32 v111, v111, v226
v_sub_f32 v112, v112, v227
v_sub_f32 v113, v113, v227
v_sub_f32 v114, v114, v227
v_sub_f32 v115, v115, v227
v_sub_f32 v116, v116, v227
v_sub_f32 v117, v117, v227
v_sub_f32 v118, v118, v227
v_sub_f32 v119, v119, v227
v_sub_f32 v120, v120, v227
v_sub_f32 v121, v121, v227
v_sub_f32 v122, v122, v227
v_sub_f32 v123, v123, v227
v_sub_f32 v124, v124, v227
v_sub_f32 v125, v125, v227
v_sub_f32 v126, v126, v227
v_sub_f32 v127, v127, v227
v_sub_f32 v64, v64, v227
v_sub_f32 v65, v65, v227
v_sub_f32 v66, v66, v227
v_sub_f32 v67, v67, v227
v_sub_f32 v68, v68, v227
v_sub_f32 v69, v69, v227
v_sub_f32 v70, v70, v227
v_sub_f32 v71, v71, v227
v_sub_f32 v72, v72, v227
v_sub_f32 v73, v73, v227
v_sub_f32 v74, v74, v227
v_sub_f32 v75, v75, v227
v_sub_f32 v76, v76, v227
v_sub_f32 v77, v77, v227
v_sub_f32 v78, v78, v227
v_sub_f32 v79, v79, v227
v_sub_f32 v80, v80, v227
v_sub_f32 v81, v81, v227
v_sub_f32 v82, v82, v227
v_sub_f32 v83, v83, v227
v_sub_f32 v84, v84, v227
v_sub_f32 v85, v85, v227
v_sub_f32 v86, v86, v227
v_sub_f32 v87, v87, v227
v_sub_f32 v88, v88, v227
v_sub_f32 v89, v89, v227
v_sub_f32 v90, v90, v227
v_sub_f32 v91, v91, v227
v_sub_f32 v92, v92, v227
v_sub_f32 v93, v93, v227
v_sub_f32 v94, v94, v227
v_sub_f32 v95, v95, v227
v_exp_f32 v192, v96
v_exp_f32 v193, v97
s_nop 0
v_cvt_pk_bf16_f32 v144, v192, v193
v_add_f32 v200, v192, v193
v_exp_f32 v192, v98
v_exp_f32 v193, v99
s_nop 0
v_cvt_pk_bf16_f32 v145, v192, v193
v_add_f32 v200, v200, v192
v_add_f32 v200, v200, v193
v_exp_f32 v192, v100
v_exp_f32 v193, v101
s_nop 0
v_cvt_pk_bf16_f32 v146, v192, v193
v_add_f32 v200, v200, v192
v_add_f32 v200, v200, v193
v_exp_f32 v192, v102
v_exp_f32 v193, v103
s_nop 0
v_cvt_pk_bf16_f32 v147, v192, v193
v_add_f32 v200, v200, v192
v_add_f32 v200, v200, v193
v_exp_f32 v192, v104
v_exp_f32 v193, v105
s_nop 0
v_cvt_pk_bf16_f32 v148, v192, v193
v_add_f32 v200, v200, v192
v_add_f32 v200, v200, v193
v_exp_f32 v192, v106
v_exp_f32 v193, v107
s_nop 0
v_cvt_pk_bf16_f32 v149, v192, v193
v_add_f32 v200, v200, v192
v_add_f32 v200, v200, v193
v_exp_f32 v192, v108
v_exp_f32 v193, v109
s_nop 0
v_cvt_pk_bf16_f32 v150, v192, v193
v_add_f32 v200, v200, v192
v_add_f32 v200, v200, v193
v_exp_f32 v192, v110
v_exp_f32 v193, v111
s_nop 0
v_cvt_pk_bf16_f32 v151, v192, v193
v_add_f32 v200, v200, v192
v_add_f32 v200, v200, v193
v_exp_f32 v192, v112
v_exp_f32 v193, v113
s_nop 0
v_cvt_pk_bf16_f32 v152, v192, v193
v_add_f32 v201, v192, v193
v_exp_f32 v192, v114
v_exp_f32 v193, v115
s_nop 0
v_cvt_pk_bf16_f32 v153, v192, v193
v_add_f32 v201, v201, v192
v_add_f32 v201, v201, v193
v_exp_f32 v192, v116
v_exp_f32 v193, v117
s_nop 0
v_cvt_pk_bf16_f32 v154, v192, v193
v_add_f32 v201, v201, v192
v_add_f32 v201, v201, v193
v_exp_f32 v192, v118
v_exp_f32 v193, v119
s_nop 0
v_cvt_pk_bf16_f32 v155, v192, v193
v_add_f32 v201, v201, v192
v_add_f32 v201, v201, v193
v_exp_f32 v192, v120
v_exp_f32 v193, v121
s_nop 0
v_cvt_pk_bf16_f32 v156, v192, v193
v_add_f32 v201, v201, v192
v_add_f32 v201, v201, v193
v_exp_f32 v192, v122
v_exp_f32 v193, v123
s_nop 0
v_cvt_pk_bf16_f32 v157, v192, v193
v_add_f32 v201, v201, v192
v_add_f32 v201, v201, v193
v_exp_f32 v192, v124
v_exp_f32 v193, v125
s_nop 0
v_cvt_pk_bf16_f32 v158, v192, v193
v_add_f32 v201, v201, v192
v_add_f32 v201, v201, v193
v_exp_f32 v192, v126
v_exp_f32 v193, v127
s_nop 0
v_cvt_pk_bf16_f32 v159, v192, v193
v_add_f32 v201, v201, v192
v_add_f32 v201, v201, v193
s_branch attn_join7
attn_slow8:
s_nop 15
s_nop 7
v_max3_f32 v227, v64, v65, v66
v_max3_f32 v227, v227, v67, v68
v_max3_f32 v227, v227, v69, v70
v_max3_f32 v227, v227, v71, v72
v_max3_f32 v227, v227, v73, v74
v_max3_f32 v227, v227, v75, v76
v_max3_f32 v227, v227, v77, v78
v_max3_f32 v227, v227, v79, v80
v_max3_f32 v227, v227, v81, v82
v_max3_f32 v227, v227, v83, v84
v_max3_f32 v227, v227, v85, v86
v_max3_f32 v227, v227, v87, v88
v_max3_f32 v227, v227, v89, v90
v_max3_f32 v227, v227, v91, v92
v_max3_f32 v227, v227, v93, v94
v_max_f32 v227, v227, v95
v_mov_b32 v211, v227
s_nop 1
v_permlane32_swap_b32 v211, v227
s_nop 1
v_max_f32 v227, v227, v211
v_mov_b32 v226, 0
v_max_f32 v227, 0, v227
s_call_b64 s[30:31], attn_rescale
v_sub_f32 v64, v64, v227
v_sub_f32 v65, v65, v227
v_sub_f32 v66, v66, v227
v_sub_f32 v67, v67, v227
v_sub_f32 v68, v68, v227
v_sub_f32 v69, v69, v227
v_sub_f32 v70, v70, v227
v_sub_f32 v71, v71, v227
v_sub_f32 v72, v72, v227
v_sub_f32 v73, v73, v227
v_sub_f32 v74, v74, v227
v_sub_f32 v75, v75, v227
v_sub_f32 v76, v76, v227
v_sub_f32 v77, v77, v227
v_sub_f32 v78, v78, v227
v_sub_f32 v79, v79, v227
v_sub_f32 v80, v80, v227
v_sub_f32 v81, v81, v227
v_sub_f32 v82, v82, v227
v_sub_f32 v83, v83, v227
v_sub_f32 v84, v84, v227
v_sub_f32 v85, v85, v227
v_sub_f32 v86, v86, v227
v_sub_f32 v87, v87, v227
v_sub_f32 v88, v88, v227
v_sub_f32 v89, v89, v227
v_sub_f32 v90, v90, v227
v_sub_f32 v91, v91, v227
v_sub_f32 v92, v92, v227
v_sub_f32 v93, v93, v227
v_sub_f32 v94, v94, v227
v_sub_f32 v95, v95, v227
v_sub_f32 v96, v96, v227
v_sub_f32 v97, v97, v227
v_sub_f32 v98, v98, v227
v_sub_f32 v99, v99, v227
v_sub_f32 v100, v100, v227
v_sub_f32 v101, v101, v227
v_sub_f32 v102, v102, v227
v_sub_f32 v103, v103, v227
v_sub_f32 v104, v104, v227
v_sub_f32 v105, v105, v227
v_sub_f32 v106, v106, v227
v_sub_f32 v107, v107, v227
v_sub_f32 v108, v108, v227
v_sub_f32 v109, v109, v227
v_sub_f32 v110, v110, v227
v_sub_f32 v111, v111, v227
v_sub_f32 v112, v112, v227
v_sub_f32 v113, v113, v227
v_sub_f32 v114, v114, v227
v_sub_f32 v115, v115, v227
v_sub_f32 v116, v116, v227
v_sub_f32 v117, v117, v227
v_sub_f32 v118, v118, v227
v_sub_f32 v119, v119, v227
v_sub_f32 v120, v120, v227
v_sub_f32 v121, v121, v227
v_sub_f32 v122, v122, v227
v_sub_f32 v123, v123, v227
v_sub_f32 v124, v124, v227
v_sub_f32 v125, v125, v227
v_sub_f32 v126, v126, v227
v_sub_f32 v127, v127, v227
v_exp_f32 v192, v64
v_exp_f32 v193, v65
s_nop 0
v_cvt_pk_bf16_f32 v128, v192, v193
v_add_f32 v200, v192, v193
v_exp_f32 v192, v66
v_exp_f32 v193, v67
s_nop 0
v_cvt_pk_bf16_f32 v129, v192, v193
v_add_f32 v200, v200, v192
v_add_f32 v200, v200, v193
v_exp_f32 v192, v68
v_exp_f32 v193, v69
s_nop 0
v_cvt_pk_bf16_f32 v130, v192, v193
v_add_f32 v200, v200, v192
v_add_f32 v200, v200, v193
v_exp_f32 v192, v70
v_exp_f32 v193, v71
s_nop 0
v_cvt_pk_bf16_f32 v131, v192, v193
v_add_f32 v200, v200, v192
v_add_f32 v200, v200, v193
v_exp_f32 v192, v72
v_exp_f32 v193, v73
s_nop 0
v_cvt_pk_bf16_f32 v132, v192, v193
v_add_f32 v200, v200, v192
v_add_f32 v200, v200, v193
v_exp_f32 v192, v74
v_exp_f32 v193, v75
s_nop 0
v_cvt_pk_bf16_f32 v133, v192, v193
v_add_f32 v200, v200, v192
v_add_f32 v200, v200, v193
v_exp_f32 v192, v76
v_exp_f32 v193, v77
s_nop 0
v_cvt_pk_bf16_f32 v134, v192, v193
v_add_f32 v200, v200, v192
v_add_f32 v200, v200, v193
v_exp_f32 v192, v78
v_exp_f32 v193, v79
s_nop 0
v_cvt_pk_bf16_f32 v135, v192, v193
v_add_f32 v200, v200, v192
v_add_f32 v200, v200, v193
v_exp_f32 v192, v80
v_exp_f32 v193, v81
s_nop 0
v_cvt_pk_bf16_f32 v136, v192, v193
v_add_f32 v201, v192, v193
v_exp_f32 v192, v82
v_exp_f32 v193, v83
s_nop 0
v_cvt_pk_bf16_f32 v137, v192, v193
v_add_f32 v201, v201, v192
v_add_f32 v201, v201, v193
v_exp_f32 v192, v84
v_exp_f32 v193, v85
s_nop 0
v_cvt_pk_bf16_f32 v138, v192, v193
v_add_f32 v201, v201, v192
v_add_f32 v201, v201, v193
v_exp_f32 v192, v86
v_exp_f32 v193, v87
s_nop 0
v_cvt_pk_bf16_f32 v139, v192, v193
v_add_f32 v201, v201, v192
v_add_f32 v201, v201, v193
v_exp_f32 v192, v88
v_exp_f32 v193, v89
s_nop 0
v_cvt_pk_bf16_f32 v140, v192, v193
v_add_f32 v201, v201, v192
v_add_f32 v201, v201, v193
v_exp_f32 v192, v90
v_exp_f32 v193, v91
s_nop 0
v_cvt_pk_bf16_f32 v141, v192, v193
v_add_f32 v201, v201, v192
v_add_f32 v201, v201, v193
v_exp_f32 v192, v92
v_exp_f32 v193, v93
s_nop 0
v_cvt_pk_bf16_f32 v142, v192, v193
v_add_f32 v201, v201, v192
v_add_f32 v201, v201, v193
v_exp_f32 v192, v94
v_exp_f32 v193, v95
s_nop 0
v_cvt_pk_bf16_f32 v143, v192, v193
v_add_f32 v201, v201, v192
v_add_f32 v201, v201, v193
s_branch attn_join8
attn_slow9:
s_nop 15
s_nop 7
v_max3_f32 v227, v96, v97, v98
v_max3_f32 v227, v227, v99, v100
v_max3_f32 v227, v227, v101, v102
v_max3_f32 v227, v227, v103, v104
v_max3_f32 v227, v227, v105, v106
v_max3_f32 v227, v227, v107, v108
v_max3_f32 v227, v227, v109, v110
v_max3_f32 v227, v227, v111, v112
v_max3_f32 v227, v227, v113, v114
v_max3_f32 v227, v227, v115, v116
v_max3_f32 v227, v227, v117, v118
v_max3_f32 v227, v227, v119, v120
v_max3_f32 v227, v227, v121, v122
v_max3_f32 v227, v227, v123, v124
v_max3_f32 v227, v227, v125, v126
v_max_f32 v227, v227, v127
v_mov_b32 v211, v227
s_nop 1
v_permlane32_swap_b32 v211, v227
s_nop 1
v_max_f32 v227, v227, v211
v_mov_b32 v226, 0
v_max_f32 v227, 0, v227
s_call_b64 s[30:31], attn_rescale
v_sub_f32 v96, v96, v227
v_sub_f32 v97, v97, v227
v_sub_f32 v98, v98, v227
v_sub_f32 v99, v99, v227
v_sub_f32 v100, v100, v227
v_sub_f32 v101, v101, v227
v_sub_f32 v102, v102, v227
v_sub_f32 v103, v103, v227
v_sub_f32 v104, v104, v227
v_sub_f32 v105, v105, v227
v_sub_f32 v106, v106, v227
v_sub_f32 v107, v107, v227
v_sub_f32 v108, v108, v227
v_sub_f32 v109, v109, v227
v_sub_f32 v110, v110, v227
v_sub_f32 v111, v111, v227
v_sub_f32 v112, v112, v227
v_sub_f32 v113, v113, v227
v_sub_f32 v114, v114, v227
v_sub_f32 v115, v115, v227
v_sub_f32 v116, v116, v227
v_sub_f32 v117, v117, v227
v_sub_f32 v118, v118, v227
v_sub_f32 v119, v119, v227
v_sub_f32 v120, v120, v227
v_sub_f32 v121, v121, v227
v_sub_f32 v122, v122, v227
v_sub_f32 v123, v123, v227
v_sub_f32 v124, v124, v227
v_sub_f32 v125, v125, v227
v_sub_f32 v126, v126, v227
v_sub_f32 v127, v127, v227
v_sub_f32 v64, v64, v227
v_sub_f32 v65, v65, v227
v_sub_f32 v66, v66, v227
v_sub_f32 v67, v67, v227
v_sub_f32 v68, v68, v227
v_sub_f32 v69, v69, v227
v_sub_f32 v70, v70, v227
v_sub_f32 v71, v71, v227
v_sub_f32 v72, v72, v227
v_sub_f32 v73, v73, v227
v_sub_f32 v74, v74, v227
v_sub_f32 v75, v75, v227
v_sub_f32 v76, v76, v227
v_sub_f32 v77, v77, v227
v_sub_f32 v78, v78, v227
v_sub_f32 v79, v79, v227
v_sub_f32 v80, v80, v227
v_sub_f32 v81, v81, v227
v_sub_f32 v82, v82, v227
v_sub_f32 v83, v83, v227
v_sub_f32 v84, v84, v227
v_sub_f32 v85, v85, v227
v_sub_f32 v86, v86, v227
v_sub_f32 v87, v87, v227
v_sub_f32 v88, v88, v227
v_sub_f32 v89, v89, v227
v_sub_f32 v90, v90, v227
v_sub_f32 v91, v91, v227
v_sub_f32 v92, v92, v227
v_sub_f32 v93, v93, v227
v_sub_f32 v94, v94, v227
v_sub_f32 v95, v95, v227
v_exp_f32 v192, v96
v_exp_f32 v193, v97
s_nop 0
v_cvt_pk_bf16_f32 v144, v192, v193
v_add_f32 v200, v192, v193
v_exp_f32 v192, v98
v_exp_f32 v193, v99
s_nop 0
v_cvt_pk_bf16_f32 v145, v192, v193
v_add_f32 v200, v200, v192
v_add_f32 v200, v200, v193
v_exp_f32 v192, v100
v_exp_f32 v193, v101
s_nop 0
v_cvt_pk_bf16_f32 v146, v192, v193
v_add_f32 v200, v200, v192
v_add_f32 v200, v200, v193
v_exp_f32 v192, v102
v_exp_f32 v193, v103
s_nop 0
v_cvt_pk_bf16_f32 v147, v192, v193
v_add_f32 v200, v200, v192
v_add_f32 v200, v200, v193
v_exp_f32 v192, v104
v_exp_f32 v193, v105
s_nop 0
v_cvt_pk_bf16_f32 v148, v192, v193
v_add_f32 v200, v200, v192
v_add_f32 v200, v200, v193
v_exp_f32 v192, v106
v_exp_f32 v193, v107
s_nop 0
v_cvt_pk_bf16_f32 v149, v192, v193
v_add_f32 v200, v200, v192
v_add_f32 v200, v200, v193
v_exp_f32 v192, v108
v_exp_f32 v193, v109
s_nop 0
v_cvt_pk_bf16_f32 v150, v192, v193
v_add_f32 v200, v200, v192
v_add_f32 v200, v200, v193
v_exp_f32 v192, v110
v_exp_f32 v193, v111
s_nop 0
v_cvt_pk_bf16_f32 v151, v192, v193
v_add_f32 v200, v200, v192
v_add_f32 v200, v200, v193
v_exp_f32 v192, v112
v_exp_f32 v193, v113
s_nop 0
v_cvt_pk_bf16_f32 v152, v192, v193
v_add_f32 v201, v192, v193
v_exp_f32 v192, v114
v_exp_f32 v193, v115
s_nop 0
v_cvt_pk_bf16_f32 v153, v192, v193
v_add_f32 v201, v201, v192
v_add_f32 v201, v201, v193
v_exp_f32 v192, v116
v_exp_f32 v193, v117
s_nop 0
v_cvt_pk_bf16_f32 v154, v192, v193
v_add_f32 v201, v201, v192
v_add_f32 v201, v201, v193
v_exp_f32 v192, v118
v_exp_f32 v193, v119
s_nop 0
v_cvt_pk_bf16_f32 v155, v192, v193
v_add_f32 v201, v201, v192
v_add_f32 v201, v201, v193
v_exp_f32 v192, v120
v_exp_f32 v193, v121
s_nop 0
v_cvt_pk_bf16_f32 v156, v192, v193
v_add_f32 v201, v201, v192
v_add_f32 v201, v201, v193
v_exp_f32 v192, v122
v_exp_f32 v193, v123
s_nop 0
v_cvt_pk_bf16_f32 v157, v192, v193
v_add_f32 v201, v201, v192
v_add_f32 v201, v201, v193
v_exp_f32 v192, v124
v_exp_f32 v193, v125
s_nop 0
v_cvt_pk_bf16_f32 v158, v192, v193
v_add_f32 v201, v201, v192
v_add_f32 v201, v201, v193
v_exp_f32 v192, v126
v_exp_f32 v193, v127
s_nop 0
v_cvt_pk_bf16_f32 v159, v192, v193
v_add_f32 v201, v201, v192
v_add_f32 v201, v201, v193
s_branch attn_join9
attn_slow10:
s_nop 15
s_nop 7
v_max3_f32 v227, v64, v65, v66
v_max3_f32 v227, v227, v67, v68
v_max3_f32 v227, v227, v69, v70
v_max3_f32 v227, v227, v71, v72
v_max3_f32 v227, v227, v73, v74
v_max3_f32 v227, v227, v75, v76
v_max3_f32 v227, v227, v77, v78
v_max3_f32 v227, v227, v79, v80
v_max3_f32 v227, v227, v81, v82
v_max3_f32 v227, v227, v83, v84
v_max3_f32 v227, v227, v85, v86
v_max3_f32 v227, v227, v87, v88
v_max3_f32 v227, v227, v89, v90
v_max3_f32 v227, v227, v91, v92
v_max3_f32 v227, v227, v93, v94
v_max_f32 v227, v227, v95
v_mov_b32 v211, v227
s_nop 1
v_permlane32_swap_b32 v211, v227
s_nop 1
v_max_f32 v227, v227, v211
v_mov_b32 v226, 0
v_max_f32 v227, 0, v227
s_call_b64 s[30:31], attn_rescale
v_sub_f32 v64, v64, v227
v_sub_f32 v65, v65, v227
v_sub_f32 v66, v66, v227
v_sub_f32 v67, v67, v227
v_sub_f32 v68, v68, v227
v_sub_f32 v69, v69, v227
v_sub_f32 v70, v70, v227
v_sub_f32 v71, v71, v227
v_sub_f32 v72, v72, v227
v_sub_f32 v73, v73, v227
v_sub_f32 v74, v74, v227
v_sub_f32 v75, v75, v227
v_sub_f32 v76, v76, v227
v_sub_f32 v77, v77, v227
v_sub_f32 v78, v78, v227
v_sub_f32 v79, v79, v227
v_sub_f32 v80, v80, v227
v_sub_f32 v81, v81, v227
v_sub_f32 v82, v82, v227
v_sub_f32 v83, v83, v227
v_sub_f32 v84, v84, v227
v_sub_f32 v85, v85, v227
v_sub_f32 v86, v86, v227
v_sub_f32 v87, v87, v227
v_sub_f32 v88, v88, v227
v_sub_f32 v89, v89, v227
v_sub_f32 v90, v90, v227
v_sub_f32 v91, v91, v227
v_sub_f32 v92, v92, v227
v_sub_f32 v93, v93, v227
v_sub_f32 v94, v94, v227
v_sub_f32 v95, v95, v227
v_sub_f32 v96, v96, v227
v_sub_f32 v97, v97, v227
v_sub_f32 v98, v98, v227
v_sub_f32 v99, v99, v227
v_sub_f32 v100, v100, v227
v_sub_f32 v101, v101, v227
v_sub_f32 v102, v102, v227
v_sub_f32 v103, v103, v227
v_sub_f32 v104, v104, v227
v_sub_f32 v105, v105, v227
v_sub_f32 v106, v106, v227
v_sub_f32 v107, v107, v227
v_sub_f32 v108, v108, v227
v_sub_f32 v109, v109, v227
v_sub_f32 v110, v110, v227
v_sub_f32 v111, v111, v227
v_sub_f32 v112, v112, v227
v_sub_f32 v113, v113, v227
v_sub_f32 v114, v114, v227
v_sub_f32 v115, v115, v227
v_sub_f32 v116, v116, v227
v_sub_f32 v117, v117, v227
v_sub_f32 v118, v118, v227
v_sub_f32 v119, v119, v227
v_sub_f32 v120, v120, v227
v_sub_f32 v121, v121, v227
v_sub_f32 v122, v122, v227
v_sub_f32 v123, v123, v227
v_sub_f32 v124, v124, v227
v_sub_f32 v125, v125, v227
v_sub_f32 v126, v126, v227
v_sub_f32 v127, v127, v227
v_exp_f32 v192, v64
v_exp_f32 v193, v65
s_nop 0
v_cvt_pk_bf16_f32 v128, v192, v193
v_add_f32 v200, v192, v193
v_exp_f32 v192, v66
v_exp_f32 v193, v67
s_nop 0
v_cvt_pk_bf16_f32 v129, v192, v193
v_add_f32 v200, v200, v192
v_add_f32 v200, v200, v193
v_exp_f32 v192, v68
v_exp_f32 v193, v69
s_nop 0
v_cvt_pk_bf16_f32 v130, v192, v193
v_add_f32 v200, v200, v192
v_add_f32 v200, v200, v193
v_exp_f32 v192, v70
v_exp_f32 v193, v71
s_nop 0
v_cvt_pk_bf16_f32 v131, v192, v193
v_add_f32 v200, v200, v192
v_add_f32 v200, v200, v193
v_exp_f32 v192, v72
v_exp_f32 v193, v73
s_nop 0
v_cvt_pk_bf16_f32 v132, v192, v193
v_add_f32 v200, v200, v192
v_add_f32 v200, v200, v193
v_exp_f32 v192, v74
v_exp_f32 v193, v75
s_nop 0
v_cvt_pk_bf16_f32 v133, v192, v193
v_add_f32 v200, v200, v192
v_add_f32 v200, v200, v193
v_exp_f32 v192, v76
v_exp_f32 v193, v77
s_nop 0
v_cvt_pk_bf16_f32 v134, v192, v193
v_add_f32 v200, v200, v192
v_add_f32 v200, v200, v193
v_exp_f32 v192, v78
v_exp_f32 v193, v79
s_nop 0
v_cvt_pk_bf16_f32 v135, v192, v193
v_add_f32 v200, v200, v192
v_add_f32 v200, v200, v193
v_exp_f32 v192, v80
v_exp_f32 v193, v81
s_nop 0
v_cvt_pk_bf16_f32 v136, v192, v193
v_add_f32 v201, v192, v193
v_exp_f32 v192, v82
v_exp_f32 v193, v83
s_nop 0
v_cvt_pk_bf16_f32 v137, v192, v193
v_add_f32 v201, v201, v192
v_add_f32 v201, v201, v193
v_exp_f32 v192, v84
v_exp_f32 v193, v85
s_nop 0
v_cvt_pk_bf16_f32 v138, v192, v193
v_add_f32 v201, v201, v192
v_add_f32 v201, v201, v193
v_exp_f32 v192, v86
v_exp_f32 v193, v87
s_nop 0
v_cvt_pk_bf16_f32 v139, v192, v193
v_add_f32 v201, v201, v192
v_add_f32 v201, v201, v193
v_exp_f32 v192, v88
v_exp_f32 v193, v89
s_nop 0
v_cvt_pk_bf16_f32 v140, v192, v193
v_add_f32 v201, v201, v192
v_add_f32 v201, v201, v193
v_exp_f32 v192, v90
v_exp_f32 v193, v91
s_nop 0
v_cvt_pk_bf16_f32 v141, v192, v193
v_add_f32 v201, v201, v192
v_add_f32 v201, v201, v193
v_exp_f32 v192, v92
v_exp_f32 v193, v93
s_nop 0
v_cvt_pk_bf16_f32 v142, v192, v193
v_add_f32 v201, v201, v192
v_add_f32 v201, v201, v193
v_exp_f32 v192, v94
v_exp_f32 v193, v95
s_nop 0
v_cvt_pk_bf16_f32 v143, v192, v193
v_add_f32 v201, v201, v192
v_add_f32 v201, v201, v193
s_branch attn_join10
attn_slow11:
s_nop 15
s_nop 7
v_max3_f32 v227, v96, v97, v98
v_max3_f32 v227, v227, v99, v100
v_max3_f32 v227, v227, v101, v102
v_max3_f32 v227, v227, v103, v104
v_max3_f32 v227, v227, v105, v106
v_max3_f32 v227, v227, v107, v108
v_max3_f32 v227, v227, v109, v110
v_max3_f32 v227, v227, v111, v112
v_max3_f32 v227, v227, v113, v114
v_max3_f32 v227, v227, v115, v116
v_max3_f32 v227, v227, v117, v118
v_max3_f32 v227, v227, v119, v120
v_max3_f32 v227, v227, v121, v122
v_max3_f32 v227, v227, v123, v124
v_max3_f32 v227, v227, v125, v126
v_max_f32 v227, v227, v127
v_mov_b32 v211, v227
s_nop 1
v_permlane32_swap_b32 v211, v227
s_nop 1
v_max_f32 v227, v227, v211
v_mov_b32 v226, 0
v_max_f32 v227, 0, v227
s_call_b64 s[30:31], attn_rescale
v_sub_f32 v96, v96, v227
v_sub_f32 v97, v97, v227
v_sub_f32 v98, v98, v227
v_sub_f32 v99, v99, v227
v_sub_f32 v100, v100, v227
v_sub_f32 v101, v101, v227
v_sub_f32 v102, v102, v227
v_sub_f32 v103, v103, v227
v_sub_f32 v104, v104, v227
v_sub_f32 v105, v105, v227
v_sub_f32 v106, v106, v227
v_sub_f32 v107, v107, v227
v_sub_f32 v108, v108, v227
v_sub_f32 v109, v109, v227
v_sub_f32 v110, v110, v227
v_sub_f32 v111, v111, v227
v_sub_f32 v112, v112, v227
v_sub_f32 v113, v113, v227
v_sub_f32 v114, v114, v227
v_sub_f32 v115, v115, v227
v_sub_f32 v116, v116, v227
v_sub_f32 v117, v117, v227
v_sub_f32 v118, v118, v227
v_sub_f32 v119, v119, v227
v_sub_f32 v120, v120, v227
v_sub_f32 v121, v121, v227
v_sub_f32 v122, v122, v227
v_sub_f32 v123, v123, v227
v_sub_f32 v124, v124, v227
v_sub_f32 v125, v125, v227
v_sub_f32 v126, v126, v227
v_sub_f32 v127, v127, v227
v_sub_f32 v64, v64, v227
v_sub_f32 v65, v65, v227
v_sub_f32 v66, v66, v227
v_sub_f32 v67, v67, v227
v_sub_f32 v68, v68, v227
v_sub_f32 v69, v69, v227
v_sub_f32 v70, v70, v227
v_sub_f32 v71, v71, v227
v_sub_f32 v72, v72, v227
v_sub_f32 v73, v73, v227
v_sub_f32 v74, v74, v227
v_sub_f32 v75, v75, v227
v_sub_f32 v76, v76, v227
v_sub_f32 v77, v77, v227
v_sub_f32 v78, v78, v227
v_sub_f32 v79, v79, v227
v_sub_f32 v80, v80, v227
v_sub_f32 v81, v81, v227
v_sub_f32 v82, v82, v227
v_sub_f32 v83, v83, v227
v_sub_f32 v84, v84, v227
v_sub_f32 v85, v85, v227
v_sub_f32 v86, v86, v227
v_sub_f32 v87, v87, v227
v_sub_f32 v88, v88, v227
v_sub_f32 v89, v89, v227
v_sub_f32 v90, v90, v227
v_sub_f32 v91, v91, v227
v_sub_f32 v92, v92, v227
v_sub_f32 v93, v93, v227
v_sub_f32 v94, v94, v227
v_sub_f32 v95, v95, v227
v_exp_f32 v192, v96
v_exp_f32 v193, v97
s_nop 0
v_cvt_pk_bf16_f32 v144, v192, v193
v_add_f32 v200, v192, v193
v_exp_f32 v192, v98
v_exp_f32 v193, v99
s_nop 0
v_cvt_pk_bf16_f32 v145, v192, v193
v_add_f32 v200, v200, v192
v_add_f32 v200, v200, v193
v_exp_f32 v192, v100
v_exp_f32 v193, v101
s_nop 0
v_cvt_pk_bf16_f32 v146, v192, v193
v_add_f32 v200, v200, v192
v_add_f32 v200, v200, v193
v_exp_f32 v192, v102
v_exp_f32 v193, v103
s_nop 0
v_cvt_pk_bf16_f32 v147, v192, v193
v_add_f32 v200, v200, v192
v_add_f32 v200, v200, v193
v_exp_f32 v192, v104
v_exp_f32 v193, v105
s_nop 0
v_cvt_pk_bf16_f32 v148, v192, v193
v_add_f32 v200, v200, v192
v_add_f32 v200, v200, v193
v_exp_f32 v192, v106
v_exp_f32 v193, v107
s_nop 0
v_cvt_pk_bf16_f32 v149, v192, v193
v_add_f32 v200, v200, v192
v_add_f32 v200, v200, v193
v_exp_f32 v192, v108
v_exp_f32 v193, v109
s_nop 0
v_cvt_pk_bf16_f32 v150, v192, v193
v_add_f32 v200, v200, v192
v_add_f32 v200, v200, v193
v_exp_f32 v192, v110
v_exp_f32 v193, v111
s_nop 0
v_cvt_pk_bf16_f32 v151, v192, v193
v_add_f32 v200, v200, v192
v_add_f32 v200, v200, v193
v_exp_f32 v192, v112
v_exp_f32 v193, v113
s_nop 0
v_cvt_pk_bf16_f32 v152, v192, v193
v_add_f32 v201, v192, v193
v_exp_f32 v192, v114
v_exp_f32 v193, v115
s_nop 0
v_cvt_pk_bf16_f32 v153, v192, v193
v_add_f32 v201, v201, v192
v_add_f32 v201, v201, v193
v_exp_f32 v192, v116
v_exp_f32 v193, v117
s_nop 0
v_cvt_pk_bf16_f32 v154, v192, v193
v_add_f32 v201, v201, v192
v_add_f32 v201, v201, v193
v_exp_f32 v192, v118
v_exp_f32 v193, v119
s_nop 0
v_cvt_pk_bf16_f32 v155, v192, v193
v_add_f32 v201, v201, v192
v_add_f32 v201, v201, v193
v_exp_f32 v192, v120
v_exp_f32 v193, v121
s_nop 0
v_cvt_pk_bf16_f32 v156, v192, v193
v_add_f32 v201, v201, v192
v_add_f32 v201, v201, v193
v_exp_f32 v192, v122
v_exp_f32 v193, v123
s_nop 0
v_cvt_pk_bf16_f32 v157, v192, v193
v_add_f32 v201, v201, v192
v_add_f32 v201, v201, v193
v_exp_f32 v192, v124
v_exp_f32 v193, v125
s_nop 0
v_cvt_pk_bf16_f32 v158, v192, v193
v_add_f32 v201, v201, v192
v_add_f32 v201, v201, v193
v_exp_f32 v192, v126
v_exp_f32 v193, v127
s_nop 0
v_cvt_pk_bf16_f32 v159, v192, v193
v_add_f32 v201, v201, v192
v_add_f32 v201, v201, v193
s_branch attn_join11
attn_slow12:
s_nop 15
s_nop 7
v_max3_f32 v227, v64, v65, v66
v_max3_f32 v227, v227, v67, v68
v_max3_f32 v227, v227, v69, v70
v_max3_f32 v227, v227, v71, v72
v_max3_f32 v227, v227, v73, v74
v_max3_f32 v227, v227, v75, v76
v_max3_f32 v227, v227, v77, v78
v_max3_f32 v227, v227, v79, v80
v_max3_f32 v227, v227, v81, v82
v_max3_f32 v227, v227, v83, v84
v_max3_f32 v227, v227, v85, v86
v_max3_f32 v227, v227, v87, v88
v_max3_f32 v227, v227, v89, v90
v_max3_f32 v227, v227, v91, v92
v_max3_f32 v227, v227, v93, v94
v_max_f32 v227, v227, v95
v_mov_b32 v211, v227
s_nop 1
v_permlane32_swap_b32 v211, v227
s_nop 1
v_max_f32 v227, v227, v211
v_mov_b32 v226, 0
v_max_f32 v227, 0, v227
s_call_b64 s[30:31], attn_rescale
v_sub_f32 v64, v64, v227
v_sub_f32 v65, v65, v227
v_sub_f32 v66, v66, v227
v_sub_f32 v67, v67, v227
v_sub_f32 v68, v68, v227
v_sub_f32 v69, v69, v227
v_sub_f32 v70, v70, v227
v_sub_f32 v71, v71, v227
v_sub_f32 v72, v72, v227
v_sub_f32 v73, v73, v227
v_sub_f32 v74, v74, v227
v_sub_f32 v75, v75, v227
v_sub_f32 v76, v76, v227
v_sub_f32 v77, v77, v227
v_sub_f32 v78, v78, v227
v_sub_f32 v79, v79, v227
v_sub_f32 v80, v80, v227
v_sub_f32 v81, v81, v227
v_sub_f32 v82, v82, v227
v_sub_f32 v83, v83, v227
v_sub_f32 v84, v84, v227
v_sub_f32 v85, v85, v227
v_sub_f32 v86, v86, v227
v_sub_f32 v87, v87, v227
v_sub_f32 v88, v88, v227
v_sub_f32 v89, v89, v227
v_sub_f32 v90, v90, v227
v_sub_f32 v91, v91, v227
v_sub_f32 v92, v92, v227
v_sub_f32 v93, v93, v227
v_sub_f32 v94, v94, v227
v_sub_f32 v95, v95, v227
v_sub_f32 v96, v96, v227
v_sub_f32 v97, v97, v227
v_sub_f32 v98, v98, v227
v_sub_f32 v99, v99, v227
v_sub_f32 v100, v100, v227
v_sub_f32 v101, v101, v227
v_sub_f32 v102, v102, v227
v_sub_f32 v103, v103, v227
v_sub_f32 v104, v104, v227
v_sub_f32 v105, v105, v227
v_sub_f32 v106, v106, v227
v_sub_f32 v107, v107, v227
v_sub_f32 v108, v108, v227
v_sub_f32 v109, v109, v227
v_sub_f32 v110, v110, v227
v_sub_f32 v111, v111, v227
v_sub_f32 v112, v112, v227
v_sub_f32 v113, v113, v227
v_sub_f32 v114, v114, v227
v_sub_f32 v115, v115, v227
v_sub_f32 v116, v116, v227
v_sub_f32 v117, v117, v227
v_sub_f32 v118, v118, v227
v_sub_f32 v119, v119, v227
v_sub_f32 v120, v120, v227
v_sub_f32 v121, v121, v227
v_sub_f32 v122, v122, v227
v_sub_f32 v123, v123, v227
v_sub_f32 v124, v124, v227
v_sub_f32 v125, v125, v227
v_sub_f32 v126, v126, v227
v_sub_f32 v127, v127, v227
v_exp_f32 v192, v64
v_exp_f32 v193, v65
s_nop 0
v_cvt_pk_bf16_f32 v128, v192, v193
v_add_f32 v200, v192, v193
v_exp_f32 v192, v66
v_exp_f32 v193, v67
s_nop 0
v_cvt_pk_bf16_f32 v129, v192, v193
v_add_f32 v200, v200, v192
v_add_f32 v200, v200, v193
v_exp_f32 v192, v68
v_exp_f32 v193, v69
s_nop 0
v_cvt_pk_bf16_f32 v130, v192, v193
v_add_f32 v200, v200, v192
v_add_f32 v200, v200, v193
v_exp_f32 v192, v70
v_exp_f32 v193, v71
s_nop 0
v_cvt_pk_bf16_f32 v131, v192, v193
v_add_f32 v200, v200, v192
v_add_f32 v200, v200, v193
v_exp_f32 v192, v72
v_exp_f32 v193, v73
s_nop 0
v_cvt_pk_bf16_f32 v132, v192, v193
v_add_f32 v200, v200, v192
v_add_f32 v200, v200, v193
v_exp_f32 v192, v74
v_exp_f32 v193, v75
s_nop 0
v_cvt_pk_bf16_f32 v133, v192, v193
v_add_f32 v200, v200, v192
v_add_f32 v200, v200, v193
v_exp_f32 v192, v76
v_exp_f32 v193, v77
s_nop 0
v_cvt_pk_bf16_f32 v134, v192, v193
v_add_f32 v200, v200, v192
v_add_f32 v200, v200, v193
v_exp_f32 v192, v78
v_exp_f32 v193, v79
s_nop 0
v_cvt_pk_bf16_f32 v135, v192, v193
v_add_f32 v200, v200, v192
v_add_f32 v200, v200, v193
v_exp_f32 v192, v80
v_exp_f32 v193, v81
s_nop 0
v_cvt_pk_bf16_f32 v136, v192, v193
v_add_f32 v201, v192, v193
v_exp_f32 v192, v82
v_exp_f32 v193, v83
s_nop 0
v_cvt_pk_bf16_f32 v137, v192, v193
v_add_f32 v201, v201, v192
v_add_f32 v201, v201, v193
v_exp_f32 v192, v84
v_exp_f32 v193, v85
s_nop 0
v_cvt_pk_bf16_f32 v138, v192, v193
v_add_f32 v201, v201, v192
v_add_f32 v201, v201, v193
v_exp_f32 v192, v86
v_exp_f32 v193, v87
s_nop 0
v_cvt_pk_bf16_f32 v139, v192, v193
v_add_f32 v201, v201, v192
v_add_f32 v201, v201, v193
v_exp_f32 v192, v88
v_exp_f32 v193, v89
s_nop 0
v_cvt_pk_bf16_f32 v140, v192, v193
v_add_f32 v201, v201, v192
v_add_f32 v201, v201, v193
v_exp_f32 v192, v90
v_exp_f32 v193, v91
s_nop 0
v_cvt_pk_bf16_f32 v141, v192, v193
v_add_f32 v201, v201, v192
v_add_f32 v201, v201, v193
v_exp_f32 v192, v92
v_exp_f32 v193, v93
s_nop 0
v_cvt_pk_bf16_f32 v142, v192, v193
v_add_f32 v201, v201, v192
v_add_f32 v201, v201, v193
v_exp_f32 v192, v94
v_exp_f32 v193, v95
s_nop 0
v_cvt_pk_bf16_f32 v143, v192, v193
v_add_f32 v201, v201, v192
v_add_f32 v201, v201, v193
s_branch attn_join12
attn_slow13:
s_nop 15
s_nop 7
v_max3_f32 v227, v96, v97, v98
v_max3_f32 v227, v227, v99, v100
v_max3_f32 v227, v227, v101, v102
v_max3_f32 v227, v227, v103, v104
v_max3_f32 v227, v227, v105, v106
v_max3_f32 v227, v227, v107, v108
v_max3_f32 v227, v227, v109, v110
v_max3_f32 v227, v227, v111, v112
v_max3_f32 v227, v227, v113, v114
v_max3_f32 v227, v227, v115, v116
v_max3_f32 v227, v227, v117, v118
v_max3_f32 v227, v227, v119, v120
v_max3_f32 v227, v227, v121, v122
v_max3_f32 v227, v227, v123, v124
v_max3_f32 v227, v227, v125, v126
v_max_f32 v227, v227, v127
v_mov_b32 v211, v227
s_nop 1
v_permlane32_swap_b32 v211, v227
s_nop 1
v_max_f32 v227, v227, v211
v_mov_b32 v226, 0
v_max_f32 v227, 0, v227
s_call_b64 s[30:31], attn_rescale
v_sub_f32 v96, v96, v227
v_sub_f32 v97, v97, v227
v_sub_f32 v98, v98, v227
v_sub_f32 v99, v99, v227
v_sub_f32 v100, v100, v227
v_sub_f32 v101, v101, v227
v_sub_f32 v102, v102, v227
v_sub_f32 v103, v103, v227
v_sub_f32 v104, v104, v227
v_sub_f32 v105, v105, v227
v_sub_f32 v106, v106, v227
v_sub_f32 v107, v107, v227
v_sub_f32 v108, v108, v227
v_sub_f32 v109, v109, v227
v_sub_f32 v110, v110, v227
v_sub_f32 v111, v111, v227
v_sub_f32 v112, v112, v227
v_sub_f32 v113, v113, v227
v_sub_f32 v114, v114, v227
v_sub_f32 v115, v115, v227
v_sub_f32 v116, v116, v227
v_sub_f32 v117, v117, v227
v_sub_f32 v118, v118, v227
v_sub_f32 v119, v119, v227
v_sub_f32 v120, v120, v227
v_sub_f32 v121, v121, v227
v_sub_f32 v122, v122, v227
v_sub_f32 v123, v123, v227
v_sub_f32 v124, v124, v227
v_sub_f32 v125, v125, v227
v_sub_f32 v126, v126, v227
v_sub_f32 v127, v127, v227
v_exp_f32 v192, v96
v_exp_f32 v193, v97
s_nop 0
v_cvt_pk_bf16_f32 v144, v192, v193
v_add_f32 v200, v192, v193
v_exp_f32 v192, v98
v_exp_f32 v193, v99
s_nop 0
v_cvt_pk_bf16_f32 v145, v192, v193
v_add_f32 v200, v200, v192
v_add_f32 v200, v200, v193
v_exp_f32 v192, v100
v_exp_f32 v193, v101
s_nop 0
v_cvt_pk_bf16_f32 v146, v192, v193
v_add_f32 v200, v200, v192
v_add_f32 v200, v200, v193
v_exp_f32 v192, v102
v_exp_f32 v193, v103
s_nop 0
v_cvt_pk_bf16_f32 v147, v192, v193
v_add_f32 v200, v200, v192
v_add_f32 v200, v200, v193
v_exp_f32 v192, v104
v_exp_f32 v193, v105
s_nop 0
v_cvt_pk_bf16_f32 v148, v192, v193
v_add_f32 v200, v200, v192
v_add_f32 v200, v200, v193
v_exp_f32 v192, v106
v_exp_f32 v193, v107
s_nop 0
v_cvt_pk_bf16_f32 v149, v192, v193
v_add_f32 v200, v200, v192
v_add_f32 v200, v200, v193
v_exp_f32 v192, v108
v_exp_f32 v193, v109
s_nop 0
v_cvt_pk_bf16_f32 v150, v192, v193
v_add_f32 v200, v200, v192
v_add_f32 v200, v200, v193
v_exp_f32 v192, v110
v_exp_f32 v193, v111
s_nop 0
v_cvt_pk_bf16_f32 v151, v192, v193
v_add_f32 v200, v200, v192
v_add_f32 v200, v200, v193
v_exp_f32 v192, v112
v_exp_f32 v193, v113
s_nop 0
v_cvt_pk_bf16_f32 v152, v192, v193
v_add_f32 v201, v192, v193
v_exp_f32 v192, v114
v_exp_f32 v193, v115
s_nop 0
v_cvt_pk_bf16_f32 v153, v192, v193
v_add_f32 v201, v201, v192
v_add_f32 v201, v201, v193
v_exp_f32 v192, v116
v_exp_f32 v193, v117
s_nop 0
v_cvt_pk_bf16_f32 v154, v192, v193
v_add_f32 v201, v201, v192
v_add_f32 v201, v201, v193
v_exp_f32 v192, v118
v_exp_f32 v193, v119
s_nop 0
v_cvt_pk_bf16_f32 v155, v192, v193
v_add_f32 v201, v201, v192
v_add_f32 v201, v201, v193
v_exp_f32 v192, v120
v_exp_f32 v193, v121
s_nop 0
v_cvt_pk_bf16_f32 v156, v192, v193
v_add_f32 v201, v201, v192
v_add_f32 v201, v201, v193
v_exp_f32 v192, v122
v_exp_f32 v193, v123
s_nop 0
v_cvt_pk_bf16_f32 v157, v192, v193
v_add_f32 v201, v201, v192
v_add_f32 v201, v201, v193
v_exp_f32 v192, v124
v_exp_f32 v193, v125
s_nop 0
v_cvt_pk_bf16_f32 v158, v192, v193
v_add_f32 v201, v201, v192
v_add_f32 v201, v201, v193
v_exp_f32 v192, v126
v_exp_f32 v193, v127
s_nop 0
v_cvt_pk_bf16_f32 v159, v192, v193
v_add_f32 v201, v201, v192
v_add_f32 v201, v201, v193
s_branch attn_join13
attn_rescale:
v_exp_f32 v228, -v226
v_exp_f32 v229, -v227
s_nop 0
v_accvgpr_read_b32 v210, a0
v_accvgpr_read_b32 v211, a1
v_accvgpr_read_b32 v212, a2
v_accvgpr_read_b32 v213, a3
v_mul_f32 v210, v210, v228
v_mul_f32 v211, v211, v228
v_mul_f32 v212, v212, v228
v_mul_f32 v213, v213, v228
v_accvgpr_write_b32 a0, v210
v_accvgpr_write_b32 a1, v211
v_accvgpr_write_b32 a2, v212
v_accvgpr_write_b32 a3, v213
v_accvgpr_read_b32 v210, a4
v_accvgpr_read_b32 v211, a5
v_accvgpr_read_b32 v212, a6
v_accvgpr_read_b32 v213, a7
v_mul_f32 v210, v210, v228
v_mul_f32 v211, v211, v228
v_mul_f32 v212, v212, v228
v_mul_f32 v213, v213, v228
v_accvgpr_write_b32 a4, v210
v_accvgpr_write_b32 a5, v211
v_accvgpr_write_b32 a6, v212
v_accvgpr_write_b32 a7, v213
v_accvgpr_read_b32 v210, a8
v_accvgpr_read_b32 v211, a9
v_accvgpr_read_b32 v212, a10
v_accvgpr_read_b32 v213, a11
v_mul_f32 v210, v210, v228
v_mul_f32 v211, v211, v228
v_mul_f32 v212, v212, v228
v_mul_f32 v213, v213, v228
v_accvgpr_write_b32 a8, v210
v_accvgpr_write_b32 a9, v211
v_accvgpr_write_b32 a10, v212
v_accvgpr_write_b32 a11, v213
v_accvgpr_read_b32 v210, a12
v_accvgpr_read_b32 v211, a13
v_accvgpr_read_b32 v212, a14
v_accvgpr_read_b32 v213, a15
v_mul_f32 v210, v210, v228
v_mul_f32 v211, v211, v228
v_mul_f32 v212, v212, v228
v_mul_f32 v213, v213, v228
v_accvgpr_write_b32 a12, v210
v_accvgpr_write_b32 a13, v211
v_accvgpr_write_b32 a14, v212
v_accvgpr_write_b32 a15, v213
v_accvgpr_read_b32 v210, a16
v_accvgpr_read_b32 v211, a17
v_accvgpr_read_b32 v212, a18
v_accvgpr_read_b32 v213, a19
v_mul_f32 v210, v210, v228
v_mul_f32 v211, v211, v228
v_mul_f32 v212, v212, v228
v_mul_f32 v213, v213, v228
v_accvgpr_write_b32 a16, v210
v_accvgpr_write_b32 a17, v211
v_accvgpr_write_b32 a18, v212
v_accvgpr_write_b32 a19, v213
v_accvgpr_read_b32 v210, a20
v_accvgpr_read_b32 v211, a21
v_accvgpr_read_b32 v212, a22
v_accvgpr_read_b32 v213, a23
v_mul_f32 v210, v210, v228
v_mul_f32 v211, v211, v228
v_mul_f32 v212, v212, v228
v_mul_f32 v213, v213, v228
v_accvgpr_write_b32 a20, v210
v_accvgpr_write_b32 a21, v211
v_accvgpr_write_b32 a22, v212
v_accvgpr_write_b32 a23, v213
v_accvgpr_read_b32 v210, a24
v_accvgpr_read_b32 v211, a25
v_accvgpr_read_b32 v212, a26
v_accvgpr_read_b32 v213, a27
v_mul_f32 v210, v210, v228
v_mul_f32 v211, v211, v228
v_mul_f32 v212, v212, v228
v_mul_f32 v213, v213, v228
v_accvgpr_write_b32 a24, v210
v_accvgpr_write_b32 a25, v211
v_accvgpr_write_b32 a26, v212
v_accvgpr_write_b32 a27, v213
v_accvgpr_read_b32 v210, a28
v_accvgpr_read_b32 v211, a29
v_accvgpr_read_b32 v212, a30
v_accvgpr_read_b32 v213, a31
v_mul_f32 v210, v210, v228
v_mul_f32 v211, v211, v228
v_mul_f32 v212, v212, v228
v_mul_f32 v213, v213, v228
v_accvgpr_write_b32 a28, v210
v_accvgpr_write_b32 a29, v211
v_accvgpr_write_b32 a30, v212
v_accvgpr_write_b32 a31, v213
v_accvgpr_read_b32 v210, a32
v_accvgpr_read_b32 v211, a33
v_accvgpr_read_b32 v212, a34
v_accvgpr_read_b32 v213, a35
v_mul_f32 v210, v210, v228
v_mul_f32 v211, v211, v228
v_mul_f32 v212, v212, v228
v_mul_f32 v213, v213, v228
v_accvgpr_write_b32 a32, v210
v_accvgpr_write_b32 a33, v211
v_accvgpr_write_b32 a34, v212
v_accvgpr_write_b32 a35, v213
v_accvgpr_read_b32 v210, a36
v_accvgpr_read_b32 v211, a37
v_accvgpr_read_b32 v212, a38
v_accvgpr_read_b32 v213, a39
v_mul_f32 v210, v210, v228
v_mul_f32 v211, v211, v228
v_mul_f32 v212, v212, v228
v_mul_f32 v213, v213, v228
v_accvgpr_write_b32 a36, v210
v_accvgpr_write_b32 a37, v211
v_accvgpr_write_b32 a38, v212
v_accvgpr_write_b32 a39, v213
v_accvgpr_read_b32 v210, a40
v_accvgpr_read_b32 v211, a41
v_accvgpr_read_b32 v212, a42
v_accvgpr_read_b32 v213, a43
v_mul_f32 v210, v210, v228
v_mul_f32 v211, v211, v228
v_mul_f32 v212, v212, v228
v_mul_f32 v213, v213, v228
v_accvgpr_write_b32 a40, v210
v_accvgpr_write_b32 a41, v211
v_accvgpr_write_b32 a42, v212
v_accvgpr_write_b32 a43, v213
v_accvgpr_read_b32 v210, a44
v_accvgpr_read_b32 v211, a45
v_accvgpr_read_b32 v212, a46
v_accvgpr_read_b32 v213, a47
v_mul_f32 v210, v210, v228
v_mul_f32 v211, v211, v228
v_mul_f32 v212, v212, v228
v_mul_f32 v213, v213, v228
v_accvgpr_write_b32 a44, v210
v_accvgpr_write_b32 a45, v211
v_accvgpr_write_b32 a46, v212
v_accvgpr_write_b32 a47, v213
v_accvgpr_read_b32 v210, a48
v_accvgpr_read_b32 v211, a49
v_accvgpr_read_b32 v212, a50
v_accvgpr_read_b32 v213, a51
v_mul_f32 v210, v210, v228
v_mul_f32 v211, v211, v228
v_mul_f32 v212, v212, v228
v_mul_f32 v213, v213, v228
v_accvgpr_write_b32 a48, v210
v_accvgpr_write_b32 a49, v211
v_accvgpr_write_b32 a50, v212
v_accvgpr_write_b32 a51, v213
v_accvgpr_read_b32 v210, a52
v_accvgpr_read_b32 v211, a53
v_accvgpr_read_b32 v212, a54
v_accvgpr_read_b32 v213, a55
v_mul_f32 v210, v210, v228
v_mul_f32 v211, v211, v228
v_mul_f32 v212, v212, v228
v_mul_f32 v213, v213, v228
v_accvgpr_write_b32 a52, v210
v_accvgpr_write_b32 a53, v211
v_accvgpr_write_b32 a54, v212
v_accvgpr_write_b32 a55, v213
v_accvgpr_read_b32 v210, a56
v_accvgpr_read_b32 v211, a57
v_accvgpr_read_b32 v212, a58
v_accvgpr_read_b32 v213, a59
v_mul_f32 v210, v210, v228
v_mul_f32 v211, v211, v228
v_mul_f32 v212, v212, v228
v_mul_f32 v213, v213, v228
v_accvgpr_write_b32 a56, v210
v_accvgpr_write_b32 a57, v211
v_accvgpr_write_b32 a58, v212
v_accvgpr_write_b32 a59, v213
v_accvgpr_read_b32 v210, a60
v_accvgpr_read_b32 v211, a61
v_accvgpr_read_b32 v212, a62
v_accvgpr_read_b32 v213, a63
v_mul_f32 v210, v210, v228
v_mul_f32 v211, v211, v228
v_mul_f32 v212, v212, v228
v_mul_f32 v213, v213, v228
v_accvgpr_write_b32 a60, v210
v_accvgpr_write_b32 a61, v211
v_accvgpr_write_b32 a62, v212
v_accvgpr_write_b32 a63, v213
v_accvgpr_read_b32 v210, a64
v_accvgpr_read_b32 v211, a65
v_accvgpr_read_b32 v212, a66
v_accvgpr_read_b32 v213, a67
v_mul_f32 v210, v210, v229
v_mul_f32 v211, v211, v229
v_mul_f32 v212, v212, v229
v_mul_f32 v213, v213, v229
v_accvgpr_write_b32 a64, v210
v_accvgpr_write_b32 a65, v211
v_accvgpr_write_b32 a66, v212
v_accvgpr_write_b32 a67, v213
v_accvgpr_read_b32 v210, a68
v_accvgpr_read_b32 v211, a69
v_accvgpr_read_b32 v212, a70
v_accvgpr_read_b32 v213, a71
v_mul_f32 v210, v210, v229
v_mul_f32 v211, v211, v229
v_mul_f32 v212, v212, v229
v_mul_f32 v213, v213, v229
v_accvgpr_write_b32 a68, v210
v_accvgpr_write_b32 a69, v211
v_accvgpr_write_b32 a70, v212
v_accvgpr_write_b32 a71, v213
v_accvgpr_read_b32 v210, a72
v_accvgpr_read_b32 v211, a73
v_accvgpr_read_b32 v212, a74
v_accvgpr_read_b32 v213, a75
v_mul_f32 v210, v210, v229
v_mul_f32 v211, v211, v229
v_mul_f32 v212, v212, v229
v_mul_f32 v213, v213, v229
v_accvgpr_write_b32 a72, v210
v_accvgpr_write_b32 a73, v211
v_accvgpr_write_b32 a74, v212
v_accvgpr_write_b32 a75, v213
v_accvgpr_read_b32 v210, a76
v_accvgpr_read_b32 v211, a77
v_accvgpr_read_b32 v212, a78
v_accvgpr_read_b32 v213, a79
v_mul_f32 v210, v210, v229
v_mul_f32 v211, v211, v229
v_mul_f32 v212, v212, v229
v_mul_f32 v213, v213, v229
v_accvgpr_write_b32 a76, v210
v_accvgpr_write_b32 a77, v211
v_accvgpr_write_b32 a78, v212
v_accvgpr_write_b32 a79, v213
v_accvgpr_read_b32 v210, a80
v_accvgpr_read_b32 v211, a81
v_accvgpr_read_b32 v212, a82
v_accvgpr_read_b32 v213, a83
v_mul_f32 v210, v210, v229
v_mul_f32 v211, v211, v229
v_mul_f32 v212, v212, v229
v_mul_f32 v213, v213, v229
v_accvgpr_write_b32 a80, v210
v_accvgpr_write_b32 a81, v211
v_accvgpr_write_b32 a82, v212
v_accvgpr_write_b32 a83, v213
v_accvgpr_read_b32 v210, a84
v_accvgpr_read_b32 v211, a85
v_accvgpr_read_b32 v212, a86
v_accvgpr_read_b32 v213, a87
v_mul_f32 v210, v210, v229
v_mul_f32 v211, v211, v229
v_mul_f32 v212, v212, v229
v_mul_f32 v213, v213, v229
v_accvgpr_write_b32 a84, v210
v_accvgpr_write_b32 a85, v211
v_accvgpr_write_b32 a86, v212
v_accvgpr_write_b32 a87, v213
v_accvgpr_read_b32 v210, a88
v_accvgpr_read_b32 v211, a89
v_accvgpr_read_b32 v212, a90
v_accvgpr_read_b32 v213, a91
v_mul_f32 v210, v210, v229
v_mul_f32 v211, v211, v229
v_mul_f32 v212, v212, v229
v_mul_f32 v213, v213, v229
v_accvgpr_write_b32 a88, v210
v_accvgpr_write_b32 a89, v211
v_accvgpr_write_b32 a90, v212
v_accvgpr_write_b32 a91, v213
v_accvgpr_read_b32 v210, a92
v_accvgpr_read_b32 v211, a93
v_accvgpr_read_b32 v212, a94
v_accvgpr_read_b32 v213, a95
v_mul_f32 v210, v210, v229
v_mul_f32 v211, v211, v229
v_mul_f32 v212, v212, v229
v_mul_f32 v213, v213, v229
v_accvgpr_write_b32 a92, v210
v_accvgpr_write_b32 a93, v211
v_accvgpr_write_b32 a94, v212
v_accvgpr_write_b32 a95, v213
v_accvgpr_read_b32 v210, a96
v_accvgpr_read_b32 v211, a97
v_accvgpr_read_b32 v212, a98
v_accvgpr_read_b32 v213, a99
v_mul_f32 v210, v210, v229
v_mul_f32 v211, v211, v229
v_mul_f32 v212, v212, v229
v_mul_f32 v213, v213, v229
v_accvgpr_write_b32 a96, v210
v_accvgpr_write_b32 a97, v211
v_accvgpr_write_b32 a98, v212
v_accvgpr_write_b32 a99, v213
v_accvgpr_read_b32 v210, a100
v_accvgpr_read_b32 v211, a101
v_accvgpr_read_b32 v212, a102
v_accvgpr_read_b32 v213, a103
v_mul_f32 v210, v210, v229
v_mul_f32 v211, v211, v229
v_mul_f32 v212, v212, v229
v_mul_f32 v213, v213, v229
v_accvgpr_write_b32 a100, v210
v_accvgpr_write_b32 a101, v211
v_accvgpr_write_b32 a102, v212
v_accvgpr_write_b32 a103, v213
v_accvgpr_read_b32 v210, a104
v_accvgpr_read_b32 v211, a105
v_accvgpr_read_b32 v212, a106
v_accvgpr_read_b32 v213, a107
v_mul_f32 v210, v210, v229
v_mul_f32 v211, v211, v229
v_mul_f32 v212, v212, v229
v_mul_f32 v213, v213, v229
v_accvgpr_write_b32 a104, v210
v_accvgpr_write_b32 a105, v211
v_accvgpr_write_b32 a106, v212
v_accvgpr_write_b32 a107, v213
v_accvgpr_read_b32 v210, a108
v_accvgpr_read_b32 v211, a109
v_accvgpr_read_b32 v212, a110
v_accvgpr_read_b32 v213, a111
v_mul_f32 v210, v210, v229
v_mul_f32 v211, v211, v229
v_mul_f32 v212, v212, v229
v_mul_f32 v213, v213, v229
v_accvgpr_write_b32 a108, v210
v_accvgpr_write_b32 a109, v211
v_accvgpr_write_b32 a110, v212
v_accvgpr_write_b32 a111, v213
v_accvgpr_read_b32 v210, a112
v_accvgpr_read_b32 v211, a113
v_accvgpr_read_b32 v212, a114
v_accvgpr_read_b32 v213, a115
v_mul_f32 v210, v210, v229
v_mul_f32 v211, v211, v229
v_mul_f32 v212, v212, v229
v_mul_f32 v213, v213, v229
v_accvgpr_write_b32 a112, v210
v_accvgpr_write_b32 a113, v211
v_accvgpr_write_b32 a114, v212
v_accvgpr_write_b32 a115, v213
v_accvgpr_read_b32 v210, a116
v_accvgpr_read_b32 v211, a117
v_accvgpr_read_b32 v212, a118
v_accvgpr_read_b32 v213, a119
v_mul_f32 v210, v210, v229
v_mul_f32 v211, v211, v229
v_mul_f32 v212, v212, v229
v_mul_f32 v213, v213, v229
v_accvgpr_write_b32 a116, v210
v_accvgpr_write_b32 a117, v211
v_accvgpr_write_b32 a118, v212
v_accvgpr_write_b32 a119, v213
v_accvgpr_read_b32 v210, a120
v_accvgpr_read_b32 v211, a121
v_accvgpr_read_b32 v212, a122
v_accvgpr_read_b32 v213, a123
v_mul_f32 v210, v210, v229
v_mul_f32 v211, v211, v229
v_mul_f32 v212, v212, v229
v_mul_f32 v213, v213, v229
v_accvgpr_write_b32 a120, v210
v_accvgpr_write_b32 a121, v211
v_accvgpr_write_b32 a122, v212
v_accvgpr_write_b32 a123, v213
v_accvgpr_read_b32 v210, a124
v_accvgpr_read_b32 v211, a125
v_accvgpr_read_b32 v212, a126
v_accvgpr_read_b32 v213, a127
v_mul_f32 v210, v210, v229
v_mul_f32 v211, v211, v229
v_mul_f32 v212, v212, v229
v_mul_f32 v213, v213, v229
v_accvgpr_write_b32 a124, v210
v_accvgpr_write_b32 a125, v211
v_accvgpr_write_b32 a126, v212
v_accvgpr_write_b32 a127, v213
v_mul_f32 v202, v202, v228
v_mul_f32 v203, v203, v229
v_sub_f32 v160, v160, v226
v_sub_f32 v176, v176, v227
v_sub_f32 v161, v161, v226
v_sub_f32 v177, v177, v227
v_sub_f32 v162, v162, v226
v_sub_f32 v178, v178, v227
v_sub_f32 v163, v163, v226
v_sub_f32 v179, v179, v227
v_sub_f32 v164, v164, v226
v_sub_f32 v180, v180, v227
v_sub_f32 v165, v165, v226
v_sub_f32 v181, v181, v227
v_sub_f32 v166, v166, v226
v_sub_f32 v182, v182, v227
v_sub_f32 v167, v167, v226
v_sub_f32 v183, v183, v227
v_sub_f32 v168, v168, v226
v_sub_f32 v184, v184, v227
v_sub_f32 v169, v169, v226
v_sub_f32 v185, v185, v227
v_sub_f32 v170, v170, v226
v_sub_f32 v186, v186, v227
v_sub_f32 v171, v171, v226
v_sub_f32 v187, v187, v227
v_sub_f32 v172, v172, v226
v_sub_f32 v188, v188, v227
v_sub_f32 v173, v173, v226
v_sub_f32 v189, v189, v227
v_sub_f32 v174, v174, v226
v_sub_f32 v190, v190, v227
v_sub_f32 v175, v175, v226
v_sub_f32 v191, v191, v227
s_nop 1
s_setpc_b64 s[30:31]
.section .rodata,"a"
.p2align 6
.amdhsa_kernel gated_mix__compressed_kv_cla__mixer_token_mlp__prompt_kernel
  .amdhsa_next_free_vgpr 512
  .amdhsa_next_free_sgpr 102
  .amdhsa_accum_offset 256
  .amdhsa_group_segment_fixed_size 0
  .amdhsa_kernarg_size 120
  .amdhsa_user_sgpr_count 2
  .amdhsa_user_sgpr_kernarg_segment_ptr 1
  .amdhsa_system_sgpr_workgroup_id_x 1
  .amdhsa_float_denorm_mode_32 3
.end_amdhsa_kernel
.text
```
